```python
import torch

def _softmax(x, axis=-1):
    return torch.softmax(x, dim=axis)
def _gelu(x):
    return torch.nn.functional.gelu(x, approximate="tanh")
def _silu(x):
    return torch.nn.functional.silu(x)
def _sigmoid(x):
    return torch.sigmoid(x)
def _layernorm(x, axis=-1, eps=1e-5):
    m = x.mean(dim=axis, keepdim=True)
    v = x.var(dim=axis, keepdim=True, unbiased=False)
    return (x - m) / torch.sqrt(v + eps)
def _scatter_add(tgt, idx, src, axis=0):
    return tgt.clone().index_add_(axis, idx, src)
def _segment_sum(src, seg, n):
    out = torch.zeros((n,) + src.shape[1:], dtype=src.dtype)
    return out.index_add_(0, seg, src)
def _pad(x, pw):
    flat = tuple(v for pair in reversed(pw) for v in pair)
    return torch.nn.functional.pad(x, flat)

kernel_name = 'standalone__gqa_softmax__near_ridge'

def setup_inputs():

    _w = (lambda a: (lambda t: t.to(torch.bfloat16) if t.is_floating_point() else t)(torch.as_tensor(a)))
    B, Hq, Hkv, Sq, Sk, D = 32, 16, 8, 384, 384, 256
    return {
        "q": _w((lambda *s: torch.randn(*s, dtype=torch.bfloat16) * 0.8)(B, Hq, Sq, D)),
        "k": _w((lambda *s: torch.randn(*s, dtype=torch.bfloat16) * 0.8)(B, Hkv, Sk, D)),
        "v": _w((lambda *s: torch.randn(*s, dtype=torch.bfloat16) * 0.05)(B, Hkv, Sk, D)),
    }

def reference(q, k, v):
    B, Hq, Sq, D = q.shape
    Hkv = k.shape[1]
    rep = Hq // Hkv
    k = (lambda x, n, axis: torch.repeat_interleave(x, n, dim=axis))(k, rep, axis=1)
    v = (lambda x, n, axis: torch.repeat_interleave(x, n, dim=axis))(v, rep, axis=1)
    scale = D ** -0.5
    scores = torch.einsum("bhqd,bhkd->bhqk", q, k) * scale
    p = _softmax(scores, axis=-1)
    return torch.einsum("bhqk,bhkd->bhqd", p, v)
```

```asm
; @launch grid=(256,1,1) block=(256,1,1) lds=163840
.amdgcn_target "amdgcn-amd-amdhsa--gfx950"
.text
.globl standalone__gqa_softmax__near_ridge_kernel
.p2align 8
.type standalone__gqa_softmax__near_ridge_kernel,@function
standalone__gqa_softmax__near_ridge_kernel:
s_cmp_ge_u32 s2, 256
s_cbranch_scc1 L_end
s_load_dwordx4 s[4:7], s[0:1], 0
s_load_dwordx4 s[8:11], s[0:1], 16
v_lshrrev_b32 v200, 6, v0
v_and_b32 v205, 63, v0
v_readfirstlane_b32 s32, v200
s_and_b32 s47, s2, 7
s_lshr_b32 s43, s2, 3
v_lshrrev_b32 v200, 3, v205
v_and_b32 v201, 7, v205
v_xor_b32 v201, v201, v200
v_lshlrev_b32 v201, 4, v201
v_lshl_add_u32 v239, v200, 9, v201
s_and_b32 s101, s43, 7
s_lshl_b32 s101, s101, 12
s_lshl_b32 s44, s32, 7
s_add_u32 s101, s101, s44
s_getpc_b64 s[28:29]
s_add_u32 s28, s28, s101
s_addc_u32 s29, s29, 0
global_load_dword v206, v239, s[28:29]
s_and_b32 s101, s101, 0x3fff
s_mul_i32 s47, s47, 96
s_lshl_b32 s97, s32, 15
s_add_u32 s35, s43, s47
s_lshl_b32 s34, s35, 17
s_add_u32 s34, s34, s97
s_lshl_b32 s38, s32, 10
s_mov_b32 s22, 0x8000
s_mov_b32 s23, 0x20000
s_mov_b32 s48, 0
s_mov_b32 s49, 4096
s_mov_b32 s50, 8192
s_mov_b32 s51, 12288
s_mov_b32 s52, 16384
s_mov_b32 s53, 20480
s_mov_b32 s54, 24576
s_mov_b32 s55, 28672
s_mov_b32 s74, s35
s_mul_hi_u32 s35, s35, 0x55555556
s_mul_i32 s35, s35, 196608
s_mul_hi_u32 s68, s43, 0x55555556
s_mul_i32 s68, s68, 3
s_sub_u32 s68, s43, s68
s_lshl_b32 s56, s68, 13
s_add_u32 s58, s56, 0x2000
s_cmp_eq_u32 s58, 0x6000
s_cselect_b32 s58, 0, s58
s_add_u32 s60, s58, 0x2000
s_cmp_eq_u32 s60, 0x6000
s_cselect_b32 s60, 0, s60
s_add_u32 s57, s56, 0x1000
s_add_u32 s59, s58, 0x1000
s_add_u32 s61, s60, 0x1000
s_add_u32 s39, s38, 24576
s_add_u32 s40, s38, 49152
s_add_u32 s69, s38, 73728
s_add_u32 s75, s38, 98304
s_add_u32 s46, s38, 122880
s_mov_b32 s19, 0x20000
s_mov_b32 s95, 0x20000
s_lshl_b32 s44, s32, 7
s_waitcnt lgkmcnt(0)
s_add_u32 s70, s6, s44
s_addc_u32 s71, s7, 0
s_add_u32 s20, s4, s34
s_addc_u32 s21, s5, 0
s_getreg_b32 s3, hwreg(HW_REG_XCC_ID, 0, 1)
s_xor_b32 s3, s3, 1
s_mul_i32 s3, s3, 5
s_mov_b32 s18, 24576
s_add_u32 s16, s70, s35
s_addc_u32 s17, s71, 0
s_add_u32 m0, s38, s56
s_nop 0
buffer_load_dwordx4 v239, s[16:19], s56 offen lds
s_add_u32 m0, s38, s57
s_nop 0
buffer_load_dwordx4 v239, s[16:19], s57 offen lds
s_cmp_le_u32 s3, 0
s_cbranch_scc1 L_y0
s_waitcnt vmcnt(0)
L_y0:
s_add_u32 m0, s46, 4294942720
s_nop 0
buffer_load_dwordx4 v239, s[20:23], s48 offen offset:0 nt lds
s_add_u32 m0, s46, 4294946816
s_nop 0
buffer_load_dwordx4 v239, s[20:23], s49 offen offset:0 nt lds
s_cmp_le_u32 s3, 1
s_cbranch_scc1 L_y1
s_waitcnt vmcnt(0)
L_y1:
s_add_u32 m0, s46, 4294950784
s_nop 0
buffer_load_dwordx4 v239, s[20:23], s48 offen offset:128 nt lds
s_add_u32 m0, s46, 4294954880
s_nop 0
buffer_load_dwordx4 v239, s[20:23], s49 offen offset:128 nt lds
s_cmp_le_u32 s3, 2
s_cbranch_scc1 L_y2
s_waitcnt vmcnt(0)
L_y2:
s_add_u32 m0, s46, 4294958848
s_nop 0
buffer_load_dwordx4 v239, s[20:23], s48 offen offset:256 nt lds
s_add_u32 m0, s46, 4294962944
s_nop 0
buffer_load_dwordx4 v239, s[20:23], s49 offen offset:256 nt lds
s_cmp_le_u32 s3, 3
s_cbranch_scc1 L_y3
s_waitcnt vmcnt(0)
L_y3:
s_add_u32 m0, s46, 4294966912
s_nop 0
buffer_load_dwordx4 v239, s[20:23], s48 offen offset:384 nt lds
s_add_u32 m0, s46, 3712
s_nop 0
buffer_load_dwordx4 v239, s[20:23], s49 offen offset:384 nt lds
s_cmp_le_u32 s3, 4
s_cbranch_scc1 L_y4
s_waitcnt vmcnt(0)
L_y4:
s_add_u32 m0, s46, 8192
s_nop 0
buffer_load_dwordx4 v239, s[20:23], s50 offen offset:0 nt lds
s_add_u32 m0, s46, 12288
s_nop 0
buffer_load_dwordx4 v239, s[20:23], s51 offen offset:0 nt lds
s_add_u32 m0, s46, 16256
s_nop 0
buffer_load_dwordx4 v239, s[20:23], s50 offen offset:128 nt lds
s_add_u32 m0, s46, 20352
s_nop 0
buffer_load_dwordx4 v239, s[20:23], s51 offen offset:128 nt lds
s_add_u32 m0, s38, s58
s_nop 0
buffer_load_dwordx4 v239, s[16:19], s58 offen lds
s_add_u32 m0, s38, s59
s_nop 0
buffer_load_dwordx4 v239, s[16:19], s59 offen lds
s_add_u32 m0, s38, s60
s_nop 0
buffer_load_dwordx4 v239, s[16:19], s60 offen lds
s_add_u32 m0, s38, s61
s_nop 0
buffer_load_dwordx4 v239, s[16:19], s61 offen lds
s_add_u32 m0, s46, 24320
s_nop 0
buffer_load_dwordx4 v239, s[20:23], s50 offen offset:256 nt lds
s_add_u32 m0, s46, 28416
s_nop 0
buffer_load_dwordx4 v239, s[20:23], s51 offen offset:256 nt lds
s_add_u32 m0, s46, 32384
s_nop 0
buffer_load_dwordx4 v239, s[20:23], s50 offen offset:384 nt lds
s_add_u32 m0, s46, 36480
s_nop 0
buffer_load_dwordx4 v239, s[20:23], s51 offen offset:384 nt lds
s_mov_b32 s94, 24576
s_add_u32 s68, s35, 24576
s_add_u32 s92, s70, s68
s_addc_u32 s93, s71, 0
s_add_u32 m0, s39, s56
s_nop 0
buffer_load_dwordx4 v239, s[92:95], s56 offen lds
s_add_u32 m0, s39, s57
s_nop 0
buffer_load_dwordx4 v239, s[92:95], s57 offen lds
s_add_u32 m0, s39, s58
s_nop 0
buffer_load_dwordx4 v239, s[92:95], s58 offen lds
s_add_u32 m0, s39, s59
s_nop 0
buffer_load_dwordx4 v239, s[92:95], s59 offen lds
s_add_u32 m0, s39, s60
s_nop 0
buffer_load_dwordx4 v239, s[92:95], s60 offen lds
s_add_u32 m0, s39, s61
s_nop 0
buffer_load_dwordx4 v239, s[92:95], s61 offen lds
s_add_u32 s16, s16, 49152
s_addc_u32 s17, s17, 0
s_add_u32 m0, s40, s56
s_nop 0
buffer_load_dwordx4 v239, s[16:19], s56 offen lds
s_add_u32 m0, s40, s57
s_nop 0
buffer_load_dwordx4 v239, s[16:19], s57 offen lds
s_add_u32 m0, s40, s58
s_nop 0
buffer_load_dwordx4 v239, s[16:19], s58 offen lds
s_add_u32 m0, s40, s59
s_nop 0
buffer_load_dwordx4 v239, s[16:19], s59 offen lds
s_add_u32 m0, s40, s60
s_nop 0
buffer_load_dwordx4 v239, s[16:19], s60 offen lds
s_add_u32 m0, s40, s61
s_nop 0
buffer_load_dwordx4 v239, s[16:19], s61 offen lds
s_add_u32 s36, s74, 32
s_lshl_b32 s45, s36, 17
s_add_u32 s45, s45, s97
s_mul_hi_u32 s36, s36, 0x55555556
s_mul_i32 s36, s36, 196608
s_add_u32 s37, s74, 64
s_lshl_b32 s96, s37, 17
s_add_u32 s96, s96, s97
s_mul_hi_u32 s37, s37, 0x55555556
s_mul_i32 s37, s37, 196608
s_lshl_b32 s44, s32, 12
s_add_u32 s72, s8, s44
s_addc_u32 s73, s9, 0
s_add_u32 s24, s10, s34
s_addc_u32 s25, s11, 0
s_mov_b32 s26, 0x8000
s_mov_b32 s27, 0x20000
s_mov_b32 s30, 196608
s_mov_b32 s31, 0x20000
s_lshl_b32 s62, s56, 2
s_lshl_b32 s63, s57, 2
s_lshl_b32 s64, s58, 2
s_lshl_b32 s65, s59, 2
s_lshl_b32 s66, s60, 2
s_lshl_b32 s67, s61, 2
s_mov_b32 s41, 0x3db8aa3b
s_mov_b32 s42, 0x53800000
s_mov_b32 s79, 0x5f800000
s_mov_b32 s100, 0x35800000
s_mov_b32 s78, 0xc2051592
v_lshl_add_u32 v248, v205, 4, s46
v_and_b32 v200, 7, v205
v_bfe_u32 v201, v205, 3, 1
v_lshlrev_b32 v201, 12, v201
v_lshl_add_u32 v201, v200, 7, v201
v_add_u32 v201, s46, v201
v_lshrrev_b32 v202, 4, v205
v_xor_b32 v203, v202, v200
v_lshl_add_u32 v232, v203, 4, v201
v_xor_b32 v233, 64, v232
v_subrev_u32 v236, s46, v232
v_add_u32 v249, 57344, v236
v_subrev_u32 v186, 0x10000, v232
v_subrev_u32 v188, 0x12000, v232
v_subrev_u32 v237, s46, v233
v_add_u32 v250, 57344, v237
v_subrev_u32 v187, 0x10000, v233
v_subrev_u32 v189, 0x12000, v233
v_lshrrev_b32 v203, 1, v202
v_xor_b32 v203, v203, v200
v_lshl_add_u32 v203, v203, 4, v201
v_and_b32 v204, 1, v202
v_lshl_add_u32 v240, v204, 3, v203
v_xor_b32 v241, 32, v240
v_xor_b32 v242, 64, v240
v_xor_b32 v243, 0x60, v240
v_bfe_u32 v200, v205, 2, 3
v_bfe_u32 v201, v205, 1, 1
v_xor_b32 v201, v201, v200
v_lshlrev_b32 v201, 4, v201
v_lshl_add_u32 v201, v200, 7, v201
v_and_b32 v200, 1, v205
v_lshl_add_u32 v201, v200, 3, v201
v_lshrrev_b32 v200, 5, v205
v_lshl_add_u32 v234, v200, 10, v201
v_add_u32 v235, 57344, v234
v_and_b32 v200, 3, v205
v_mov_b32 v201, 0x3f803f80
v_cmp_eq_u32 vcc, 0, v200
s_nop 1
v_cndmask_b32 v201, 0, v201, vcc
v_accvgpr_write_b32 a252, v201
v_accvgpr_write_b32 a253, v201
v_accvgpr_write_b32 a254, v201
v_accvgpr_write_b32 a255, v201
s_waitcnt vmcnt(30)
ds_read_b128 a[0:3], v186 offset:40960
ds_read_b128 a[4:7], v187 offset:40960
s_waitcnt vmcnt(28)
ds_read_b128 a[8:11], v186 offset:49152
ds_read_b128 a[12:15], v187 offset:49152
s_waitcnt vmcnt(26)
ds_read_b128 a[16:19], v186 offset:57344
ds_read_b128 a[20:23], v187 offset:57344
s_waitcnt vmcnt(24)
ds_read_b128 a[24:27], v232 offset:0
ds_read_b128 a[28:31], v233 offset:0
s_waitcnt vmcnt(22)
ds_read_b128 a[32:35], v232 offset:8192
ds_read_b128 a[36:39], v233 offset:8192
s_waitcnt vmcnt(20)
ds_read_b128 a[40:43], v232 offset:16384
ds_read_b128 a[44:47], v233 offset:16384
s_waitcnt vmcnt(14)
ds_read_b128 a[48:51], v232 offset:24576
ds_read_b128 a[52:55], v233 offset:24576
s_waitcnt vmcnt(12)
ds_read_b128 a[56:59], v232 offset:32768
ds_read_b128 a[60:63], v233 offset:32768
s_waitcnt vmcnt(16)
s_barrier
ds_read_b128 a[128:131], v236 offset:0
ds_read_b128 a[132:135], v237 offset:0
ds_read_b128 a[136:139], v236 offset:1024
ds_read_b128 a[140:143], v237 offset:1024
ds_read_b128 a[144:147], v236 offset:2048
ds_read_b128 a[148:151], v237 offset:2048
ds_read_b128 a[152:155], v236 offset:3072
ds_read_b128 a[156:159], v237 offset:3072
s_waitcnt lgkmcnt(0)
.p2align 3
L_p1_0:
v_mfma_f32_16x16x32_bf16 v[40:43], a[128:131], a[0:3], 0
s_add_u32 m0, s69, s56
s_add_u32 s92, s92, 49152
s_addc_u32 s93, s93, 0
v_mfma_f32_16x16x32_bf16 v[40:43], a[132:135], a[4:7], v[40:43]
ds_read_b128 a[160:163], v236 offset:8192
v_mfma_f32_16x16x32_bf16 v[40:43], a[136:139], a[8:11], v[40:43]
ds_read_b128 a[164:167], v237 offset:8192
v_mfma_f32_16x16x32_bf16 v[40:43], a[140:143], a[12:15], v[40:43]
ds_read_b128 a[168:171], v236 offset:9216
v_mfma_f32_16x16x32_bf16 v[40:43], a[144:147], a[16:19], v[40:43]
buffer_load_dwordx4 v239, s[92:95], s56 offen lds
v_mfma_f32_16x16x32_bf16 v[40:43], a[148:151], a[20:23], v[40:43]
ds_read_b128 a[172:175], v237 offset:9216
s_add_u32 m0, s69, s57
v_mfma_f32_16x16x32_bf16 v[40:43], a[152:155], a[24:27], v[40:43]
s_add_u32 s16, s16, 49152
s_addc_u32 s17, s17, 0
v_mfma_f32_16x16x32_bf16 v[40:43], a[156:159], a[28:31], v[40:43]
ds_read_b128 v[192:195], v236 offset:10240
buffer_load_dwordx4 v239, s[92:95], s57 offen lds
v_mfma_f32_16x16x32_bf16 v[88:91], a[156:159], a[60:63], 0
ds_read_b128 v[196:199], v237 offset:10240
s_add_u32 m0, s69, s58
v_mfma_f32_16x16x32_bf16 v[88:91], a[152:155], a[56:59], v[88:91]
ds_read_b128 a[156:159], v237 offset:11264
v_mfma_f32_16x16x32_bf16 v[88:91], a[148:151], a[52:55], v[88:91]
ds_read_b128 a[152:155], v236 offset:11264
v_max3_f32 v184, v40, v41, v42
v_max_f32 v184, v184, v43
v_mov_b32 v185, v184
v_mfma_f32_16x16x32_bf16 v[88:91], a[144:147], a[48:51], v[88:91]
s_nop 0
v_permlane32_swap_b32 v184, v185
v_max_f32 v184, v184, v185
v_mov_b32 v185, v184
s_nop 1
v_permlane16_swap_b32 v184, v185
v_max_f32 v184, v184, v185
v_sub_f32 v228, s78, v184
v_mul_f32 v185, s41, v228
v_fma_f32 v40, v40, s41, v185
v_fma_f32 v41, v41, s41, v185
v_mfma_f32_16x16x32_bf16 v[88:91], a[140:143], a[44:47], v[88:91]
buffer_load_dwordx4 v239, s[92:95], s58 offen lds
v_exp_f32 v40, v40
v_mov_b32 v229, v228
v_mov_b32 v230, v228
v_mov_b32 v231, v228
v_mfma_f32_16x16x32_bf16 v[88:91], a[136:139], a[40:43], v[88:91]
s_add_u32 m0, s69, s59
v_fma_f32 v42, v42, s41, v185
v_fma_f32 v43, v43, s41, v185
v_mfma_f32_16x16x32_bf16 v[88:91], a[132:135], a[36:39], v[88:91]
v_exp_f32 v41, v41
v_mfma_f32_16x16x32_bf16 v[88:91], a[128:131], a[32:35], v[88:91]
s_waitcnt lgkmcnt(0)
v_exp_f32 v42, v42
v_mfma_f32_16x16x32_bf16 v[136:139], a[160:163], a[0:3], v[228:231]
v_exp_f32 v43, v43
v_mfma_f32_16x16x32_bf16 v[136:139], a[164:167], a[4:7], v[136:139]
ds_read_b128 a[128:131], v236 offset:16384
v_cvt_pk_bf16_f32 v0, v40, v41
s_nop 0
v_max3_f32 v184, v88, v89, v90
v_max_f32 v184, v184, v91
v_mov_b32 v185, v184
v_mfma_f32_16x16x32_bf16 v[136:139], a[168:171], a[8:11], v[136:139]
ds_read_b128 a[132:135], v237 offset:16384
v_cvt_pk_bf16_f32 v1, v42, v43
v_permlane32_swap_b32 v184, v185
v_max_f32 v184, v184, v185
v_mov_b32 v185, v184
v_mfma_f32_16x16x32_bf16 v[136:139], a[172:175], a[12:15], v[136:139]
ds_read_b128 a[136:139], v236 offset:17408
v_permlane16_swap_b32 v184, v185
v_max_f32 v184, v184, v185
v_sub_f32 v252, s78, v184
v_mul_f32 v185, s41, v252
v_fma_f32 v88, v88, s41, v185
v_fma_f32 v89, v89, s41, v185
v_mfma_f32_16x16x32_bf16 v[136:139], v[192:195], a[16:19], v[136:139]
buffer_load_dwordx4 v239, s[92:95], s59 offen lds
v_exp_f32 v88, v88
v_mov_b32 v253, v252
v_mov_b32 v254, v252
v_mov_b32 v255, v252
v_mfma_f32_16x16x32_bf16 v[136:139], v[196:199], a[20:23], v[136:139]
ds_read_b128 a[140:143], v237 offset:17408
v_fma_f32 v90, v90, s41, v185
v_fma_f32 v91, v91, s41, v185
v_mfma_f32_16x16x32_bf16 v[136:139], a[152:155], a[24:27], v[136:139]
s_add_u32 m0, s69, s60
v_exp_f32 v89, v89
v_mfma_f32_16x16x32_bf16 v[136:139], a[156:159], a[28:31], v[136:139]
ds_read_b128 a[144:147], v236 offset:18432
v_exp_f32 v90, v90
v_mfma_f32_16x16x32_bf16 v[40:43], a[156:159], a[60:63], v[252:255]
ds_read_b128 a[148:151], v237 offset:18432
v_exp_f32 v91, v91
v_mfma_f32_16x16x32_bf16 v[40:43], a[152:155], a[56:59], v[40:43]
ds_read_b128 a[156:159], v237 offset:19456
v_cvt_pk_bf16_f32 v48, v88, v89
v_mfma_f32_16x16x32_bf16 v[40:43], v[196:199], a[52:55], v[40:43]
ds_read_b128 a[152:155], v236 offset:19456
v_cvt_pk_bf16_f32 v49, v90, v91
v_mfma_f32_16x16x32_bf16 v[40:43], v[192:195], a[48:51], v[40:43]
buffer_load_dwordx4 v239, s[92:95], s60 offen lds
v_mul_f32 v136, s41, v136
v_mul_f32 v137, s41, v137
v_mfma_f32_16x16x32_bf16 v[40:43], a[172:175], a[44:47], v[40:43]
s_add_u32 m0, s69, s61
v_exp_f32 v136, v136
v_mfma_f32_16x16x32_bf16 v[40:43], a[168:171], a[40:43], v[40:43]
buffer_load_dwordx4 v239, s[92:95], s61 offen lds
v_mul_f32 v138, s41, v138
v_mul_f32 v139, s41, v139
v_mfma_f32_16x16x32_bf16 v[40:43], a[164:167], a[36:39], v[40:43]
s_add_u32 m0, s46, 4294942720
v_exp_f32 v137, v137
v_mfma_f32_16x16x32_bf16 v[40:43], a[160:163], a[32:35], v[40:43]
s_waitcnt vmcnt(12) lgkmcnt(0)
v_exp_f32 v138, v138
v_mfma_f32_16x16x32_bf16 v[88:91], a[128:131], a[0:3], v[228:231]
s_barrier
v_exp_f32 v139, v139
v_mfma_f32_16x16x32_bf16 v[88:91], a[132:135], a[4:7], v[88:91]
ds_read_b128 a[160:163], v236 offset:24576
v_cvt_pk_bf16_f32 v2, v136, v137
v_mfma_f32_16x16x32_bf16 v[88:91], a[136:139], a[8:11], v[88:91]
ds_read_b128 a[164:167], v237 offset:24576
v_cvt_pk_bf16_f32 v3, v138, v139
v_mfma_f32_16x16x32_bf16 v[88:91], a[140:143], a[12:15], v[88:91]
ds_read_b128 a[168:171], v236 offset:25600
v_mul_f32 v40, s41, v40
v_mul_f32 v41, s41, v41
v_mfma_f32_16x16x32_bf16 v[88:91], a[144:147], a[16:19], v[88:91]
buffer_load_dwordx4 v239, s[20:23], s52 offen offset:0 nt lds
v_exp_f32 v40, v40
v_mfma_f32_16x16x32_bf16 v[88:91], a[148:151], a[20:23], v[88:91]
ds_read_b128 a[172:175], v237 offset:25600
v_mul_f32 v42, s41, v42
v_mul_f32 v43, s41, v43
v_mfma_f32_16x16x32_bf16 v[88:91], a[152:155], a[24:27], v[88:91]
s_add_u32 m0, s46, 4294946816
v_exp_f32 v41, v41
v_mfma_f32_16x16x32_bf16 v[88:91], a[156:159], a[28:31], v[88:91]
ds_read_b128 v[192:195], v236 offset:26624
v_exp_f32 v42, v42
v_mfma_f32_16x16x32_bf16 v[136:139], a[156:159], a[60:63], v[252:255]
ds_read_b128 v[196:199], v237 offset:26624
v_exp_f32 v43, v43
v_mfma_f32_16x16x32_bf16 v[136:139], a[152:155], a[56:59], v[136:139]
ds_read_b128 a[156:159], v237 offset:27648
v_cvt_pk_bf16_f32 v50, v40, v41
v_mfma_f32_16x16x32_bf16 v[136:139], a[148:151], a[52:55], v[136:139]
ds_read_b128 a[152:155], v236 offset:27648
v_cvt_pk_bf16_f32 v51, v42, v43
v_mfma_f32_16x16x32_bf16 v[136:139], a[144:147], a[48:51], v[136:139]
buffer_load_dwordx4 v239, s[20:23], s53 offen offset:0 nt lds
v_mul_f32 v88, s41, v88
v_mul_f32 v89, s41, v89
v_mfma_f32_16x16x32_bf16 v[136:139], a[140:143], a[44:47], v[136:139]
s_add_u32 m0, s46, 4294950784
v_exp_f32 v88, v88
v_mfma_f32_16x16x32_bf16 v[136:139], a[136:139], a[40:43], v[136:139]
buffer_load_dwordx4 v239, s[20:23], s52 offen offset:128 nt lds
v_mul_f32 v90, s41, v90
v_mul_f32 v91, s41, v91
v_mfma_f32_16x16x32_bf16 v[136:139], a[132:135], a[36:39], v[136:139]
s_add_u32 m0, s46, 4294954880
v_exp_f32 v89, v89
v_mfma_f32_16x16x32_bf16 v[136:139], a[128:131], a[32:35], v[136:139]
s_waitcnt lgkmcnt(0)
v_exp_f32 v90, v90
v_mfma_f32_16x16x32_bf16 v[40:43], a[160:163], a[0:3], v[228:231]
buffer_load_dwordx4 v239, s[20:23], s53 offen offset:128 nt lds
v_exp_f32 v91, v91
v_mfma_f32_16x16x32_bf16 v[40:43], a[164:167], a[4:7], v[40:43]
ds_read_b128 a[128:131], v236 offset:32768
v_cvt_pk_bf16_f32 v4, v88, v89
v_mfma_f32_16x16x32_bf16 v[40:43], a[168:171], a[8:11], v[40:43]
ds_read_b128 a[132:135], v237 offset:32768
v_cvt_pk_bf16_f32 v5, v90, v91
v_mfma_f32_16x16x32_bf16 v[40:43], a[172:175], a[12:15], v[40:43]
ds_read_b128 a[136:139], v236 offset:33792
v_mul_f32 v136, s41, v136
v_mul_f32 v137, s41, v137
v_mfma_f32_16x16x32_bf16 v[40:43], v[192:195], a[16:19], v[40:43]
s_add_u32 m0, s46, 4294958848
v_exp_f32 v136, v136
v_mfma_f32_16x16x32_bf16 v[40:43], v[196:199], a[20:23], v[40:43]
ds_read_b128 a[140:143], v237 offset:33792
v_mul_f32 v138, s41, v138
v_mul_f32 v139, s41, v139
v_mfma_f32_16x16x32_bf16 v[40:43], a[152:155], a[24:27], v[40:43]
v_exp_f32 v137, v137
v_mfma_f32_16x16x32_bf16 v[40:43], a[156:159], a[28:31], v[40:43]
ds_read_b128 a[144:147], v236 offset:34816
v_exp_f32 v138, v138
v_mfma_f32_16x16x32_bf16 v[208:211], a[252:255], v[0:3], 0
buffer_load_dwordx4 v239, s[20:23], s52 offen offset:256 nt lds
v_mfma_f32_16x16x32_bf16 v[88:91], a[156:159], a[60:63], v[252:255]
ds_read_b128 a[148:151], v237 offset:34816
v_exp_f32 v139, v139
v_mfma_f32_16x16x32_bf16 v[88:91], a[152:155], a[56:59], v[88:91]
ds_read_b128 a[156:159], v237 offset:35840
v_cvt_pk_bf16_f32 v52, v136, v137
v_mfma_f32_16x16x32_bf16 v[88:91], v[196:199], a[52:55], v[88:91]
ds_read_b128 a[152:155], v236 offset:35840
v_cvt_pk_bf16_f32 v53, v138, v139
v_mfma_f32_16x16x32_bf16 v[88:91], v[192:195], a[48:51], v[88:91]
s_add_u32 m0, s46, 4294962944
v_mul_f32 v40, s41, v40
v_mul_f32 v41, s41, v41
v_mfma_f32_16x16x32_bf16 v[88:91], a[172:175], a[44:47], v[88:91]
buffer_load_dwordx4 v239, s[20:23], s53 offen offset:256 nt lds
v_exp_f32 v40, v40
v_mfma_f32_16x16x32_bf16 v[88:91], a[168:171], a[40:43], v[88:91]
s_add_u32 m0, s46, 4294966912
v_mul_f32 v42, s41, v42
v_mul_f32 v43, s41, v43
v_mfma_f32_16x16x32_bf16 v[88:91], a[164:167], a[36:39], v[88:91]
buffer_load_dwordx4 v239, s[20:23], s52 offen offset:384 nt lds
v_exp_f32 v41, v41
v_mfma_f32_16x16x32_bf16 v[88:91], a[160:163], a[32:35], v[88:91]
s_waitcnt lgkmcnt(0)
v_exp_f32 v42, v42
v_mfma_f32_16x16x32_bf16 v[200:203], a[128:131], a[0:3], v[228:231]
s_add_u32 m0, s46, 3712
v_exp_f32 v43, v43
v_mfma_f32_16x16x32_bf16 v[200:203], a[132:135], a[4:7], v[200:203]
ds_read_b128 a[160:163], v236 offset:40960
v_cvt_pk_bf16_f32 v6, v40, v41
v_mfma_f32_16x16x32_bf16 v[200:203], a[136:139], a[8:11], v[200:203]
ds_read_b128 a[164:167], v237 offset:40960
v_cvt_pk_bf16_f32 v7, v42, v43
v_mfma_f32_16x16x32_bf16 v[200:203], a[140:143], a[12:15], v[200:203]
ds_read_b128 a[168:171], v236 offset:41984
v_mul_f32 v88, s41, v88
v_mul_f32 v89, s41, v89
v_mfma_f32_16x16x32_bf16 v[200:203], a[144:147], a[16:19], v[200:203]
v_exp_f32 v88, v88
v_mfma_f32_16x16x32_bf16 v[200:203], a[148:151], a[20:23], v[200:203]
ds_read_b128 a[172:175], v237 offset:41984
v_mul_f32 v90, s41, v90
v_mul_f32 v91, s41, v91
v_mfma_f32_16x16x32_bf16 v[200:203], a[152:155], a[24:27], v[200:203]
v_exp_f32 v89, v89
v_mfma_f32_16x16x32_bf16 v[200:203], a[156:159], a[28:31], v[200:203]
ds_read_b128 v[192:195], v236 offset:43008
v_exp_f32 v90, v90
v_mfma_f32_16x16x32_bf16 v[210:213], a[252:255], v[48:51], 0
buffer_load_dwordx4 v239, s[20:23], s53 offen offset:384 nt lds
v_mfma_f32_16x16x32_bf16 v[204:207], a[156:159], a[60:63], v[252:255]
ds_read_b128 v[196:199], v237 offset:43008
v_exp_f32 v91, v91
v_mfma_f32_16x16x32_bf16 v[204:207], a[152:155], a[56:59], v[204:207]
ds_read_b128 a[156:159], v237 offset:44032
v_cvt_pk_bf16_f32 v54, v88, v89
v_mfma_f32_16x16x32_bf16 v[204:207], a[148:151], a[52:55], v[204:207]
ds_read_b128 a[152:155], v236 offset:44032
v_cvt_pk_bf16_f32 v55, v90, v91
v_mfma_f32_16x16x32_bf16 v[204:207], a[144:147], a[48:51], v[204:207]
s_add_u32 m0, s46, 8192
v_mul_f32 v200, s41, v200
v_mul_f32 v201, s41, v201
v_mfma_f32_16x16x32_bf16 v[204:207], a[140:143], a[44:47], v[204:207]
buffer_load_dwordx4 v239, s[20:23], s54 offen offset:0 nt lds
v_exp_f32 v200, v200
v_mfma_f32_16x16x32_bf16 v[204:207], a[136:139], a[40:43], v[204:207]
s_add_u32 m0, s46, 12288
v_mul_f32 v202, s41, v202
v_mul_f32 v203, s41, v203
v_mfma_f32_16x16x32_bf16 v[204:207], a[132:135], a[36:39], v[204:207]
buffer_load_dwordx4 v239, s[20:23], s55 offen offset:0 nt lds
v_exp_f32 v201, v201
v_mfma_f32_16x16x32_bf16 v[204:207], a[128:131], a[32:35], v[204:207]
s_waitcnt vmcnt(16) lgkmcnt(0)
v_exp_f32 v202, v202
v_mfma_f32_16x16x32_bf16 v[224:227], a[160:163], a[0:3], v[228:231]
s_barrier
v_exp_f32 v203, v203
v_mfma_f32_16x16x32_bf16 v[224:227], a[164:167], a[4:7], v[224:227]
ds_read_b128 a[128:131], v236 offset:49152
v_cvt_pk_bf16_f32 v8, v200, v201
v_mfma_f32_16x16x32_bf16 v[224:227], a[168:171], a[8:11], v[224:227]
ds_read_b128 a[132:135], v237 offset:49152
v_cvt_pk_bf16_f32 v9, v202, v203
v_mfma_f32_16x16x32_bf16 v[224:227], a[172:175], a[12:15], v[224:227]
ds_read_b128 a[136:139], v236 offset:50176
v_mul_f32 v204, s41, v204
v_mul_f32 v205, s41, v205
v_mfma_f32_16x16x32_bf16 v[224:227], v[192:195], a[16:19], v[224:227]
s_add_u32 m0, s46, 16256
v_exp_f32 v204, v204
v_mfma_f32_16x16x32_bf16 v[224:227], v[196:199], a[20:23], v[224:227]
ds_read_b128 a[140:143], v237 offset:50176
v_mul_f32 v206, s41, v206
v_mul_f32 v207, s41, v207
v_mfma_f32_16x16x32_bf16 v[224:227], a[152:155], a[24:27], v[224:227]
buffer_load_dwordx4 v239, s[20:23], s54 offen offset:128 nt lds
v_exp_f32 v205, v205
v_mfma_f32_16x16x32_bf16 v[224:227], a[156:159], a[28:31], v[224:227]
ds_read_b128 a[144:147], v236 offset:51200
v_exp_f32 v206, v206
v_mfma_f32_16x16x32_bf16 v[208:211], a[252:255], v[4:7], v[208:211]
s_add_u32 m0, s46, 20352
s_add_u32 s92, s92, 49152
s_addc_u32 s93, s93, 0
v_mfma_f32_16x16x32_bf16 v[200:203], a[156:159], a[60:63], v[252:255]
ds_read_b128 a[148:151], v237 offset:51200
buffer_load_dwordx4 v239, s[20:23], s55 offen offset:128 nt lds
v_exp_f32 v207, v207
v_mfma_f32_16x16x32_bf16 v[200:203], a[152:155], a[56:59], v[200:203]
ds_read_b128 a[156:159], v237 offset:52224
v_cvt_pk_bf16_f32 v56, v204, v205
v_mfma_f32_16x16x32_bf16 v[200:203], v[196:199], a[52:55], v[200:203]
ds_read_b128 a[152:155], v236 offset:52224
v_cvt_pk_bf16_f32 v57, v206, v207
v_mfma_f32_16x16x32_bf16 v[200:203], v[192:195], a[48:51], v[200:203]
s_add_u32 m0, s46, 24320
v_mul_f32 v224, s41, v224
v_mul_f32 v225, s41, v225
v_mfma_f32_16x16x32_bf16 v[200:203], a[172:175], a[44:47], v[200:203]
buffer_load_dwordx4 v239, s[20:23], s54 offen offset:256 nt lds
v_exp_f32 v224, v224
v_mfma_f32_16x16x32_bf16 v[200:203], a[168:171], a[40:43], v[200:203]
s_add_u32 m0, s46, 28416
v_mul_f32 v226, s41, v226
v_mul_f32 v227, s41, v227
v_mfma_f32_16x16x32_bf16 v[200:203], a[164:167], a[36:39], v[200:203]
buffer_load_dwordx4 v239, s[20:23], s55 offen offset:256 nt lds
v_exp_f32 v225, v225
v_mfma_f32_16x16x32_bf16 v[200:203], a[160:163], a[32:35], v[200:203]
s_waitcnt lgkmcnt(0)
v_exp_f32 v226, v226
v_mfma_f32_16x16x32_bf16 v[204:207], a[128:131], a[0:3], v[228:231]
s_add_u32 m0, s46, 32384
v_exp_f32 v227, v227
v_mfma_f32_16x16x32_bf16 v[204:207], a[132:135], a[4:7], v[204:207]
ds_read_b128 a[160:163], v236 offset:57344
v_cvt_pk_bf16_f32 v10, v224, v225
v_mfma_f32_16x16x32_bf16 v[204:207], a[136:139], a[8:11], v[204:207]
ds_read_b128 a[164:167], v237 offset:57344
v_cvt_pk_bf16_f32 v11, v226, v227
v_mfma_f32_16x16x32_bf16 v[204:207], a[140:143], a[12:15], v[204:207]
ds_read_b128 a[168:171], v236 offset:58368
v_mul_f32 v200, s41, v200
v_mul_f32 v201, s41, v201
v_mfma_f32_16x16x32_bf16 v[204:207], a[144:147], a[16:19], v[204:207]
v_exp_f32 v200, v200
v_mfma_f32_16x16x32_bf16 v[204:207], a[148:151], a[20:23], v[204:207]
ds_read_b128 a[172:175], v237 offset:58368
v_mul_f32 v202, s41, v202
v_mul_f32 v203, s41, v203
v_mfma_f32_16x16x32_bf16 v[204:207], a[152:155], a[24:27], v[204:207]
v_exp_f32 v201, v201
v_mfma_f32_16x16x32_bf16 v[204:207], a[156:159], a[28:31], v[204:207]
ds_read_b128 v[192:195], v236 offset:59392
v_exp_f32 v202, v202
v_mfma_f32_16x16x32_bf16 v[210:213], a[252:255], v[52:55], v[210:213]
buffer_load_dwordx4 v239, s[20:23], s54 offen offset:384 nt lds
v_mfma_f32_16x16x32_bf16 v[224:227], a[156:159], a[60:63], v[252:255]
ds_read_b128 v[196:199], v237 offset:59392
v_exp_f32 v203, v203
v_mfma_f32_16x16x32_bf16 v[224:227], a[152:155], a[56:59], v[224:227]
ds_read_b128 a[156:159], v237 offset:60416
v_cvt_pk_bf16_f32 v58, v200, v201
v_mfma_f32_16x16x32_bf16 v[224:227], a[148:151], a[52:55], v[224:227]
ds_read_b128 a[152:155], v236 offset:60416
v_cvt_pk_bf16_f32 v59, v202, v203
v_mfma_f32_16x16x32_bf16 v[224:227], a[144:147], a[48:51], v[224:227]
s_add_u32 m0, s46, 36480
v_mul_f32 v204, s41, v204
v_mul_f32 v205, s41, v205
v_mfma_f32_16x16x32_bf16 v[224:227], a[140:143], a[44:47], v[224:227]
buffer_load_dwordx4 v239, s[20:23], s55 offen offset:384 nt lds
v_exp_f32 v204, v204
v_mfma_f32_16x16x32_bf16 v[224:227], a[136:139], a[40:43], v[224:227]
s_waitcnt vmcnt(14)
v_mul_f32 v206, s41, v206
v_mul_f32 v207, s41, v207
v_mfma_f32_16x16x32_bf16 v[224:227], a[132:135], a[36:39], v[224:227]
ds_read_b128 a[64:67], v186 offset:40960
v_exp_f32 v205, v205
v_mfma_f32_16x16x32_bf16 v[224:227], a[128:131], a[32:35], v[224:227]
s_waitcnt lgkmcnt(1)
v_exp_f32 v206, v206
v_mfma_f32_16x16x32_bf16 v[200:203], a[160:163], a[0:3], v[228:231]
ds_read_b128 a[68:71], v187 offset:40960
v_exp_f32 v207, v207
v_mfma_f32_16x16x32_bf16 v[200:203], a[164:167], a[4:7], v[200:203]
ds_read_b128 a[128:131], v249 offset:8192
v_cvt_pk_bf16_f32 v12, v204, v205
v_mfma_f32_16x16x32_bf16 v[200:203], a[168:171], a[8:11], v[200:203]
ds_read_b128 a[132:135], v250 offset:8192
v_cvt_pk_bf16_f32 v13, v206, v207
v_mfma_f32_16x16x32_bf16 v[200:203], a[172:175], a[12:15], v[200:203]
ds_read_b128 a[136:139], v249 offset:9216
v_mul_f32 v224, s41, v224
v_mul_f32 v225, s41, v225
v_mfma_f32_16x16x32_bf16 v[200:203], v[192:195], a[16:19], v[200:203]
s_add_u32 m0, s75, s56
v_exp_f32 v224, v224
v_mfma_f32_16x16x32_bf16 v[200:203], v[196:199], a[20:23], v[200:203]
ds_read_b128 a[140:143], v250 offset:9216
v_mul_f32 v226, s41, v226
v_mul_f32 v227, s41, v227
v_mfma_f32_16x16x32_bf16 v[200:203], a[152:155], a[24:27], v[200:203]
s_waitcnt lgkmcnt(4)
v_exp_f32 v225, v225
v_mfma_f32_16x16x32_bf16 v[200:203], a[156:159], a[28:31], v[200:203]
ds_read_b128 a[144:147], v249 offset:10240
v_exp_f32 v226, v226
v_mfma_f32_16x16x32_bf16 v[208:211], a[252:255], v[8:11], v[208:211]
s_waitcnt vmcnt(12)
s_add_u32 s20, s4, s45
s_addc_u32 s21, s5, 0
v_mfma_f32_16x16x32_bf16 v[204:207], a[156:159], a[60:63], v[252:255]
ds_read_b128 a[148:151], v250 offset:10240
v_exp_f32 v227, v227
v_mfma_f32_16x16x32_bf16 v[204:207], a[152:155], a[56:59], v[204:207]
ds_read_b128 a[156:159], v250 offset:11264
v_cvt_pk_bf16_f32 v60, v224, v225
v_mfma_f32_16x16x32_bf16 v[204:207], v[196:199], a[52:55], v[204:207]
ds_read_b128 a[152:155], v249 offset:11264
v_cvt_pk_bf16_f32 v61, v226, v227
v_mfma_f32_16x16x32_bf16 v[204:207], v[192:195], a[48:51], v[204:207]
ds_read_b128 a[72:75], v186 offset:49152
v_mul_f32 v200, s41, v200
v_mul_f32 v201, s41, v201
v_mfma_f32_16x16x32_bf16 v[204:207], a[172:175], a[44:47], v[204:207]
ds_read_b128 a[76:79], v187 offset:49152
v_exp_f32 v200, v200
v_mfma_f32_16x16x32_bf16 v[204:207], a[168:171], a[40:43], v[204:207]
v_mul_f32 v202, s41, v202
v_mul_f32 v203, s41, v203
v_mfma_f32_16x16x32_bf16 v[204:207], a[164:167], a[36:39], v[204:207]
v_exp_f32 v201, v201
v_mfma_f32_16x16x32_bf16 v[204:207], a[160:163], a[32:35], v[204:207]
s_waitcnt vmcnt(16) lgkmcnt(2)
v_exp_f32 v202, v202
v_mfma_f32_16x16x32_bf16 v[224:227], a[128:131], a[0:3], v[228:231]
s_barrier
v_exp_f32 v203, v203
v_mfma_f32_16x16x32_bf16 v[224:227], a[132:135], a[4:7], v[224:227]
ds_read_b128 a[160:163], v249 offset:16384
v_cvt_pk_bf16_f32 v14, v200, v201
v_mfma_f32_16x16x32_bf16 v[224:227], a[136:139], a[8:11], v[224:227]
ds_read_b128 a[164:167], v250 offset:16384
v_cvt_pk_bf16_f32 v15, v202, v203
v_mfma_f32_16x16x32_bf16 v[224:227], a[140:143], a[12:15], v[224:227]
ds_read_b128 a[168:171], v249 offset:17408
v_mul_f32 v204, s41, v204
v_mul_f32 v205, s41, v205
v_mfma_f32_16x16x32_bf16 v[224:227], a[144:147], a[16:19], v[224:227]
s_waitcnt lgkmcnt(3)
v_exp_f32 v204, v204
v_mfma_f32_16x16x32_bf16 v[224:227], a[148:151], a[20:23], v[224:227]
ds_read_b128 a[172:175], v250 offset:17408
v_mul_f32 v206, s41, v206
v_mul_f32 v207, s41, v207
v_mfma_f32_16x16x32_bf16 v[224:227], a[152:155], a[24:27], v[224:227]
s_waitcnt vmcnt(10)
v_exp_f32 v205, v205
v_mfma_f32_16x16x32_bf16 v[224:227], a[156:159], a[28:31], v[224:227]
ds_read_b128 v[192:195], v249 offset:18432
v_exp_f32 v206, v206
v_mfma_f32_16x16x32_bf16 v[210:213], a[252:255], v[56:59], v[210:213]
ds_read_b128 a[80:83], v186 offset:57344
v_mfma_f32_16x16x32_bf16 v[200:203], a[156:159], a[60:63], v[252:255]
ds_read_b128 v[196:199], v250 offset:18432
ds_read_b128 a[84:87], v187 offset:57344
v_exp_f32 v207, v207
v_mfma_f32_16x16x32_bf16 v[200:203], a[152:155], a[56:59], v[200:203]
ds_read_b128 a[156:159], v250 offset:19456
v_cvt_pk_bf16_f32 v62, v204, v205
v_mfma_f32_16x16x32_bf16 v[200:203], a[148:151], a[52:55], v[200:203]
ds_read_b128 a[152:155], v249 offset:19456
v_cvt_pk_bf16_f32 v63, v206, v207
v_mfma_f32_16x16x32_bf16 v[200:203], a[144:147], a[48:51], v[200:203]
v_mul_f32 v224, s41, v224
v_mul_f32 v225, s41, v225
v_mfma_f32_16x16x32_bf16 v[200:203], a[140:143], a[44:47], v[200:203]
v_exp_f32 v224, v224
v_mfma_f32_16x16x32_bf16 v[200:203], a[136:139], a[40:43], v[200:203]
s_waitcnt lgkmcnt(2)
v_mul_f32 v226, s41, v226
v_mul_f32 v227, s41, v227
v_mfma_f32_16x16x32_bf16 v[200:203], a[132:135], a[36:39], v[200:203]
s_waitcnt vmcnt(8)
v_exp_f32 v225, v225
v_mfma_f32_16x16x32_bf16 v[200:203], a[128:131], a[32:35], v[200:203]
s_waitcnt lgkmcnt(0)
v_exp_f32 v226, v226
v_mfma_f32_16x16x32_bf16 v[204:207], a[160:163], a[0:3], v[228:231]
ds_read_b128 a[88:91], v232 offset:0
v_exp_f32 v227, v227
v_mfma_f32_16x16x32_bf16 v[204:207], a[164:167], a[4:7], v[204:207]
ds_read_b128 a[128:131], v249 offset:24576
v_cvt_pk_bf16_f32 v16, v224, v225
v_mfma_f32_16x16x32_bf16 v[204:207], a[168:171], a[8:11], v[204:207]
ds_read_b128 a[132:135], v250 offset:24576
v_cvt_pk_bf16_f32 v17, v226, v227
v_mfma_f32_16x16x32_bf16 v[204:207], a[172:175], a[12:15], v[204:207]
ds_read_b128 a[136:139], v249 offset:25600
v_mul_f32 v200, s41, v200
v_mul_f32 v201, s41, v201
v_mfma_f32_16x16x32_bf16 v[204:207], v[192:195], a[16:19], v[204:207]
ds_read_b128 a[92:95], v233 offset:0
v_exp_f32 v200, v200
v_mfma_f32_16x16x32_bf16 v[204:207], v[196:199], a[20:23], v[204:207]
ds_read_b128 a[140:143], v250 offset:25600
v_mul_f32 v202, s41, v202
v_mul_f32 v203, s41, v203
v_mfma_f32_16x16x32_bf16 v[204:207], a[152:155], a[24:27], v[204:207]
v_exp_f32 v201, v201
v_mfma_f32_16x16x32_bf16 v[204:207], a[156:159], a[28:31], v[204:207]
ds_read_b128 a[144:147], v249 offset:26624
v_exp_f32 v202, v202
v_mfma_f32_16x16x32_bf16 v[208:211], a[252:255], v[12:15], v[208:211]
v_mfma_f32_16x16x32_bf16 v[224:227], a[156:159], a[60:63], v[252:255]
ds_read_b128 a[148:151], v250 offset:26624
s_waitcnt lgkmcnt(3)
v_exp_f32 v203, v203
v_mfma_f32_16x16x32_bf16 v[224:227], a[152:155], a[56:59], v[224:227]
ds_read_b128 a[156:159], v250 offset:27648
v_cvt_pk_bf16_f32 v64, v200, v201
v_mfma_f32_16x16x32_bf16 v[224:227], v[196:199], a[52:55], v[224:227]
ds_read_b128 a[152:155], v249 offset:27648
v_cvt_pk_bf16_f32 v65, v202, v203
v_mfma_f32_16x16x32_bf16 v[224:227], v[192:195], a[48:51], v[224:227]
s_waitcnt vmcnt(6)
v_mul_f32 v204, s41, v204
v_mul_f32 v205, s41, v205
v_mfma_f32_16x16x32_bf16 v[224:227], a[172:175], a[44:47], v[224:227]
ds_read_b128 a[96:99], v232 offset:8192
v_exp_f32 v204, v204
v_mfma_f32_16x16x32_bf16 v[224:227], a[168:171], a[40:43], v[224:227]
ds_read_b128 a[100:103], v233 offset:8192
v_mul_f32 v206, s41, v206
v_mul_f32 v207, s41, v207
v_mfma_f32_16x16x32_bf16 v[224:227], a[164:167], a[36:39], v[224:227]
v_exp_f32 v205, v205
v_mfma_f32_16x16x32_bf16 v[224:227], a[160:163], a[32:35], v[224:227]
s_waitcnt lgkmcnt(2)
v_exp_f32 v206, v206
v_mfma_f32_16x16x32_bf16 v[200:203], a[128:131], a[0:3], v[228:231]
v_exp_f32 v207, v207
v_mfma_f32_16x16x32_bf16 v[200:203], a[132:135], a[4:7], v[200:203]
ds_read_b128 a[160:163], v249 offset:32768
v_cvt_pk_bf16_f32 v18, v204, v205
v_mfma_f32_16x16x32_bf16 v[200:203], a[136:139], a[8:11], v[200:203]
ds_read_b128 a[164:167], v250 offset:32768
v_cvt_pk_bf16_f32 v19, v206, v207
v_mfma_f32_16x16x32_bf16 v[200:203], a[140:143], a[12:15], v[200:203]
ds_read_b128 a[168:171], v249 offset:33792
v_mul_f32 v224, s41, v224
v_mul_f32 v225, s41, v225
v_mfma_f32_16x16x32_bf16 v[200:203], a[144:147], a[16:19], v[200:203]
s_waitcnt lgkmcnt(3)
v_exp_f32 v224, v224
v_mfma_f32_16x16x32_bf16 v[200:203], a[148:151], a[20:23], v[200:203]
ds_read_b128 a[172:175], v250 offset:33792
v_mul_f32 v226, s41, v226
v_mul_f32 v227, s41, v227
v_mfma_f32_16x16x32_bf16 v[200:203], a[152:155], a[24:27], v[200:203]
s_waitcnt vmcnt(4)
v_exp_f32 v225, v225
v_mfma_f32_16x16x32_bf16 v[200:203], a[156:159], a[28:31], v[200:203]
ds_read_b128 v[192:195], v249 offset:34816
v_exp_f32 v226, v226
v_mfma_f32_16x16x32_bf16 v[210:213], a[252:255], v[60:63], v[210:213]
ds_read_b128 a[104:107], v232 offset:16384
v_mfma_f32_16x16x32_bf16 v[204:207], a[156:159], a[60:63], v[252:255]
ds_read_b128 v[196:199], v250 offset:34816
ds_read_b128 a[108:111], v233 offset:16384
v_exp_f32 v227, v227
v_mfma_f32_16x16x32_bf16 v[204:207], a[152:155], a[56:59], v[204:207]
ds_read_b128 a[156:159], v250 offset:35840
v_cvt_pk_bf16_f32 v66, v224, v225
v_mfma_f32_16x16x32_bf16 v[204:207], a[148:151], a[52:55], v[204:207]
ds_read_b128 a[152:155], v249 offset:35840
v_cvt_pk_bf16_f32 v67, v226, v227
v_mfma_f32_16x16x32_bf16 v[204:207], a[144:147], a[48:51], v[204:207]
v_mul_f32 v200, s41, v200
v_mul_f32 v201, s41, v201
v_mfma_f32_16x16x32_bf16 v[204:207], a[140:143], a[44:47], v[204:207]
v_exp_f32 v200, v200
v_mfma_f32_16x16x32_bf16 v[204:207], a[136:139], a[40:43], v[204:207]
s_waitcnt lgkmcnt(2)
v_mul_f32 v202, s41, v202
v_mul_f32 v203, s41, v203
v_mfma_f32_16x16x32_bf16 v[204:207], a[132:135], a[36:39], v[204:207]
v_exp_f32 v201, v201
v_mfma_f32_16x16x32_bf16 v[204:207], a[128:131], a[32:35], v[204:207]
s_waitcnt lgkmcnt(0)
v_exp_f32 v202, v202
v_mfma_f32_16x16x32_bf16 v[224:227], a[160:163], a[0:3], v[228:231]
s_waitcnt vmcnt(2)
v_exp_f32 v203, v203
v_mfma_f32_16x16x32_bf16 v[224:227], a[164:167], a[4:7], v[224:227]
ds_read_b128 a[128:131], v236 offset:0
v_cvt_pk_bf16_f32 v20, v200, v201
v_mfma_f32_16x16x32_bf16 v[224:227], a[168:171], a[8:11], v[224:227]
ds_read_b128 a[132:135], v237 offset:0
v_cvt_pk_bf16_f32 v21, v202, v203
v_mfma_f32_16x16x32_bf16 v[224:227], a[172:175], a[12:15], v[224:227]
ds_read_b128 a[136:139], v236 offset:1024
v_mul_f32 v204, s41, v204
v_mul_f32 v205, s41, v205
v_mfma_f32_16x16x32_bf16 v[224:227], v[192:195], a[16:19], v[224:227]
ds_read_b128 a[112:115], v232 offset:24576
v_exp_f32 v204, v204
v_mfma_f32_16x16x32_bf16 v[224:227], v[196:199], a[20:23], v[224:227]
ds_read_b128 a[140:143], v237 offset:1024
v_mul_f32 v206, s41, v206
v_mul_f32 v207, s41, v207
v_mfma_f32_16x16x32_bf16 v[224:227], a[152:155], a[24:27], v[224:227]
ds_read_b128 a[116:119], v233 offset:24576
v_exp_f32 v205, v205
v_mfma_f32_16x16x32_bf16 v[224:227], a[156:159], a[28:31], v[224:227]
ds_read_b128 a[144:147], v236 offset:2048
v_exp_f32 v206, v206
v_mfma_f32_16x16x32_bf16 v[208:211], a[252:255], v[16:19], v[208:211]
v_mfma_f32_16x16x32_bf16 v[200:203], a[156:159], a[60:63], v[252:255]
ds_read_b128 a[148:151], v237 offset:2048
v_exp_f32 v207, v207
v_mfma_f32_16x16x32_bf16 v[200:203], a[152:155], a[56:59], v[200:203]
ds_read_b128 a[156:159], v237 offset:3072
v_cvt_pk_bf16_f32 v68, v204, v205
v_mfma_f32_16x16x32_bf16 v[200:203], v[196:199], a[52:55], v[200:203]
ds_read_b128 a[152:155], v236 offset:3072
v_cvt_pk_bf16_f32 v69, v206, v207
v_mfma_f32_16x16x32_bf16 v[200:203], v[192:195], a[48:51], v[200:203]
s_waitcnt lgkmcnt(4)
v_mul_f32 v224, s41, v224
v_mul_f32 v225, s41, v225
v_mfma_f32_16x16x32_bf16 v[200:203], a[172:175], a[44:47], v[200:203]
s_waitcnt vmcnt(0)
v_exp_f32 v224, v224
v_mfma_f32_16x16x32_bf16 v[200:203], a[168:171], a[40:43], v[200:203]
ds_read_b128 a[120:123], v232 offset:32768
v_mul_f32 v226, s41, v226
v_mul_f32 v227, s41, v227
v_mfma_f32_16x16x32_bf16 v[200:203], a[164:167], a[36:39], v[200:203]
ds_read_b128 a[124:127], v233 offset:32768
v_exp_f32 v225, v225
v_mfma_f32_16x16x32_bf16 v[200:203], a[160:163], a[32:35], v[200:203]
s_waitcnt lgkmcnt(2)
v_exp_f32 v226, v226
v_mfma_f32_16x16x32_bf16 v[204:207], a[128:131], a[64:67], 0
v_exp_f32 v227, v227
v_mfma_f32_16x16x32_bf16 v[204:207], a[132:135], a[68:71], v[204:207]
ds_read_b128 a[160:163], v236 offset:8192
v_cvt_pk_bf16_f32 v22, v224, v225
v_mfma_f32_16x16x32_bf16 v[204:207], a[136:139], a[72:75], v[204:207]
ds_read_b128 a[164:167], v237 offset:8192
v_cvt_pk_bf16_f32 v23, v226, v227
v_mfma_f32_16x16x32_bf16 v[204:207], a[140:143], a[76:79], v[204:207]
ds_read_b128 a[168:171], v236 offset:9216
v_mul_f32 v200, s41, v200
v_mul_f32 v201, s41, v201
v_mfma_f32_16x16x32_bf16 v[204:207], a[144:147], a[80:83], v[204:207]
s_waitcnt lgkmcnt(3)
v_exp_f32 v200, v200
v_mfma_f32_16x16x32_bf16 v[204:207], a[148:151], a[84:87], v[204:207]
ds_read_b128 a[172:175], v237 offset:9216
v_mul_f32 v202, s41, v202
v_mul_f32 v203, s41, v203
v_mfma_f32_16x16x32_bf16 v[204:207], a[152:155], a[88:91], v[204:207]
v_exp_f32 v201, v201
v_mfma_f32_16x16x32_bf16 v[204:207], a[156:159], a[92:95], v[204:207]
ds_read_b128 v[192:195], v236 offset:10240
v_exp_f32 v202, v202
v_mfma_f32_16x16x32_bf16 v[210:213], a[252:255], v[64:67], v[210:213]
v_mfma_f32_16x16x32_bf16 v[224:227], a[156:159], a[124:127], 0
ds_read_b128 v[196:199], v237 offset:10240
v_exp_f32 v203, v203
v_mfma_f32_16x16x32_bf16 v[224:227], a[152:155], a[120:123], v[224:227]
ds_read_b128 a[156:159], v237 offset:11264
v_cvt_pk_bf16_f32 v70, v200, v201
v_max3_f32 v184, v204, v205, v206
v_max_f32 v184, v184, v207
v_mov_b32 v185, v184
v_mfma_f32_16x16x32_bf16 v[224:227], a[148:151], a[116:119], v[224:227]
ds_read_b128 a[152:155], v236 offset:11264
v_cvt_pk_bf16_f32 v71, v202, v203
v_permlane32_swap_b32 v184, v185
v_max_f32 v184, v184, v185
v_mov_b32 v185, v184
v_mfma_f32_16x16x32_bf16 v[224:227], a[144:147], a[112:115], v[224:227]
s_nop 0
v_permlane16_swap_b32 v184, v185
v_max_f32 v184, v184, v185
v_sub_f32 v244, s78, v184
v_mul_f32 v185, s41, v244
v_fma_f32 v204, v204, s41, v185
v_fma_f32 v205, v205, s41, v185
v_mfma_f32_16x16x32_bf16 v[224:227], a[140:143], a[108:111], v[224:227]
v_exp_f32 v204, v204
v_mov_b32 v245, v244
v_mov_b32 v246, v244
v_mov_b32 v247, v244
v_mfma_f32_16x16x32_bf16 v[224:227], a[136:139], a[104:107], v[224:227]
v_fma_f32 v206, v206, s41, v185
v_fma_f32 v207, v207, s41, v185
v_mfma_f32_16x16x32_bf16 v[224:227], a[132:135], a[100:103], v[224:227]
v_exp_f32 v205, v205
v_mfma_f32_16x16x32_bf16 v[224:227], a[128:131], a[96:99], v[224:227]
s_waitcnt lgkmcnt(0)
v_exp_f32 v206, v206
v_mfma_f32_16x16x32_bf16 v[200:203], a[160:163], a[64:67], v[244:247]
v_exp_f32 v207, v207
v_mfma_f32_16x16x32_bf16 v[200:203], a[164:167], a[68:71], v[200:203]
ds_read_b128 a[128:131], v236 offset:16384
v_cvt_pk_bf16_f32 v96, v204, v205
s_nop 0
v_max3_f32 v184, v224, v225, v226
v_max_f32 v184, v184, v227
v_mov_b32 v185, v184
v_mfma_f32_16x16x32_bf16 v[200:203], a[168:171], a[72:75], v[200:203]
ds_read_b128 a[132:135], v237 offset:16384
v_cvt_pk_bf16_f32 v97, v206, v207
v_permlane32_swap_b32 v184, v185
v_max_f32 v184, v184, v185
v_mov_b32 v185, v184
v_mfma_f32_16x16x32_bf16 v[200:203], a[172:175], a[76:79], v[200:203]
ds_read_b128 a[136:139], v236 offset:17408
v_permlane16_swap_b32 v184, v185
v_max_f32 v184, v184, v185
v_sub_f32 v220, s78, v184
v_mul_f32 v185, s41, v220
v_fma_f32 v224, v224, s41, v185
v_fma_f32 v225, v225, s41, v185
v_mfma_f32_16x16x32_bf16 v[200:203], v[192:195], a[80:83], v[200:203]
v_exp_f32 v224, v224
v_mov_b32 v221, v220
v_mov_b32 v222, v220
v_mov_b32 v223, v220
v_mfma_f32_16x16x32_bf16 v[200:203], v[196:199], a[84:87], v[200:203]
ds_read_b128 a[140:143], v237 offset:17408
v_fma_f32 v226, v226, s41, v185
v_fma_f32 v227, v227, s41, v185
v_mfma_f32_16x16x32_bf16 v[200:203], a[152:155], a[88:91], v[200:203]
v_exp_f32 v225, v225
v_mfma_f32_16x16x32_bf16 v[200:203], a[156:159], a[92:95], v[200:203]
ds_read_b128 a[144:147], v236 offset:18432
v_exp_f32 v226, v226
v_mfma_f32_16x16x32_bf16 v[208:211], a[252:255], v[20:23], v[208:211]
v_mfma_f32_16x16x32_bf16 v[204:207], a[156:159], a[124:127], v[220:223]
ds_read_b128 a[148:151], v237 offset:18432
v_exp_f32 v227, v227
v_mfma_f32_16x16x32_bf16 v[204:207], a[152:155], a[120:123], v[204:207]
ds_read_b128 a[156:159], v237 offset:19456
v_cvt_pk_bf16_f32 v144, v224, v225
v_mfma_f32_16x16x32_bf16 v[204:207], v[196:199], a[116:119], v[204:207]
ds_read_b128 a[152:155], v236 offset:19456
v_cvt_pk_bf16_f32 v145, v226, v227
v_mfma_f32_16x16x32_bf16 v[204:207], v[192:195], a[112:115], v[204:207]
v_mul_f32 v200, s41, v200
v_mul_f32 v201, s41, v201
v_mfma_f32_16x16x32_bf16 v[204:207], a[172:175], a[108:111], v[204:207]
v_exp_f32 v200, v200
v_mfma_f32_16x16x32_bf16 v[204:207], a[168:171], a[104:107], v[204:207]
v_mul_f32 v202, s41, v202
v_mul_f32 v203, s41, v203
v_mfma_f32_16x16x32_bf16 v[204:207], a[164:167], a[100:103], v[204:207]
v_exp_f32 v201, v201
v_mfma_f32_16x16x32_bf16 v[204:207], a[160:163], a[96:99], v[204:207]
s_waitcnt lgkmcnt(0)
v_exp_f32 v202, v202
v_mfma_f32_16x16x32_bf16 v[224:227], a[128:131], a[64:67], v[244:247]
s_barrier
v_exp_f32 v203, v203
v_mfma_f32_16x16x32_bf16 v[224:227], a[132:135], a[68:71], v[224:227]
ds_read_b128 a[160:163], v236 offset:24576
v_cvt_pk_bf16_f32 v98, v200, v201
v_mfma_f32_16x16x32_bf16 v[224:227], a[136:139], a[72:75], v[224:227]
ds_read_b128 a[164:167], v237 offset:24576
v_cvt_pk_bf16_f32 v99, v202, v203
v_mfma_f32_16x16x32_bf16 v[224:227], a[140:143], a[76:79], v[224:227]
ds_read_b128 a[168:171], v236 offset:25600
v_mul_f32 v204, s41, v204
v_mul_f32 v205, s41, v205
v_mfma_f32_16x16x32_bf16 v[224:227], a[144:147], a[80:83], v[224:227]
buffer_load_dwordx4 v239, s[16:19], s56 offen lds
v_exp_f32 v204, v204
v_mfma_f32_16x16x32_bf16 v[224:227], a[148:151], a[84:87], v[224:227]
ds_read_b128 a[172:175], v237 offset:25600
v_mul_f32 v206, s41, v206
v_mul_f32 v207, s41, v207
v_mfma_f32_16x16x32_bf16 v[224:227], a[152:155], a[88:91], v[224:227]
s_add_u32 m0, s75, s57
v_exp_f32 v205, v205
v_mfma_f32_16x16x32_bf16 v[224:227], a[156:159], a[92:95], v[224:227]
ds_read_b128 v[192:195], v236 offset:26624
buffer_load_dwordx4 v239, s[16:19], s57 offen lds
s_add_u32 m0, s75, s58
v_exp_f32 v206, v206
v_mfma_f32_16x16x32_bf16 v[210:213], a[252:255], v[68:71], v[210:213]
buffer_load_dwordx4 v239, s[16:19], s58 offen lds
v_mfma_f32_16x16x32_bf16 v[200:203], a[156:159], a[124:127], v[220:223]
ds_read_b128 v[196:199], v237 offset:26624
v_exp_f32 v207, v207
v_mfma_f32_16x16x32_bf16 v[200:203], a[152:155], a[120:123], v[200:203]
ds_read_b128 a[156:159], v237 offset:27648
v_cvt_pk_bf16_f32 v146, v204, v205
v_mfma_f32_16x16x32_bf16 v[200:203], a[148:151], a[116:119], v[200:203]
ds_read_b128 a[152:155], v236 offset:27648
v_cvt_pk_bf16_f32 v147, v206, v207
v_mfma_f32_16x16x32_bf16 v[200:203], a[144:147], a[112:115], v[200:203]
s_add_u32 m0, s75, s59
v_mul_f32 v224, s41, v224
v_mul_f32 v225, s41, v225
v_mfma_f32_16x16x32_bf16 v[200:203], a[140:143], a[108:111], v[200:203]
buffer_load_dwordx4 v239, s[16:19], s59 offen lds
v_exp_f32 v224, v224
v_mfma_f32_16x16x32_bf16 v[200:203], a[136:139], a[104:107], v[200:203]
s_add_u32 m0, s75, s60
v_mul_f32 v226, s41, v226
v_mul_f32 v227, s41, v227
v_mfma_f32_16x16x32_bf16 v[200:203], a[132:135], a[100:103], v[200:203]
buffer_load_dwordx4 v239, s[16:19], s60 offen lds
v_exp_f32 v225, v225
v_mfma_f32_16x16x32_bf16 v[200:203], a[128:131], a[96:99], v[200:203]
s_waitcnt lgkmcnt(0)
v_exp_f32 v226, v226
v_mfma_f32_16x16x32_bf16 v[204:207], a[160:163], a[64:67], v[244:247]
s_add_u32 m0, s75, s61
v_exp_f32 v227, v227
v_mfma_f32_16x16x32_bf16 v[204:207], a[164:167], a[68:71], v[204:207]
ds_read_b128 a[128:131], v236 offset:32768
v_cvt_pk_bf16_f32 v100, v224, v225
v_mfma_f32_16x16x32_bf16 v[204:207], a[168:171], a[72:75], v[204:207]
ds_read_b128 a[132:135], v237 offset:32768
v_cvt_pk_bf16_f32 v101, v226, v227
v_mfma_f32_16x16x32_bf16 v[204:207], a[172:175], a[76:79], v[204:207]
ds_read_b128 a[136:139], v236 offset:33792
v_mul_f32 v200, s41, v200
v_mul_f32 v201, s41, v201
v_mfma_f32_16x16x32_bf16 v[204:207], v[192:195], a[80:83], v[204:207]
buffer_load_dwordx4 v239, s[16:19], s61 offen lds
v_exp_f32 v200, v200
v_mfma_f32_16x16x32_bf16 v[204:207], v[196:199], a[84:87], v[204:207]
ds_read_b128 a[140:143], v237 offset:33792
v_mul_f32 v202, s41, v202
v_mul_f32 v203, s41, v203
v_mfma_f32_16x16x32_bf16 v[204:207], a[152:155], a[88:91], v[204:207]
s_add_u32 m0, s38, s56
v_exp_f32 v201, v201
v_mfma_f32_16x16x32_bf16 v[204:207], a[156:159], a[92:95], v[204:207]
ds_read_b128 a[144:147], v236 offset:34816
buffer_load_dwordx4 v239, s[92:95], s56 offen lds
s_add_u32 m0, s38, s57
v_exp_f32 v202, v202
v_mfma_f32_16x16x32_bf16 v[212:215], a[252:255], v[96:99], 0
buffer_load_dwordx4 v239, s[92:95], s57 offen lds
v_mfma_f32_16x16x32_bf16 v[224:227], a[156:159], a[124:127], v[220:223]
ds_read_b128 a[148:151], v237 offset:34816
v_exp_f32 v203, v203
v_mfma_f32_16x16x32_bf16 v[224:227], a[152:155], a[120:123], v[224:227]
ds_read_b128 a[156:159], v237 offset:35840
v_cvt_pk_bf16_f32 v148, v200, v201
v_mfma_f32_16x16x32_bf16 v[224:227], v[196:199], a[116:119], v[224:227]
ds_read_b128 a[152:155], v236 offset:35840
v_cvt_pk_bf16_f32 v149, v202, v203
v_mfma_f32_16x16x32_bf16 v[224:227], v[192:195], a[112:115], v[224:227]
s_add_u32 m0, s38, s58
v_mul_f32 v204, s41, v204
v_mul_f32 v205, s41, v205
v_mfma_f32_16x16x32_bf16 v[224:227], a[172:175], a[108:111], v[224:227]
buffer_load_dwordx4 v239, s[92:95], s58 offen lds
v_exp_f32 v204, v204
v_mfma_f32_16x16x32_bf16 v[224:227], a[168:171], a[104:107], v[224:227]
s_add_u32 m0, s38, s59
v_mul_f32 v206, s41, v206
v_mul_f32 v207, s41, v207
v_mfma_f32_16x16x32_bf16 v[224:227], a[164:167], a[100:103], v[224:227]
buffer_load_dwordx4 v239, s[92:95], s59 offen lds
v_exp_f32 v205, v205
v_mfma_f32_16x16x32_bf16 v[224:227], a[160:163], a[96:99], v[224:227]
s_waitcnt lgkmcnt(0)
v_exp_f32 v206, v206
v_mfma_f32_16x16x32_bf16 v[200:203], a[128:131], a[64:67], v[244:247]
s_add_u32 m0, s38, s60
v_exp_f32 v207, v207
v_mfma_f32_16x16x32_bf16 v[200:203], a[132:135], a[68:71], v[200:203]
ds_read_b128 a[160:163], v236 offset:40960
v_cvt_pk_bf16_f32 v102, v204, v205
v_mfma_f32_16x16x32_bf16 v[200:203], a[136:139], a[72:75], v[200:203]
ds_read_b128 a[164:167], v237 offset:40960
v_cvt_pk_bf16_f32 v103, v206, v207
v_mfma_f32_16x16x32_bf16 v[200:203], a[140:143], a[76:79], v[200:203]
ds_read_b128 a[168:171], v236 offset:41984
v_mul_f32 v224, s41, v224
v_mul_f32 v225, s41, v225
v_mfma_f32_16x16x32_bf16 v[200:203], a[144:147], a[80:83], v[200:203]
buffer_load_dwordx4 v239, s[92:95], s60 offen lds
v_exp_f32 v224, v224
v_mfma_f32_16x16x32_bf16 v[200:203], a[148:151], a[84:87], v[200:203]
ds_read_b128 a[172:175], v237 offset:41984
v_mul_f32 v226, s41, v226
v_mul_f32 v227, s41, v227
v_mfma_f32_16x16x32_bf16 v[200:203], a[152:155], a[88:91], v[200:203]
s_add_u32 m0, s38, s61
v_exp_f32 v225, v225
v_mfma_f32_16x16x32_bf16 v[200:203], a[156:159], a[92:95], v[200:203]
ds_read_b128 v[192:195], v236 offset:43008
v_exp_f32 v226, v226
v_mfma_f32_16x16x32_bf16 v[214:217], a[252:255], v[144:147], 0
buffer_load_dwordx4 v239, s[92:95], s61 offen lds
v_mfma_f32_16x16x32_bf16 v[204:207], a[156:159], a[124:127], v[220:223]
ds_read_b128 v[196:199], v237 offset:43008
v_exp_f32 v227, v227
v_mfma_f32_16x16x32_bf16 v[204:207], a[152:155], a[120:123], v[204:207]
ds_read_b128 a[156:159], v237 offset:44032
v_cvt_pk_bf16_f32 v150, v224, v225
v_mfma_f32_16x16x32_bf16 v[204:207], a[148:151], a[116:119], v[204:207]
ds_read_b128 a[152:155], v236 offset:44032
v_cvt_pk_bf16_f32 v151, v226, v227
v_mfma_f32_16x16x32_bf16 v[204:207], a[144:147], a[112:115], v[204:207]
s_add_u32 m0, s39, s56
v_mul_f32 v200, s41, v200
v_mul_f32 v201, s41, v201
v_mfma_f32_16x16x32_bf16 v[204:207], a[140:143], a[108:111], v[204:207]
v_exp_f32 v200, v200
v_mfma_f32_16x16x32_bf16 v[204:207], a[136:139], a[104:107], v[204:207]
v_mul_f32 v202, s41, v202
v_mul_f32 v203, s41, v203
v_mfma_f32_16x16x32_bf16 v[204:207], a[132:135], a[100:103], v[204:207]
v_exp_f32 v201, v201
v_mfma_f32_16x16x32_bf16 v[204:207], a[128:131], a[96:99], v[204:207]
s_waitcnt lgkmcnt(0)
v_exp_f32 v202, v202
v_mfma_f32_16x16x32_bf16 v[224:227], a[160:163], a[64:67], v[244:247]
s_barrier
v_exp_f32 v203, v203
v_mfma_f32_16x16x32_bf16 v[224:227], a[164:167], a[68:71], v[224:227]
ds_read_b128 a[128:131], v236 offset:49152
v_cvt_pk_bf16_f32 v104, v200, v201
v_mfma_f32_16x16x32_bf16 v[224:227], a[168:171], a[72:75], v[224:227]
ds_read_b128 a[132:135], v237 offset:49152
v_cvt_pk_bf16_f32 v105, v202, v203
v_mfma_f32_16x16x32_bf16 v[224:227], a[172:175], a[76:79], v[224:227]
ds_read_b128 a[136:139], v236 offset:50176
v_mul_f32 v204, s41, v204
v_mul_f32 v205, s41, v205
v_mfma_f32_16x16x32_bf16 v[224:227], v[192:195], a[80:83], v[224:227]
v_exp_f32 v204, v204
v_mfma_f32_16x16x32_bf16 v[224:227], v[196:199], a[84:87], v[224:227]
ds_read_b128 a[140:143], v237 offset:50176
v_mul_f32 v206, s41, v206
v_mul_f32 v207, s41, v207
v_mfma_f32_16x16x32_bf16 v[224:227], a[152:155], a[88:91], v[224:227]
v_exp_f32 v205, v205
v_mfma_f32_16x16x32_bf16 v[224:227], a[156:159], a[92:95], v[224:227]
ds_read_b128 a[144:147], v236 offset:51200
v_exp_f32 v206, v206
v_mfma_f32_16x16x32_bf16 v[212:215], a[252:255], v[100:103], v[212:215]
s_add_u32 s16, s16, 49152
s_addc_u32 s17, s17, 0
v_mfma_f32_16x16x32_bf16 v[200:203], a[156:159], a[124:127], v[220:223]
ds_read_b128 a[148:151], v237 offset:51200
v_exp_f32 v207, v207
v_mfma_f32_16x16x32_bf16 v[200:203], a[152:155], a[120:123], v[200:203]
ds_read_b128 a[156:159], v237 offset:52224
v_cvt_pk_bf16_f32 v152, v204, v205
v_mfma_f32_16x16x32_bf16 v[200:203], v[196:199], a[116:119], v[200:203]
ds_read_b128 a[152:155], v236 offset:52224
v_cvt_pk_bf16_f32 v153, v206, v207
v_mfma_f32_16x16x32_bf16 v[200:203], v[192:195], a[112:115], v[200:203]
v_mul_f32 v224, s41, v224
v_mul_f32 v225, s41, v225
v_mfma_f32_16x16x32_bf16 v[200:203], a[172:175], a[108:111], v[200:203]
v_exp_f32 v224, v224
v_mfma_f32_16x16x32_bf16 v[200:203], a[168:171], a[104:107], v[200:203]
v_mul_f32 v226, s41, v226
v_mul_f32 v227, s41, v227
v_mfma_f32_16x16x32_bf16 v[200:203], a[164:167], a[100:103], v[200:203]
v_exp_f32 v225, v225
v_mfma_f32_16x16x32_bf16 v[200:203], a[160:163], a[96:99], v[200:203]
s_waitcnt lgkmcnt(0)
v_exp_f32 v226, v226
v_mfma_f32_16x16x32_bf16 v[204:207], a[128:131], a[64:67], v[244:247]
v_exp_f32 v227, v227
v_mfma_f32_16x16x32_bf16 v[204:207], a[132:135], a[68:71], v[204:207]
ds_read_b128 a[160:163], v236 offset:57344
v_cvt_pk_bf16_f32 v106, v224, v225
v_mfma_f32_16x16x32_bf16 v[204:207], a[136:139], a[72:75], v[204:207]
ds_read_b128 a[164:167], v237 offset:57344
v_cvt_pk_bf16_f32 v107, v226, v227
v_mfma_f32_16x16x32_bf16 v[204:207], a[140:143], a[76:79], v[204:207]
ds_read_b128 a[168:171], v236 offset:58368
v_mul_f32 v200, s41, v200
v_mul_f32 v201, s41, v201
v_mfma_f32_16x16x32_bf16 v[204:207], a[144:147], a[80:83], v[204:207]
v_exp_f32 v200, v200
v_mfma_f32_16x16x32_bf16 v[204:207], a[148:151], a[84:87], v[204:207]
ds_read_b128 a[172:175], v237 offset:58368
v_mul_f32 v202, s41, v202
v_mul_f32 v203, s41, v203
v_mfma_f32_16x16x32_bf16 v[204:207], a[152:155], a[88:91], v[204:207]
v_exp_f32 v201, v201
v_mfma_f32_16x16x32_bf16 v[204:207], a[156:159], a[92:95], v[204:207]
ds_read_b128 v[192:195], v236 offset:59392
v_exp_f32 v202, v202
v_mfma_f32_16x16x32_bf16 v[214:217], a[252:255], v[148:151], v[214:217]
s_add_u32 s92, s92, 49152
s_addc_u32 s93, s93, 0
v_mfma_f32_16x16x32_bf16 v[224:227], a[156:159], a[124:127], v[220:223]
ds_read_b128 v[196:199], v237 offset:59392
v_exp_f32 v203, v203
v_mfma_f32_16x16x32_bf16 v[224:227], a[152:155], a[120:123], v[224:227]
ds_read_b128 a[156:159], v237 offset:60416
v_cvt_pk_bf16_f32 v154, v200, v201
v_mfma_f32_16x16x32_bf16 v[224:227], a[148:151], a[116:119], v[224:227]
ds_read_b128 a[152:155], v236 offset:60416
v_cvt_pk_bf16_f32 v155, v202, v203
v_mfma_f32_16x16x32_bf16 v[224:227], a[144:147], a[112:115], v[224:227]
v_mul_f32 v204, s41, v204
v_mul_f32 v205, s41, v205
v_mfma_f32_16x16x32_bf16 v[224:227], a[140:143], a[108:111], v[224:227]
v_exp_f32 v204, v204
v_mfma_f32_16x16x32_bf16 v[224:227], a[136:139], a[104:107], v[224:227]
v_mul_f32 v206, s41, v206
v_mul_f32 v207, s41, v207
v_mfma_f32_16x16x32_bf16 v[224:227], a[132:135], a[100:103], v[224:227]
v_exp_f32 v205, v205
v_mfma_f32_16x16x32_bf16 v[224:227], a[128:131], a[96:99], v[224:227]
s_waitcnt lgkmcnt(0)
v_exp_f32 v206, v206
v_mfma_f32_16x16x32_bf16 v[200:203], a[160:163], a[64:67], v[244:247]
v_exp_f32 v207, v207
v_mfma_f32_16x16x32_bf16 v[200:203], a[164:167], a[68:71], v[200:203]
ds_read_b128 a[128:131], v249 offset:8192
v_cvt_pk_bf16_f32 v108, v204, v205
v_mfma_f32_16x16x32_bf16 v[200:203], a[168:171], a[72:75], v[200:203]
ds_read_b128 a[132:135], v250 offset:8192
v_cvt_pk_bf16_f32 v109, v206, v207
v_mfma_f32_16x16x32_bf16 v[200:203], a[172:175], a[76:79], v[200:203]
ds_read_b128 a[136:139], v249 offset:9216
v_mul_f32 v224, s41, v224
v_mul_f32 v225, s41, v225
v_mfma_f32_16x16x32_bf16 v[200:203], v[192:195], a[80:83], v[200:203]
v_exp_f32 v224, v224
v_mfma_f32_16x16x32_bf16 v[200:203], v[196:199], a[84:87], v[200:203]
ds_read_b128 a[140:143], v250 offset:9216
v_mul_f32 v226, s41, v226
v_mul_f32 v227, s41, v227
v_mfma_f32_16x16x32_bf16 v[200:203], a[152:155], a[88:91], v[200:203]
v_exp_f32 v225, v225
v_mfma_f32_16x16x32_bf16 v[200:203], a[156:159], a[92:95], v[200:203]
ds_read_b128 a[144:147], v249 offset:10240
v_exp_f32 v226, v226
v_mfma_f32_16x16x32_bf16 v[212:215], a[252:255], v[104:107], v[212:215]
v_mfma_f32_16x16x32_bf16 v[204:207], a[156:159], a[124:127], v[220:223]
ds_read_b128 a[148:151], v250 offset:10240
v_exp_f32 v227, v227
v_mfma_f32_16x16x32_bf16 v[204:207], a[152:155], a[120:123], v[204:207]
ds_read_b128 a[156:159], v250 offset:11264
v_cvt_pk_bf16_f32 v156, v224, v225
v_mfma_f32_16x16x32_bf16 v[204:207], v[196:199], a[116:119], v[204:207]
ds_read_b128 a[152:155], v249 offset:11264
v_cvt_pk_bf16_f32 v157, v226, v227
v_mfma_f32_16x16x32_bf16 v[204:207], v[192:195], a[112:115], v[204:207]
v_mul_f32 v200, s41, v200
v_mul_f32 v201, s41, v201
v_mfma_f32_16x16x32_bf16 v[204:207], a[172:175], a[108:111], v[204:207]
v_exp_f32 v200, v200
v_mfma_f32_16x16x32_bf16 v[204:207], a[168:171], a[104:107], v[204:207]
v_mul_f32 v202, s41, v202
v_mul_f32 v203, s41, v203
v_mfma_f32_16x16x32_bf16 v[204:207], a[164:167], a[100:103], v[204:207]
v_exp_f32 v201, v201
v_mfma_f32_16x16x32_bf16 v[204:207], a[160:163], a[96:99], v[204:207]
s_waitcnt lgkmcnt(0)
v_exp_f32 v202, v202
v_mfma_f32_16x16x32_bf16 v[224:227], a[128:131], a[64:67], v[244:247]
v_exp_f32 v203, v203
v_mfma_f32_16x16x32_bf16 v[224:227], a[132:135], a[68:71], v[224:227]
ds_read_b128 a[160:163], v249 offset:16384
v_cvt_pk_bf16_f32 v110, v200, v201
v_mfma_f32_16x16x32_bf16 v[224:227], a[136:139], a[72:75], v[224:227]
ds_read_b128 a[164:167], v250 offset:16384
v_cvt_pk_bf16_f32 v111, v202, v203
v_mfma_f32_16x16x32_bf16 v[224:227], a[140:143], a[76:79], v[224:227]
ds_read_b128 a[168:171], v249 offset:17408
v_mul_f32 v204, s41, v204
v_mul_f32 v205, s41, v205
v_mfma_f32_16x16x32_bf16 v[224:227], a[144:147], a[80:83], v[224:227]
v_exp_f32 v204, v204
v_mfma_f32_16x16x32_bf16 v[224:227], a[148:151], a[84:87], v[224:227]
ds_read_b128 a[172:175], v250 offset:17408
v_mul_f32 v206, s41, v206
v_mul_f32 v207, s41, v207
v_mfma_f32_16x16x32_bf16 v[224:227], a[152:155], a[88:91], v[224:227]
v_exp_f32 v205, v205
v_mfma_f32_16x16x32_bf16 v[224:227], a[156:159], a[92:95], v[224:227]
ds_read_b128 v[192:195], v249 offset:18432
v_exp_f32 v206, v206
v_mfma_f32_16x16x32_bf16 v[214:217], a[252:255], v[152:155], v[214:217]
v_mfma_f32_16x16x32_bf16 v[200:203], a[156:159], a[124:127], v[220:223]
ds_read_b128 v[196:199], v250 offset:18432
v_exp_f32 v207, v207
v_mfma_f32_16x16x32_bf16 v[200:203], a[152:155], a[120:123], v[200:203]
ds_read_b128 a[156:159], v250 offset:19456
v_cvt_pk_bf16_f32 v158, v204, v205
v_mfma_f32_16x16x32_bf16 v[200:203], a[148:151], a[116:119], v[200:203]
ds_read_b128 a[152:155], v249 offset:19456
v_cvt_pk_bf16_f32 v159, v206, v207
v_mfma_f32_16x16x32_bf16 v[200:203], a[144:147], a[112:115], v[200:203]
v_mul_f32 v224, s41, v224
v_mul_f32 v225, s41, v225
v_mfma_f32_16x16x32_bf16 v[200:203], a[140:143], a[108:111], v[200:203]
v_exp_f32 v224, v224
v_mfma_f32_16x16x32_bf16 v[200:203], a[136:139], a[104:107], v[200:203]
v_mul_f32 v226, s41, v226
v_mul_f32 v227, s41, v227
v_mfma_f32_16x16x32_bf16 v[200:203], a[132:135], a[100:103], v[200:203]
v_exp_f32 v225, v225
v_mfma_f32_16x16x32_bf16 v[200:203], a[128:131], a[96:99], v[200:203]
s_waitcnt lgkmcnt(0)
v_exp_f32 v226, v226
v_mfma_f32_16x16x32_bf16 v[204:207], a[160:163], a[64:67], v[244:247]
v_exp_f32 v227, v227
v_mfma_f32_16x16x32_bf16 v[204:207], a[164:167], a[68:71], v[204:207]
ds_read_b128 a[128:131], v249 offset:24576
v_cvt_pk_bf16_f32 v112, v224, v225
v_mfma_f32_16x16x32_bf16 v[204:207], a[168:171], a[72:75], v[204:207]
ds_read_b128 a[132:135], v250 offset:24576
v_cvt_pk_bf16_f32 v113, v226, v227
v_mfma_f32_16x16x32_bf16 v[204:207], a[172:175], a[76:79], v[204:207]
ds_read_b128 a[136:139], v249 offset:25600
v_mul_f32 v200, s41, v200
v_mul_f32 v201, s41, v201
v_mfma_f32_16x16x32_bf16 v[204:207], v[192:195], a[80:83], v[204:207]
v_exp_f32 v200, v200
v_mfma_f32_16x16x32_bf16 v[204:207], v[196:199], a[84:87], v[204:207]
ds_read_b128 a[140:143], v250 offset:25600
v_mul_f32 v202, s41, v202
v_mul_f32 v203, s41, v203
v_mfma_f32_16x16x32_bf16 v[204:207], a[152:155], a[88:91], v[204:207]
v_exp_f32 v201, v201
v_mfma_f32_16x16x32_bf16 v[204:207], a[156:159], a[92:95], v[204:207]
ds_read_b128 a[144:147], v249 offset:26624
v_exp_f32 v202, v202
v_mfma_f32_16x16x32_bf16 v[212:215], a[252:255], v[108:111], v[212:215]
v_mfma_f32_16x16x32_bf16 v[224:227], a[156:159], a[124:127], v[220:223]
ds_read_b128 a[148:151], v250 offset:26624
v_exp_f32 v203, v203
v_mfma_f32_16x16x32_bf16 v[224:227], a[152:155], a[120:123], v[224:227]
ds_read_b128 a[156:159], v250 offset:27648
v_cvt_pk_bf16_f32 v160, v200, v201
v_mfma_f32_16x16x32_bf16 v[224:227], v[196:199], a[116:119], v[224:227]
ds_read_b128 a[152:155], v249 offset:27648
v_cvt_pk_bf16_f32 v161, v202, v203
v_mfma_f32_16x16x32_bf16 v[224:227], v[192:195], a[112:115], v[224:227]
v_mul_f32 v204, s41, v204
v_mul_f32 v205, s41, v205
v_mfma_f32_16x16x32_bf16 v[224:227], a[172:175], a[108:111], v[224:227]
v_exp_f32 v204, v204
v_mfma_f32_16x16x32_bf16 v[224:227], a[168:171], a[104:107], v[224:227]
v_mul_f32 v206, s41, v206
v_mul_f32 v207, s41, v207
v_mfma_f32_16x16x32_bf16 v[224:227], a[164:167], a[100:103], v[224:227]
v_exp_f32 v205, v205
v_mfma_f32_16x16x32_bf16 v[224:227], a[160:163], a[96:99], v[224:227]
s_waitcnt lgkmcnt(0)
v_exp_f32 v206, v206
v_mfma_f32_16x16x32_bf16 v[200:203], a[128:131], a[64:67], v[244:247]
v_exp_f32 v207, v207
v_mfma_f32_16x16x32_bf16 v[200:203], a[132:135], a[68:71], v[200:203]
ds_read_b128 a[160:163], v249 offset:32768
v_cvt_pk_bf16_f32 v114, v204, v205
v_mfma_f32_16x16x32_bf16 v[200:203], a[136:139], a[72:75], v[200:203]
ds_read_b128 a[164:167], v250 offset:32768
v_cvt_pk_bf16_f32 v115, v206, v207
v_mfma_f32_16x16x32_bf16 v[200:203], a[140:143], a[76:79], v[200:203]
ds_read_b128 a[168:171], v249 offset:33792
v_mul_f32 v224, s41, v224
v_mul_f32 v225, s41, v225
v_mfma_f32_16x16x32_bf16 v[200:203], a[144:147], a[80:83], v[200:203]
v_exp_f32 v224, v224
v_mfma_f32_16x16x32_bf16 v[200:203], a[148:151], a[84:87], v[200:203]
ds_read_b128 a[172:175], v250 offset:33792
v_mul_f32 v226, s41, v226
v_mul_f32 v227, s41, v227
v_mfma_f32_16x16x32_bf16 v[200:203], a[152:155], a[88:91], v[200:203]
v_exp_f32 v225, v225
v_mfma_f32_16x16x32_bf16 v[200:203], a[156:159], a[92:95], v[200:203]
ds_read_b128 v[192:195], v249 offset:34816
v_exp_f32 v226, v226
v_mfma_f32_16x16x32_bf16 v[214:217], a[252:255], v[156:159], v[214:217]
v_mfma_f32_16x16x32_bf16 v[204:207], a[156:159], a[124:127], v[220:223]
ds_read_b128 v[196:199], v250 offset:34816
v_exp_f32 v227, v227
v_mfma_f32_16x16x32_bf16 v[204:207], a[152:155], a[120:123], v[204:207]
ds_read_b128 a[156:159], v250 offset:35840
v_cvt_pk_bf16_f32 v162, v224, v225
v_mfma_f32_16x16x32_bf16 v[204:207], a[148:151], a[116:119], v[204:207]
ds_read_b128 a[152:155], v249 offset:35840
v_cvt_pk_bf16_f32 v163, v226, v227
v_mfma_f32_16x16x32_bf16 v[204:207], a[144:147], a[112:115], v[204:207]
v_mul_f32 v200, s41, v200
v_mul_f32 v201, s41, v201
v_mfma_f32_16x16x32_bf16 v[204:207], a[140:143], a[108:111], v[204:207]
v_exp_f32 v200, v200
v_mfma_f32_16x16x32_bf16 v[204:207], a[136:139], a[104:107], v[204:207]
v_mul_f32 v202, s41, v202
v_mul_f32 v203, s41, v203
v_mfma_f32_16x16x32_bf16 v[204:207], a[132:135], a[100:103], v[204:207]
v_exp_f32 v201, v201
v_mfma_f32_16x16x32_bf16 v[204:207], a[128:131], a[96:99], v[204:207]
s_waitcnt vmcnt(0) lgkmcnt(0)
v_exp_f32 v202, v202
v_mfma_f32_16x16x32_bf16 v[224:227], a[160:163], a[64:67], v[244:247]
s_barrier
v_exp_f32 v203, v203
v_mfma_f32_16x16x32_bf16 v[224:227], a[164:167], a[68:71], v[224:227]
ds_read_b128 a[128:131], v249 offset:40960
v_cvt_pk_bf16_f32 v116, v200, v201
v_mfma_f32_16x16x32_bf16 v[224:227], a[168:171], a[72:75], v[224:227]
ds_read_b128 a[132:135], v250 offset:40960
v_cvt_pk_bf16_f32 v117, v202, v203
v_mfma_f32_16x16x32_bf16 v[224:227], a[172:175], a[76:79], v[224:227]
ds_read_b128 a[136:139], v249 offset:41984
v_mul_f32 v204, s41, v204
v_mul_f32 v205, s41, v205
v_mfma_f32_16x16x32_bf16 v[224:227], v[192:195], a[80:83], v[224:227]
buffer_load_dwordx4 v239, s[16:19], s56 offen lds
v_exp_f32 v204, v204
v_mfma_f32_16x16x32_bf16 v[224:227], v[196:199], a[84:87], v[224:227]
ds_read_b128 a[140:143], v250 offset:41984
v_mul_f32 v206, s41, v206
v_mul_f32 v207, s41, v207
v_mfma_f32_16x16x32_bf16 v[224:227], a[152:155], a[88:91], v[224:227]
s_add_u32 m0, s39, s57
v_exp_f32 v205, v205
v_mfma_f32_16x16x32_bf16 v[224:227], a[156:159], a[92:95], v[224:227]
ds_read_b128 a[144:147], v249 offset:43008
v_exp_f32 v206, v206
v_mfma_f32_16x16x32_bf16 v[212:215], a[252:255], v[112:115], v[212:215]
buffer_load_dwordx4 v239, s[16:19], s57 offen lds
v_mfma_f32_16x16x32_bf16 v[200:203], a[156:159], a[124:127], v[220:223]
ds_read_b128 a[148:151], v250 offset:43008
v_exp_f32 v207, v207
v_mfma_f32_16x16x32_bf16 v[200:203], a[152:155], a[120:123], v[200:203]
ds_read_b128 a[156:159], v250 offset:44032
v_cvt_pk_bf16_f32 v164, v204, v205
v_mfma_f32_16x16x32_bf16 v[200:203], v[196:199], a[116:119], v[200:203]
ds_read_b128 a[152:155], v249 offset:44032
v_cvt_pk_bf16_f32 v165, v206, v207
v_mfma_f32_16x16x32_bf16 v[200:203], v[192:195], a[112:115], v[200:203]
s_add_u32 m0, s46, 16384
v_mul_f32 v224, s41, v224
v_mul_f32 v225, s41, v225
v_mfma_f32_16x16x32_bf16 v[200:203], a[172:175], a[108:111], v[200:203]
buffer_load_dwordx4 v239, s[20:23], s48 offen offset:0 nt lds
v_exp_f32 v224, v224
v_mfma_f32_16x16x32_bf16 v[200:203], a[168:171], a[104:107], v[200:203]
s_add_u32 m0, s39, s58
v_mul_f32 v226, s41, v226
v_mul_f32 v227, s41, v227
v_mfma_f32_16x16x32_bf16 v[200:203], a[164:167], a[100:103], v[200:203]
s_add_u32 s74, s101, L_t0-L_pc0
v_exp_f32 v225, v225
v_mfma_f32_16x16x32_bf16 v[200:203], a[160:163], a[96:99], v[200:203]
s_waitcnt lgkmcnt(2)
v_exp_f32 v226, v226
v_mfma_f32_16x16x32_bf16 v[204:207], a[128:131], a[0:3], v[228:231]
s_getpc_b64 s[28:29]
L_pc0:
s_add_u32 s28, s28, s74
s_addc_u32 s29, s29, 0
v_exp_f32 v227, v227
v_mfma_f32_16x16x32_bf16 v[204:207], a[132:135], a[4:7], v[204:207]
ds_read_b128 a[160:163], v249 offset:49152
v_cvt_pk_bf16_f32 v118, v224, v225
v_mfma_f32_16x16x32_bf16 v[204:207], a[136:139], a[8:11], v[204:207]
ds_read_b128 a[164:167], v250 offset:49152
v_cvt_pk_bf16_f32 v119, v226, v227
v_mfma_f32_16x16x32_bf16 v[204:207], a[140:143], a[12:15], v[204:207]
global_load_dword v251, v239, s[28:29]
v_mul_f32 v200, s41, v200
v_mul_f32 v201, s41, v201
v_mfma_f32_16x16x32_bf16 v[204:207], a[144:147], a[16:19], v[204:207]
v_exp_f32 v200, v200
v_mfma_f32_16x16x32_bf16 v[204:207], a[148:151], a[20:23], v[204:207]
s_waitcnt lgkmcnt(2)
v_mul_f32 v202, s41, v202
v_mul_f32 v203, s41, v203
v_mfma_f32_16x16x32_bf16 v[204:207], a[152:155], a[24:27], v[204:207]
v_exp_f32 v201, v201
v_mfma_f32_16x16x32_bf16 v[204:207], a[156:159], a[28:31], v[204:207]
v_exp_f32 v202, v202
v_mfma_f32_16x16x32_bf16 v[214:217], a[252:255], v[160:163], v[214:217]
buffer_load_dwordx4 v239, s[16:19], s58 offen lds
v_mfma_f32_16x16x32_bf16 v[224:227], a[156:159], a[60:63], v[252:255]
s_add_u32 m0, s46, 20480
v_exp_f32 v203, v203
v_mfma_f32_16x16x32_bf16 v[224:227], a[152:155], a[56:59], v[224:227]
ds_read_b128 a[168:171], v249 offset:50176
v_cvt_pk_bf16_f32 v166, v200, v201
v_mfma_f32_16x16x32_bf16 v[224:227], a[148:151], a[52:55], v[224:227]
ds_read_b128 a[172:175], v250 offset:50176
v_cvt_pk_bf16_f32 v167, v202, v203
v_mfma_f32_16x16x32_bf16 v[224:227], a[144:147], a[48:51], v[224:227]
buffer_load_dwordx4 v239, s[20:23], s49 offen offset:0 nt lds
v_mul_f32 v204, s41, v204
v_mul_f32 v205, s41, v205
v_mfma_f32_16x16x32_bf16 v[224:227], a[140:143], a[44:47], v[224:227]
s_add_u32 m0, s39, s59
v_exp_f32 v204, v204
v_mfma_f32_16x16x32_bf16 v[224:227], a[136:139], a[40:43], v[224:227]
buffer_load_dwordx4 v239, s[16:19], s59 offen lds
v_mul_f32 v206, s41, v206
v_mul_f32 v207, s41, v207
v_mfma_f32_16x16x32_bf16 v[224:227], a[132:135], a[36:39], v[224:227]
s_add_u32 m0, s39, s60
v_exp_f32 v205, v205
v_mfma_f32_16x16x32_bf16 v[224:227], a[128:131], a[32:35], v[224:227]
v_exp_f32 v206, v206
v_mfma_f32_16x16x32_bf16 v[200:203], a[128:131], a[64:67], v[244:247]
v_exp_f32 v207, v207
v_mfma_f32_16x16x32_bf16 v[200:203], a[132:135], a[68:71], v[200:203]
ds_read_b128 v[192:195], v249 offset:51200
v_cvt_pk_bf16_f32 v24, v204, v205
v_mfma_f32_16x16x32_bf16 v[200:203], a[136:139], a[72:75], v[200:203]
ds_read_b128 v[196:199], v250 offset:51200
v_cvt_pk_bf16_f32 v25, v206, v207
v_mfma_f32_16x16x32_bf16 v[200:203], a[140:143], a[76:79], v[200:203]
v_mul_f32 v224, s41, v224
v_mul_f32 v225, s41, v225
v_mfma_f32_16x16x32_bf16 v[200:203], a[144:147], a[80:83], v[200:203]
v_exp_f32 v224, v224
v_mfma_f32_16x16x32_bf16 v[200:203], a[148:151], a[84:87], v[200:203]
v_mul_f32 v226, s41, v226
v_mul_f32 v227, s41, v227
v_mfma_f32_16x16x32_bf16 v[200:203], a[152:155], a[88:91], v[200:203]
v_exp_f32 v225, v225
v_mfma_f32_16x16x32_bf16 v[200:203], a[156:159], a[92:95], v[200:203]
v_exp_f32 v226, v226
v_mfma_f32_16x16x32_bf16 v[212:215], a[252:255], v[116:119], v[212:215]
buffer_load_dwordx4 v239, s[16:19], s60 offen lds
v_mfma_f32_16x16x32_bf16 v[204:207], a[156:159], a[124:127], v[220:223]
s_add_u32 m0, s39, s61
v_exp_f32 v227, v227
v_mfma_f32_16x16x32_bf16 v[204:207], a[152:155], a[120:123], v[204:207]
ds_read_b128 a[156:159], v250 offset:52224
v_cvt_pk_bf16_f32 v72, v224, v225
v_mfma_f32_16x16x32_bf16 v[204:207], a[148:151], a[116:119], v[204:207]
ds_read_b128 a[152:155], v249 offset:52224
v_cvt_pk_bf16_f32 v73, v226, v227
v_mfma_f32_16x16x32_bf16 v[204:207], a[144:147], a[112:115], v[204:207]
v_mul_f32 v200, s41, v200
v_mul_f32 v201, s41, v201
v_mfma_f32_16x16x32_bf16 v[204:207], a[140:143], a[108:111], v[204:207]
v_exp_f32 v200, v200
v_mfma_f32_16x16x32_bf16 v[204:207], a[136:139], a[104:107], v[204:207]
v_mul_f32 v202, s41, v202
v_mul_f32 v203, s41, v203
v_mfma_f32_16x16x32_bf16 v[204:207], a[132:135], a[100:103], v[204:207]
v_exp_f32 v201, v201
v_mfma_f32_16x16x32_bf16 v[204:207], a[128:131], a[96:99], v[204:207]
s_waitcnt lgkmcnt(2)
v_exp_f32 v202, v202
v_mfma_f32_16x16x32_bf16 v[224:227], a[160:163], a[0:3], v[228:231]
buffer_load_dwordx4 v239, s[16:19], s61 offen lds
v_exp_f32 v203, v203
v_mfma_f32_16x16x32_bf16 v[224:227], a[164:167], a[4:7], v[224:227]
ds_read_b128 a[128:131], v249 offset:57344
v_cvt_pk_bf16_f32 v120, v200, v201
v_mfma_f32_16x16x32_bf16 v[224:227], a[168:171], a[8:11], v[224:227]
ds_read_b128 a[132:135], v250 offset:57344
v_cvt_pk_bf16_f32 v121, v202, v203
v_mfma_f32_16x16x32_bf16 v[224:227], a[172:175], a[12:15], v[224:227]
s_add_u32 m0, s40, s56
v_mul_f32 v204, s41, v204
v_mul_f32 v205, s41, v205
v_mfma_f32_16x16x32_bf16 v[224:227], v[192:195], a[16:19], v[224:227]
s_mov_b32 s18, 85632
v_exp_f32 v204, v204
v_mfma_f32_16x16x32_bf16 v[224:227], v[196:199], a[20:23], v[224:227]
s_waitcnt lgkmcnt(2)
v_mul_f32 v206, s41, v206
v_mul_f32 v207, s41, v207
v_mfma_f32_16x16x32_bf16 v[224:227], a[152:155], a[24:27], v[224:227]
s_add_u32 s16, s72, s35
s_addc_u32 s17, s73, 0
v_exp_f32 v205, v205
v_mfma_f32_16x16x32_bf16 v[224:227], a[156:159], a[28:31], v[224:227]
v_exp_f32 v206, v206
v_mfma_f32_16x16x32_bf16 v[214:217], a[252:255], v[164:167], v[214:217]
buffer_load_dwordx4 v239, s[92:95], s56 offen lds
v_mfma_f32_16x16x32_bf16 v[200:203], a[156:159], a[60:63], v[252:255]
s_add_u32 m0, s46, 24448
v_exp_f32 v207, v207
v_mfma_f32_16x16x32_bf16 v[200:203], a[152:155], a[56:59], v[200:203]
ds_read_b128 a[136:139], v249 offset:58368
v_cvt_pk_bf16_f32 v168, v204, v205
v_mfma_f32_16x16x32_bf16 v[200:203], v[196:199], a[52:55], v[200:203]
ds_read_b128 a[140:143], v250 offset:58368
v_cvt_pk_bf16_f32 v169, v206, v207
v_mfma_f32_16x16x32_bf16 v[200:203], v[192:195], a[48:51], v[200:203]
v_mul_f32 v224, s41, v224
v_mul_f32 v225, s41, v225
v_mfma_f32_16x16x32_bf16 v[200:203], a[172:175], a[44:47], v[200:203]
v_exp_f32 v224, v224
v_mfma_f32_16x16x32_bf16 v[200:203], a[168:171], a[40:43], v[200:203]
v_mul_f32 v226, s41, v226
v_mul_f32 v227, s41, v227
v_mfma_f32_16x16x32_bf16 v[200:203], a[164:167], a[36:39], v[200:203]
v_exp_f32 v225, v225
v_mfma_f32_16x16x32_bf16 v[200:203], a[160:163], a[32:35], v[200:203]
v_exp_f32 v226, v226
v_mfma_f32_16x16x32_bf16 v[204:207], a[160:163], a[64:67], v[244:247]
v_exp_f32 v227, v227
v_mfma_f32_16x16x32_bf16 v[204:207], a[164:167], a[68:71], v[204:207]
ds_read_b128 a[144:147], v249 offset:59392
v_cvt_pk_bf16_f32 v26, v224, v225
v_mfma_f32_16x16x32_bf16 v[204:207], a[168:171], a[72:75], v[204:207]
ds_read_b128 a[148:151], v250 offset:59392
v_cvt_pk_bf16_f32 v27, v226, v227
v_mfma_f32_16x16x32_bf16 v[204:207], a[172:175], a[76:79], v[204:207]
v_mul_f32 v200, s41, v200
v_mul_f32 v201, s41, v201
v_mfma_f32_16x16x32_bf16 v[204:207], v[192:195], a[80:83], v[204:207]
buffer_load_dwordx4 v239, s[20:23], s48 offen offset:128 nt lds
v_exp_f32 v200, v200
v_mfma_f32_16x16x32_bf16 v[204:207], v[196:199], a[84:87], v[204:207]
s_add_u32 m0, s40, s57
v_mul_f32 v202, s41, v202
v_mul_f32 v203, s41, v203
v_mfma_f32_16x16x32_bf16 v[204:207], a[152:155], a[88:91], v[204:207]
v_exp_f32 v201, v201
v_mfma_f32_16x16x32_bf16 v[204:207], a[156:159], a[92:95], v[204:207]
v_exp_f32 v202, v202
v_mfma_f32_16x16x32_bf16 v[208:211], a[252:255], v[24:27], v[208:211]
buffer_load_dwordx4 v239, s[92:95], s57 offen lds
v_mfma_f32_16x16x32_bf16 v[224:227], a[156:159], a[124:127], v[220:223]
s_add_u32 m0, s40, s58
v_exp_f32 v203, v203
v_mfma_f32_16x16x32_bf16 v[224:227], a[152:155], a[120:123], v[224:227]
ds_read_b128 a[156:159], v250 offset:60416
v_cvt_pk_bf16_f32 v74, v200, v201
v_mfma_f32_16x16x32_bf16 v[224:227], v[196:199], a[116:119], v[224:227]
ds_read_b128 a[152:155], v249 offset:60416
v_cvt_pk_bf16_f32 v75, v202, v203
v_mfma_f32_16x16x32_bf16 v[224:227], v[192:195], a[112:115], v[224:227]
buffer_load_dwordx4 v239, s[92:95], s58 offen lds
v_mul_f32 v204, s41, v204
v_mul_f32 v205, s41, v205
v_mfma_f32_16x16x32_bf16 v[224:227], a[172:175], a[108:111], v[224:227]
s_add_u32 m0, s46, 28544
v_exp_f32 v204, v204
v_mfma_f32_16x16x32_bf16 v[224:227], a[168:171], a[104:107], v[224:227]
v_mul_f32 v206, s41, v206
v_mul_f32 v207, s41, v207
v_mfma_f32_16x16x32_bf16 v[224:227], a[164:167], a[100:103], v[224:227]
v_exp_f32 v205, v205
v_mfma_f32_16x16x32_bf16 v[224:227], a[160:163], a[96:99], v[224:227]
s_waitcnt lgkmcnt(2)
v_exp_f32 v206, v206
v_mfma_f32_16x16x32_bf16 v[200:203], a[128:131], a[0:3], v[228:231]
v_exp_f32 v207, v207
v_mfma_f32_16x16x32_bf16 v[200:203], a[132:135], a[4:7], v[200:203]
ds_read_b128 a[160:163], v236 offset:0
v_cvt_pk_bf16_f32 v122, v204, v205
v_mfma_f32_16x16x32_bf16 v[200:203], a[136:139], a[8:11], v[200:203]
ds_read_b128 a[164:167], v237 offset:0
v_cvt_pk_bf16_f32 v123, v206, v207
v_mfma_f32_16x16x32_bf16 v[200:203], a[140:143], a[12:15], v[200:203]
buffer_load_dwordx4 v239, s[20:23], s49 offen offset:128 nt lds
v_mul_f32 v224, s41, v224
v_mul_f32 v225, s41, v225
v_mfma_f32_16x16x32_bf16 v[200:203], a[144:147], a[16:19], v[200:203]
s_add_u32 m0, s40, s59
v_exp_f32 v224, v224
v_mfma_f32_16x16x32_bf16 v[200:203], a[148:151], a[20:23], v[200:203]
s_waitcnt lgkmcnt(2)
v_mul_f32 v226, s41, v226
v_mul_f32 v227, s41, v227
v_mfma_f32_16x16x32_bf16 v[200:203], a[152:155], a[24:27], v[200:203]
v_exp_f32 v225, v225
v_mfma_f32_16x16x32_bf16 v[200:203], a[156:159], a[28:31], v[200:203]
v_exp_f32 v226, v226
v_mfma_f32_16x16x32_bf16 v[210:213], a[252:255], v[72:75], v[210:213]
buffer_load_dwordx4 v239, s[92:95], s59 offen lds
v_mfma_f32_16x16x32_bf16 v[204:207], a[156:159], a[60:63], v[252:255]
s_add_u32 m0, s40, s60
v_exp_f32 v227, v227
v_mfma_f32_16x16x32_bf16 v[204:207], a[152:155], a[56:59], v[204:207]
ds_read_b128 a[168:171], v236 offset:1024
v_cvt_pk_bf16_f32 v170, v224, v225
v_mfma_f32_16x16x32_bf16 v[204:207], a[148:151], a[52:55], v[204:207]
ds_read_b128 a[172:175], v237 offset:1024
v_cvt_pk_bf16_f32 v171, v226, v227
v_mfma_f32_16x16x32_bf16 v[204:207], a[144:147], a[48:51], v[204:207]
v_mul_f32 v200, s41, v200
v_mul_f32 v201, s41, v201
v_mfma_f32_16x16x32_bf16 v[204:207], a[140:143], a[44:47], v[204:207]
v_exp_f32 v200, v200
v_mfma_f32_16x16x32_bf16 v[204:207], a[136:139], a[40:43], v[204:207]
v_mul_f32 v202, s41, v202
v_mul_f32 v203, s41, v203
v_mfma_f32_16x16x32_bf16 v[204:207], a[132:135], a[36:39], v[204:207]
buffer_load_dwordx4 v239, s[92:95], s60 offen lds
v_exp_f32 v201, v201
v_mfma_f32_16x16x32_bf16 v[204:207], a[128:131], a[32:35], v[204:207]
s_add_u32 m0, s40, s61
v_exp_f32 v202, v202
v_mfma_f32_16x16x32_bf16 v[224:227], a[128:131], a[64:67], v[244:247]
v_exp_f32 v203, v203
v_mfma_f32_16x16x32_bf16 v[224:227], a[132:135], a[68:71], v[224:227]
ds_read_b128 v[192:195], v236 offset:2048
v_cvt_pk_bf16_f32 v28, v200, v201
v_mfma_f32_16x16x32_bf16 v[224:227], a[136:139], a[72:75], v[224:227]
ds_read_b128 v[196:199], v237 offset:2048
v_cvt_pk_bf16_f32 v29, v202, v203
v_mfma_f32_16x16x32_bf16 v[224:227], a[140:143], a[76:79], v[224:227]
v_mul_f32 v204, s41, v204
v_mul_f32 v205, s41, v205
v_mfma_f32_16x16x32_bf16 v[224:227], a[144:147], a[80:83], v[224:227]
v_exp_f32 v204, v204
v_mfma_f32_16x16x32_bf16 v[224:227], a[148:151], a[84:87], v[224:227]
v_mul_f32 v206, s41, v206
v_mul_f32 v207, s41, v207
v_mfma_f32_16x16x32_bf16 v[224:227], a[152:155], a[88:91], v[224:227]
v_exp_f32 v205, v205
v_mfma_f32_16x16x32_bf16 v[224:227], a[156:159], a[92:95], v[224:227]
v_exp_f32 v206, v206
v_mfma_f32_16x16x32_bf16 v[212:215], a[252:255], v[120:123], v[212:215]
buffer_load_dwordx4 v239, s[92:95], s61 offen lds
v_mfma_f32_16x16x32_bf16 v[200:203], a[156:159], a[124:127], v[220:223]
s_add_u32 m0, s69, s56
v_exp_f32 v207, v207
v_mfma_f32_16x16x32_bf16 v[200:203], a[152:155], a[120:123], v[200:203]
ds_read_b128 a[156:159], v237 offset:3072
v_cvt_pk_bf16_f32 v76, v204, v205
v_mfma_f32_16x16x32_bf16 v[200:203], a[148:151], a[116:119], v[200:203]
ds_read_b128 a[152:155], v236 offset:3072
v_cvt_pk_bf16_f32 v77, v206, v207
v_mfma_f32_16x16x32_bf16 v[200:203], a[144:147], a[112:115], v[200:203]
s_mov_b32 s94, 85632
v_mul_f32 v224, s41, v224
v_mul_f32 v225, s41, v225
v_mfma_f32_16x16x32_bf16 v[200:203], a[140:143], a[108:111], v[200:203]
s_add_u32 s68, s35, 98304
v_exp_f32 v224, v224
v_mfma_f32_16x16x32_bf16 v[200:203], a[136:139], a[104:107], v[200:203]
s_add_u32 s92, s72, s68
s_addc_u32 s93, s73, 0
v_mul_f32 v226, s41, v226
v_mul_f32 v227, s41, v227
v_mfma_f32_16x16x32_bf16 v[200:203], a[132:135], a[100:103], v[200:203]
v_exp_f32 v225, v225
v_mfma_f32_16x16x32_bf16 v[200:203], a[128:131], a[96:99], v[200:203]
s_waitcnt lgkmcnt(2)
v_exp_f32 v226, v226
v_mfma_f32_16x16x32_bf16 v[204:207], a[160:163], a[0:3], v[228:231]
v_exp_f32 v227, v227
v_mfma_f32_16x16x32_bf16 v[204:207], a[164:167], a[4:7], v[204:207]
ds_read_b128 a[128:131], v236 offset:8192
v_cvt_pk_bf16_f32 v124, v224, v225
v_mfma_f32_16x16x32_bf16 v[204:207], a[168:171], a[8:11], v[204:207]
ds_read_b128 a[132:135], v237 offset:8192
v_cvt_pk_bf16_f32 v125, v226, v227
v_mfma_f32_16x16x32_bf16 v[204:207], a[172:175], a[12:15], v[204:207]
v_mul_f32 v200, s41, v200
v_mul_f32 v201, s41, v201
v_mfma_f32_16x16x32_bf16 v[204:207], v[192:195], a[16:19], v[204:207]
v_exp_f32 v200, v200
v_mfma_f32_16x16x32_bf16 v[204:207], v[196:199], a[20:23], v[204:207]
s_waitcnt lgkmcnt(2)
v_mul_f32 v202, s41, v202
v_mul_f32 v203, s41, v203
v_mfma_f32_16x16x32_bf16 v[204:207], a[152:155], a[24:27], v[204:207]
buffer_load_dwordx4 v239, s[16:19], s62 offen lds
v_exp_f32 v201, v201
v_mfma_f32_16x16x32_bf16 v[204:207], a[156:159], a[28:31], v[204:207]
s_add_u32 m0, s69, s57
v_exp_f32 v202, v202
v_mfma_f32_16x16x32_bf16 v[214:217], a[252:255], v[168:171], v[214:217]
buffer_load_dwordx4 v239, s[16:19], s63 offen lds
v_mfma_f32_16x16x32_bf16 v[224:227], a[156:159], a[60:63], v[252:255]
s_add_u32 m0, s46, 32512
v_exp_f32 v203, v203
v_mfma_f32_16x16x32_bf16 v[224:227], a[152:155], a[56:59], v[224:227]
ds_read_b128 a[136:139], v236 offset:9216
v_cvt_pk_bf16_f32 v172, v200, v201
v_mfma_f32_16x16x32_bf16 v[224:227], v[196:199], a[52:55], v[224:227]
ds_read_b128 a[140:143], v237 offset:9216
v_cvt_pk_bf16_f32 v173, v202, v203
v_mfma_f32_16x16x32_bf16 v[224:227], v[192:195], a[48:51], v[224:227]
v_mul_f32 v204, s41, v204
v_mul_f32 v205, s41, v205
v_mfma_f32_16x16x32_bf16 v[224:227], a[172:175], a[44:47], v[224:227]
v_exp_f32 v204, v204
v_mfma_f32_16x16x32_bf16 v[224:227], a[168:171], a[40:43], v[224:227]
buffer_load_dwordx4 v239, s[20:23], s48 offen offset:256 nt lds
v_mul_f32 v206, s41, v206
v_mul_f32 v207, s41, v207
v_mfma_f32_16x16x32_bf16 v[224:227], a[164:167], a[36:39], v[224:227]
s_add_u32 m0, s69, s58
v_exp_f32 v205, v205
v_mfma_f32_16x16x32_bf16 v[224:227], a[160:163], a[32:35], v[224:227]
s_waitcnt vmcnt(14)
v_exp_f32 v206, v206
v_mfma_f32_16x16x32_bf16 v[200:203], a[160:163], a[64:67], v[244:247]
ds_read_b128 a[176:179], v232 offset:16384
v_exp_f32 v207, v207
v_mfma_f32_16x16x32_bf16 v[200:203], a[164:167], a[68:71], v[200:203]
ds_read_b128 a[144:147], v236 offset:10240
v_cvt_pk_bf16_f32 v30, v204, v205
v_mfma_f32_16x16x32_bf16 v[200:203], a[168:171], a[72:75], v[200:203]
ds_read_b128 a[148:151], v237 offset:10240
v_cvt_pk_bf16_f32 v31, v206, v207
v_mfma_f32_16x16x32_bf16 v[200:203], a[172:175], a[76:79], v[200:203]
ds_read_b128 a[180:183], v233 offset:16384
v_mul_f32 v224, s41, v224
v_mul_f32 v225, s41, v225
v_mfma_f32_16x16x32_bf16 v[200:203], v[192:195], a[80:83], v[200:203]
v_exp_f32 v224, v224
v_mfma_f32_16x16x32_bf16 v[200:203], v[196:199], a[84:87], v[200:203]
v_mul_f32 v226, s41, v226
v_mul_f32 v227, s41, v227
v_mfma_f32_16x16x32_bf16 v[200:203], a[152:155], a[88:91], v[200:203]
v_exp_f32 v225, v225
v_mfma_f32_16x16x32_bf16 v[200:203], a[156:159], a[92:95], v[200:203]
v_exp_f32 v226, v226
v_mfma_f32_16x16x32_bf16 v[208:211], a[252:255], v[28:31], v[208:211]
buffer_load_dwordx4 v239, s[16:19], s64 offen lds
v_mfma_f32_16x16x32_bf16 v[204:207], a[156:159], a[124:127], v[220:223]
s_add_u32 m0, s46, 36608
v_exp_f32 v227, v227
v_mfma_f32_16x16x32_bf16 v[204:207], a[152:155], a[120:123], v[204:207]
ds_read_b128 a[156:159], v237 offset:11264
v_cvt_pk_bf16_f32 v78, v224, v225
v_mfma_f32_16x16x32_bf16 v[204:207], v[196:199], a[116:119], v[204:207]
ds_read_b128 a[152:155], v236 offset:11264
v_cvt_pk_bf16_f32 v79, v226, v227
v_mfma_f32_16x16x32_bf16 v[204:207], v[192:195], a[112:115], v[204:207]
s_waitcnt lgkmcnt(2)
v_mul_f32 v200, s41, v200
v_mul_f32 v201, s41, v201
v_mfma_f32_16x16x32_bf16 v[204:207], a[172:175], a[108:111], v[204:207]
buffer_load_dwordx4 v239, s[20:23], s49 offen offset:256 nt lds
v_exp_f32 v200, v200
v_mfma_f32_16x16x32_bf16 v[204:207], a[168:171], a[104:107], v[204:207]
s_add_u32 m0, s69, s59
v_mul_f32 v202, s41, v202
v_mul_f32 v203, s41, v203
v_mfma_f32_16x16x32_bf16 v[204:207], a[164:167], a[100:103], v[204:207]
buffer_load_dwordx4 v239, s[16:19], s65 offen lds
v_exp_f32 v201, v201
v_mfma_f32_16x16x32_bf16 v[204:207], a[160:163], a[96:99], v[204:207]
s_waitcnt lgkmcnt(3)
v_exp_f32 v202, v202
v_mfma_f32_16x16x32_bf16 v[224:227], a[128:131], a[0:3], v[228:231]
s_add_u32 m0, s69, s60
v_exp_f32 v203, v203
v_mfma_f32_16x16x32_bf16 v[224:227], a[132:135], a[4:7], v[224:227]
ds_read_b128 a[160:163], v236 offset:16384
v_cvt_pk_bf16_f32 v126, v200, v201
v_mfma_f32_16x16x32_bf16 v[224:227], a[136:139], a[8:11], v[224:227]
ds_read_b128 a[164:167], v237 offset:16384
v_cvt_pk_bf16_f32 v127, v202, v203
v_mfma_f32_16x16x32_bf16 v[224:227], a[140:143], a[12:15], v[224:227]
v_mul_f32 v204, s41, v204
v_mul_f32 v205, s41, v205
v_mfma_f32_16x16x32_bf16 v[224:227], a[144:147], a[16:19], v[224:227]
v_exp_f32 v204, v204
v_mfma_f32_16x16x32_bf16 v[224:227], a[148:151], a[20:23], v[224:227]
s_waitcnt lgkmcnt(2)
v_mul_f32 v206, s41, v206
v_mul_f32 v207, s41, v207
v_mfma_f32_16x16x32_bf16 v[224:227], a[152:155], a[24:27], v[224:227]
v_exp_f32 v205, v205
v_mfma_f32_16x16x32_bf16 v[224:227], a[156:159], a[28:31], v[224:227]
v_exp_f32 v206, v206
v_mfma_f32_16x16x32_bf16 v[210:213], a[252:255], v[76:79], v[210:213]
buffer_load_dwordx4 v239, s[16:19], s66 offen lds
v_mfma_f32_16x16x32_bf16 v[200:203], a[156:159], a[60:63], v[252:255]
s_add_u32 m0, s69, s61
v_exp_f32 v207, v207
v_mfma_f32_16x16x32_bf16 v[200:203], a[152:155], a[56:59], v[200:203]
ds_read_b128 a[168:171], v236 offset:17408
v_cvt_pk_bf16_f32 v174, v204, v205
v_mfma_f32_16x16x32_bf16 v[200:203], a[148:151], a[52:55], v[200:203]
ds_read_b128 a[172:175], v237 offset:17408
v_cvt_pk_bf16_f32 v175, v206, v207
v_mfma_f32_16x16x32_bf16 v[200:203], a[144:147], a[48:51], v[200:203]
v_mul_f32 v224, s41, v224
v_mul_f32 v225, s41, v225
v_mfma_f32_16x16x32_bf16 v[200:203], a[140:143], a[44:47], v[200:203]
v_exp_f32 v224, v224
v_mfma_f32_16x16x32_bf16 v[200:203], a[136:139], a[40:43], v[200:203]
v_mul_f32 v226, s41, v226
v_mul_f32 v227, s41, v227
v_mfma_f32_16x16x32_bf16 v[200:203], a[132:135], a[36:39], v[200:203]
v_exp_f32 v225, v225
v_mfma_f32_16x16x32_bf16 v[200:203], a[128:131], a[32:35], v[200:203]
v_exp_f32 v226, v226
v_mfma_f32_16x16x32_bf16 v[204:207], a[128:131], a[64:67], v[244:247]
v_exp_f32 v227, v227
v_mfma_f32_16x16x32_bf16 v[204:207], a[132:135], a[68:71], v[204:207]
ds_read_b128 v[192:195], v236 offset:18432
v_cvt_pk_bf16_f32 v32, v224, v225
v_mfma_f32_16x16x32_bf16 v[204:207], a[136:139], a[72:75], v[204:207]
ds_read_b128 v[196:199], v237 offset:18432
v_cvt_pk_bf16_f32 v33, v226, v227
v_mfma_f32_16x16x32_bf16 v[204:207], a[140:143], a[76:79], v[204:207]
v_mul_f32 v200, s41, v200
v_mul_f32 v201, s41, v201
v_mfma_f32_16x16x32_bf16 v[204:207], a[144:147], a[80:83], v[204:207]
v_exp_f32 v200, v200
v_mfma_f32_16x16x32_bf16 v[204:207], a[148:151], a[84:87], v[204:207]
v_mul_f32 v202, s41, v202
v_mul_f32 v203, s41, v203
v_mfma_f32_16x16x32_bf16 v[204:207], a[152:155], a[88:91], v[204:207]
v_exp_f32 v201, v201
v_mfma_f32_16x16x32_bf16 v[204:207], a[156:159], a[92:95], v[204:207]
v_exp_f32 v202, v202
v_mfma_f32_16x16x32_bf16 v[212:215], a[252:255], v[124:127], v[212:215]
buffer_load_dwordx4 v239, s[16:19], s67 offen lds
v_mfma_f32_16x16x32_bf16 v[224:227], a[156:159], a[124:127], v[220:223]
s_add_u32 m0, s75, s56
v_exp_f32 v203, v203
v_mfma_f32_16x16x32_bf16 v[224:227], a[152:155], a[120:123], v[224:227]
ds_read_b128 a[156:159], v237 offset:19456
v_cvt_pk_bf16_f32 v80, v200, v201
v_mfma_f32_16x16x32_bf16 v[224:227], a[148:151], a[116:119], v[224:227]
ds_read_b128 a[152:155], v236 offset:19456
v_cvt_pk_bf16_f32 v81, v202, v203
v_mfma_f32_16x16x32_bf16 v[224:227], a[144:147], a[112:115], v[224:227]
s_add_u32 s16, s16, 128
s_addc_u32 s17, s17, 0
v_mul_f32 v204, s41, v204
v_mul_f32 v205, s41, v205
v_mfma_f32_16x16x32_bf16 v[224:227], a[140:143], a[108:111], v[224:227]
v_exp_f32 v204, v204
v_mfma_f32_16x16x32_bf16 v[224:227], a[136:139], a[104:107], v[224:227]
v_mul_f32 v206, s41, v206
v_mul_f32 v207, s41, v207
v_mfma_f32_16x16x32_bf16 v[224:227], a[132:135], a[100:103], v[224:227]
v_exp_f32 v205, v205
v_mfma_f32_16x16x32_bf16 v[224:227], a[128:131], a[96:99], v[224:227]
s_waitcnt vmcnt(8) lgkmcnt(0)
v_exp_f32 v206, v206
v_mfma_f32_16x16x32_bf16 v[200:203], a[160:163], a[0:3], v[228:231]
s_barrier
v_exp_f32 v207, v207
v_mfma_f32_16x16x32_bf16 v[200:203], a[164:167], a[4:7], v[200:203]
ds_read_b128 a[128:131], v236 offset:24576
v_cvt_pk_bf16_f32 v128, v204, v205
v_mfma_f32_16x16x32_bf16 v[200:203], a[168:171], a[8:11], v[200:203]
ds_read_b128 a[132:135], v237 offset:24576
v_cvt_pk_bf16_f32 v129, v206, v207
v_mfma_f32_16x16x32_bf16 v[200:203], a[172:175], a[12:15], v[200:203]
v_mul_f32 v224, s41, v224
v_mul_f32 v225, s41, v225
v_mfma_f32_16x16x32_bf16 v[200:203], v[192:195], a[16:19], v[200:203]
v_exp_f32 v224, v224
v_mfma_f32_16x16x32_bf16 v[200:203], v[196:199], a[20:23], v[200:203]
v_mul_f32 v226, s41, v226
v_mul_f32 v227, s41, v227
v_mfma_f32_16x16x32_bf16 v[200:203], a[152:155], a[24:27], v[200:203]
v_exp_f32 v225, v225
v_mfma_f32_16x16x32_bf16 v[200:203], a[156:159], a[28:31], v[200:203]
s_waitcnt vmcnt(11)
v_exp_f32 v226, v226
v_mfma_f32_16x16x32_bf16 v[214:217], a[252:255], v[172:175], v[214:217]
buffer_load_dwordx4 v239, s[92:95], s62 offen lds
v_mfma_f32_16x16x32_bf16 v[204:207], a[156:159], a[60:63], v[252:255]
ds_read_b128 a[184:187], v232 offset:24576
v_exp_f32 v227, v227
v_mfma_f32_16x16x32_bf16 v[204:207], a[152:155], a[56:59], v[204:207]
ds_read_b128 a[136:139], v236 offset:25600
v_cvt_pk_bf16_f32 v176, v224, v225
v_mfma_f32_16x16x32_bf16 v[204:207], v[196:199], a[52:55], v[204:207]
ds_read_b128 a[140:143], v237 offset:25600
v_cvt_pk_bf16_f32 v177, v226, v227
v_mfma_f32_16x16x32_bf16 v[204:207], v[192:195], a[48:51], v[204:207]
ds_read_b128 a[188:191], v233 offset:24576
v_mul_f32 v200, s41, v200
v_mul_f32 v201, s41, v201
v_mfma_f32_16x16x32_bf16 v[204:207], a[172:175], a[44:47], v[204:207]
s_add_u32 m0, s46, 16000
v_exp_f32 v200, v200
v_mfma_f32_16x16x32_bf16 v[204:207], a[168:171], a[40:43], v[204:207]
buffer_load_dwordx4 v239, s[20:23], s48 offen offset:384 nt lds
v_mul_f32 v202, s41, v202
v_mul_f32 v203, s41, v203
v_mfma_f32_16x16x32_bf16 v[204:207], a[164:167], a[36:39], v[204:207]
s_add_u32 m0, s75, s57
v_exp_f32 v201, v201
v_mfma_f32_16x16x32_bf16 v[204:207], a[160:163], a[32:35], v[204:207]
v_exp_f32 v202, v202
v_mfma_f32_16x16x32_bf16 v[224:227], a[160:163], a[64:67], v[244:247]
s_waitcnt lgkmcnt(0)
v_exp_f32 v203, v203
v_mfma_f32_16x16x32_bf16 v[224:227], a[164:167], a[68:71], v[224:227]
ds_read_b128 a[144:147], v236 offset:26624
v_cvt_pk_bf16_f32 v34, v200, v201
v_mfma_f32_16x16x32_bf16 v[224:227], a[168:171], a[72:75], v[224:227]
ds_read_b128 a[148:151], v237 offset:26624
v_cvt_pk_bf16_f32 v35, v202, v203
v_mfma_f32_16x16x32_bf16 v[224:227], a[172:175], a[76:79], v[224:227]
v_mul_f32 v204, s41, v204
v_mul_f32 v205, s41, v205
v_mfma_f32_16x16x32_bf16 v[224:227], v[192:195], a[80:83], v[224:227]
v_exp_f32 v204, v204
v_mfma_f32_16x16x32_bf16 v[224:227], v[196:199], a[84:87], v[224:227]
v_mul_f32 v206, s41, v206
v_mul_f32 v207, s41, v207
v_mfma_f32_16x16x32_bf16 v[224:227], a[152:155], a[88:91], v[224:227]
v_exp_f32 v205, v205
v_mfma_f32_16x16x32_bf16 v[224:227], a[156:159], a[92:95], v[224:227]
v_exp_f32 v206, v206
v_mfma_f32_16x16x32_bf16 v[208:211], a[252:255], v[32:35], v[208:211]
buffer_load_dwordx4 v239, s[92:95], s63 offen lds
v_mfma_f32_16x16x32_bf16 v[200:203], a[156:159], a[124:127], v[220:223]
s_add_u32 m0, s46, 20096
v_exp_f32 v207, v207
v_mfma_f32_16x16x32_bf16 v[200:203], a[152:155], a[120:123], v[200:203]
ds_read_b128 a[156:159], v237 offset:27648
v_cvt_pk_bf16_f32 v82, v204, v205
v_mfma_f32_16x16x32_bf16 v[200:203], v[196:199], a[116:119], v[200:203]
ds_read_b128 a[152:155], v236 offset:27648
v_cvt_pk_bf16_f32 v83, v206, v207
v_mfma_f32_16x16x32_bf16 v[200:203], v[192:195], a[112:115], v[200:203]
buffer_load_dwordx4 v239, s[20:23], s49 offen offset:384 nt lds
v_mul_f32 v224, s41, v224
v_mul_f32 v225, s41, v225
v_mfma_f32_16x16x32_bf16 v[200:203], a[172:175], a[108:111], v[200:203]
s_add_u32 m0, s75, s58
v_exp_f32 v224, v224
v_mfma_f32_16x16x32_bf16 v[200:203], a[168:171], a[104:107], v[200:203]
v_mul_f32 v226, s41, v226
v_mul_f32 v227, s41, v227
v_mfma_f32_16x16x32_bf16 v[200:203], a[164:167], a[100:103], v[200:203]
v_exp_f32 v225, v225
v_mfma_f32_16x16x32_bf16 v[200:203], a[160:163], a[96:99], v[200:203]
s_waitcnt lgkmcnt(2)
v_exp_f32 v226, v226
v_mfma_f32_16x16x32_bf16 v[204:207], a[128:131], a[0:3], v[228:231]
v_exp_f32 v227, v227
v_mfma_f32_16x16x32_bf16 v[204:207], a[132:135], a[4:7], v[204:207]
ds_read_b128 a[160:163], v236 offset:32768
v_cvt_pk_bf16_f32 v130, v224, v225
v_mfma_f32_16x16x32_bf16 v[204:207], a[136:139], a[8:11], v[204:207]
ds_read_b128 a[164:167], v237 offset:32768
v_cvt_pk_bf16_f32 v131, v226, v227
v_mfma_f32_16x16x32_bf16 v[204:207], a[140:143], a[12:15], v[204:207]
v_mul_f32 v200, s41, v200
v_mul_f32 v201, s41, v201
v_mfma_f32_16x16x32_bf16 v[204:207], a[144:147], a[16:19], v[204:207]
v_exp_f32 v200, v200
v_mfma_f32_16x16x32_bf16 v[204:207], a[148:151], a[20:23], v[204:207]
s_waitcnt lgkmcnt(2)
v_mul_f32 v202, s41, v202
v_mul_f32 v203, s41, v203
v_mfma_f32_16x16x32_bf16 v[204:207], a[152:155], a[24:27], v[204:207]
v_exp_f32 v201, v201
v_mfma_f32_16x16x32_bf16 v[204:207], a[156:159], a[28:31], v[204:207]
v_exp_f32 v202, v202
v_mfma_f32_16x16x32_bf16 v[210:213], a[252:255], v[80:83], v[210:213]
buffer_load_dwordx4 v239, s[92:95], s64 offen lds
v_mfma_f32_16x16x32_bf16 v[224:227], a[156:159], a[60:63], v[252:255]
s_add_u32 m0, s46, 24576
v_exp_f32 v203, v203
v_mfma_f32_16x16x32_bf16 v[224:227], a[152:155], a[56:59], v[224:227]
ds_read_b128 a[168:171], v236 offset:33792
v_cvt_pk_bf16_f32 v178, v200, v201
v_mfma_f32_16x16x32_bf16 v[224:227], a[148:151], a[52:55], v[224:227]
ds_read_b128 a[172:175], v237 offset:33792
v_cvt_pk_bf16_f32 v179, v202, v203
v_mfma_f32_16x16x32_bf16 v[224:227], a[144:147], a[48:51], v[224:227]
v_mul_f32 v204, s41, v204
v_mul_f32 v205, s41, v205
v_mfma_f32_16x16x32_bf16 v[224:227], a[140:143], a[44:47], v[224:227]
v_exp_f32 v204, v204
v_mfma_f32_16x16x32_bf16 v[224:227], a[136:139], a[40:43], v[224:227]
v_mul_f32 v206, s41, v206
v_mul_f32 v207, s41, v207
v_mfma_f32_16x16x32_bf16 v[224:227], a[132:135], a[36:39], v[224:227]
v_exp_f32 v205, v205
v_mfma_f32_16x16x32_bf16 v[224:227], a[128:131], a[32:35], v[224:227]
v_exp_f32 v206, v206
v_mfma_f32_16x16x32_bf16 v[200:203], a[128:131], a[64:67], v[244:247]
buffer_load_dwordx4 v239, s[20:23], s50 offen offset:0 nt lds
v_exp_f32 v207, v207
v_mfma_f32_16x16x32_bf16 v[200:203], a[132:135], a[68:71], v[200:203]
ds_read_b128 v[192:195], v236 offset:34816
v_cvt_pk_bf16_f32 v36, v204, v205
v_mfma_f32_16x16x32_bf16 v[200:203], a[136:139], a[72:75], v[200:203]
ds_read_b128 v[196:199], v237 offset:34816
v_cvt_pk_bf16_f32 v37, v206, v207
v_mfma_f32_16x16x32_bf16 v[200:203], a[140:143], a[76:79], v[200:203]
s_add_u32 m0, s75, s59
v_mul_f32 v224, s41, v224
v_mul_f32 v225, s41, v225
v_mfma_f32_16x16x32_bf16 v[200:203], a[144:147], a[80:83], v[200:203]
v_exp_f32 v224, v224
v_mfma_f32_16x16x32_bf16 v[200:203], a[148:151], a[84:87], v[200:203]
v_mul_f32 v226, s41, v226
v_mul_f32 v227, s41, v227
v_mfma_f32_16x16x32_bf16 v[200:203], a[152:155], a[88:91], v[200:203]
v_exp_f32 v225, v225
v_mfma_f32_16x16x32_bf16 v[200:203], a[156:159], a[92:95], v[200:203]
v_exp_f32 v226, v226
v_mfma_f32_16x16x32_bf16 v[212:215], a[252:255], v[128:131], v[212:215]
buffer_load_dwordx4 v239, s[92:95], s65 offen lds
v_mfma_f32_16x16x32_bf16 v[204:207], a[156:159], a[124:127], v[220:223]
s_add_u32 m0, s46, 28672
v_exp_f32 v227, v227
v_mfma_f32_16x16x32_bf16 v[204:207], a[152:155], a[120:123], v[204:207]
ds_read_b128 a[156:159], v237 offset:35840
v_cvt_pk_bf16_f32 v84, v224, v225
v_mfma_f32_16x16x32_bf16 v[204:207], a[148:151], a[116:119], v[204:207]
ds_read_b128 a[152:155], v236 offset:35840
v_cvt_pk_bf16_f32 v85, v226, v227
v_mfma_f32_16x16x32_bf16 v[204:207], a[144:147], a[112:115], v[204:207]
v_mul_f32 v200, s41, v200
v_mul_f32 v201, s41, v201
v_mfma_f32_16x16x32_bf16 v[204:207], a[140:143], a[108:111], v[204:207]
v_exp_f32 v200, v200
v_mfma_f32_16x16x32_bf16 v[204:207], a[136:139], a[104:107], v[204:207]
v_mul_f32 v202, s41, v202
v_mul_f32 v203, s41, v203
v_mfma_f32_16x16x32_bf16 v[204:207], a[132:135], a[100:103], v[204:207]
v_exp_f32 v201, v201
v_mfma_f32_16x16x32_bf16 v[204:207], a[128:131], a[96:99], v[204:207]
s_waitcnt lgkmcnt(2)
v_exp_f32 v202, v202
v_mfma_f32_16x16x32_bf16 v[224:227], a[160:163], a[0:3], v[228:231]
buffer_load_dwordx4 v239, s[20:23], s51 offen offset:0 nt lds
v_exp_f32 v203, v203
v_mfma_f32_16x16x32_bf16 v[224:227], a[164:167], a[4:7], v[224:227]
ds_read_b128 a[128:131], v236 offset:40960
v_cvt_pk_bf16_f32 v132, v200, v201
v_mfma_f32_16x16x32_bf16 v[224:227], a[168:171], a[8:11], v[224:227]
ds_read_b128 a[132:135], v237 offset:40960
v_cvt_pk_bf16_f32 v133, v202, v203
v_mfma_f32_16x16x32_bf16 v[224:227], a[172:175], a[12:15], v[224:227]
s_add_u32 m0, s75, s60
v_mul_f32 v204, s41, v204
v_mul_f32 v205, s41, v205
v_mfma_f32_16x16x32_bf16 v[224:227], v[192:195], a[16:19], v[224:227]
s_waitcnt vmcnt(11)
v_exp_f32 v204, v204
v_mfma_f32_16x16x32_bf16 v[224:227], v[196:199], a[20:23], v[224:227]
s_waitcnt lgkmcnt(2)
v_mul_f32 v206, s41, v206
v_mul_f32 v207, s41, v207
v_mfma_f32_16x16x32_bf16 v[224:227], a[152:155], a[24:27], v[224:227]
ds_read_b128 a[192:195], v232 offset:32768
v_exp_f32 v205, v205
v_mfma_f32_16x16x32_bf16 v[224:227], a[156:159], a[28:31], v[224:227]
ds_read_b128 a[196:199], v233 offset:32768
v_exp_f32 v206, v206
v_mfma_f32_16x16x32_bf16 v[214:217], a[252:255], v[176:179], v[214:217]
buffer_load_dwordx4 v239, s[92:95], s66 offen lds
v_mfma_f32_16x16x32_bf16 v[200:203], a[156:159], a[60:63], v[252:255]
s_add_u32 m0, s46, 32640
v_exp_f32 v207, v207
v_mfma_f32_16x16x32_bf16 v[200:203], a[152:155], a[56:59], v[200:203]
ds_read_b128 a[136:139], v236 offset:41984
v_cvt_pk_bf16_f32 v180, v204, v205
v_mfma_f32_16x16x32_bf16 v[200:203], v[196:199], a[52:55], v[200:203]
ds_read_b128 a[140:143], v237 offset:41984
v_cvt_pk_bf16_f32 v181, v206, v207
v_mfma_f32_16x16x32_bf16 v[200:203], v[192:195], a[48:51], v[200:203]
s_waitcnt lgkmcnt(2)
v_mul_f32 v224, s41, v224
v_mul_f32 v225, s41, v225
v_mfma_f32_16x16x32_bf16 v[200:203], a[172:175], a[44:47], v[200:203]
v_exp_f32 v224, v224
v_mfma_f32_16x16x32_bf16 v[200:203], a[168:171], a[40:43], v[200:203]
v_mul_f32 v226, s41, v226
v_mul_f32 v227, s41, v227
v_mfma_f32_16x16x32_bf16 v[200:203], a[164:167], a[36:39], v[200:203]
v_exp_f32 v225, v225
v_mfma_f32_16x16x32_bf16 v[200:203], a[160:163], a[32:35], v[200:203]
v_exp_f32 v226, v226
v_mfma_f32_16x16x32_bf16 v[204:207], a[160:163], a[64:67], v[244:247]
v_exp_f32 v227, v227
v_mfma_f32_16x16x32_bf16 v[204:207], a[164:167], a[68:71], v[204:207]
ds_read_b128 a[144:147], v236 offset:43008
v_cvt_pk_bf16_f32 v38, v224, v225
v_mfma_f32_16x16x32_bf16 v[204:207], a[168:171], a[72:75], v[204:207]
ds_read_b128 a[148:151], v237 offset:43008
v_cvt_pk_bf16_f32 v39, v226, v227
v_mfma_f32_16x16x32_bf16 v[204:207], a[172:175], a[76:79], v[204:207]
v_mul_f32 v200, s41, v200
v_mul_f32 v201, s41, v201
v_mfma_f32_16x16x32_bf16 v[204:207], v[192:195], a[80:83], v[204:207]
v_exp_f32 v200, v200
v_mfma_f32_16x16x32_bf16 v[204:207], v[196:199], a[84:87], v[204:207]
v_mul_f32 v202, s41, v202
v_mul_f32 v203, s41, v203
v_mfma_f32_16x16x32_bf16 v[204:207], a[152:155], a[88:91], v[204:207]
buffer_load_dwordx4 v239, s[20:23], s50 offen offset:128 nt lds
v_exp_f32 v201, v201
v_mfma_f32_16x16x32_bf16 v[204:207], a[156:159], a[92:95], v[204:207]
s_add_u32 m0, s75, s61
v_exp_f32 v202, v202
v_mfma_f32_16x16x32_bf16 v[208:211], a[252:255], v[36:39], v[208:211]
buffer_load_dwordx4 v239, s[92:95], s67 offen lds
v_mfma_f32_16x16x32_bf16 v[224:227], a[156:159], a[124:127], v[220:223]
s_add_u32 m0, s46, 36736
v_exp_f32 v203, v203
v_mfma_f32_16x16x32_bf16 v[224:227], a[152:155], a[120:123], v[224:227]
ds_read_b128 a[156:159], v237 offset:44032
v_cvt_pk_bf16_f32 v86, v200, v201
v_mfma_f32_16x16x32_bf16 v[224:227], v[196:199], a[116:119], v[224:227]
ds_read_b128 a[152:155], v236 offset:44032
v_cvt_pk_bf16_f32 v87, v202, v203
v_mfma_f32_16x16x32_bf16 v[224:227], v[192:195], a[112:115], v[224:227]
s_add_u32 s92, s92, 128
s_addc_u32 s93, s93, 0
v_mul_f32 v204, s41, v204
v_mul_f32 v205, s41, v205
v_mfma_f32_16x16x32_bf16 v[224:227], a[172:175], a[108:111], v[224:227]
v_exp_f32 v204, v204
v_mfma_f32_16x16x32_bf16 v[224:227], a[168:171], a[104:107], v[224:227]
v_mul_f32 v206, s41, v206
v_mul_f32 v207, s41, v207
v_mfma_f32_16x16x32_bf16 v[224:227], a[164:167], a[100:103], v[224:227]
v_exp_f32 v205, v205
v_mfma_f32_16x16x32_bf16 v[224:227], a[160:163], a[96:99], v[224:227]
s_waitcnt lgkmcnt(2)
v_exp_f32 v206, v206
v_mfma_f32_16x16x32_bf16 v[200:203], a[128:131], a[0:3], v[228:231]
v_exp_f32 v207, v207
v_mfma_f32_16x16x32_bf16 v[200:203], a[132:135], a[4:7], v[200:203]
ds_read_b128 a[160:163], v236 offset:49152
v_cvt_pk_bf16_f32 v134, v204, v205
v_mfma_f32_16x16x32_bf16 v[200:203], a[136:139], a[8:11], v[200:203]
ds_read_b128 a[164:167], v237 offset:49152
v_cvt_pk_bf16_f32 v135, v206, v207
v_mfma_f32_16x16x32_bf16 v[200:203], a[140:143], a[12:15], v[200:203]
v_mul_f32 v224, s41, v224
v_mul_f32 v225, s41, v225
v_mfma_f32_16x16x32_bf16 v[200:203], a[144:147], a[16:19], v[200:203]
v_exp_f32 v224, v224
v_mfma_f32_16x16x32_bf16 v[200:203], a[148:151], a[20:23], v[200:203]
s_waitcnt lgkmcnt(2)
v_mul_f32 v226, s41, v226
v_mul_f32 v227, s41, v227
v_mfma_f32_16x16x32_bf16 v[200:203], a[152:155], a[24:27], v[200:203]
buffer_load_dwordx4 v239, s[20:23], s51 offen offset:128 nt lds
v_exp_f32 v225, v225
v_mfma_f32_16x16x32_bf16 v[200:203], a[156:159], a[28:31], v[200:203]
s_add_u32 m0, s38, s56
v_exp_f32 v226, v226
v_mfma_f32_16x16x32_bf16 v[210:213], a[252:255], v[84:87], v[210:213]
buffer_load_dwordx4 v239, s[16:19], s62 offen lds
v_mfma_f32_16x16x32_bf16 v[204:207], a[156:159], a[60:63], v[252:255]
s_add_u32 m0, s38, s57
v_exp_f32 v227, v227
v_mfma_f32_16x16x32_bf16 v[204:207], a[152:155], a[56:59], v[204:207]
ds_read_b128 a[168:171], v236 offset:50176
v_cvt_pk_bf16_f32 v182, v224, v225
v_mfma_f32_16x16x32_bf16 v[204:207], a[148:151], a[52:55], v[204:207]
ds_read_b128 a[172:175], v237 offset:50176
v_cvt_pk_bf16_f32 v183, v226, v227
v_mfma_f32_16x16x32_bf16 v[204:207], a[144:147], a[48:51], v[204:207]
v_mul_f32 v200, s41, v200
v_mul_f32 v201, s41, v201
v_mfma_f32_16x16x32_bf16 v[204:207], a[140:143], a[44:47], v[204:207]
v_exp_f32 v200, v200
v_mfma_f32_16x16x32_bf16 v[204:207], a[136:139], a[40:43], v[204:207]
v_mul_f32 v202, s41, v202
v_mul_f32 v203, s41, v203
v_mfma_f32_16x16x32_bf16 v[204:207], a[132:135], a[36:39], v[204:207]
v_exp_f32 v201, v201
v_mfma_f32_16x16x32_bf16 v[204:207], a[128:131], a[32:35], v[204:207]
v_exp_f32 v202, v202
v_mfma_f32_16x16x32_bf16 v[224:227], a[128:131], a[64:67], v[244:247]
v_exp_f32 v203, v203
v_mfma_f32_16x16x32_bf16 v[224:227], a[132:135], a[68:71], v[224:227]
ds_read_b128 v[192:195], v236 offset:51200
v_cvt_pk_bf16_f32 v40, v200, v201
v_mfma_f32_16x16x32_bf16 v[224:227], a[136:139], a[72:75], v[224:227]
ds_read_b128 v[196:199], v237 offset:51200
v_cvt_pk_bf16_f32 v41, v202, v203
v_mfma_f32_16x16x32_bf16 v[224:227], a[140:143], a[76:79], v[224:227]
s_waitcnt vmcnt(9)
v_mul_f32 v204, s41, v204
v_mul_f32 v205, s41, v205
v_mfma_f32_16x16x32_bf16 v[224:227], a[144:147], a[80:83], v[224:227]
ds_read_b128 a[200:203], v232 offset:16384
v_exp_f32 v204, v204
v_mfma_f32_16x16x32_bf16 v[224:227], a[148:151], a[84:87], v[224:227]
ds_read_b128 a[204:207], v233 offset:16384
v_mul_f32 v206, s41, v206
v_mul_f32 v207, s41, v207
v_mfma_f32_16x16x32_bf16 v[224:227], a[152:155], a[88:91], v[224:227]
v_exp_f32 v205, v205
v_mfma_f32_16x16x32_bf16 v[224:227], a[156:159], a[92:95], v[224:227]
v_exp_f32 v206, v206
v_mfma_f32_16x16x32_bf16 v[212:215], a[252:255], v[132:135], v[212:215]
buffer_load_dwordx4 v239, s[16:19], s63 offen lds
v_mfma_f32_16x16x32_bf16 v[200:203], a[156:159], a[124:127], v[220:223]
s_add_u32 m0, s46, 16128
v_exp_f32 v207, v207
v_mfma_f32_16x16x32_bf16 v[200:203], a[152:155], a[120:123], v[200:203]
ds_read_b128 a[156:159], v237 offset:52224
v_cvt_pk_bf16_f32 v88, v204, v205
v_mfma_f32_16x16x32_bf16 v[200:203], a[148:151], a[116:119], v[200:203]
ds_read_b128 a[152:155], v236 offset:52224
v_cvt_pk_bf16_f32 v89, v206, v207
v_mfma_f32_16x16x32_bf16 v[200:203], a[144:147], a[112:115], v[200:203]
s_waitcnt lgkmcnt(2)
v_mul_f32 v224, s41, v224
v_mul_f32 v225, s41, v225
v_mfma_f32_16x16x32_bf16 v[200:203], a[140:143], a[108:111], v[200:203]
buffer_load_dwordx4 v239, s[20:23], s50 offen offset:256 nt lds
v_exp_f32 v224, v224
v_mfma_f32_16x16x32_bf16 v[200:203], a[136:139], a[104:107], v[200:203]
s_add_u32 m0, s38, s58
v_mul_f32 v226, s41, v226
v_mul_f32 v227, s41, v227
v_mfma_f32_16x16x32_bf16 v[200:203], a[132:135], a[100:103], v[200:203]
v_exp_f32 v225, v225
v_mfma_f32_16x16x32_bf16 v[200:203], a[128:131], a[96:99], v[200:203]
s_waitcnt lgkmcnt(4)
v_exp_f32 v226, v226
v_mfma_f32_16x16x32_bf16 v[204:207], a[160:163], a[0:3], v[228:231]
v_exp_f32 v227, v227
v_mfma_f32_16x16x32_bf16 v[204:207], a[164:167], a[4:7], v[204:207]
ds_read_b128 a[128:131], v236 offset:57344
v_cvt_pk_bf16_f32 v136, v224, v225
v_mfma_f32_16x16x32_bf16 v[204:207], a[168:171], a[8:11], v[204:207]
ds_read_b128 a[132:135], v237 offset:57344
v_cvt_pk_bf16_f32 v137, v226, v227
v_mfma_f32_16x16x32_bf16 v[204:207], a[172:175], a[12:15], v[204:207]
v_mul_f32 v200, s41, v200
v_mul_f32 v201, s41, v201
v_mfma_f32_16x16x32_bf16 v[204:207], v[192:195], a[16:19], v[204:207]
v_exp_f32 v200, v200
v_mfma_f32_16x16x32_bf16 v[204:207], v[196:199], a[20:23], v[204:207]
s_waitcnt lgkmcnt(2)
v_mul_f32 v202, s41, v202
v_mul_f32 v203, s41, v203
v_mfma_f32_16x16x32_bf16 v[204:207], a[152:155], a[24:27], v[204:207]
v_exp_f32 v201, v201
v_mfma_f32_16x16x32_bf16 v[204:207], a[156:159], a[28:31], v[204:207]
v_exp_f32 v202, v202
v_mfma_f32_16x16x32_bf16 v[214:217], a[252:255], v[180:183], v[214:217]
buffer_load_dwordx4 v239, s[16:19], s64 offen lds
v_mfma_f32_16x16x32_bf16 v[224:227], a[156:159], a[60:63], v[252:255]
s_add_u32 m0, s46, 20224
v_exp_f32 v203, v203
v_mfma_f32_16x16x32_bf16 v[224:227], a[152:155], a[56:59], v[224:227]
ds_read_b128 a[136:139], v236 offset:58368
v_cvt_pk_bf16_f32 v184, v200, v201
v_mfma_f32_16x16x32_bf16 v[224:227], v[196:199], a[52:55], v[224:227]
ds_read_b128 a[140:143], v237 offset:58368
v_cvt_pk_bf16_f32 v185, v202, v203
v_mfma_f32_16x16x32_bf16 v[224:227], v[192:195], a[48:51], v[224:227]
buffer_load_dwordx4 v239, s[20:23], s51 offen offset:256 nt lds
v_mul_f32 v204, s41, v204
v_mul_f32 v205, s41, v205
v_mfma_f32_16x16x32_bf16 v[224:227], a[172:175], a[44:47], v[224:227]
s_add_u32 m0, s38, s59
v_exp_f32 v204, v204
v_mfma_f32_16x16x32_bf16 v[224:227], a[168:171], a[40:43], v[224:227]
v_mul_f32 v206, s41, v206
v_mul_f32 v207, s41, v207
v_mfma_f32_16x16x32_bf16 v[224:227], a[164:167], a[36:39], v[224:227]
v_exp_f32 v205, v205
v_mfma_f32_16x16x32_bf16 v[224:227], a[160:163], a[32:35], v[224:227]
v_exp_f32 v206, v206
v_mfma_f32_16x16x32_bf16 v[200:203], a[160:163], a[64:67], v[244:247]
v_exp_f32 v207, v207
v_mfma_f32_16x16x32_bf16 v[200:203], a[164:167], a[68:71], v[200:203]
ds_read_b128 a[144:147], v236 offset:59392
v_cvt_pk_bf16_f32 v42, v204, v205
v_mfma_f32_16x16x32_bf16 v[200:203], a[168:171], a[72:75], v[200:203]
ds_read_b128 a[148:151], v237 offset:59392
v_cvt_pk_bf16_f32 v43, v206, v207
v_mfma_f32_16x16x32_bf16 v[200:203], a[172:175], a[76:79], v[200:203]
v_mul_f32 v224, s41, v224
v_mul_f32 v225, s41, v225
v_mfma_f32_16x16x32_bf16 v[200:203], v[192:195], a[80:83], v[200:203]
v_exp_f32 v224, v224
v_mfma_f32_16x16x32_bf16 v[200:203], v[196:199], a[84:87], v[200:203]
v_mul_f32 v226, s41, v226
v_mul_f32 v227, s41, v227
v_mfma_f32_16x16x32_bf16 v[200:203], a[152:155], a[88:91], v[200:203]
v_exp_f32 v225, v225
v_mfma_f32_16x16x32_bf16 v[200:203], a[156:159], a[92:95], v[200:203]
v_exp_f32 v226, v226
v_mfma_f32_16x16x32_bf16 v[208:211], a[252:255], v[40:43], v[208:211]
buffer_load_dwordx4 v239, s[16:19], s65 offen lds
v_mfma_f32_16x16x32_bf16 v[204:207], a[156:159], a[124:127], v[220:223]
s_waitcnt vmcnt(10)
v_exp_f32 v227, v227
v_mfma_f32_16x16x32_bf16 v[204:207], a[152:155], a[120:123], v[204:207]
ds_read_b128 a[156:159], v237 offset:60416
v_cvt_pk_bf16_f32 v90, v224, v225
v_mfma_f32_16x16x32_bf16 v[204:207], v[196:199], a[116:119], v[204:207]
ds_read_b128 a[152:155], v236 offset:60416
v_cvt_pk_bf16_f32 v91, v226, v227
v_mfma_f32_16x16x32_bf16 v[204:207], v[192:195], a[112:115], v[204:207]
ds_read_b128 a[208:211], v232 offset:24576
v_mul_f32 v200, s41, v200
v_mul_f32 v201, s41, v201
v_mfma_f32_16x16x32_bf16 v[204:207], a[172:175], a[108:111], v[204:207]
ds_read_b128 a[212:215], v233 offset:24576
v_exp_f32 v200, v200
v_mfma_f32_16x16x32_bf16 v[204:207], a[168:171], a[104:107], v[204:207]
s_add_u32 m0, s46, 24192
v_mul_f32 v202, s41, v202
v_mul_f32 v203, s41, v203
v_mfma_f32_16x16x32_bf16 v[204:207], a[164:167], a[100:103], v[204:207]
v_exp_f32 v201, v201
v_mfma_f32_16x16x32_bf16 v[204:207], a[160:163], a[96:99], v[204:207]
s_waitcnt lgkmcnt(4)
v_exp_f32 v202, v202
v_mfma_f32_16x16x32_bf16 v[224:227], a[128:131], a[0:3], v[228:231]
v_exp_f32 v203, v203
v_mfma_f32_16x16x32_bf16 v[224:227], a[132:135], a[4:7], v[224:227]
ds_read_b128 a[160:163], v249 offset:8192
v_cvt_pk_bf16_f32 v138, v200, v201
v_mfma_f32_16x16x32_bf16 v[224:227], a[136:139], a[8:11], v[224:227]
ds_read_b128 a[164:167], v250 offset:8192
v_cvt_pk_bf16_f32 v139, v202, v203
v_mfma_f32_16x16x32_bf16 v[224:227], a[140:143], a[12:15], v[224:227]
s_waitcnt lgkmcnt(2)
v_mul_f32 v204, s41, v204
v_mul_f32 v205, s41, v205
v_mfma_f32_16x16x32_bf16 v[224:227], a[144:147], a[16:19], v[224:227]
buffer_load_dwordx4 v239, s[20:23], s50 offen offset:384 nt lds
v_exp_f32 v204, v204
v_mfma_f32_16x16x32_bf16 v[224:227], a[148:151], a[20:23], v[224:227]
s_waitcnt lgkmcnt(4)
v_mul_f32 v206, s41, v206
v_mul_f32 v207, s41, v207
v_mfma_f32_16x16x32_bf16 v[224:227], a[152:155], a[24:27], v[224:227]
s_add_u32 m0, s38, s60
v_exp_f32 v205, v205
v_mfma_f32_16x16x32_bf16 v[224:227], a[156:159], a[28:31], v[224:227]
v_exp_f32 v206, v206
v_mfma_f32_16x16x32_bf16 v[210:213], a[252:255], v[88:91], v[210:213]
buffer_load_dwordx4 v239, s[16:19], s66 offen lds
v_mfma_f32_16x16x32_bf16 v[200:203], a[156:159], a[60:63], v[252:255]
s_add_u32 m0, s46, 28288
v_exp_f32 v207, v207
v_mfma_f32_16x16x32_bf16 v[200:203], a[152:155], a[56:59], v[200:203]
ds_read_b128 a[168:171], v249 offset:9216
v_cvt_pk_bf16_f32 v186, v204, v205
v_mfma_f32_16x16x32_bf16 v[200:203], a[148:151], a[52:55], v[200:203]
ds_read_b128 a[172:175], v250 offset:9216
v_cvt_pk_bf16_f32 v187, v206, v207
v_mfma_f32_16x16x32_bf16 v[200:203], a[144:147], a[48:51], v[200:203]
v_mul_f32 v224, s41, v224
v_mul_f32 v225, s41, v225
v_mfma_f32_16x16x32_bf16 v[200:203], a[140:143], a[44:47], v[200:203]
v_exp_f32 v224, v224
v_mfma_f32_16x16x32_bf16 v[200:203], a[136:139], a[40:43], v[200:203]
v_mul_f32 v226, s41, v226
v_mul_f32 v227, s41, v227
v_mfma_f32_16x16x32_bf16 v[200:203], a[132:135], a[36:39], v[200:203]
v_exp_f32 v225, v225
v_mfma_f32_16x16x32_bf16 v[200:203], a[128:131], a[32:35], v[200:203]
v_exp_f32 v226, v226
v_mfma_f32_16x16x32_bf16 v[204:207], a[128:131], a[64:67], v[244:247]
buffer_load_dwordx4 v239, s[20:23], s51 offen offset:384 nt lds
v_exp_f32 v227, v227
v_mfma_f32_16x16x32_bf16 v[204:207], a[132:135], a[68:71], v[204:207]
ds_read_b128 v[192:195], v249 offset:10240
v_cvt_pk_bf16_f32 v44, v224, v225
v_mfma_f32_16x16x32_bf16 v[204:207], a[136:139], a[72:75], v[204:207]
ds_read_b128 v[196:199], v250 offset:10240
v_cvt_pk_bf16_f32 v45, v226, v227
v_mfma_f32_16x16x32_bf16 v[204:207], a[140:143], a[76:79], v[204:207]
s_add_u32 m0, s38, s61
v_mul_f32 v200, s41, v200
v_mul_f32 v201, s41, v201
v_mfma_f32_16x16x32_bf16 v[204:207], a[144:147], a[80:83], v[204:207]
v_exp_f32 v200, v200
v_mfma_f32_16x16x32_bf16 v[204:207], a[148:151], a[84:87], v[204:207]
v_mul_f32 v202, s41, v202
v_mul_f32 v203, s41, v203
v_mfma_f32_16x16x32_bf16 v[204:207], a[152:155], a[88:91], v[204:207]
v_exp_f32 v201, v201
v_mfma_f32_16x16x32_bf16 v[204:207], a[156:159], a[92:95], v[204:207]
v_exp_f32 v202, v202
v_mfma_f32_16x16x32_bf16 v[212:215], a[252:255], v[136:139], v[212:215]
buffer_load_dwordx4 v239, s[16:19], s67 offen lds
v_mfma_f32_16x16x32_bf16 v[224:227], a[156:159], a[124:127], v[220:223]
s_waitcnt vmcnt(10)
v_exp_f32 v203, v203
v_mfma_f32_16x16x32_bf16 v[224:227], a[152:155], a[120:123], v[224:227]
ds_read_b128 a[156:159], v250 offset:11264
v_cvt_pk_bf16_f32 v92, v200, v201
v_mfma_f32_16x16x32_bf16 v[224:227], a[148:151], a[116:119], v[224:227]
ds_read_b128 a[152:155], v249 offset:11264
v_cvt_pk_bf16_f32 v93, v202, v203
v_mfma_f32_16x16x32_bf16 v[224:227], a[144:147], a[112:115], v[224:227]
ds_read_b128 a[216:219], v232 offset:32768
v_mul_f32 v204, s41, v204
v_mul_f32 v205, s41, v205
v_mfma_f32_16x16x32_bf16 v[224:227], a[140:143], a[108:111], v[224:227]
ds_read_b128 a[220:223], v233 offset:32768
v_exp_f32 v204, v204
v_mfma_f32_16x16x32_bf16 v[224:227], a[136:139], a[104:107], v[224:227]
s_add_u32 m0, s46, 32768
v_mul_f32 v206, s41, v206
v_mul_f32 v207, s41, v207
v_mfma_f32_16x16x32_bf16 v[224:227], a[132:135], a[100:103], v[224:227]
s_add_u32 s16, s16, 128
s_addc_u32 s17, s17, 0
v_exp_f32 v205, v205
v_mfma_f32_16x16x32_bf16 v[224:227], a[128:131], a[96:99], v[224:227]
s_waitcnt vmcnt(11) lgkmcnt(2)
v_exp_f32 v206, v206
v_mfma_f32_16x16x32_bf16 v[200:203], a[160:163], a[0:3], v[228:231]
s_barrier
v_exp_f32 v207, v207
v_mfma_f32_16x16x32_bf16 v[200:203], a[164:167], a[4:7], v[200:203]
ds_read_b64_tr_b16 a[128:129], v235 offset:16384
v_cvt_pk_bf16_f32 v140, v204, v205
v_mfma_f32_16x16x32_bf16 v[200:203], a[168:171], a[8:11], v[200:203]
ds_read_b64_tr_b16 a[130:131], v235 offset:18432
v_cvt_pk_bf16_f32 v141, v206, v207
v_mfma_f32_16x16x32_bf16 v[200:203], a[172:175], a[12:15], v[200:203]
s_waitcnt lgkmcnt(2)
v_mul_f32 v224, s41, v224
v_mul_f32 v225, s41, v225
v_mfma_f32_16x16x32_bf16 v[200:203], v[192:195], a[16:19], v[200:203]
buffer_load_dwordx4 v239, s[20:23], s52 offen offset:0 nt lds
v_exp_f32 v224, v224
v_mfma_f32_16x16x32_bf16 v[200:203], v[196:199], a[20:23], v[200:203]
s_add_u32 m0, s46, 36864
v_mul_f32 v226, s41, v226
v_mul_f32 v227, s41, v227
v_mfma_f32_16x16x32_bf16 v[200:203], a[152:155], a[24:27], v[200:203]
v_exp_f32 v225, v225
v_mfma_f32_16x16x32_bf16 v[200:203], a[156:159], a[28:31], v[200:203]
v_exp_f32 v226, v226
v_mfma_f32_16x16x32_bf16 v[214:217], a[252:255], v[184:187], v[214:217]
ds_read_b64_tr_b16 a[132:133], v235 offset:20480
v_mfma_f32_16x16x32_bf16 v[204:207], a[156:159], a[60:63], v[252:255]
v_exp_f32 v227, v227
v_mfma_f32_16x16x32_bf16 v[204:207], a[152:155], a[56:59], v[204:207]
ds_read_b64_tr_b16 a[134:135], v235 offset:22528
v_cvt_pk_bf16_f32 v188, v224, v225
v_mfma_f32_16x16x32_bf16 v[204:207], v[196:199], a[52:55], v[204:207]
ds_read_b64_tr_b16 a[136:137], v235 offset:24576
v_cvt_pk_bf16_f32 v189, v226, v227
v_mfma_f32_16x16x32_bf16 v[204:207], v[192:195], a[48:51], v[204:207]
v_mul_f32 v200, s41, v200
v_mul_f32 v201, s41, v201
v_mfma_f32_16x16x32_bf16 v[204:207], a[172:175], a[44:47], v[204:207]
v_exp_f32 v200, v200
v_mfma_f32_16x16x32_bf16 v[204:207], a[168:171], a[40:43], v[204:207]
ds_read_b64_tr_b16 a[138:139], v235 offset:26624
v_mul_f32 v202, s41, v202
v_mul_f32 v203, s41, v203
v_mfma_f32_16x16x32_bf16 v[204:207], a[164:167], a[36:39], v[204:207]
v_exp_f32 v201, v201
v_mfma_f32_16x16x32_bf16 v[204:207], a[160:163], a[32:35], v[204:207]
v_exp_f32 v202, v202
v_mfma_f32_16x16x32_bf16 v[224:227], a[160:163], a[64:67], v[244:247]
buffer_load_dwordx4 v239, s[20:23], s53 offen offset:0 nt lds
v_exp_f32 v203, v203
v_mfma_f32_16x16x32_bf16 v[224:227], a[164:167], a[68:71], v[224:227]
ds_read_b64_tr_b16 a[140:141], v235 offset:28672
v_cvt_pk_bf16_f32 v46, v200, v201
v_mfma_f32_16x16x32_bf16 v[224:227], a[168:171], a[72:75], v[224:227]
ds_read_b64_tr_b16 a[142:143], v235 offset:30720
v_cvt_pk_bf16_f32 v47, v202, v203
v_mfma_f32_16x16x32_bf16 v[224:227], a[172:175], a[76:79], v[224:227]
s_add_u32 m0, s46, 16256
v_mul_f32 v204, s41, v204
v_mul_f32 v205, s41, v205
L_t0:
v_mfma_f32_16x16x32_bf16 v[224:227], v[192:195], a[80:83], v[224:227]
v_exp_f32 v204, v204
v_mfma_f32_16x16x32_bf16 v[224:227], v[196:199], a[84:87], v[224:227]
ds_read_b64_tr_b16 a[144:145], v235 offset:32768
v_mul_f32 v206, s41, v206
v_mul_f32 v207, s41, v207
v_mfma_f32_16x16x32_bf16 v[224:227], a[152:155], a[88:91], v[224:227]
v_exp_f32 v205, v205
v_mfma_f32_16x16x32_bf16 v[224:227], a[156:159], a[92:95], v[224:227]
v_exp_f32 v206, v206
v_mfma_f32_16x16x32_bf16 v[208:211], a[252:255], v[44:47], v[208:211]
ds_read_b64_tr_b16 a[146:147], v235 offset:34816
v_mfma_f32_16x16x32_bf16 v[200:203], a[156:159], a[124:127], v[220:223]
v_exp_f32 v207, v207
v_mfma_f32_16x16x32_bf16 v[200:203], a[152:155], a[120:123], v[200:203]
ds_read_b64_tr_b16 a[148:149], v235 offset:36864
v_cvt_pk_bf16_f32 v94, v204, v205
v_mfma_f32_16x16x32_bf16 v[200:203], v[196:199], a[116:119], v[200:203]
ds_read_b64_tr_b16 a[150:151], v235 offset:38912
v_cvt_pk_bf16_f32 v95, v206, v207
v_mfma_f32_16x16x32_bf16 v[200:203], v[192:195], a[112:115], v[200:203]
v_mul_f32 v224, s41, v224
v_mul_f32 v225, s41, v225
v_mfma_f32_16x16x32_bf16 v[200:203], a[172:175], a[108:111], v[200:203]
v_exp_f32 v224, v224
v_mfma_f32_16x16x32_bf16 v[200:203], a[168:171], a[104:107], v[200:203]
s_waitcnt vmcnt(7)
v_mul_f32 v226, s41, v226
v_mul_f32 v227, s41, v227
v_mfma_f32_16x16x32_bf16 v[200:203], a[164:167], a[100:103], v[200:203]
ds_read_b128 a[224:227], v232 offset:16384
v_exp_f32 v225, v225
v_mfma_f32_16x16x32_bf16 v[200:203], a[160:163], a[96:99], v[200:203]
ds_read_b128 a[228:231], v233 offset:16384
v_exp_f32 v226, v226
v_mfma_f32_16x16x32_bf16 v[210:213], a[252:255], v[92:95], v[210:213]
s_waitcnt lgkmcnt(2)
v_exp_f32 v227, v227
L_p2_0:
v_mfma_f32_16x16x32_bf16 v[192:195], a[148:151], v[20:23], 0
ds_read_b64_tr_b16 a[152:153], v235 offset:40960
v_cvt_pk_bf16_f32 v142, v224, v225
v_mfma_f32_16x16x32_bf16 v[192:195], a[144:147], v[16:19], v[192:195]
ds_read_b64_tr_b16 a[154:155], v235 offset:43008
v_cvt_pk_bf16_f32 v143, v226, v227
v_mfma_f32_16x16x32_bf16 v[192:195], a[140:143], v[12:15], v[192:195]
v_mul_f32 v200, s41, v200
v_mul_f32 v201, s41, v201
v_mfma_f32_16x16x32_bf16 v[192:195], a[136:139], v[8:11], v[192:195]
s_waitcnt lgkmcnt(2)
v_exp_f32 v200, v200
v_mfma_f32_16x16x32_bf16 v[192:195], a[132:135], v[4:7], v[192:195]
v_mul_f32 v202, s41, v202
v_mul_f32 v203, s41, v203
v_mfma_f32_16x16x32_bf16 v[192:195], a[128:131], v[0:3], v[192:195]
v_exp_f32 v201, v201
v_mfma_f32_16x16x32_bf16 v[212:215], a[252:255], v[140:143], v[212:215]
v_exp_f32 v202, v202
v_mfma_f32_16x16x32_bf16 v[196:199], a[128:131], v[48:51], 0
v_exp_f32 v203, v203
v_mfma_f32_16x16x32_bf16 v[196:199], a[132:135], v[52:55], v[196:199]
ds_read_b64_tr_b16 a[156:157], v235 offset:45056
v_cvt_pk_bf16_f32 v190, v200, v201
v_mfma_f32_16x16x32_bf16 v[196:199], a[136:139], v[56:59], v[196:199]
ds_read_b64_tr_b16 a[158:159], v235 offset:47104
v_cvt_pk_bf16_f32 v191, v202, v203
v_mfma_f32_16x16x32_bf16 v[196:199], a[140:143], v[60:63], v[196:199]
ds_read_b64_tr_b16 a[160:161], v235 offset:49152
v_add_f32 v224, v208, v210
v_mfma_f32_16x16x32_bf16 v[196:199], a[144:147], v[64:67], v[196:199]
ds_read_b64_tr_b16 a[162:163], v235 offset:51200
v_add_f32 v224, v224, v212
v_mfma_f32_16x16x32_bf16 v[196:199], a[148:151], v[68:71], v[196:199]
buffer_load_dwordx4 v239, s[20:23], s52 offen offset:128 nt lds
v_mfma_f32_16x16x32_bf16 v[214:217], a[252:255], v[188:191], v[214:217]
s_add_u32 m0, s39, s56
v_min3_f32 v225, v208, v210, v212
v_mfma_f32_16x16x32_bf16 v[200:203], a[148:151], v[116:119], 0
ds_read_b64_tr_b16 a[164:165], v235 offset:53248
buffer_load_dwordx4 v239, s[92:95], s62 offen lds
v_mfma_f32_16x16x32_bf16 v[200:203], a[144:147], v[112:115], v[200:203]
ds_read_b64_tr_b16 a[166:167], v235 offset:55296
s_add_u32 m0, s39, s57
v_mfma_f32_16x16x32_bf16 v[200:203], a[140:143], v[108:111], v[200:203]
ds_read_b64_tr_b16 a[168:169], v235 offset:57344
v_add_f32 v224, v224, v214
v_mfma_f32_16x16x32_bf16 v[200:203], a[136:139], v[104:107], v[200:203]
ds_read_b64_tr_b16 a[170:171], v235 offset:59392
v_cmp_ngt_f32 vcc, s42, v224
v_mfma_f32_16x16x32_bf16 v[200:203], a[132:135], v[100:103], v[200:203]
ds_read_b64_tr_b16 a[172:173], v235 offset:61440
v_min_f32 v225, v225, v214
v_mfma_f32_16x16x32_bf16 v[200:203], a[128:131], v[96:99], v[200:203]
ds_read_b64_tr_b16 a[174:175], v235 offset:63488
v_cmp_gt_f32_e64 s[98:99], s100, v225
v_mfma_f32_16x16x32_bf16 v[204:207], a[128:131], v[144:147], 0
buffer_load_dwordx4 v239, s[92:95], s63 offen lds
v_mfma_f32_16x16x32_bf16 v[204:207], a[132:135], v[148:151], v[204:207]
s_or_b64 vcc, vcc, s[98:99]
s_add_u32 m0, s46, 20352
v_xor_b32 v235, 32, v235
v_mfma_f32_16x16x32_bf16 v[204:207], a[136:139], v[152:155], v[204:207]
buffer_load_dwordx4 v239, s[20:23], s53 offen offset:128 nt lds
v_mfma_f32_16x16x32_bf16 v[204:207], a[140:143], v[156:159], v[204:207]
s_add_u32 m0, s39, s58
v_mfma_f32_16x16x32_bf16 v[204:207], a[144:147], v[160:163], v[204:207]
v_mfma_f32_16x16x32_bf16 v[204:207], a[148:151], v[164:167], v[204:207]
s_waitcnt lgkmcnt(0)
s_cbranch_vccnz L_fb0
L_back0:
v_mfma_f32_16x16x32_bf16 v[204:207], a[172:175], v[188:191], v[204:207]
v_rcp_f32 v247, v214
v_mfma_f32_16x16x32_bf16 v[204:207], a[168:171], v[184:187], v[204:207]
ds_read_b64_tr_b16 a[128:129], v235 offset:16384
v_accvgpr_mov_b32 a0, a176
v_mfma_f32_16x16x32_bf16 v[204:207], a[164:167], v[180:183], v[204:207]
ds_read_b64_tr_b16 a[130:131], v235 offset:18432
v_accvgpr_mov_b32 a1, a177
v_mfma_f32_16x16x32_bf16 v[204:207], a[160:163], v[176:179], v[204:207]
ds_read_b64_tr_b16 a[132:133], v235 offset:20480
v_accvgpr_mov_b32 a2, a178
v_mfma_f32_16x16x32_bf16 v[204:207], a[156:159], v[172:175], v[204:207]
v_rcp_f32 v246, v212
v_mfma_f32_16x16x32_bf16 v[204:207], a[152:155], v[168:171], v[204:207]
ds_read_b64_tr_b16 a[134:135], v235 offset:22528
v_accvgpr_mov_b32 a3, a179
v_mfma_f32_16x16x32_bf16 v[200:203], a[152:155], v[120:123], v[200:203]
ds_read_b64_tr_b16 a[136:137], v235 offset:24576
v_accvgpr_mov_b32 a4, a180
v_mfma_f32_16x16x32_bf16 v[200:203], a[156:159], v[124:127], v[200:203]
ds_read_b64_tr_b16 a[138:139], v235 offset:26624
v_accvgpr_mov_b32 a5, a181
v_mfma_f32_16x16x32_bf16 v[200:203], a[160:163], v[128:131], v[200:203]
buffer_load_dwordx4 v239, s[92:95], s64 offen lds
v_mfma_f32_16x16x32_bf16 v[200:203], a[164:167], v[132:135], v[200:203]
ds_read_b64_tr_b16 a[140:141], v235 offset:28672
v_max3_f32 v228, |v204|, |v205|, |v206|
v_mfma_f32_16x16x32_bf16 v[200:203], a[168:171], v[136:139], v[200:203]
ds_read_b64_tr_b16 a[142:143], v235 offset:30720
v_mul_f32 v204, v247, v204
v_mfma_f32_16x16x32_bf16 v[200:203], a[172:175], v[140:143], v[200:203]
ds_read_b64_tr_b16 a[144:145], v235 offset:32768
s_waitcnt vmcnt(8)
v_mfma_f32_16x16x32_bf16 v[196:199], a[172:175], v[92:95], v[196:199]
ds_read_b128 a[232:235], v232 offset:24576
v_rcp_f32 v244, v208
v_mfma_f32_16x16x32_bf16 v[196:199], a[168:171], v[88:91], v[196:199]
ds_read_b64_tr_b16 a[146:147], v235 offset:34816
v_rcp_f32 v245, v210
v_mfma_f32_16x16x32_bf16 v[196:199], a[164:167], v[84:87], v[196:199]
ds_read_b64_tr_b16 a[148:149], v235 offset:36864
v_mul_f32 v205, v247, v205
v_mfma_f32_16x16x32_bf16 v[196:199], a[160:163], v[80:83], v[196:199]
ds_read_b64_tr_b16 a[150:151], v235 offset:38912
v_cvt_pk_bf16_f32 v216, v204, v205
v_mfma_f32_16x16x32_bf16 v[196:199], a[156:159], v[76:79], v[196:199]
ds_read_b128 a[236:239], v233 offset:24576
v_mul_f32 v206, v247, v206
v_mfma_f32_16x16x32_bf16 v[196:199], a[152:155], v[72:75], v[196:199]
s_add_u32 m0, s39, s59
v_max_f32_e64 v228, v228, |v207|
v_mul_f32 v207, v247, v207
v_mfma_f32_16x16x32_bf16 v[192:195], a[152:155], v[24:27], v[192:195]
buffer_load_dwordx4 v239, s[92:95], s65 offen lds
v_mfma_f32_16x16x32_bf16 v[192:195], a[156:159], v[28:31], v[192:195]
s_add_u32 m0, s46, 24320
v_cvt_pk_bf16_f32 v217, v206, v207
v_max3_f32 v229, |v200|, |v201|, |v202|
v_mfma_f32_16x16x32_bf16 v[192:195], a[160:163], v[32:35], v[192:195]
v_mul_f32 v200, v246, v200
v_mul_f32 v201, v246, v201
v_mfma_f32_16x16x32_bf16 v[192:195], a[164:167], v[36:39], v[192:195]
s_waitcnt lgkmcnt(0)
v_cvt_pk_bf16_f32 v208, v200, v201
v_mul_f32 v202, v246, v202
v_mfma_f32_16x16x32_bf16 v[192:195], a[168:171], v[40:43], v[192:195]
buffer_load_dwordx4 v239, s[20:23], s52 offen offset:256 nt lds
v_mfma_f32_16x16x32_bf16 v[192:195], a[172:175], v[44:47], v[192:195]
s_waitcnt lgkmcnt(1)
v_max_f32_e64 v229, v229, |v203|
v_mul_f32 v203, v246, v203
v_mfma_f32_16x16x32_bf16 v[204:207], a[148:151], v[164:167], 0
s_add_u32 m0, s39, s60
v_cvt_pk_bf16_f32 v209, v202, v203
v_min_f32 v228, v228, v229
v_mfma_f32_16x16x32_bf16 v[204:207], a[144:147], v[160:163], v[204:207]
ds_read_b64_tr_b16 a[152:153], v235 offset:40960
v_max3_f32 v229, |v196|, |v197|, |v198|
v_mfma_f32_16x16x32_bf16 v[204:207], a[140:143], v[156:159], v[204:207]
ds_read_b64_tr_b16 a[154:155], v235 offset:43008
v_mul_f32 v196, v245, v196
v_mfma_f32_16x16x32_bf16 v[204:207], a[136:139], v[152:155], v[204:207]
ds_read_b64_tr_b16 a[156:157], v235 offset:45056
v_mul_f32 v197, v245, v197
v_mfma_f32_16x16x32_bf16 v[204:207], a[132:135], v[148:151], v[204:207]
buffer_load_dwordx4 v239, s[92:95], s66 offen lds
v_mfma_f32_16x16x32_bf16 v[204:207], a[128:131], v[144:147], v[204:207]
ds_read_b64_tr_b16 a[158:159], v235 offset:47104
v_cvt_pk_bf16_f32 v226, v196, v197
v_mfma_f32_16x16x32_bf16 v[200:203], a[128:131], v[96:99], 0
ds_read_b64_tr_b16 a[160:161], v235 offset:49152
v_mul_f32 v198, v245, v198
v_mfma_f32_16x16x32_bf16 v[200:203], a[132:135], v[100:103], v[200:203]
ds_read_b64_tr_b16 a[162:163], v235 offset:51200
v_max_f32_e64 v229, v229, |v199|
v_mfma_f32_16x16x32_bf16 v[200:203], a[136:139], v[104:107], v[200:203]
s_add_u32 m0, s46, 28416
v_mul_f32 v199, v245, v199
v_cvt_pk_bf16_f32 v227, v198, v199
v_mfma_f32_16x16x32_bf16 v[200:203], a[140:143], v[108:111], v[200:203]
ds_read_b64_tr_b16 a[164:165], v235 offset:53248
v_min_f32 v228, v228, v229
v_mfma_f32_16x16x32_bf16 v[200:203], a[144:147], v[112:115], v[200:203]
ds_read_b64_tr_b16 a[166:167], v235 offset:55296
v_max3_f32 v229, |v192|, |v193|, |v194|
v_mfma_f32_16x16x32_bf16 v[200:203], a[148:151], v[116:119], v[200:203]
ds_read_b64_tr_b16 a[168:169], v235 offset:57344
v_mul_f32 v192, v244, v192
v_mfma_f32_16x16x32_bf16 v[196:199], a[148:151], v[68:71], 0
buffer_load_dwordx4 v239, s[20:23], s53 offen offset:256 nt lds
v_mfma_f32_16x16x32_bf16 v[196:199], a[144:147], v[64:67], v[196:199]
ds_read_b64_tr_b16 a[170:171], v235 offset:59392
v_mul_f32 v193, v244, v193
v_mfma_f32_16x16x32_bf16 v[196:199], a[140:143], v[60:63], v[196:199]
ds_read_b64_tr_b16 a[172:173], v235 offset:61440
v_cvt_pk_bf16_f32 v224, v192, v193
v_mfma_f32_16x16x32_bf16 v[196:199], a[136:139], v[56:59], v[196:199]
ds_read_b64_tr_b16 a[174:175], v235 offset:63488
v_mul_f32 v194, v244, v194
v_mfma_f32_16x16x32_bf16 v[196:199], a[132:135], v[52:55], v[196:199]
s_add_u32 m0, s39, s61
v_max_f32_e64 v229, v229, |v195|
v_mul_f32 v195, v244, v195
v_mfma_f32_16x16x32_bf16 v[196:199], a[128:131], v[48:51], v[196:199]
v_cvt_pk_bf16_f32 v225, v194, v195
v_min_f32 v228, v228, v229
v_mfma_f32_16x16x32_bf16 v[192:195], a[128:131], v[0:3], 0
buffer_load_dwordx4 v239, s[92:95], s67 offen lds
v_mfma_f32_16x16x32_bf16 v[192:195], a[132:135], v[4:7], v[192:195]
ds_write_b64 v240, v[224:225] offset:0
v_mfma_f32_16x16x32_bf16 v[192:195], a[136:139], v[8:11], v[192:195]
ds_write_b64 v240, v[226:227] offset:8192
v_mfma_f32_16x16x32_bf16 v[192:195], a[140:143], v[12:15], v[192:195]
s_add_u32 m0, s40, s56
v_xor_b32 v235, 0x60, v235
v_cmp_gt_f32 vcc, s79, v228
v_mfma_f32_16x16x32_bf16 v[192:195], a[144:147], v[16:19], v[192:195]
s_add_u32 s92, s92, 128
s_addc_u32 s93, s93, 0
v_mul_f32 v228, 0x40800000, v228
v_mfma_f32_16x16x32_bf16 v[192:195], a[148:151], v[20:23], v[192:195]
s_waitcnt lgkmcnt(2)
v_cndmask_b32 v228, 0, v228, vcc
v_mov_b32 v229, v228
v_mfma_f32_16x16x32_bf16 v[192:195], a[172:175], v[44:47], v[192:195]
v_mov_b32 v230, v228
v_mov_b32 v231, v228
v_mfma_f32_16x16x32_bf16 v[192:195], a[168:171], v[40:43], v[192:195]
ds_read_b64_tr_b16 a[128:129], v235 offset:16384
v_mul_f32_e64 v252, -v228, v244
v_mfma_f32_16x16x32_bf16 v[192:195], a[164:167], v[36:39], v[192:195]
ds_read_b64_tr_b16 a[130:131], v235 offset:18432
s_waitcnt vmcnt(10)
v_mfma_f32_16x16x32_bf16 v[192:195], a[160:163], v[32:35], v[192:195]
ds_read_b64_tr_b16 a[132:133], v235 offset:20480
v_mul_f32_e64 v253, -v228, v245
v_mfma_f32_16x16x32_bf16 v[192:195], a[156:159], v[28:31], v[192:195]
ds_read_b128 a[64:67], v232 offset:32768
v_mul_f32_e64 v254, -v228, v246
v_mfma_f32_16x16x32_bf16 v[192:195], a[152:155], v[24:27], v[192:195]
ds_read_b64_tr_b16 a[134:135], v235 offset:22528
v_mul_f32_e64 v255, -v228, v247
v_mfma_f32_16x16x32_bf16 v[196:199], a[152:155], v[72:75], v[196:199]
ds_read_b64_tr_b16 a[136:137], v235 offset:24576
v_accvgpr_mov_b32 a6, a182
v_mfma_f32_16x16x32_bf16 v[196:199], a[156:159], v[76:79], v[196:199]
ds_read_b64_tr_b16 a[138:139], v235 offset:26624
v_accvgpr_mov_b32 a7, a183
v_mfma_f32_16x16x32_bf16 v[196:199], a[160:163], v[80:83], v[196:199]
ds_read_b128 a[68:71], v233 offset:32768
v_accvgpr_mov_b32 a8, a184
v_mfma_f32_16x16x32_bf16 v[196:199], a[164:167], v[84:87], v[196:199]
ds_read_b64_tr_b16 a[140:141], v235 offset:28672
v_mul_f32 v192, v244, v192
v_mfma_f32_16x16x32_bf16 v[196:199], a[168:171], v[88:91], v[196:199]
ds_read_b64_tr_b16 a[142:143], v235 offset:30720
v_mul_f32 v193, v244, v193
v_mfma_f32_16x16x32_bf16 v[196:199], a[172:175], v[92:95], v[196:199]
ds_read_b64_tr_b16 a[144:145], v235 offset:32768
v_cvt_pk_bf16_f32 v192, v192, v193
v_mfma_f32_16x16x32_bf16 v[200:203], a[172:175], v[140:143], v[200:203]
buffer_load_dwordx4 v239, s[16:19], s62 offen lds
v_mfma_f32_16x16x32_bf16 v[200:203], a[168:171], v[136:139], v[200:203]
ds_read_b64_tr_b16 a[146:147], v235 offset:34816
s_add_u32 m0, s46, 32384
v_mfma_f32_16x16x32_bf16 v[200:203], a[164:167], v[132:135], v[200:203]
ds_read_b64_tr_b16 a[148:149], v235 offset:36864
s_waitcnt lgkmcnt(5)
v_mfma_f32_16x16x32_bf16 v[200:203], a[160:163], v[128:131], v[200:203]
ds_read_b64_tr_b16 a[150:151], v235 offset:38912
v_mul_f32 v194, v244, v194
v_mfma_f32_16x16x32_bf16 v[200:203], a[156:159], v[124:127], v[200:203]
buffer_load_dwordx4 v239, s[20:23], s52 offen offset:384 nt lds
v_mfma_f32_16x16x32_bf16 v[200:203], a[152:155], v[120:123], v[200:203]
s_add_u32 m0, s40, s57
v_mul_f32 v195, v244, v195
v_cvt_pk_bf16_f32 v193, v194, v195
v_mfma_f32_16x16x32_bf16 v[204:207], a[152:155], v[168:171], v[204:207]
ds_write_b64 v241, v[192:193] offset:0
v_mfma_f32_16x16x32_bf16 v[204:207], a[156:159], v[172:175], v[204:207]
buffer_load_dwordx4 v239, s[16:19], s63 offen lds
v_mfma_f32_16x16x32_bf16 v[204:207], a[160:163], v[176:179], v[204:207]
s_add_u32 m0, s40, s58
v_mul_f32 v196, v245, v196
v_mul_f32 v197, v245, v197
v_mfma_f32_16x16x32_bf16 v[204:207], a[164:167], v[180:183], v[204:207]
v_cvt_pk_bf16_f32 v196, v196, v197
v_mul_f32 v198, v245, v198
v_mfma_f32_16x16x32_bf16 v[204:207], a[168:171], v[184:187], v[204:207]
v_mul_f32 v199, v245, v199
v_cvt_pk_bf16_f32 v197, v198, v199
v_mfma_f32_16x16x32_bf16 v[204:207], a[172:175], v[188:191], v[204:207]
s_waitcnt lgkmcnt(1)
v_mul_f32 v200, v246, v200
v_mul_f32 v201, v246, v201
v_mfma_f32_16x16x32_bf16 v[192:195], a[148:151], v[20:23], v[228:231]
ds_write_b64 v241, v[196:197] offset:8192
v_mfma_f32_16x16x32_bf16 v[192:195], a[144:147], v[16:19], v[192:195]
ds_read_b64_tr_b16 a[152:153], v235 offset:40960
v_cvt_pk_bf16_f32 v210, v200, v201
v_mfma_f32_16x16x32_bf16 v[192:195], a[140:143], v[12:15], v[192:195]
ds_read_b64_tr_b16 a[154:155], v235 offset:43008
v_mul_f32 v202, v246, v202
v_mfma_f32_16x16x32_bf16 v[192:195], a[136:139], v[8:11], v[192:195]
ds_read_b64_tr_b16 a[156:157], v235 offset:45056
v_mul_f32 v203, v246, v203
v_mfma_f32_16x16x32_bf16 v[192:195], a[132:135], v[4:7], v[192:195]
buffer_load_dwordx4 v239, s[16:19], s64 offen lds
v_mfma_f32_16x16x32_bf16 v[192:195], a[128:131], v[0:3], v[192:195]
ds_read_b64_tr_b16 a[158:159], v235 offset:47104
s_add_u32 m0, s46, 36480
v_mfma_f32_16x16x32_bf16 v[196:199], a[128:131], v[48:51], v[228:231]
ds_read_b64_tr_b16 a[160:161], v235 offset:49152
v_cvt_pk_bf16_f32 v211, v202, v203
v_mfma_f32_16x16x32_bf16 v[196:199], a[132:135], v[52:55], v[196:199]
ds_read_b64_tr_b16 a[162:163], v235 offset:51200
v_mul_f32 v204, v247, v204
v_mfma_f32_16x16x32_bf16 v[196:199], a[136:139], v[56:59], v[196:199]
buffer_load_dwordx4 v239, s[20:23], s53 offen offset:384 nt lds
v_mfma_f32_16x16x32_bf16 v[196:199], a[140:143], v[60:63], v[196:199]
ds_read_b64_tr_b16 a[164:165], v235 offset:53248
v_mul_f32 v205, v247, v205
v_mfma_f32_16x16x32_bf16 v[196:199], a[144:147], v[64:67], v[196:199]
ds_read_b64_tr_b16 a[166:167], v235 offset:55296
v_cvt_pk_bf16_f32 v218, v204, v205
v_mfma_f32_16x16x32_bf16 v[196:199], a[148:151], v[68:71], v[196:199]
ds_read_b64_tr_b16 a[168:169], v235 offset:57344
v_mul_f32 v206, v247, v206
v_mfma_f32_16x16x32_bf16 v[200:203], a[148:151], v[116:119], v[228:231]
s_add_u32 m0, s40, s59
v_mul_f32 v207, v247, v207
v_cvt_pk_bf16_f32 v219, v206, v207
v_mfma_f32_16x16x32_bf16 v[200:203], a[144:147], v[112:115], v[200:203]
ds_read_b64_tr_b16 a[170:171], v235 offset:59392
v_accvgpr_mov_b32 a9, a185
v_mfma_f32_16x16x32_bf16 v[200:203], a[140:143], v[108:111], v[200:203]
ds_read_b64_tr_b16 a[172:173], v235 offset:61440
v_accvgpr_mov_b32 a10, a186
v_mfma_f32_16x16x32_bf16 v[200:203], a[136:139], v[104:107], v[200:203]
ds_read_b64_tr_b16 a[174:175], v235 offset:63488
v_xor_b32 v235, 32, v235
v_mfma_f32_16x16x32_bf16 v[200:203], a[132:135], v[100:103], v[200:203]
buffer_load_dwordx4 v239, s[16:19], s65 offen lds
v_mfma_f32_16x16x32_bf16 v[200:203], a[128:131], v[96:99], v[200:203]
s_add_u32 m0, s40, s60
v_accvgpr_mov_b32 a11, a187
v_accvgpr_mov_b32 a12, a188
v_mfma_f32_16x16x32_bf16 v[204:207], a[128:131], v[144:147], v[228:231]
s_waitcnt vmcnt(12)
v_accvgpr_mov_b32 a13, a189
v_accvgpr_mov_b32 a14, a190
v_mfma_f32_16x16x32_bf16 v[204:207], a[132:135], v[148:151], v[204:207]
ds_read_b128 a[72:75], v232 offset:16384
v_accvgpr_mov_b32 a15, a191
v_mfma_f32_16x16x32_bf16 v[204:207], a[136:139], v[152:155], v[204:207]
ds_read_b128 a[76:79], v233 offset:16384
v_accvgpr_mov_b32 a16, a192
v_mfma_f32_16x16x32_bf16 v[204:207], a[140:143], v[156:159], v[204:207]
v_accvgpr_mov_b32 a17, a193
v_accvgpr_mov_b32 a18, a194
v_mfma_f32_16x16x32_bf16 v[204:207], a[144:147], v[160:163], v[204:207]
v_accvgpr_mov_b32 a19, a195
v_accvgpr_mov_b32 a20, a196
v_mfma_f32_16x16x32_bf16 v[204:207], a[148:151], v[164:167], v[204:207]
s_waitcnt lgkmcnt(2)
v_accvgpr_mov_b32 a21, a197
v_accvgpr_mov_b32 a22, a198
v_mfma_f32_16x16x32_bf16 v[204:207], a[172:175], v[188:191], v[204:207]
v_accvgpr_mov_b32 a23, a199
v_accvgpr_mov_b32 a24, a200
v_mfma_f32_16x16x32_bf16 v[204:207], a[168:171], v[184:187], v[204:207]
ds_read_b64_tr_b16 a[128:129], v235 offset:16384
s_waitcnt lgkmcnt(1)
v_mfma_f32_16x16x32_bf16 v[204:207], a[164:167], v[180:183], v[204:207]
ds_read_b64_tr_b16 a[130:131], v235 offset:18432
v_accvgpr_mov_b32 a25, a201
v_mfma_f32_16x16x32_bf16 v[204:207], a[160:163], v[176:179], v[204:207]
ds_read_b64_tr_b16 a[132:133], v235 offset:20480
v_accvgpr_mov_b32 a26, a202
v_mfma_f32_16x16x32_bf16 v[204:207], a[156:159], v[172:175], v[204:207]
buffer_load_dwordx4 v239, s[16:19], s66 offen lds
v_mfma_f32_16x16x32_bf16 v[204:207], a[152:155], v[168:171], v[204:207]
ds_read_b64_tr_b16 a[134:135], v235 offset:22528
s_add_u32 m0, s46, 16384
v_mfma_f32_16x16x32_bf16 v[200:203], a[152:155], v[120:123], v[200:203]
ds_read_b64_tr_b16 a[136:137], v235 offset:24576
v_accvgpr_mov_b32 a27, a203
v_mfma_f32_16x16x32_bf16 v[200:203], a[156:159], v[124:127], v[200:203]
ds_read_b64_tr_b16 a[138:139], v235 offset:26624
v_accvgpr_mov_b32 a28, a204
v_mfma_f32_16x16x32_bf16 v[200:203], a[160:163], v[128:131], v[200:203]
buffer_load_dwordx4 v239, s[20:23], s54 offen offset:0 nt lds
v_mfma_f32_16x16x32_bf16 v[200:203], a[164:167], v[132:135], v[200:203]
ds_read_b64_tr_b16 a[140:141], v235 offset:28672
v_fma_f32 v204, v204, v247, v255
v_mfma_f32_16x16x32_bf16 v[200:203], a[168:171], v[136:139], v[200:203]
ds_read_b64_tr_b16 a[142:143], v235 offset:30720
v_fma_f32 v205, v205, v247, v255
v_mfma_f32_16x16x32_bf16 v[200:203], a[172:175], v[140:143], v[200:203]
ds_read_b64_tr_b16 a[144:145], v235 offset:32768
v_cvt_pk_bf16_f32 v220, v204, v205
v_mfma_f32_16x16x32_bf16 v[196:199], a[172:175], v[92:95], v[196:199]
s_add_u32 m0, s40, s61
v_fma_f32 v206, v206, v247, v255
v_fma_f32 v207, v207, v247, v255
v_mfma_f32_16x16x32_bf16 v[196:199], a[168:171], v[88:91], v[196:199]
ds_read_b64_tr_b16 a[146:147], v235 offset:34816
v_cvt_pk_bf16_f32 v221, v206, v207
v_mfma_f32_16x16x32_bf16 v[196:199], a[164:167], v[84:87], v[196:199]
ds_read_b64_tr_b16 a[148:149], v235 offset:36864
v_accvgpr_mov_b32 a29, a205
v_mfma_f32_16x16x32_bf16 v[196:199], a[160:163], v[80:83], v[196:199]
ds_read_b64_tr_b16 a[150:151], v235 offset:38912
v_fma_f32 v200, v200, v246, v254
v_mfma_f32_16x16x32_bf16 v[196:199], a[156:159], v[76:79], v[196:199]
buffer_load_dwordx4 v239, s[16:19], s67 offen lds
v_mfma_f32_16x16x32_bf16 v[196:199], a[152:155], v[72:75], v[196:199]
s_add_u32 m0, s46, 20480
v_fma_f32 v201, v201, v246, v254
v_cvt_pk_bf16_f32 v212, v200, v201
v_mfma_f32_16x16x32_bf16 v[192:195], a[152:155], v[24:27], v[192:195]
v_fma_f32 v202, v202, v246, v254
v_fma_f32 v203, v203, v246, v254
v_mfma_f32_16x16x32_bf16 v[192:195], a[156:159], v[28:31], v[192:195]
s_add_u32 s16, s16, 128
s_addc_u32 s17, s17, 0
v_cvt_pk_bf16_f32 v213, v202, v203
v_mfma_f32_16x16x32_bf16 v[192:195], a[160:163], v[32:35], v[192:195]
buffer_load_dwordx4 v239, s[20:23], s55 offen offset:0 nt lds
v_mfma_f32_16x16x32_bf16 v[192:195], a[164:167], v[36:39], v[192:195]
s_add_u32 m0, s46, 24448
v_fma_f32 v196, v196, v245, v253
v_fma_f32 v197, v197, v245, v253
v_mfma_f32_16x16x32_bf16 v[192:195], a[168:171], v[40:43], v[192:195]
v_cvt_pk_bf16_f32 v196, v196, v197
v_fma_f32 v198, v198, v245, v253
v_mfma_f32_16x16x32_bf16 v[192:195], a[172:175], v[44:47], v[192:195]
s_waitcnt lgkmcnt(0)
v_fma_f32 v199, v199, v245, v253
v_cvt_pk_bf16_f32 v197, v198, v199
v_mfma_f32_16x16x32_bf16 v[204:207], a[148:151], v[164:167], v[228:231]
ds_write_b64 v242, v[196:197] offset:8192
v_mfma_f32_16x16x32_bf16 v[204:207], a[144:147], v[160:163], v[204:207]
ds_read_b64_tr_b16 a[152:153], v235 offset:40960
v_accvgpr_mov_b32 a30, a206
v_mfma_f32_16x16x32_bf16 v[204:207], a[140:143], v[156:159], v[204:207]
ds_read_b64_tr_b16 a[154:155], v235 offset:43008
v_accvgpr_mov_b32 a31, a207
v_mfma_f32_16x16x32_bf16 v[204:207], a[136:139], v[152:155], v[204:207]
ds_read_b64_tr_b16 a[156:157], v235 offset:45056
v_fma_f32 v192, v192, v244, v252
v_mfma_f32_16x16x32_bf16 v[204:207], a[132:135], v[148:151], v[204:207]
v_fma_f32 v193, v193, v244, v252
v_cvt_pk_bf16_f32 v192, v192, v193
v_mfma_f32_16x16x32_bf16 v[204:207], a[128:131], v[144:147], v[204:207]
ds_read_b64_tr_b16 a[158:159], v235 offset:47104
v_fma_f32 v194, v194, v244, v252
v_mfma_f32_16x16x32_bf16 v[200:203], a[128:131], v[96:99], v[228:231]
ds_read_b64_tr_b16 a[160:161], v235 offset:49152
v_fma_f32 v195, v195, v244, v252
v_mfma_f32_16x16x32_bf16 v[200:203], a[132:135], v[100:103], v[200:203]
ds_read_b64_tr_b16 a[162:163], v235 offset:51200
v_cvt_pk_bf16_f32 v193, v194, v195
v_mfma_f32_16x16x32_bf16 v[200:203], a[136:139], v[104:107], v[200:203]
v_accvgpr_mov_b32 a32, a208
v_accvgpr_mov_b32 a33, a209
v_mfma_f32_16x16x32_bf16 v[200:203], a[140:143], v[108:111], v[200:203]
ds_read_b64_tr_b16 a[164:165], v235 offset:53248
v_accvgpr_mov_b32 a34, a210
v_mfma_f32_16x16x32_bf16 v[200:203], a[144:147], v[112:115], v[200:203]
ds_read_b64_tr_b16 a[166:167], v235 offset:55296
v_accvgpr_mov_b32 a35, a211
v_mfma_f32_16x16x32_bf16 v[200:203], a[148:151], v[116:119], v[200:203]
ds_read_b64_tr_b16 a[168:169], v235 offset:57344
v_accvgpr_mov_b32 a36, a212
v_mfma_f32_16x16x32_bf16 v[196:199], a[148:151], v[68:71], v[228:231]
v_accvgpr_mov_b32 a37, a213
v_accvgpr_mov_b32 a38, a214
v_mfma_f32_16x16x32_bf16 v[196:199], a[144:147], v[64:67], v[196:199]
ds_read_b64_tr_b16 a[170:171], v235 offset:59392
v_accvgpr_mov_b32 a39, a215
v_mfma_f32_16x16x32_bf16 v[196:199], a[140:143], v[60:63], v[196:199]
ds_read_b64_tr_b16 a[172:173], v235 offset:61440
v_accvgpr_mov_b32 a40, a216
v_mfma_f32_16x16x32_bf16 v[196:199], a[136:139], v[56:59], v[196:199]
ds_read_b64_tr_b16 a[174:175], v235 offset:63488
s_waitcnt vmcnt(11)
v_mfma_f32_16x16x32_bf16 v[196:199], a[132:135], v[52:55], v[196:199]
ds_write_b64 v242, v[192:193] offset:0
v_mfma_f32_16x16x32_bf16 v[196:199], a[128:131], v[48:51], v[196:199]
ds_read_b128 a[80:83], v232 offset:24576
v_xor_b32 v235, 0x60, v235
v_mfma_f32_16x16x32_bf16 v[192:195], a[128:131], v[0:3], v[228:231]
ds_read_b128 a[84:87], v233 offset:24576
v_accvgpr_mov_b32 a41, a217
v_mfma_f32_16x16x32_bf16 v[192:195], a[132:135], v[4:7], v[192:195]
v_accvgpr_mov_b32 a42, a218
v_accvgpr_mov_b32 a43, a219
v_mfma_f32_16x16x32_bf16 v[192:195], a[136:139], v[8:11], v[192:195]
v_accvgpr_mov_b32 a44, a220
v_accvgpr_mov_b32 a45, a221
v_mfma_f32_16x16x32_bf16 v[192:195], a[140:143], v[12:15], v[192:195]
v_accvgpr_mov_b32 a46, a222
v_accvgpr_mov_b32 a47, a223
v_mfma_f32_16x16x32_bf16 v[192:195], a[144:147], v[16:19], v[192:195]
v_accvgpr_mov_b32 a48, a224
v_accvgpr_mov_b32 a49, a225
v_mfma_f32_16x16x32_bf16 v[192:195], a[148:151], v[20:23], v[192:195]
s_waitcnt vmcnt(10) lgkmcnt(3)
s_waitcnt lgkmcnt(0)
v_accvgpr_mov_b32 a50, a226
v_mfma_f32_16x16x32_bf16 v[192:195], a[172:175], v[44:47], v[192:195]
s_barrier
v_accvgpr_mov_b32 a51, a227
v_accvgpr_mov_b32 a52, a228
v_mfma_f32_16x16x32_bf16 v[192:195], a[168:171], v[40:43], v[192:195]
ds_read_b64_tr_b16 a[128:129], v234 offset:0
v_accvgpr_mov_b32 a53, a229
v_mfma_f32_16x16x32_bf16 v[192:195], a[164:167], v[36:39], v[192:195]
ds_read_b64_tr_b16 a[130:131], v234 offset:2048
v_accvgpr_mov_b32 a54, a230
v_mfma_f32_16x16x32_bf16 v[192:195], a[160:163], v[32:35], v[192:195]
ds_read_b64_tr_b16 a[132:133], v234 offset:4096
v_accvgpr_mov_b32 a55, a231
v_mfma_f32_16x16x32_bf16 v[192:195], a[156:159], v[28:31], v[192:195]
buffer_load_dwordx4 v239, s[20:23], s54 offen offset:128 nt lds
v_mfma_f32_16x16x32_bf16 v[192:195], a[152:155], v[24:27], v[192:195]
ds_read_b64_tr_b16 a[134:135], v234 offset:6144
s_add_u32 m0, s69, s56
v_mfma_f32_16x16x32_bf16 v[196:199], a[152:155], v[72:75], v[196:199]
ds_read_b64_tr_b16 a[136:137], v234 offset:8192
v_accvgpr_mov_b32 a56, a232
v_mfma_f32_16x16x32_bf16 v[196:199], a[156:159], v[76:79], v[196:199]
ds_read_b64_tr_b16 a[138:139], v234 offset:10240
v_accvgpr_mov_b32 a57, a233
v_mfma_f32_16x16x32_bf16 v[196:199], a[160:163], v[80:83], v[196:199]
buffer_load_dwordx4 v239, s[92:95], s62 offen lds
v_mfma_f32_16x16x32_bf16 v[196:199], a[164:167], v[84:87], v[196:199]
ds_read_b64_tr_b16 a[140:141], v234 offset:12288
v_fma_f32 v192, v192, v244, v252
v_mfma_f32_16x16x32_bf16 v[196:199], a[168:171], v[88:91], v[196:199]
ds_read_b64_tr_b16 a[142:143], v234 offset:14336
v_fma_f32 v193, v193, v244, v252
v_mfma_f32_16x16x32_bf16 v[196:199], a[172:175], v[92:95], v[196:199]
ds_read_b64_tr_b16 a[144:145], v234 offset:16384
v_cvt_pk_bf16_f32 v192, v192, v193
v_mfma_f32_16x16x32_bf16 v[200:203], a[172:175], v[140:143], v[200:203]
s_add_u32 m0, s46, 28544
v_fma_f32 v194, v194, v244, v252
v_fma_f32 v195, v195, v244, v252
v_mfma_f32_16x16x32_bf16 v[200:203], a[168:171], v[136:139], v[200:203]
ds_read_b64_tr_b16 a[146:147], v234 offset:18432
v_cvt_pk_bf16_f32 v193, v194, v195
v_mfma_f32_16x16x32_bf16 v[200:203], a[164:167], v[132:135], v[200:203]
ds_read_b64_tr_b16 a[148:149], v234 offset:20480
v_accvgpr_mov_b32 a58, a234
v_mfma_f32_16x16x32_bf16 v[200:203], a[160:163], v[128:131], v[200:203]
ds_read_b64_tr_b16 a[150:151], v234 offset:22528
v_fma_f32 v196, v196, v245, v253
v_mfma_f32_16x16x32_bf16 v[200:203], a[156:159], v[124:127], v[200:203]
ds_write_b64 v243, v[192:193] offset:0
v_mfma_f32_16x16x32_bf16 v[200:203], a[152:155], v[120:123], v[200:203]
buffer_load_dwordx4 v239, s[20:23], s55 offen offset:128 nt lds
v_mfma_f32_16x16x32_bf16 v[204:207], a[152:155], v[168:171], v[204:207]
s_add_u32 m0, s69, s57
v_fma_f32 v197, v197, v245, v253
v_cvt_pk_bf16_f32 v196, v196, v197
v_mfma_f32_16x16x32_bf16 v[204:207], a[156:159], v[172:175], v[204:207]
buffer_load_dwordx4 v239, s[92:95], s63 offen lds
v_mfma_f32_16x16x32_bf16 v[204:207], a[160:163], v[176:179], v[204:207]
ds_read_b128 a[240:243], v248 offset:0
v_fma_f32 v198, v198, v245, v253
v_mfma_f32_16x16x32_bf16 v[204:207], a[164:167], v[180:183], v[204:207]
ds_read_b128 a[244:247], v248 offset:4096
v_fma_f32 v199, v199, v245, v253
v_mfma_f32_16x16x32_bf16 v[204:207], a[168:171], v[184:187], v[204:207]
ds_write_b64 v240, v[208:209] offset:0
v_mfma_f32_16x16x32_bf16 v[204:207], a[172:175], v[188:191], v[204:207]
s_waitcnt lgkmcnt(4)
v_cvt_pk_bf16_f32 v197, v198, v199
v_fma_f32 v200, v200, v246, v254
v_mfma_f32_16x16x32_bf16 v[192:195], a[148:151], v[20:23], v[228:231]
ds_write_b64 v243, v[196:197] offset:8192
v_mfma_f32_16x16x32_bf16 v[192:195], a[144:147], v[16:19], v[192:195]
ds_read_b64_tr_b16 a[152:153], v234 offset:24576
v_fma_f32 v201, v201, v246, v254
v_mfma_f32_16x16x32_bf16 v[192:195], a[140:143], v[12:15], v[192:195]
ds_read_b64_tr_b16 a[154:155], v234 offset:26624
v_cvt_pk_bf16_f32 v214, v200, v201
v_mfma_f32_16x16x32_bf16 v[192:195], a[136:139], v[8:11], v[192:195]
ds_read_b64_tr_b16 a[156:157], v234 offset:28672
v_fma_f32 v202, v202, v246, v254
v_mfma_f32_16x16x32_bf16 v[192:195], a[132:135], v[4:7], v[192:195]
ds_read_b128 a[248:251], v248 offset:8192
v_fma_f32 v203, v203, v246, v254
v_mfma_f32_16x16x32_bf16 v[192:195], a[128:131], v[0:3], v[192:195]
ds_read_b64_tr_b16 a[158:159], v234 offset:30720
v_cvt_pk_bf16_f32 v215, v202, v203
v_mfma_f32_16x16x32_bf16 v[196:199], a[128:131], v[48:51], v[228:231]
ds_read_b64_tr_b16 a[160:161], v234 offset:32768
v_fma_f32 v204, v204, v247, v255
v_mfma_f32_16x16x32_bf16 v[196:199], a[132:135], v[52:55], v[196:199]
ds_read_b64_tr_b16 a[162:163], v234 offset:34816
v_fma_f32 v205, v205, v247, v255
v_mfma_f32_16x16x32_bf16 v[196:199], a[136:139], v[56:59], v[196:199]
ds_read_b128 a[176:179], v248 offset:12288
v_cvt_pk_bf16_f32 v222, v204, v205
v_mfma_f32_16x16x32_bf16 v[196:199], a[140:143], v[60:63], v[196:199]
ds_read_b64_tr_b16 a[164:165], v234 offset:36864
v_fma_f32 v206, v206, v247, v255
v_mfma_f32_16x16x32_bf16 v[196:199], a[144:147], v[64:67], v[196:199]
ds_read_b64_tr_b16 a[166:167], v234 offset:38912
s_add_u32 m0, s69, s58
v_mfma_f32_16x16x32_bf16 v[196:199], a[148:151], v[68:71], v[196:199]
ds_read_b64_tr_b16 a[168:169], v234 offset:40960
v_fma_f32 v207, v207, v247, v255
v_mfma_f32_16x16x32_bf16 v[200:203], a[148:151], v[116:119], v[228:231]
buffer_load_dwordx4 v239, s[92:95], s64 offen lds
v_mfma_f32_16x16x32_bf16 v[200:203], a[144:147], v[112:115], v[200:203]
ds_read_b64_tr_b16 a[170:171], v234 offset:43008
v_cvt_pk_bf16_f32 v223, v206, v207
v_mfma_f32_16x16x32_bf16 v[200:203], a[140:143], v[108:111], v[200:203]
ds_read_b64_tr_b16 a[172:173], v234 offset:45056
s_waitcnt lgkmcnt(15)
v_mfma_f32_16x16x32_bf16 v[200:203], a[136:139], v[104:107], v[200:203]
ds_read_b64_tr_b16 a[174:175], v234 offset:47104
v_xor_b32 v234, 32, v234
v_mfma_f32_16x16x32_bf16 v[200:203], a[132:135], v[100:103], v[200:203]
buffer_store_dwordx4 a[240:243], v239, s[24:27], s48 offen offset:0 sc1
v_mfma_f32_16x16x32_bf16 v[200:203], a[128:131], v[96:99], v[200:203]
ds_write_b64 v240, v[216:217] offset:8192
v_mfma_f32_16x16x32_bf16 v[204:207], a[128:131], v[144:147], v[228:231]
ds_write_b64 v241, v[210:211] offset:0
v_mfma_f32_16x16x32_bf16 v[204:207], a[132:135], v[148:151], v[204:207]
ds_write_b64 v242, v[212:213] offset:0
v_mfma_f32_16x16x32_bf16 v[204:207], a[136:139], v[152:155], v[204:207]
ds_write_b64 v243, v[214:215] offset:0
v_mfma_f32_16x16x32_bf16 v[204:207], a[140:143], v[156:159], v[204:207]
ds_write_b64 v241, v[218:219] offset:8192
v_mfma_f32_16x16x32_bf16 v[204:207], a[144:147], v[160:163], v[204:207]
ds_write_b64 v242, v[220:221] offset:8192
v_mfma_f32_16x16x32_bf16 v[204:207], a[148:151], v[164:167], v[204:207]
s_waitcnt lgkmcnt(6)
s_add_u32 m0, s69, s59
s_waitcnt vmcnt(11)
v_mfma_f32_16x16x32_bf16 v[204:207], a[172:175], v[188:191], v[204:207]
buffer_load_dwordx4 v239, s[92:95], s65 offen lds
v_mfma_f32_16x16x32_bf16 v[204:207], a[168:171], v[184:187], v[204:207]
ds_read_b64_tr_b16 a[128:129], v234 offset:0
s_add_u32 m0, s69, s60
v_mfma_f32_16x16x32_bf16 v[204:207], a[164:167], v[180:183], v[204:207]
ds_read_b64_tr_b16 a[130:131], v234 offset:2048
s_waitcnt lgkmcnt(14)
v_mfma_f32_16x16x32_bf16 v[204:207], a[160:163], v[176:179], v[204:207]
ds_read_b64_tr_b16 a[132:133], v234 offset:4096
v_accvgpr_mov_b32 a59, a235
v_mfma_f32_16x16x32_bf16 v[204:207], a[156:159], v[172:175], v[204:207]
ds_read_b128 a[88:91], v232 offset:32768
v_accvgpr_mov_b32 a60, a236
v_mfma_f32_16x16x32_bf16 v[204:207], a[152:155], v[168:171], v[204:207]
ds_read_b64_tr_b16 a[134:135], v234 offset:6144
v_accvgpr_mov_b32 a61, a237
v_mfma_f32_16x16x32_bf16 v[200:203], a[152:155], v[120:123], v[200:203]
ds_read_b64_tr_b16 a[136:137], v234 offset:8192
v_accvgpr_mov_b32 a62, a238
v_mfma_f32_16x16x32_bf16 v[200:203], a[156:159], v[124:127], v[200:203]
ds_read_b64_tr_b16 a[138:139], v234 offset:10240
v_accvgpr_mov_b32 a63, a239
v_mfma_f32_16x16x32_bf16 v[200:203], a[160:163], v[128:131], v[200:203]
ds_read_b128 a[92:95], v233 offset:32768
v_mfma_f32_16x16x32_bf16 v[200:203], a[164:167], v[132:135], v[200:203]
ds_read_b64_tr_b16 a[140:141], v234 offset:12288
v_fma_f32 v204, v204, v247, v255
v_mfma_f32_16x16x32_bf16 v[200:203], a[168:171], v[136:139], v[200:203]
ds_read_b64_tr_b16 a[142:143], v234 offset:14336
v_fma_f32 v205, v205, v247, v255
v_mfma_f32_16x16x32_bf16 v[200:203], a[172:175], v[140:143], v[200:203]
ds_read_b64_tr_b16 a[144:145], v234 offset:16384
v_cvt_pk_bf16_f32 v216, v204, v205
v_mfma_f32_16x16x32_bf16 v[196:199], a[172:175], v[92:95], v[196:199]
buffer_load_dwordx4 v239, s[92:95], s66 offen lds
v_mfma_f32_16x16x32_bf16 v[196:199], a[168:171], v[88:91], v[196:199]
ds_read_b64_tr_b16 a[146:147], v234 offset:18432
s_waitcnt lgkmcnt(4)
v_mfma_f32_16x16x32_bf16 v[196:199], a[164:167], v[84:87], v[196:199]
ds_read_b64_tr_b16 a[148:149], v234 offset:20480
s_add_u32 m0, s46, 32512
v_mfma_f32_16x16x32_bf16 v[196:199], a[160:163], v[80:83], v[196:199]
ds_read_b64_tr_b16 a[150:151], v234 offset:22528
v_fma_f32 v206, v206, v247, v255
v_mfma_f32_16x16x32_bf16 v[196:199], a[156:159], v[76:79], v[196:199]
buffer_load_dwordx4 v239, s[20:23], s54 offen offset:256 nt lds
v_mfma_f32_16x16x32_bf16 v[196:199], a[152:155], v[72:75], v[196:199]
ds_read_b128 a[180:183], v248 offset:0
v_fma_f32 v207, v207, v247, v255
v_mfma_f32_16x16x32_bf16 v[192:195], a[152:155], v[24:27], v[192:195]
ds_read_b128 a[184:187], v248 offset:4096
v_cvt_pk_bf16_f32 v217, v206, v207
v_mfma_f32_16x16x32_bf16 v[192:195], a[156:159], v[28:31], v[192:195]
ds_write_b64 v243, v[222:223] offset:8192
v_mfma_f32_16x16x32_bf16 v[192:195], a[160:163], v[32:35], v[192:195]
s_add_u32 m0, s69, s61
v_fma_f32 v200, v200, v246, v254
v_fma_f32 v201, v201, v246, v254
v_mfma_f32_16x16x32_bf16 v[192:195], a[164:167], v[36:39], v[192:195]
v_cvt_pk_bf16_f32 v208, v200, v201
v_fma_f32 v202, v202, v246, v254
v_mfma_f32_16x16x32_bf16 v[192:195], a[168:171], v[40:43], v[192:195]
ds_read_b128 a[188:191], v248 offset:8192
v_fma_f32 v203, v203, v246, v254
v_mfma_f32_16x16x32_bf16 v[192:195], a[172:175], v[44:47], v[192:195]
s_waitcnt lgkmcnt(4)
v_cvt_pk_bf16_f32 v209, v202, v203
v_fma_f32 v196, v196, v245, v253
v_mfma_f32_16x16x32_bf16 v[204:207], a[148:151], v[164:167], v[228:231]
ds_read_b128 a[192:195], v248 offset:12288
v_fma_f32 v197, v197, v245, v253
v_mfma_f32_16x16x32_bf16 v[204:207], a[144:147], v[160:163], v[204:207]
ds_read_b64_tr_b16 a[152:153], v234 offset:24576
v_cvt_pk_bf16_f32 v226, v196, v197
v_mfma_f32_16x16x32_bf16 v[204:207], a[140:143], v[156:159], v[204:207]
ds_read_b64_tr_b16 a[154:155], v234 offset:26624
v_fma_f32 v198, v198, v245, v253
v_mfma_f32_16x16x32_bf16 v[204:207], a[136:139], v[152:155], v[204:207]
ds_read_b64_tr_b16 a[156:157], v234 offset:28672
v_fma_f32 v199, v199, v245, v253
v_mfma_f32_16x16x32_bf16 v[204:207], a[132:135], v[148:151], v[204:207]
buffer_load_dwordx4 v239, s[92:95], s67 offen lds
v_mfma_f32_16x16x32_bf16 v[204:207], a[128:131], v[144:147], v[204:207]
ds_read_b64_tr_b16 a[158:159], v234 offset:30720
v_cvt_pk_bf16_f32 v227, v198, v199
v_mfma_f32_16x16x32_bf16 v[200:203], a[128:131], v[96:99], v[228:231]
ds_read_b64_tr_b16 a[160:161], v234 offset:32768
s_add_u32 m0, s46, 36608
v_mfma_f32_16x16x32_bf16 v[200:203], a[132:135], v[100:103], v[200:203]
ds_read_b64_tr_b16 a[162:163], v234 offset:34816
v_fma_f32 v192, v192, v244, v252
v_mfma_f32_16x16x32_bf16 v[200:203], a[136:139], v[104:107], v[200:203]
buffer_load_dwordx4 v239, s[20:23], s55 offen offset:256 nt lds
v_mfma_f32_16x16x32_bf16 v[200:203], a[140:143], v[108:111], v[200:203]
ds_read_b64_tr_b16 a[164:165], v234 offset:36864
v_fma_f32 v193, v193, v244, v252
v_mfma_f32_16x16x32_bf16 v[200:203], a[144:147], v[112:115], v[200:203]
ds_read_b64_tr_b16 a[166:167], v234 offset:38912
v_cvt_pk_bf16_f32 v224, v192, v193
v_mfma_f32_16x16x32_bf16 v[200:203], a[148:151], v[116:119], v[200:203]
ds_read_b64_tr_b16 a[168:169], v234 offset:40960
v_fma_f32 v194, v194, v244, v252
v_mfma_f32_16x16x32_bf16 v[196:199], a[148:151], v[68:71], v[228:231]
buffer_store_dwordx4 a[244:247], v239, s[24:27], s49 offen offset:0 sc1
v_mfma_f32_16x16x32_bf16 v[196:199], a[144:147], v[64:67], v[196:199]
ds_read_b64_tr_b16 a[170:171], v234 offset:43008
v_fma_f32 v195, v195, v244, v252
v_mfma_f32_16x16x32_bf16 v[196:199], a[140:143], v[60:63], v[196:199]
ds_read_b64_tr_b16 a[172:173], v234 offset:45056
v_cvt_pk_bf16_f32 v225, v194, v195
v_mfma_f32_16x16x32_bf16 v[196:199], a[136:139], v[56:59], v[196:199]
ds_read_b64_tr_b16 a[174:175], v234 offset:47104
v_xor_b32 v234, 0x60, v234
v_mfma_f32_16x16x32_bf16 v[196:199], a[132:135], v[52:55], v[196:199]
ds_write_b64 v240, v[226:227] offset:8192
v_mfma_f32_16x16x32_bf16 v[196:199], a[128:131], v[48:51], v[196:199]
ds_write_b64 v240, v[224:225] offset:0
v_mfma_f32_16x16x32_bf16 v[192:195], a[128:131], v[0:3], v[228:231]
s_add_u32 m0, s75, s56
s_waitcnt vmcnt(12)
s_waitcnt lgkmcnt(15)
v_mfma_f32_16x16x32_bf16 v[192:195], a[132:135], v[4:7], v[192:195]
buffer_load_dwordx4 v239, s[16:19], s62 offen lds
v_mfma_f32_16x16x32_bf16 v[192:195], a[136:139], v[8:11], v[192:195]
ds_read_b128 a[96:99], v232 offset:16384
s_add_u32 m0, s75, s57
v_mfma_f32_16x16x32_bf16 v[192:195], a[140:143], v[12:15], v[192:195]
ds_read_b128 a[100:103], v233 offset:16384
s_waitcnt lgkmcnt(15)
v_mfma_f32_16x16x32_bf16 v[192:195], a[144:147], v[16:19], v[192:195]
s_add_u32 s92, s92, 128
s_addc_u32 s93, s93, 0
v_mfma_f32_16x16x32_bf16 v[192:195], a[148:151], v[20:23], v[192:195]
s_waitcnt lgkmcnt(4)
v_mfma_f32_16x16x32_bf16 v[192:195], a[172:175], v[44:47], v[192:195]
v_mfma_f32_16x16x32_bf16 v[192:195], a[168:171], v[40:43], v[192:195]
ds_read_b64_tr_b16 a[128:129], v234 offset:0
v_mfma_f32_16x16x32_bf16 v[192:195], a[164:167], v[36:39], v[192:195]
ds_read_b64_tr_b16 a[130:131], v234 offset:2048
s_waitcnt lgkmcnt(2)
v_mfma_f32_16x16x32_bf16 v[192:195], a[160:163], v[32:35], v[192:195]
ds_read_b64_tr_b16 a[132:133], v234 offset:4096
v_mfma_f32_16x16x32_bf16 v[192:195], a[156:159], v[28:31], v[192:195]
v_mfma_f32_16x16x32_bf16 v[192:195], a[152:155], v[24:27], v[192:195]
ds_read_b64_tr_b16 a[134:135], v234 offset:6144
v_mfma_f32_16x16x32_bf16 v[196:199], a[152:155], v[72:75], v[196:199]
ds_read_b64_tr_b16 a[136:137], v234 offset:8192
v_mfma_f32_16x16x32_bf16 v[196:199], a[156:159], v[76:79], v[196:199]
ds_read_b64_tr_b16 a[138:139], v234 offset:10240
v_mfma_f32_16x16x32_bf16 v[196:199], a[160:163], v[80:83], v[196:199]
buffer_load_dwordx4 v239, s[16:19], s63 offen lds
v_mfma_f32_16x16x32_bf16 v[196:199], a[164:167], v[84:87], v[196:199]
ds_read_b64_tr_b16 a[140:141], v234 offset:12288
v_fma_f32 v192, v192, v244, v252
v_mfma_f32_16x16x32_bf16 v[196:199], a[168:171], v[88:91], v[196:199]
ds_read_b64_tr_b16 a[142:143], v234 offset:14336
v_fma_f32 v193, v193, v244, v252
v_mfma_f32_16x16x32_bf16 v[196:199], a[172:175], v[92:95], v[196:199]
ds_read_b64_tr_b16 a[144:145], v234 offset:16384
v_cvt_pk_bf16_f32 v192, v192, v193
v_mfma_f32_16x16x32_bf16 v[200:203], a[172:175], v[140:143], v[200:203]
s_add_u32 m0, s75, s58
v_fma_f32 v194, v194, v244, v252
v_fma_f32 v195, v195, v244, v252
v_mfma_f32_16x16x32_bf16 v[200:203], a[168:171], v[136:139], v[200:203]
ds_read_b64_tr_b16 a[146:147], v234 offset:18432
v_cvt_pk_bf16_f32 v193, v194, v195
v_mfma_f32_16x16x32_bf16 v[200:203], a[164:167], v[132:135], v[200:203]
ds_read_b64_tr_b16 a[148:149], v234 offset:20480
v_mfma_f32_16x16x32_bf16 v[200:203], a[160:163], v[128:131], v[200:203]
ds_read_b64_tr_b16 a[150:151], v234 offset:22528
v_fma_f32 v196, v196, v245, v253
v_mfma_f32_16x16x32_bf16 v[200:203], a[156:159], v[124:127], v[200:203]
ds_write_b64 v241, v[192:193] offset:0
v_mfma_f32_16x16x32_bf16 v[200:203], a[152:155], v[120:123], v[200:203]
v_fma_f32 v197, v197, v245, v253
v_cvt_pk_bf16_f32 v196, v196, v197
v_mfma_f32_16x16x32_bf16 v[204:207], a[152:155], v[168:171], v[204:207]
v_fma_f32 v198, v198, v245, v253
v_fma_f32 v199, v199, v245, v253
v_mfma_f32_16x16x32_bf16 v[204:207], a[156:159], v[172:175], v[204:207]
v_cvt_pk_bf16_f32 v197, v198, v199
v_mfma_f32_16x16x32_bf16 v[204:207], a[160:163], v[176:179], v[204:207]
ds_write_b64 v241, v[196:197] offset:8192
v_mfma_f32_16x16x32_bf16 v[204:207], a[164:167], v[180:183], v[204:207]
buffer_load_dwordx4 v239, s[16:19], s64 offen lds
v_mfma_f32_16x16x32_bf16 v[204:207], a[168:171], v[184:187], v[204:207]
s_add_u32 m0, s46, 16000
v_fma_f32 v200, v200, v246, v254
v_fma_f32 v201, v201, v246, v254
v_mfma_f32_16x16x32_bf16 v[204:207], a[172:175], v[188:191], v[204:207]
s_waitcnt lgkmcnt(2)
v_cvt_pk_bf16_f32 v210, v200, v201
v_fma_f32 v202, v202, v246, v254
v_mfma_f32_16x16x32_bf16 v[192:195], a[148:151], v[20:23], v[228:231]
v_fma_f32 v203, v203, v246, v254
v_cvt_pk_bf16_f32 v211, v202, v203
v_mfma_f32_16x16x32_bf16 v[192:195], a[144:147], v[16:19], v[192:195]
ds_read_b64_tr_b16 a[152:153], v234 offset:24576
v_mfma_f32_16x16x32_bf16 v[192:195], a[140:143], v[12:15], v[192:195]
ds_read_b64_tr_b16 a[154:155], v234 offset:26624
v_mfma_f32_16x16x32_bf16 v[192:195], a[136:139], v[8:11], v[192:195]
ds_read_b64_tr_b16 a[156:157], v234 offset:28672
v_fma_f32 v204, v204, v247, v255
v_mfma_f32_16x16x32_bf16 v[192:195], a[132:135], v[4:7], v[192:195]
s_waitcnt vmcnt(12)
v_fma_f32 v205, v205, v247, v255
v_cvt_pk_bf16_f32 v218, v204, v205
v_mfma_f32_16x16x32_bf16 v[192:195], a[128:131], v[0:3], v[192:195]
ds_read_b64_tr_b16 a[158:159], v234 offset:30720
v_fma_f32 v206, v206, v247, v255
v_mfma_f32_16x16x32_bf16 v[196:199], a[128:131], v[48:51], v[228:231]
ds_read_b64_tr_b16 a[160:161], v234 offset:32768
v_fma_f32 v207, v207, v247, v255
v_mfma_f32_16x16x32_bf16 v[196:199], a[132:135], v[52:55], v[196:199]
ds_read_b64_tr_b16 a[162:163], v234 offset:34816
v_cvt_pk_bf16_f32 v219, v206, v207
v_mfma_f32_16x16x32_bf16 v[196:199], a[136:139], v[56:59], v[196:199]
buffer_load_dwordx4 v239, s[20:23], s54 offen offset:384 nt lds
v_mfma_f32_16x16x32_bf16 v[196:199], a[140:143], v[60:63], v[196:199]
ds_read_b64_tr_b16 a[164:165], v234 offset:36864
s_add_u32 m0, s75, s59
v_mfma_f32_16x16x32_bf16 v[196:199], a[144:147], v[64:67], v[196:199]
ds_read_b64_tr_b16 a[166:167], v234 offset:38912
v_mfma_f32_16x16x32_bf16 v[196:199], a[148:151], v[68:71], v[196:199]
ds_read_b64_tr_b16 a[168:169], v234 offset:40960
v_mfma_f32_16x16x32_bf16 v[200:203], a[148:151], v[116:119], v[228:231]
buffer_load_dwordx4 v239, s[16:19], s65 offen lds
v_mfma_f32_16x16x32_bf16 v[200:203], a[144:147], v[112:115], v[200:203]
ds_read_b64_tr_b16 a[170:171], v234 offset:43008
s_add_u32 m0, s46, 20096
v_mfma_f32_16x16x32_bf16 v[200:203], a[140:143], v[108:111], v[200:203]
ds_read_b64_tr_b16 a[172:173], v234 offset:45056
v_mfma_f32_16x16x32_bf16 v[200:203], a[136:139], v[104:107], v[200:203]
ds_read_b64_tr_b16 a[174:175], v234 offset:47104
v_xor_b32 v234, 32, v234
v_mfma_f32_16x16x32_bf16 v[200:203], a[132:135], v[100:103], v[200:203]
ds_read_b128 a[104:107], v232 offset:24576
v_mfma_f32_16x16x32_bf16 v[200:203], a[128:131], v[96:99], v[200:203]
ds_read_b128 a[108:111], v233 offset:24576
v_mfma_f32_16x16x32_bf16 v[204:207], a[128:131], v[144:147], v[228:231]
v_mfma_f32_16x16x32_bf16 v[204:207], a[132:135], v[148:151], v[204:207]
v_mfma_f32_16x16x32_bf16 v[204:207], a[136:139], v[152:155], v[204:207]
v_mfma_f32_16x16x32_bf16 v[204:207], a[140:143], v[156:159], v[204:207]
v_mfma_f32_16x16x32_bf16 v[204:207], a[144:147], v[160:163], v[204:207]
buffer_load_dwordx4 v239, s[20:23], s55 offen offset:384 nt lds
v_mfma_f32_16x16x32_bf16 v[204:207], a[148:151], v[164:167], v[204:207]
s_waitcnt lgkmcnt(2)
s_add_u32 m0, s75, s60
s_waitcnt lgkmcnt(0)
v_mfma_f32_16x16x32_bf16 v[204:207], a[172:175], v[188:191], v[204:207]
buffer_load_dwordx4 v239, s[16:19], s66 offen lds
v_mfma_f32_16x16x32_bf16 v[204:207], a[168:171], v[184:187], v[204:207]
ds_read_b64_tr_b16 a[128:129], v234 offset:0
s_add_u32 m0, s75, s61
v_mfma_f32_16x16x32_bf16 v[204:207], a[164:167], v[180:183], v[204:207]
ds_read_b64_tr_b16 a[130:131], v234 offset:2048
v_mfma_f32_16x16x32_bf16 v[204:207], a[160:163], v[176:179], v[204:207]
ds_read_b64_tr_b16 a[132:133], v234 offset:4096
v_mfma_f32_16x16x32_bf16 v[204:207], a[156:159], v[172:175], v[204:207]
buffer_store_dwordx4 a[248:251], v239, s[24:27], s50 offen offset:0 sc1
v_mfma_f32_16x16x32_bf16 v[204:207], a[152:155], v[168:171], v[204:207]
ds_read_b64_tr_b16 a[134:135], v234 offset:6144
v_mfma_f32_16x16x32_bf16 v[200:203], a[152:155], v[120:123], v[200:203]
ds_read_b64_tr_b16 a[136:137], v234 offset:8192
v_mfma_f32_16x16x32_bf16 v[200:203], a[156:159], v[124:127], v[200:203]
ds_read_b64_tr_b16 a[138:139], v234 offset:10240
v_mfma_f32_16x16x32_bf16 v[200:203], a[160:163], v[128:131], v[200:203]
s_add_u32 s20, s4, s96
s_addc_u32 s21, s5, 0
v_mfma_f32_16x16x32_bf16 v[200:203], a[164:167], v[132:135], v[200:203]
ds_read_b64_tr_b16 a[140:141], v234 offset:12288
v_fma_f32 v204, v204, v247, v255
v_mfma_f32_16x16x32_bf16 v[200:203], a[168:171], v[136:139], v[200:203]
ds_read_b64_tr_b16 a[142:143], v234 offset:14336
v_fma_f32 v205, v205, v247, v255
v_mfma_f32_16x16x32_bf16 v[200:203], a[172:175], v[140:143], v[200:203]
ds_read_b64_tr_b16 a[144:145], v234 offset:16384
v_cvt_pk_bf16_f32 v220, v204, v205
v_mfma_f32_16x16x32_bf16 v[196:199], a[172:175], v[92:95], v[196:199]
v_fma_f32 v206, v206, v247, v255
v_fma_f32 v207, v207, v247, v255
v_mfma_f32_16x16x32_bf16 v[196:199], a[168:171], v[88:91], v[196:199]
ds_read_b64_tr_b16 a[146:147], v234 offset:18432
v_cvt_pk_bf16_f32 v221, v206, v207
v_mfma_f32_16x16x32_bf16 v[196:199], a[164:167], v[84:87], v[196:199]
ds_read_b64_tr_b16 a[148:149], v234 offset:20480
v_mfma_f32_16x16x32_bf16 v[196:199], a[160:163], v[80:83], v[196:199]
ds_read_b64_tr_b16 a[150:151], v234 offset:22528
v_fma_f32 v200, v200, v246, v254
v_mfma_f32_16x16x32_bf16 v[196:199], a[156:159], v[76:79], v[196:199]
buffer_load_dwordx4 v239, s[16:19], s67 offen lds
v_mfma_f32_16x16x32_bf16 v[196:199], a[152:155], v[72:75], v[196:199]
s_add_u32 m0, s38, s56
v_fma_f32 v201, v201, v246, v254
v_cvt_pk_bf16_f32 v212, v200, v201
v_mfma_f32_16x16x32_bf16 v[192:195], a[152:155], v[24:27], v[192:195]
s_mov_b32 s18, 24576
v_fma_f32 v202, v202, v246, v254
v_fma_f32 v203, v203, v246, v254
v_mfma_f32_16x16x32_bf16 v[192:195], a[156:159], v[28:31], v[192:195]
s_add_u32 s16, s70, s36
s_addc_u32 s17, s71, 0
v_cvt_pk_bf16_f32 v213, v202, v203
v_mfma_f32_16x16x32_bf16 v[192:195], a[160:163], v[32:35], v[192:195]
v_mfma_f32_16x16x32_bf16 v[192:195], a[164:167], v[36:39], v[192:195]
v_fma_f32 v196, v196, v245, v253
v_fma_f32 v197, v197, v245, v253
v_mfma_f32_16x16x32_bf16 v[192:195], a[168:171], v[40:43], v[192:195]
v_cvt_pk_bf16_f32 v196, v196, v197
v_fma_f32 v198, v198, v245, v253
v_mfma_f32_16x16x32_bf16 v[192:195], a[172:175], v[44:47], v[192:195]
s_waitcnt lgkmcnt(0)
v_fma_f32 v199, v199, v245, v253
v_cvt_pk_bf16_f32 v197, v198, v199
v_mfma_f32_16x16x32_bf16 v[204:207], a[148:151], v[164:167], v[228:231]
ds_write_b64 v242, v[196:197] offset:8192
v_mfma_f32_16x16x32_bf16 v[204:207], a[144:147], v[160:163], v[204:207]
ds_read_b64_tr_b16 a[152:153], v234 offset:24576
v_mfma_f32_16x16x32_bf16 v[204:207], a[140:143], v[156:159], v[204:207]
ds_read_b64_tr_b16 a[154:155], v234 offset:26624
v_mfma_f32_16x16x32_bf16 v[204:207], a[136:139], v[152:155], v[204:207]
ds_read_b64_tr_b16 a[156:157], v234 offset:28672
v_fma_f32 v192, v192, v244, v252
v_mfma_f32_16x16x32_bf16 v[204:207], a[132:135], v[148:151], v[204:207]
v_fma_f32 v193, v193, v244, v252
v_cvt_pk_bf16_f32 v192, v192, v193
v_mfma_f32_16x16x32_bf16 v[204:207], a[128:131], v[144:147], v[204:207]
ds_read_b64_tr_b16 a[158:159], v234 offset:30720
v_fma_f32 v194, v194, v244, v252
v_mfma_f32_16x16x32_bf16 v[200:203], a[128:131], v[96:99], v[228:231]
ds_read_b64_tr_b16 a[160:161], v234 offset:32768
v_fma_f32 v195, v195, v244, v252
v_mfma_f32_16x16x32_bf16 v[200:203], a[132:135], v[100:103], v[200:203]
ds_read_b64_tr_b16 a[162:163], v234 offset:34816
v_cvt_pk_bf16_f32 v193, v194, v195
v_mfma_f32_16x16x32_bf16 v[200:203], a[136:139], v[104:107], v[200:203]
v_mfma_f32_16x16x32_bf16 v[200:203], a[140:143], v[108:111], v[200:203]
ds_read_b64_tr_b16 a[164:165], v234 offset:36864
v_mfma_f32_16x16x32_bf16 v[200:203], a[144:147], v[112:115], v[200:203]
ds_read_b64_tr_b16 a[166:167], v234 offset:38912
v_mfma_f32_16x16x32_bf16 v[200:203], a[148:151], v[116:119], v[200:203]
ds_read_b64_tr_b16 a[168:169], v234 offset:40960
v_mfma_f32_16x16x32_bf16 v[196:199], a[148:151], v[68:71], v[228:231]
v_mfma_f32_16x16x32_bf16 v[196:199], a[144:147], v[64:67], v[196:199]
ds_read_b64_tr_b16 a[170:171], v234 offset:43008
v_mfma_f32_16x16x32_bf16 v[196:199], a[140:143], v[60:63], v[196:199]
ds_read_b64_tr_b16 a[172:173], v234 offset:45056
v_mfma_f32_16x16x32_bf16 v[196:199], a[136:139], v[56:59], v[196:199]
ds_read_b64_tr_b16 a[174:175], v234 offset:47104
v_xor_b32 v234, 0x60, v234
v_mfma_f32_16x16x32_bf16 v[196:199], a[132:135], v[52:55], v[196:199]
ds_write_b64 v242, v[192:193] offset:0
v_mfma_f32_16x16x32_bf16 v[196:199], a[128:131], v[48:51], v[196:199]
s_waitcnt vmcnt(10)
v_mfma_f32_16x16x32_bf16 v[192:195], a[128:131], v[0:3], v[228:231]
ds_read_b128 a[112:115], v232 offset:32768
v_mfma_f32_16x16x32_bf16 v[192:195], a[132:135], v[4:7], v[192:195]
ds_read_b128 a[116:119], v233 offset:32768
v_mfma_f32_16x16x32_bf16 v[192:195], a[136:139], v[8:11], v[192:195]
v_mfma_f32_16x16x32_bf16 v[192:195], a[140:143], v[12:15], v[192:195]
v_mfma_f32_16x16x32_bf16 v[192:195], a[144:147], v[16:19], v[192:195]
v_mfma_f32_16x16x32_bf16 v[192:195], a[148:151], v[20:23], v[192:195]
s_waitcnt vmcnt(11) lgkmcnt(3)
v_mfma_f32_16x16x32_bf16 v[192:195], a[172:175], v[44:47], v[192:195]
s_barrier
s_waitcnt lgkmcnt(0)
v_mfma_f32_16x16x32_bf16 v[192:195], a[168:171], v[40:43], v[192:195]
ds_read_b64_tr_b16 a[128:129], v234 offset:49152
v_mfma_f32_16x16x32_bf16 v[192:195], a[164:167], v[36:39], v[192:195]
ds_read_b64_tr_b16 a[130:131], v234 offset:51200
v_mfma_f32_16x16x32_bf16 v[192:195], a[160:163], v[32:35], v[192:195]
ds_read_b64_tr_b16 a[132:133], v234 offset:53248
v_mfma_f32_16x16x32_bf16 v[192:195], a[156:159], v[28:31], v[192:195]
buffer_load_dwordx4 v239, s[92:95], s62 offen lds
v_mfma_f32_16x16x32_bf16 v[192:195], a[152:155], v[24:27], v[192:195]
ds_read_b64_tr_b16 a[134:135], v234 offset:55296
s_add_u32 m0, s38, s57
v_mfma_f32_16x16x32_bf16 v[196:199], a[152:155], v[72:75], v[196:199]
ds_read_b64_tr_b16 a[136:137], v234 offset:57344
v_mfma_f32_16x16x32_bf16 v[196:199], a[156:159], v[76:79], v[196:199]
ds_read_b64_tr_b16 a[138:139], v234 offset:59392
v_mfma_f32_16x16x32_bf16 v[196:199], a[160:163], v[80:83], v[196:199]
v_mfma_f32_16x16x32_bf16 v[196:199], a[164:167], v[84:87], v[196:199]
ds_read_b64_tr_b16 a[140:141], v234 offset:61440
v_fma_f32 v192, v192, v244, v252
v_mfma_f32_16x16x32_bf16 v[196:199], a[168:171], v[88:91], v[196:199]
ds_read_b64_tr_b16 a[142:143], v234 offset:63488
v_fma_f32 v193, v193, v244, v252
v_mfma_f32_16x16x32_bf16 v[196:199], a[172:175], v[92:95], v[196:199]
ds_read_b64_tr_b16 a[144:145], v235 offset:8192
v_cvt_pk_bf16_f32 v192, v192, v193
v_mfma_f32_16x16x32_bf16 v[200:203], a[172:175], v[140:143], v[200:203]
v_fma_f32 v194, v194, v244, v252
v_fma_f32 v195, v195, v244, v252
v_mfma_f32_16x16x32_bf16 v[200:203], a[168:171], v[136:139], v[200:203]
ds_read_b64_tr_b16 a[146:147], v235 offset:10240
v_cvt_pk_bf16_f32 v193, v194, v195
v_mfma_f32_16x16x32_bf16 v[200:203], a[164:167], v[132:135], v[200:203]
ds_read_b64_tr_b16 a[148:149], v235 offset:12288
v_mfma_f32_16x16x32_bf16 v[200:203], a[160:163], v[128:131], v[200:203]
ds_read_b64_tr_b16 a[150:151], v235 offset:14336
v_fma_f32 v196, v196, v245, v253
v_mfma_f32_16x16x32_bf16 v[200:203], a[156:159], v[124:127], v[200:203]
ds_write_b64 v243, v[192:193] offset:0
v_mfma_f32_16x16x32_bf16 v[200:203], a[152:155], v[120:123], v[200:203]
buffer_load_dwordx4 v239, s[92:95], s63 offen lds
v_mfma_f32_16x16x32_bf16 v[204:207], a[152:155], v[168:171], v[204:207]
s_add_u32 m0, s38, s58
v_fma_f32 v197, v197, v245, v253
v_cvt_pk_bf16_f32 v196, v196, v197
v_mfma_f32_16x16x32_bf16 v[204:207], a[156:159], v[172:175], v[204:207]
ds_read_b128 a[196:199], v248 offset:0
v_fma_f32 v198, v198, v245, v253
v_mfma_f32_16x16x32_bf16 v[204:207], a[160:163], v[176:179], v[204:207]
ds_read_b128 a[200:203], v248 offset:4096
v_fma_f32 v199, v199, v245, v253
v_mfma_f32_16x16x32_bf16 v[204:207], a[164:167], v[180:183], v[204:207]
buffer_store_dwordx4 a[176:179], v239, s[24:27], s51 offen offset:0 sc1
v_mfma_f32_16x16x32_bf16 v[204:207], a[168:171], v[184:187], v[204:207]
ds_write_b64 v240, v[208:209] offset:0
v_mfma_f32_16x16x32_bf16 v[204:207], a[172:175], v[188:191], v[204:207]
s_waitcnt lgkmcnt(4)
v_cvt_pk_bf16_f32 v197, v198, v199
v_fma_f32 v200, v200, v246, v254
v_mfma_f32_16x16x32_bf16 v[192:195], a[148:151], v[20:23], v[228:231]
ds_write_b64 v243, v[196:197] offset:8192
v_mfma_f32_16x16x32_bf16 v[192:195], a[144:147], v[16:19], v[192:195]
ds_read_b64_tr_b16 a[152:153], v235 offset:16384
v_fma_f32 v201, v201, v246, v254
v_mfma_f32_16x16x32_bf16 v[192:195], a[140:143], v[12:15], v[192:195]
ds_read_b64_tr_b16 a[154:155], v235 offset:18432
v_cvt_pk_bf16_f32 v214, v200, v201
v_mfma_f32_16x16x32_bf16 v[192:195], a[136:139], v[8:11], v[192:195]
ds_read_b64_tr_b16 a[156:157], v235 offset:20480
v_fma_f32 v202, v202, v246, v254
v_mfma_f32_16x16x32_bf16 v[192:195], a[132:135], v[4:7], v[192:195]
ds_read_b128 a[204:207], v248 offset:8192
v_fma_f32 v203, v203, v246, v254
v_mfma_f32_16x16x32_bf16 v[192:195], a[128:131], v[0:3], v[192:195]
ds_read_b64_tr_b16 a[158:159], v235 offset:22528
v_cvt_pk_bf16_f32 v215, v202, v203
v_mfma_f32_16x16x32_bf16 v[196:199], a[128:131], v[48:51], v[228:231]
ds_read_b64_tr_b16 a[160:161], v235 offset:24576
v_fma_f32 v204, v204, v247, v255
v_mfma_f32_16x16x32_bf16 v[196:199], a[132:135], v[52:55], v[196:199]
ds_read_b64_tr_b16 a[162:163], v235 offset:26624
v_fma_f32 v205, v205, v247, v255
v_mfma_f32_16x16x32_bf16 v[196:199], a[136:139], v[56:59], v[196:199]
buffer_load_dwordx4 v239, s[92:95], s64 offen lds
v_mfma_f32_16x16x32_bf16 v[196:199], a[140:143], v[60:63], v[196:199]
ds_read_b64_tr_b16 a[164:165], v235 offset:28672
v_cvt_pk_bf16_f32 v222, v204, v205
v_mfma_f32_16x16x32_bf16 v[196:199], a[144:147], v[64:67], v[196:199]
ds_read_b64_tr_b16 a[166:167], v235 offset:30720
v_fma_f32 v206, v206, v247, v255
v_mfma_f32_16x16x32_bf16 v[196:199], a[148:151], v[68:71], v[196:199]
ds_read_b64_tr_b16 a[168:169], v235 offset:32768
v_fma_f32 v207, v207, v247, v255
v_mfma_f32_16x16x32_bf16 v[200:203], a[148:151], v[116:119], v[228:231]
ds_read_b128 a[208:211], v248 offset:12288
v_cvt_pk_bf16_f32 v223, v206, v207
v_mfma_f32_16x16x32_bf16 v[200:203], a[144:147], v[112:115], v[200:203]
ds_read_b64_tr_b16 a[170:171], v235 offset:34816
s_add_u32 s74, s101, L_t1-L_pc1
v_mfma_f32_16x16x32_bf16 v[200:203], a[140:143], v[108:111], v[200:203]
ds_read_b64_tr_b16 a[172:173], v235 offset:36864
s_add_u32 m0, s38, s59
v_mfma_f32_16x16x32_bf16 v[200:203], a[136:139], v[104:107], v[200:203]
ds_read_b64_tr_b16 a[174:175], v235 offset:38912
v_xor_b32 v234, 32, v234
v_mfma_f32_16x16x32_bf16 v[200:203], a[132:135], v[100:103], v[200:203]
ds_write_b64 v240, v[216:217] offset:8192
v_mfma_f32_16x16x32_bf16 v[200:203], a[128:131], v[96:99], v[200:203]
ds_write_b64 v241, v[210:211] offset:0
v_mfma_f32_16x16x32_bf16 v[204:207], a[128:131], v[144:147], v[228:231]
ds_write_b64 v242, v[212:213] offset:0
v_mfma_f32_16x16x32_bf16 v[204:207], a[132:135], v[148:151], v[204:207]
ds_write_b64 v243, v[214:215] offset:0
v_mfma_f32_16x16x32_bf16 v[204:207], a[136:139], v[152:155], v[204:207]
ds_write_b64 v241, v[218:219] offset:8192
v_mfma_f32_16x16x32_bf16 v[204:207], a[140:143], v[156:159], v[204:207]
buffer_load_dwordx4 v239, s[92:95], s65 offen lds
v_mfma_f32_16x16x32_bf16 v[204:207], a[144:147], v[160:163], v[204:207]
ds_read_b128 a[212:215], v248 offset:0
v_xor_b32 v235, 32, v235
v_mfma_f32_16x16x32_bf16 v[204:207], a[148:151], v[164:167], v[204:207]
s_waitcnt lgkmcnt(6)
s_add_u32 m0, s38, s60
s_waitcnt lgkmcnt(15)
v_mfma_f32_16x16x32_bf16 v[204:207], a[172:175], v[188:191], v[204:207]
buffer_store_dwordx4 a[180:183], v239, s[24:27], s52 offen offset:0 sc1
v_mfma_f32_16x16x32_bf16 v[204:207], a[168:171], v[184:187], v[204:207]
ds_read_b64_tr_b16 a[128:129], v234 offset:49152
s_waitcnt lgkmcnt(10)
v_mfma_f32_16x16x32_bf16 v[204:207], a[164:167], v[180:183], v[204:207]
ds_read_b64_tr_b16 a[130:131], v234 offset:51200
v_mfma_f32_16x16x32_bf16 v[204:207], a[160:163], v[176:179], v[204:207]
ds_read_b64_tr_b16 a[132:133], v234 offset:53248
v_mfma_f32_16x16x32_bf16 v[204:207], a[156:159], v[172:175], v[204:207]
ds_read_b128 a[216:219], v248 offset:4096
s_getpc_b64 s[28:29]
L_pc1:
s_add_u32 s28, s28, s74
s_addc_u32 s29, s29, 0
v_mfma_f32_16x16x32_bf16 v[204:207], a[152:155], v[168:171], v[204:207]
ds_read_b64_tr_b16 a[134:135], v234 offset:55296
v_mfma_f32_16x16x32_bf16 v[200:203], a[152:155], v[120:123], v[200:203]
ds_read_b64_tr_b16 a[136:137], v234 offset:57344
v_mfma_f32_16x16x32_bf16 v[200:203], a[156:159], v[124:127], v[200:203]
ds_read_b64_tr_b16 a[138:139], v234 offset:59392
v_mfma_f32_16x16x32_bf16 v[200:203], a[160:163], v[128:131], v[200:203]
global_load_dword v251, v239, s[28:29]
v_mfma_f32_16x16x32_bf16 v[200:203], a[164:167], v[132:135], v[200:203]
ds_read_b64_tr_b16 a[140:141], v234 offset:61440
v_fma_f32 v204, v204, v247, v255
v_mfma_f32_16x16x32_bf16 v[200:203], a[168:171], v[136:139], v[200:203]
ds_read_b64_tr_b16 a[142:143], v234 offset:63488
v_fma_f32 v205, v205, v247, v255
v_mfma_f32_16x16x32_bf16 v[200:203], a[172:175], v[140:143], v[200:203]
ds_read_b64_tr_b16 a[144:145], v235 offset:8192
v_cvt_pk_bf16_f32 v216, v204, v205
v_mfma_f32_16x16x32_bf16 v[196:199], a[172:175], v[92:95], v[196:199]
buffer_load_dwordx4 v239, s[92:95], s66 offen lds
v_mfma_f32_16x16x32_bf16 v[196:199], a[168:171], v[88:91], v[196:199]
ds_read_b64_tr_b16 a[146:147], v235 offset:10240
v_fma_f32 v206, v206, v247, v255
v_mfma_f32_16x16x32_bf16 v[196:199], a[164:167], v[84:87], v[196:199]
ds_read_b64_tr_b16 a[148:149], v235 offset:12288
v_fma_f32 v207, v207, v247, v255
v_mfma_f32_16x16x32_bf16 v[196:199], a[160:163], v[80:83], v[196:199]
ds_read_b64_tr_b16 a[150:151], v235 offset:14336
v_cvt_pk_bf16_f32 v217, v206, v207
v_mfma_f32_16x16x32_bf16 v[196:199], a[156:159], v[76:79], v[196:199]
ds_write_b64 v242, v[220:221] offset:8192
v_mfma_f32_16x16x32_bf16 v[196:199], a[152:155], v[72:75], v[196:199]
ds_write_b64 v243, v[222:223] offset:8192
v_mfma_f32_16x16x32_bf16 v[192:195], a[152:155], v[24:27], v[192:195]
ds_write_b64 v240, v[216:217] offset:24576
v_mfma_f32_16x16x32_bf16 v[192:195], a[156:159], v[28:31], v[192:195]
s_add_u32 m0, s38, s61
v_fma_f32 v200, v200, v246, v254
v_fma_f32 v201, v201, v246, v254
v_mfma_f32_16x16x32_bf16 v[192:195], a[160:163], v[32:35], v[192:195]
ds_read_b128 a[220:223], v248 offset:8192
v_cvt_pk_bf16_f32 v208, v200, v201
v_mfma_f32_16x16x32_bf16 v[192:195], a[164:167], v[36:39], v[192:195]
ds_read_b128 a[224:227], v248 offset:12288
v_fma_f32 v202, v202, v246, v254
v_mfma_f32_16x16x32_bf16 v[192:195], a[168:171], v[40:43], v[192:195]
s_waitcnt vmcnt(11)
v_fma_f32 v203, v203, v246, v254
v_cvt_pk_bf16_f32 v209, v202, v203
v_mfma_f32_16x16x32_bf16 v[192:195], a[172:175], v[44:47], v[192:195]
s_waitcnt lgkmcnt(5)
v_fma_f32 v196, v196, v245, v253
v_fma_f32 v197, v197, v245, v253
v_mfma_f32_16x16x32_bf16 v[204:207], a[148:151], v[164:167], v[228:231]
ds_read_b128 a[120:123], v232 offset:16384
v_cvt_pk_bf16_f32 v226, v196, v197
v_mfma_f32_16x16x32_bf16 v[204:207], a[144:147], v[160:163], v[204:207]
ds_read_b64_tr_b16 a[152:153], v235 offset:16384
v_fma_f32 v198, v198, v245, v253
v_mfma_f32_16x16x32_bf16 v[204:207], a[140:143], v[156:159], v[204:207]
ds_read_b64_tr_b16 a[154:155], v235 offset:18432
v_fma_f32 v199, v199, v245, v253
v_mfma_f32_16x16x32_bf16 v[204:207], a[136:139], v[152:155], v[204:207]
ds_read_b64_tr_b16 a[156:157], v235 offset:20480
v_cvt_pk_bf16_f32 v227, v198, v199
v_mfma_f32_16x16x32_bf16 v[204:207], a[132:135], v[148:151], v[204:207]
buffer_load_dwordx4 v239, s[92:95], s67 offen lds
v_mfma_f32_16x16x32_bf16 v[204:207], a[128:131], v[144:147], v[204:207]
ds_read_b64_tr_b16 a[158:159], v235 offset:22528
v_fma_f32 v192, v192, v244, v252
v_mfma_f32_16x16x32_bf16 v[200:203], a[128:131], v[96:99], v[228:231]
ds_read_b64_tr_b16 a[160:161], v235 offset:24576
v_fma_f32 v193, v193, v244, v252
v_mfma_f32_16x16x32_bf16 v[200:203], a[132:135], v[100:103], v[200:203]
ds_read_b64_tr_b16 a[162:163], v235 offset:26624
v_cvt_pk_bf16_f32 v224, v192, v193
v_mfma_f32_16x16x32_bf16 v[200:203], a[136:139], v[104:107], v[200:203]
buffer_store_dwordx4 a[184:187], v239, s[24:27], s53 offen offset:0 sc1
v_mfma_f32_16x16x32_bf16 v[200:203], a[140:143], v[108:111], v[200:203]
ds_read_b64_tr_b16 a[164:165], v235 offset:28672
v_fma_f32 v194, v194, v244, v252
v_mfma_f32_16x16x32_bf16 v[200:203], a[144:147], v[112:115], v[200:203]
ds_read_b64_tr_b16 a[166:167], v235 offset:30720
v_fma_f32 v195, v195, v244, v252
v_mfma_f32_16x16x32_bf16 v[200:203], a[148:151], v[116:119], v[200:203]
ds_read_b64_tr_b16 a[168:169], v235 offset:32768
v_cvt_pk_bf16_f32 v225, v194, v195
v_mfma_f32_16x16x32_bf16 v[196:199], a[148:151], v[68:71], v[228:231]
ds_read_b128 a[124:127], v233 offset:16384
s_add_u32 m0, s39, s56
v_mfma_f32_16x16x32_bf16 v[196:199], a[144:147], v[64:67], v[196:199]
ds_read_b64_tr_b16 a[170:171], v235 offset:34816
s_mov_b32 s94, 24576
v_mfma_f32_16x16x32_bf16 v[196:199], a[140:143], v[60:63], v[196:199]
ds_read_b64_tr_b16 a[172:173], v235 offset:36864
s_add_u32 s68, s36, 24576
v_mfma_f32_16x16x32_bf16 v[196:199], a[136:139], v[56:59], v[196:199]
ds_read_b64_tr_b16 a[174:175], v235 offset:38912
v_xor_b32 v234, 0x60, v234
v_mfma_f32_16x16x32_bf16 v[196:199], a[132:135], v[52:55], v[196:199]
buffer_load_dwordx4 v239, s[16:19], s56 offen lds
v_mfma_f32_16x16x32_bf16 v[196:199], a[128:131], v[48:51], v[196:199]
ds_write_b64 v240, v[208:209] offset:16384
v_mfma_f32_16x16x32_bf16 v[192:195], a[128:131], v[0:3], v[228:231]
ds_write_b64 v240, v[226:227] offset:8192
v_mfma_f32_16x16x32_bf16 v[192:195], a[132:135], v[4:7], v[192:195]
ds_write_b64 v240, v[224:225] offset:0
v_mfma_f32_16x16x32_bf16 v[192:195], a[136:139], v[8:11], v[192:195]
s_add_u32 m0, s39, s57
s_waitcnt lgkmcnt(15)
v_xor_b32 v235, 0x60, v235
v_mfma_f32_16x16x32_bf16 v[192:195], a[140:143], v[12:15], v[192:195]
s_add_u32 s92, s70, s68
s_addc_u32 s93, s71, 0
s_waitcnt lgkmcnt(15)
v_mfma_f32_16x16x32_bf16 v[192:195], a[144:147], v[16:19], v[192:195]
s_waitcnt lgkmcnt(6)
v_mfma_f32_16x16x32_bf16 v[192:195], a[148:151], v[20:23], v[192:195]
s_waitcnt lgkmcnt(3)
v_mfma_f32_16x16x32_bf16 v[192:195], a[172:175], v[44:47], v[192:195]
v_mfma_f32_16x16x32_bf16 v[192:195], a[168:171], v[40:43], v[192:195]
ds_read_b64_tr_b16 a[128:129], v234 offset:49152
v_mfma_f32_16x16x32_bf16 v[192:195], a[164:167], v[36:39], v[192:195]
ds_read_b64_tr_b16 a[130:131], v234 offset:51200
v_mfma_f32_16x16x32_bf16 v[192:195], a[160:163], v[32:35], v[192:195]
ds_read_b64_tr_b16 a[132:133], v234 offset:53248
v_mfma_f32_16x16x32_bf16 v[192:195], a[156:159], v[28:31], v[192:195]
v_mfma_f32_16x16x32_bf16 v[192:195], a[152:155], v[24:27], v[192:195]
ds_read_b64_tr_b16 a[134:135], v234 offset:55296
v_mfma_f32_16x16x32_bf16 v[196:199], a[152:155], v[72:75], v[196:199]
ds_read_b64_tr_b16 a[136:137], v234 offset:57344
v_mfma_f32_16x16x32_bf16 v[196:199], a[156:159], v[76:79], v[196:199]
ds_read_b64_tr_b16 a[138:139], v234 offset:59392
v_mfma_f32_16x16x32_bf16 v[196:199], a[160:163], v[80:83], v[196:199]
buffer_load_dwordx4 v239, s[16:19], s57 offen lds
v_mfma_f32_16x16x32_bf16 v[196:199], a[164:167], v[84:87], v[196:199]
ds_read_b64_tr_b16 a[140:141], v234 offset:61440
v_fma_f32 v192, v192, v244, v252
v_mfma_f32_16x16x32_bf16 v[196:199], a[168:171], v[88:91], v[196:199]
ds_read_b64_tr_b16 a[142:143], v234 offset:63488
v_fma_f32 v193, v193, v244, v252
v_mfma_f32_16x16x32_bf16 v[196:199], a[172:175], v[92:95], v[196:199]
ds_read_b64_tr_b16 a[144:145], v235 offset:8192
v_cvt_pk_bf16_f32 v192, v192, v193
v_mfma_f32_16x16x32_bf16 v[200:203], a[172:175], v[140:143], v[200:203]
buffer_store_dwordx4 a[188:191], v239, s[24:27], s54 offen offset:0 sc1
v_mfma_f32_16x16x32_bf16 v[200:203], a[168:171], v[136:139], v[200:203]
ds_read_b64_tr_b16 a[146:147], v235 offset:10240
v_fma_f32 v194, v194, v244, v252
v_mfma_f32_16x16x32_bf16 v[200:203], a[164:167], v[132:135], v[200:203]
ds_read_b64_tr_b16 a[148:149], v235 offset:12288
v_fma_f32 v195, v195, v244, v252
v_mfma_f32_16x16x32_bf16 v[200:203], a[160:163], v[128:131], v[200:203]
ds_read_b64_tr_b16 a[150:151], v235 offset:14336
v_cvt_pk_bf16_f32 v193, v194, v195
v_mfma_f32_16x16x32_bf16 v[200:203], a[156:159], v[124:127], v[200:203]
ds_write_b64 v241, v[192:193] offset:0
v_mfma_f32_16x16x32_bf16 v[200:203], a[152:155], v[120:123], v[200:203]
s_add_u32 m0, s39, s58
v_fma_f32 v196, v196, v245, v253
v_fma_f32 v197, v197, v245, v253
v_mfma_f32_16x16x32_bf16 v[204:207], a[152:155], v[168:171], v[204:207]
v_cvt_pk_bf16_f32 v196, v196, v197
v_fma_f32 v198, v198, v245, v253
v_mfma_f32_16x16x32_bf16 v[204:207], a[156:159], v[172:175], v[204:207]
v_fma_f32 v199, v199, v245, v253
v_cvt_pk_bf16_f32 v197, v198, v199
v_mfma_f32_16x16x32_bf16 v[204:207], a[160:163], v[176:179], v[204:207]
ds_write_b64 v241, v[196:197] offset:8192
v_mfma_f32_16x16x32_bf16 v[204:207], a[164:167], v[180:183], v[204:207]
buffer_load_dwordx4 v239, s[16:19], s58 offen lds
v_mfma_f32_16x16x32_bf16 v[204:207], a[168:171], v[184:187], v[204:207]
s_add_u32 m0, s39, s59
v_fma_f32 v200, v200, v246, v254
v_fma_f32 v201, v201, v246, v254
v_mfma_f32_16x16x32_bf16 v[204:207], a[172:175], v[188:191], v[204:207]
s_waitcnt lgkmcnt(2)
v_cvt_pk_bf16_f32 v210, v200, v201
v_fma_f32 v202, v202, v246, v254
v_mfma_f32_16x16x32_bf16 v[192:195], a[148:151], v[20:23], v[228:231]
v_fma_f32 v203, v203, v246, v254
v_cvt_pk_bf16_f32 v211, v202, v203
v_mfma_f32_16x16x32_bf16 v[192:195], a[144:147], v[16:19], v[192:195]
ds_read_b64_tr_b16 a[152:153], v235 offset:16384
v_mfma_f32_16x16x32_bf16 v[192:195], a[140:143], v[12:15], v[192:195]
ds_read_b64_tr_b16 a[154:155], v235 offset:18432
v_mfma_f32_16x16x32_bf16 v[192:195], a[136:139], v[8:11], v[192:195]
ds_read_b64_tr_b16 a[156:157], v235 offset:20480
v_fma_f32 v204, v204, v247, v255
v_mfma_f32_16x16x32_bf16 v[192:195], a[132:135], v[4:7], v[192:195]
v_fma_f32 v205, v205, v247, v255
v_cvt_pk_bf16_f32 v218, v204, v205
v_mfma_f32_16x16x32_bf16 v[192:195], a[128:131], v[0:3], v[192:195]
ds_read_b64_tr_b16 a[158:159], v235 offset:22528
v_fma_f32 v206, v206, v247, v255
v_mfma_f32_16x16x32_bf16 v[196:199], a[128:131], v[48:51], v[228:231]
ds_read_b64_tr_b16 a[160:161], v235 offset:24576
v_fma_f32 v207, v207, v247, v255
v_mfma_f32_16x16x32_bf16 v[196:199], a[132:135], v[52:55], v[196:199]
ds_read_b64_tr_b16 a[162:163], v235 offset:26624
v_cvt_pk_bf16_f32 v219, v206, v207
v_mfma_f32_16x16x32_bf16 v[196:199], a[136:139], v[56:59], v[196:199]
buffer_store_dwordx4 a[192:195], v239, s[24:27], s55 offen offset:0 sc1
v_mfma_f32_16x16x32_bf16 v[196:199], a[140:143], v[60:63], v[196:199]
ds_read_b64_tr_b16 a[164:165], v235 offset:28672
v_mfma_f32_16x16x32_bf16 v[196:199], a[144:147], v[64:67], v[196:199]
ds_read_b64_tr_b16 a[166:167], v235 offset:30720
v_mfma_f32_16x16x32_bf16 v[196:199], a[148:151], v[68:71], v[196:199]
ds_read_b64_tr_b16 a[168:169], v235 offset:32768
v_mfma_f32_16x16x32_bf16 v[200:203], a[148:151], v[116:119], v[228:231]
buffer_load_dwordx4 v239, s[16:19], s59 offen lds
v_mfma_f32_16x16x32_bf16 v[200:203], a[144:147], v[112:115], v[200:203]
ds_read_b64_tr_b16 a[170:171], v235 offset:34816
s_add_u32 m0, s39, s60
v_mfma_f32_16x16x32_bf16 v[200:203], a[140:143], v[108:111], v[200:203]
ds_read_b64_tr_b16 a[172:173], v235 offset:36864
v_mfma_f32_16x16x32_bf16 v[200:203], a[136:139], v[104:107], v[200:203]
ds_read_b64_tr_b16 a[174:175], v235 offset:38912
v_xor_b32 v234, 32, v234
v_mfma_f32_16x16x32_bf16 v[200:203], a[132:135], v[100:103], v[200:203]
ds_write_b64 v241, v[210:211] offset:16384
v_mfma_f32_16x16x32_bf16 v[200:203], a[128:131], v[96:99], v[200:203]
ds_write_b64 v241, v[218:219] offset:24576
v_mfma_f32_16x16x32_bf16 v[204:207], a[128:131], v[144:147], v[228:231]
v_xor_b32 v235, 32, v235
v_mfma_f32_16x16x32_bf16 v[204:207], a[132:135], v[148:151], v[204:207]
v_mfma_f32_16x16x32_bf16 v[204:207], a[136:139], v[152:155], v[204:207]
v_mfma_f32_16x16x32_bf16 v[204:207], a[140:143], v[156:159], v[204:207]
v_mfma_f32_16x16x32_bf16 v[204:207], a[144:147], v[160:163], v[204:207]
v_mfma_f32_16x16x32_bf16 v[204:207], a[148:151], v[164:167], v[204:207]
s_waitcnt lgkmcnt(2)
v_mfma_f32_16x16x32_bf16 v[204:207], a[172:175], v[188:191], v[204:207]
buffer_load_dwordx4 v239, s[16:19], s60 offen lds
v_mfma_f32_16x16x32_bf16 v[204:207], a[168:171], v[184:187], v[204:207]
ds_read_b64_tr_b16 a[128:129], v234 offset:49152
s_add_u32 m0, s39, s61
v_mfma_f32_16x16x32_bf16 v[204:207], a[164:167], v[180:183], v[204:207]
ds_read_b64_tr_b16 a[130:131], v234 offset:51200
v_mfma_f32_16x16x32_bf16 v[204:207], a[160:163], v[176:179], v[204:207]
ds_read_b64_tr_b16 a[132:133], v234 offset:53248
v_mfma_f32_16x16x32_bf16 v[204:207], a[156:159], v[172:175], v[204:207]
v_mfma_f32_16x16x32_bf16 v[204:207], a[152:155], v[168:171], v[204:207]
ds_read_b64_tr_b16 a[134:135], v234 offset:55296
v_mfma_f32_16x16x32_bf16 v[200:203], a[152:155], v[120:123], v[200:203]
ds_read_b64_tr_b16 a[136:137], v234 offset:57344
v_mfma_f32_16x16x32_bf16 v[200:203], a[156:159], v[124:127], v[200:203]
ds_read_b64_tr_b16 a[138:139], v234 offset:59392
v_mfma_f32_16x16x32_bf16 v[200:203], a[160:163], v[128:131], v[200:203]
v_mfma_f32_16x16x32_bf16 v[200:203], a[164:167], v[132:135], v[200:203]
ds_read_b64_tr_b16 a[140:141], v234 offset:61440
v_fma_f32 v204, v204, v247, v255
v_mfma_f32_16x16x32_bf16 v[200:203], a[168:171], v[136:139], v[200:203]
ds_read_b64_tr_b16 a[142:143], v234 offset:63488
v_fma_f32 v205, v205, v247, v255
v_mfma_f32_16x16x32_bf16 v[200:203], a[172:175], v[140:143], v[200:203]
ds_read_b64_tr_b16 a[144:145], v235 offset:8192
v_cvt_pk_bf16_f32 v220, v204, v205
v_mfma_f32_16x16x32_bf16 v[196:199], a[172:175], v[92:95], v[196:199]
buffer_store_dwordx4 a[196:199], v239, s[24:27], s48 offen offset:128 sc1
v_mfma_f32_16x16x32_bf16 v[196:199], a[168:171], v[88:91], v[196:199]
ds_read_b64_tr_b16 a[146:147], v235 offset:10240
v_fma_f32 v206, v206, v247, v255
v_mfma_f32_16x16x32_bf16 v[196:199], a[164:167], v[84:87], v[196:199]
ds_read_b64_tr_b16 a[148:149], v235 offset:12288
v_fma_f32 v207, v207, v247, v255
v_mfma_f32_16x16x32_bf16 v[196:199], a[160:163], v[80:83], v[196:199]
ds_read_b64_tr_b16 a[150:151], v235 offset:14336
v_cvt_pk_bf16_f32 v221, v206, v207
v_mfma_f32_16x16x32_bf16 v[196:199], a[156:159], v[76:79], v[196:199]
buffer_load_dwordx4 v239, s[16:19], s61 offen lds
v_mfma_f32_16x16x32_bf16 v[196:199], a[152:155], v[72:75], v[196:199]
ds_write_b64 v242, v[220:221] offset:24576
v_mfma_f32_16x16x32_bf16 v[192:195], a[152:155], v[24:27], v[192:195]
s_add_u32 m0, s40, s56
v_fma_f32 v200, v200, v246, v254
v_fma_f32 v201, v201, v246, v254
v_mfma_f32_16x16x32_bf16 v[192:195], a[156:159], v[28:31], v[192:195]
v_cvt_pk_bf16_f32 v212, v200, v201
v_fma_f32 v202, v202, v246, v254
v_mfma_f32_16x16x32_bf16 v[192:195], a[160:163], v[32:35], v[192:195]
v_fma_f32 v203, v203, v246, v254
v_cvt_pk_bf16_f32 v213, v202, v203
v_mfma_f32_16x16x32_bf16 v[192:195], a[164:167], v[36:39], v[192:195]
ds_write_b64 v242, v[212:213] offset:16384
v_mfma_f32_16x16x32_bf16 v[192:195], a[168:171], v[40:43], v[192:195]
v_fma_f32 v196, v196, v245, v253
v_fma_f32 v197, v197, v245, v253
v_mfma_f32_16x16x32_bf16 v[192:195], a[172:175], v[44:47], v[192:195]
s_waitcnt lgkmcnt(2)
v_cvt_pk_bf16_f32 v196, v196, v197
v_fma_f32 v198, v198, v245, v253
v_mfma_f32_16x16x32_bf16 v[204:207], a[148:151], v[164:167], v[228:231]
v_fma_f32 v199, v199, v245, v253
v_cvt_pk_bf16_f32 v197, v198, v199
v_mfma_f32_16x16x32_bf16 v[204:207], a[144:147], v[160:163], v[204:207]
ds_read_b64_tr_b16 a[152:153], v235 offset:16384
v_mfma_f32_16x16x32_bf16 v[204:207], a[140:143], v[156:159], v[204:207]
ds_read_b64_tr_b16 a[154:155], v235 offset:18432
v_mfma_f32_16x16x32_bf16 v[204:207], a[136:139], v[152:155], v[204:207]
ds_read_b64_tr_b16 a[156:157], v235 offset:20480
v_fma_f32 v192, v192, v244, v252
v_mfma_f32_16x16x32_bf16 v[204:207], a[132:135], v[148:151], v[204:207]
ds_write_b64 v242, v[196:197] offset:8192
v_mfma_f32_16x16x32_bf16 v[204:207], a[128:131], v[144:147], v[204:207]
ds_read_b64_tr_b16 a[158:159], v235 offset:22528
v_fma_f32 v193, v193, v244, v252
v_mfma_f32_16x16x32_bf16 v[200:203], a[128:131], v[96:99], v[228:231]
ds_read_b64_tr_b16 a[160:161], v235 offset:24576
v_cvt_pk_bf16_f32 v192, v192, v193
v_mfma_f32_16x16x32_bf16 v[200:203], a[132:135], v[100:103], v[200:203]
ds_read_b64_tr_b16 a[162:163], v235 offset:26624
v_fma_f32 v194, v194, v244, v252
v_mfma_f32_16x16x32_bf16 v[200:203], a[136:139], v[104:107], v[200:203]
v_fma_f32 v195, v195, v244, v252
v_cvt_pk_bf16_f32 v193, v194, v195
v_mfma_f32_16x16x32_bf16 v[200:203], a[140:143], v[108:111], v[200:203]
ds_read_b64_tr_b16 a[164:165], v235 offset:28672
v_mfma_f32_16x16x32_bf16 v[200:203], a[144:147], v[112:115], v[200:203]
ds_read_b64_tr_b16 a[166:167], v235 offset:30720
v_mfma_f32_16x16x32_bf16 v[200:203], a[148:151], v[116:119], v[200:203]
ds_read_b64_tr_b16 a[168:169], v235 offset:32768
v_mfma_f32_16x16x32_bf16 v[196:199], a[148:151], v[68:71], v[228:231]
s_add_u32 s16, s16, 49152
s_addc_u32 s17, s17, 0
v_mfma_f32_16x16x32_bf16 v[196:199], a[144:147], v[64:67], v[196:199]
ds_read_b64_tr_b16 a[170:171], v235 offset:34816
v_mfma_f32_16x16x32_bf16 v[196:199], a[140:143], v[60:63], v[196:199]
ds_read_b64_tr_b16 a[172:173], v235 offset:36864
v_mfma_f32_16x16x32_bf16 v[196:199], a[136:139], v[56:59], v[196:199]
ds_read_b64_tr_b16 a[174:175], v235 offset:38912
v_xor_b32 v234, 0x60, v234
v_mfma_f32_16x16x32_bf16 v[196:199], a[132:135], v[52:55], v[196:199]
ds_write_b64 v242, v[192:193] offset:0
v_mfma_f32_16x16x32_bf16 v[196:199], a[128:131], v[48:51], v[196:199]
buffer_store_dwordx4 a[200:203], v239, s[24:27], s49 offen offset:128 sc1
v_mfma_f32_16x16x32_bf16 v[192:195], a[128:131], v[0:3], v[228:231]
v_xor_b32 v235, 0x60, v235
v_mfma_f32_16x16x32_bf16 v[192:195], a[132:135], v[4:7], v[192:195]
v_mfma_f32_16x16x32_bf16 v[192:195], a[136:139], v[8:11], v[192:195]
v_mfma_f32_16x16x32_bf16 v[192:195], a[140:143], v[12:15], v[192:195]
v_mfma_f32_16x16x32_bf16 v[192:195], a[144:147], v[16:19], v[192:195]
v_mfma_f32_16x16x32_bf16 v[192:195], a[148:151], v[20:23], v[192:195]
s_waitcnt vmcnt(11) lgkmcnt(1)
v_mfma_f32_16x16x32_bf16 v[192:195], a[172:175], v[44:47], v[192:195]
s_barrier
v_mfma_f32_16x16x32_bf16 v[192:195], a[168:171], v[40:43], v[192:195]
ds_read_b64_tr_b16 a[128:129], v235 offset:40960
v_mfma_f32_16x16x32_bf16 v[192:195], a[164:167], v[36:39], v[192:195]
ds_read_b64_tr_b16 a[130:131], v235 offset:43008
v_mfma_f32_16x16x32_bf16 v[192:195], a[160:163], v[32:35], v[192:195]
ds_read_b64_tr_b16 a[132:133], v235 offset:45056
v_mfma_f32_16x16x32_bf16 v[192:195], a[156:159], v[28:31], v[192:195]
buffer_load_dwordx4 v239, s[92:95], s56 offen lds
v_mfma_f32_16x16x32_bf16 v[192:195], a[152:155], v[24:27], v[192:195]
ds_read_b64_tr_b16 a[134:135], v235 offset:47104
s_add_u32 m0, s40, s57
v_mfma_f32_16x16x32_bf16 v[196:199], a[152:155], v[72:75], v[196:199]
ds_read_b64_tr_b16 a[136:137], v235 offset:49152
v_mfma_f32_16x16x32_bf16 v[196:199], a[156:159], v[76:79], v[196:199]
ds_read_b64_tr_b16 a[138:139], v235 offset:51200
v_mfma_f32_16x16x32_bf16 v[196:199], a[160:163], v[80:83], v[196:199]
v_mfma_f32_16x16x32_bf16 v[196:199], a[164:167], v[84:87], v[196:199]
ds_read_b64_tr_b16 a[140:141], v235 offset:53248
v_fma_f32 v192, v192, v244, v252
v_mfma_f32_16x16x32_bf16 v[196:199], a[168:171], v[88:91], v[196:199]
ds_read_b64_tr_b16 a[142:143], v235 offset:55296
v_fma_f32 v193, v193, v244, v252
v_mfma_f32_16x16x32_bf16 v[196:199], a[172:175], v[92:95], v[196:199]
ds_read_b64_tr_b16 a[144:145], v235 offset:57344
v_cvt_pk_bf16_f32 v192, v192, v193
v_mfma_f32_16x16x32_bf16 v[200:203], a[172:175], v[140:143], v[200:203]
v_fma_f32 v194, v194, v244, v252
v_fma_f32 v195, v195, v244, v252
v_mfma_f32_16x16x32_bf16 v[200:203], a[168:171], v[136:139], v[200:203]
ds_read_b64_tr_b16 a[146:147], v235 offset:59392
v_cvt_pk_bf16_f32 v193, v194, v195
v_mfma_f32_16x16x32_bf16 v[200:203], a[164:167], v[132:135], v[200:203]
ds_read_b64_tr_b16 a[148:149], v235 offset:61440
v_mfma_f32_16x16x32_bf16 v[200:203], a[160:163], v[128:131], v[200:203]
ds_read_b64_tr_b16 a[150:151], v235 offset:63488
v_fma_f32 v196, v196, v245, v253
v_mfma_f32_16x16x32_bf16 v[200:203], a[156:159], v[124:127], v[200:203]
ds_write_b64 v243, v[192:193] offset:0
v_mfma_f32_16x16x32_bf16 v[200:203], a[152:155], v[120:123], v[200:203]
buffer_load_dwordx4 v239, s[92:95], s57 offen lds
v_mfma_f32_16x16x32_bf16 v[204:207], a[152:155], v[168:171], v[204:207]
s_add_u32 m0, s40, s58
v_fma_f32 v197, v197, v245, v253
v_cvt_pk_bf16_f32 v196, v196, v197
v_mfma_f32_16x16x32_bf16 v[204:207], a[156:159], v[172:175], v[204:207]
ds_read_b128 a[228:231], v248 offset:0
v_fma_f32 v198, v198, v245, v253
v_mfma_f32_16x16x32_bf16 v[204:207], a[160:163], v[176:179], v[204:207]
ds_read_b128 a[232:235], v248 offset:4096
v_fma_f32 v199, v199, v245, v253
v_mfma_f32_16x16x32_bf16 v[204:207], a[164:167], v[180:183], v[204:207]
buffer_store_dwordx4 a[204:207], v239, s[24:27], s50 offen offset:128 sc1
v_mfma_f32_16x16x32_bf16 v[204:207], a[168:171], v[184:187], v[204:207]
v_cvt_pk_bf16_f32 v197, v198, v199
v_fma_f32 v200, v200, v246, v254
v_mfma_f32_16x16x32_bf16 v[204:207], a[172:175], v[188:191], v[204:207]
s_waitcnt lgkmcnt(3)
v_fma_f32 v201, v201, v246, v254
v_cvt_pk_bf16_f32 v214, v200, v201
v_mfma_f32_16x16x32_bf16 v[192:195], a[148:151], v[20:23], v[228:231]
ds_write_b64 v243, v[196:197] offset:8192
v_mfma_f32_16x16x32_bf16 v[192:195], a[144:147], v[16:19], v[192:195]
ds_read_b64_tr_b16 a[152:153], v234 offset:0
v_fma_f32 v202, v202, v246, v254
v_mfma_f32_16x16x32_bf16 v[192:195], a[140:143], v[12:15], v[192:195]
ds_read_b64_tr_b16 a[154:155], v234 offset:2048
v_fma_f32 v203, v203, v246, v254
v_mfma_f32_16x16x32_bf16 v[192:195], a[136:139], v[8:11], v[192:195]
ds_read_b64_tr_b16 a[156:157], v234 offset:4096
v_cvt_pk_bf16_f32 v215, v202, v203
v_mfma_f32_16x16x32_bf16 v[192:195], a[132:135], v[4:7], v[192:195]
ds_read_b128 a[236:239], v248 offset:8192
v_fma_f32 v204, v204, v247, v255
v_mfma_f32_16x16x32_bf16 v[192:195], a[128:131], v[0:3], v[192:195]
ds_read_b64_tr_b16 a[158:159], v234 offset:6144
v_fma_f32 v205, v205, v247, v255
v_mfma_f32_16x16x32_bf16 v[196:199], a[128:131], v[48:51], v[228:231]
ds_read_b64_tr_b16 a[160:161], v234 offset:8192
v_cvt_pk_bf16_f32 v222, v204, v205
v_mfma_f32_16x16x32_bf16 v[196:199], a[132:135], v[52:55], v[196:199]
ds_read_b64_tr_b16 a[162:163], v234 offset:10240
v_fma_f32 v206, v206, v247, v255
v_mfma_f32_16x16x32_bf16 v[196:199], a[136:139], v[56:59], v[196:199]
buffer_load_dwordx4 v239, s[92:95], s58 offen lds
v_mfma_f32_16x16x32_bf16 v[196:199], a[140:143], v[60:63], v[196:199]
ds_read_b64_tr_b16 a[164:165], v234 offset:12288
v_fma_f32 v207, v207, v247, v255
v_mfma_f32_16x16x32_bf16 v[196:199], a[144:147], v[64:67], v[196:199]
ds_read_b64_tr_b16 a[166:167], v234 offset:14336
v_cvt_pk_bf16_f32 v223, v206, v207
v_mfma_f32_16x16x32_bf16 v[196:199], a[148:151], v[68:71], v[196:199]
ds_read_b64_tr_b16 a[168:169], v234 offset:16384
s_add_u32 m0, s40, s59
v_mfma_f32_16x16x32_bf16 v[200:203], a[148:151], v[116:119], v[228:231]
ds_read_b128 a[240:243], v248 offset:12288
s_waitcnt lgkmcnt(12)
v_mfma_f32_16x16x32_bf16 v[200:203], a[144:147], v[112:115], v[200:203]
ds_read_b64_tr_b16 a[170:171], v234 offset:18432
v_mfma_f32_16x16x32_bf16 v[200:203], a[140:143], v[108:111], v[200:203]
ds_read_b64_tr_b16 a[172:173], v234 offset:20480
v_mfma_f32_16x16x32_bf16 v[200:203], a[136:139], v[104:107], v[200:203]
ds_read_b64_tr_b16 a[174:175], v234 offset:22528
v_xor_b32 v234, 32, v234
v_mfma_f32_16x16x32_bf16 v[200:203], a[132:135], v[100:103], v[200:203]
ds_write_b64 v243, v[214:215] offset:16384
v_mfma_f32_16x16x32_bf16 v[200:203], a[128:131], v[96:99], v[200:203]
ds_write_b64 v243, v[222:223] offset:24576
v_mfma_f32_16x16x32_bf16 v[204:207], a[128:131], v[144:147], v[228:231]
s_waitcnt lgkmcnt(5)
v_xor_b32 v235, 32, v235
v_mfma_f32_16x16x32_bf16 v[204:207], a[132:135], v[148:151], v[204:207]
ds_read_b128 a[244:247], v248 offset:16384
v_mfma_f32_16x16x32_bf16 v[204:207], a[136:139], v[152:155], v[204:207]
buffer_store_dwordx4 a[208:211], v239, s[24:27], s51 offen offset:128 sc1
v_mfma_f32_16x16x32_bf16 v[204:207], a[140:143], v[156:159], v[204:207]
buffer_load_dwordx4 v239, s[92:95], s59 offen lds
v_mfma_f32_16x16x32_bf16 v[204:207], a[144:147], v[160:163], v[204:207]
ds_read_b128 a[176:179], v248 offset:24576
s_add_u32 m0, s40, s60
v_mfma_f32_16x16x32_bf16 v[204:207], a[148:151], v[164:167], v[204:207]
s_waitcnt lgkmcnt(4)
v_mfma_f32_16x16x32_bf16 v[204:207], a[172:175], v[188:191], v[204:207]
ds_read_b128 a[248:251], v248 offset:20480
v_mfma_f32_16x16x32_bf16 v[204:207], a[168:171], v[184:187], v[204:207]
ds_read_b64_tr_b16 a[128:129], v235 offset:40960
v_mfma_f32_16x16x32_bf16 v[204:207], a[164:167], v[180:183], v[204:207]
ds_read_b64_tr_b16 a[130:131], v235 offset:43008
v_mfma_f32_16x16x32_bf16 v[204:207], a[160:163], v[176:179], v[204:207]
ds_read_b64_tr_b16 a[132:133], v235 offset:45056
v_mfma_f32_16x16x32_bf16 v[204:207], a[156:159], v[172:175], v[204:207]
ds_read_b128 a[180:183], v248 offset:28672
v_mfma_f32_16x16x32_bf16 v[204:207], a[152:155], v[168:171], v[204:207]
ds_read_b64_tr_b16 a[134:135], v235 offset:47104
v_mfma_f32_16x16x32_bf16 v[200:203], a[152:155], v[120:123], v[200:203]
ds_read_b64_tr_b16 a[136:137], v235 offset:49152
s_waitcnt lgkmcnt(6)
v_mfma_f32_16x16x32_bf16 v[200:203], a[156:159], v[124:127], v[200:203]
ds_read_b64_tr_b16 a[138:139], v235 offset:51200
v_mfma_f32_16x16x32_bf16 v[200:203], a[160:163], v[128:131], v[200:203]
v_mfma_f32_16x16x32_bf16 v[200:203], a[164:167], v[132:135], v[200:203]
ds_read_b64_tr_b16 a[140:141], v235 offset:53248
v_fma_f32 v204, v204, v247, v255
v_mfma_f32_16x16x32_bf16 v[200:203], a[168:171], v[136:139], v[200:203]
ds_read_b64_tr_b16 a[142:143], v235 offset:55296
v_fma_f32 v205, v205, v247, v255
v_mfma_f32_16x16x32_bf16 v[200:203], a[172:175], v[140:143], v[200:203]
ds_read_b64_tr_b16 a[144:145], v235 offset:57344
v_cvt_pk_bf16_f32 v216, v204, v205
v_mfma_f32_16x16x32_bf16 v[196:199], a[172:175], v[92:95], v[196:199]
buffer_load_dwordx4 v239, s[92:95], s60 offen lds
v_mfma_f32_16x16x32_bf16 v[196:199], a[168:171], v[88:91], v[196:199]
ds_read_b64_tr_b16 a[146:147], v235 offset:59392
v_fma_f32 v206, v206, v247, v255
v_mfma_f32_16x16x32_bf16 v[196:199], a[164:167], v[84:87], v[196:199]
ds_read_b64_tr_b16 a[148:149], v235 offset:61440
v_fma_f32 v207, v207, v247, v255
v_mfma_f32_16x16x32_bf16 v[196:199], a[160:163], v[80:83], v[196:199]
ds_read_b64_tr_b16 a[150:151], v235 offset:63488
v_cvt_pk_bf16_f32 v217, v206, v207
v_mfma_f32_16x16x32_bf16 v[196:199], a[156:159], v[76:79], v[196:199]
ds_write_b64 v240, v[216:217] offset:24576
v_mfma_f32_16x16x32_bf16 v[196:199], a[152:155], v[72:75], v[196:199]
s_add_u32 m0, s40, s61
v_fma_f32 v200, v200, v246, v254
v_fma_f32 v201, v201, v246, v254
v_mfma_f32_16x16x32_bf16 v[192:195], a[152:155], v[24:27], v[192:195]
s_waitcnt lgkmcnt(10)
v_cvt_pk_bf16_f32 v208, v200, v201
v_fma_f32 v202, v202, v246, v254
v_mfma_f32_16x16x32_bf16 v[192:195], a[156:159], v[28:31], v[192:195]
v_fma_f32 v203, v203, v246, v254
v_cvt_pk_bf16_f32 v209, v202, v203
v_mfma_f32_16x16x32_bf16 v[192:195], a[160:163], v[32:35], v[192:195]
buffer_store_dwordx4 a[212:215], v239, s[24:27], s52 offen offset:128 sc1
v_mfma_f32_16x16x32_bf16 v[192:195], a[164:167], v[36:39], v[192:195]
ds_write_b64 v240, v[208:209] offset:16384
v_mfma_f32_16x16x32_bf16 v[192:195], a[168:171], v[40:43], v[192:195]
v_fma_f32 v196, v196, v245, v253
v_fma_f32 v197, v197, v245, v253
v_mfma_f32_16x16x32_bf16 v[192:195], a[172:175], v[44:47], v[192:195]
s_waitcnt lgkmcnt(2)
v_cvt_pk_bf16_f32 v226, v196, v197
v_fma_f32 v198, v198, v245, v253
v_mfma_f32_16x16x32_bf16 v[204:207], a[148:151], v[164:167], v[228:231]
v_fma_f32 v199, v199, v245, v253
v_cvt_pk_bf16_f32 v227, v198, v199
v_mfma_f32_16x16x32_bf16 v[204:207], a[144:147], v[160:163], v[204:207]
ds_read_b64_tr_b16 a[152:153], v234 offset:0
v_mfma_f32_16x16x32_bf16 v[204:207], a[140:143], v[156:159], v[204:207]
ds_read_b64_tr_b16 a[154:155], v234 offset:2048
v_mfma_f32_16x16x32_bf16 v[204:207], a[136:139], v[152:155], v[204:207]
ds_read_b64_tr_b16 a[156:157], v234 offset:4096
v_fma_f32 v192, v192, v244, v252
v_mfma_f32_16x16x32_bf16 v[204:207], a[132:135], v[148:151], v[204:207]
buffer_load_dwordx4 v239, s[92:95], s61 offen lds
v_mfma_f32_16x16x32_bf16 v[204:207], a[128:131], v[144:147], v[204:207]
ds_read_b64_tr_b16 a[158:159], v234 offset:6144
v_fma_f32 v193, v193, v244, v252
v_mfma_f32_16x16x32_bf16 v[200:203], a[128:131], v[96:99], v[228:231]
ds_read_b64_tr_b16 a[160:161], v234 offset:8192
v_cvt_pk_bf16_f32 v224, v192, v193
v_mfma_f32_16x16x32_bf16 v[200:203], a[132:135], v[100:103], v[200:203]
ds_read_b64_tr_b16 a[162:163], v234 offset:10240
v_fma_f32 v194, v194, v244, v252
v_mfma_f32_16x16x32_bf16 v[200:203], a[136:139], v[104:107], v[200:203]
s_add_u32 m0, s69, s56
v_fma_f32 v195, v195, v244, v252
v_cvt_pk_bf16_f32 v225, v194, v195
v_mfma_f32_16x16x32_bf16 v[200:203], a[140:143], v[108:111], v[200:203]
ds_read_b64_tr_b16 a[164:165], v234 offset:12288
v_mfma_f32_16x16x32_bf16 v[200:203], a[144:147], v[112:115], v[200:203]
ds_read_b64_tr_b16 a[166:167], v234 offset:14336
v_mfma_f32_16x16x32_bf16 v[200:203], a[148:151], v[116:119], v[200:203]
ds_read_b64_tr_b16 a[168:169], v234 offset:16384
v_mfma_f32_16x16x32_bf16 v[196:199], a[148:151], v[68:71], v[228:231]
s_add_u32 s92, s92, 49152
s_addc_u32 s93, s93, 0
v_mfma_f32_16x16x32_bf16 v[196:199], a[144:147], v[64:67], v[196:199]
ds_read_b64_tr_b16 a[170:171], v234 offset:18432
v_mfma_f32_16x16x32_bf16 v[196:199], a[140:143], v[60:63], v[196:199]
ds_read_b64_tr_b16 a[172:173], v234 offset:20480
v_mfma_f32_16x16x32_bf16 v[196:199], a[136:139], v[56:59], v[196:199]
ds_read_b64_tr_b16 a[174:175], v234 offset:22528
v_xor_b32 v234, 0x60, v234
v_mfma_f32_16x16x32_bf16 v[196:199], a[132:135], v[52:55], v[196:199]
buffer_load_dwordx4 v239, s[16:19], s56 offen lds
v_mfma_f32_16x16x32_bf16 v[196:199], a[128:131], v[48:51], v[196:199]
ds_write_b64 v240, v[226:227] offset:8192
v_mfma_f32_16x16x32_bf16 v[192:195], a[128:131], v[0:3], v[228:231]
ds_write_b64 v240, v[224:225] offset:0
v_mfma_f32_16x16x32_bf16 v[192:195], a[132:135], v[4:7], v[192:195]
buffer_store_dwordx4 a[216:219], v239, s[24:27], s53 offen offset:128 sc1
v_mfma_f32_16x16x32_bf16 v[192:195], a[136:139], v[8:11], v[192:195]
s_add_u32 m0, s69, s57
v_xor_b32 v235, 0x60, v235
v_mfma_f32_16x16x32_bf16 v[192:195], a[140:143], v[12:15], v[192:195]
v_mfma_f32_16x16x32_bf16 v[192:195], a[144:147], v[16:19], v[192:195]
v_mfma_f32_16x16x32_bf16 v[192:195], a[148:151], v[20:23], v[192:195]
s_waitcnt lgkmcnt(2)
v_mfma_f32_16x16x32_bf16 v[192:195], a[172:175], v[44:47], v[192:195]
v_mfma_f32_16x16x32_bf16 v[192:195], a[168:171], v[40:43], v[192:195]
ds_read_b64_tr_b16 a[128:129], v235 offset:40960
v_mfma_f32_16x16x32_bf16 v[192:195], a[164:167], v[36:39], v[192:195]
ds_read_b64_tr_b16 a[130:131], v235 offset:43008
v_mfma_f32_16x16x32_bf16 v[192:195], a[160:163], v[32:35], v[192:195]
ds_read_b64_tr_b16 a[132:133], v235 offset:45056
v_mfma_f32_16x16x32_bf16 v[192:195], a[156:159], v[28:31], v[192:195]
v_mfma_f32_16x16x32_bf16 v[192:195], a[152:155], v[24:27], v[192:195]
ds_read_b64_tr_b16 a[134:135], v235 offset:47104
v_mfma_f32_16x16x32_bf16 v[196:199], a[152:155], v[72:75], v[196:199]
ds_read_b64_tr_b16 a[136:137], v235 offset:49152
v_mfma_f32_16x16x32_bf16 v[196:199], a[156:159], v[76:79], v[196:199]
ds_read_b64_tr_b16 a[138:139], v235 offset:51200
v_mfma_f32_16x16x32_bf16 v[196:199], a[160:163], v[80:83], v[196:199]
buffer_load_dwordx4 v239, s[16:19], s57 offen lds
v_mfma_f32_16x16x32_bf16 v[196:199], a[164:167], v[84:87], v[196:199]
ds_read_b64_tr_b16 a[140:141], v235 offset:53248
v_fma_f32 v192, v192, v244, v252
v_mfma_f32_16x16x32_bf16 v[196:199], a[168:171], v[88:91], v[196:199]
ds_read_b64_tr_b16 a[142:143], v235 offset:55296
v_fma_f32 v193, v193, v244, v252
v_mfma_f32_16x16x32_bf16 v[196:199], a[172:175], v[92:95], v[196:199]
ds_read_b64_tr_b16 a[144:145], v235 offset:57344
v_cvt_pk_bf16_f32 v192, v192, v193
v_mfma_f32_16x16x32_bf16 v[200:203], a[172:175], v[140:143], v[200:203]
s_add_u32 m0, s69, s58
v_fma_f32 v194, v194, v244, v252
v_fma_f32 v195, v195, v244, v252
v_mfma_f32_16x16x32_bf16 v[200:203], a[168:171], v[136:139], v[200:203]
ds_read_b64_tr_b16 a[146:147], v235 offset:59392
v_cvt_pk_bf16_f32 v193, v194, v195
v_mfma_f32_16x16x32_bf16 v[200:203], a[164:167], v[132:135], v[200:203]
ds_read_b64_tr_b16 a[148:149], v235 offset:61440
v_mfma_f32_16x16x32_bf16 v[200:203], a[160:163], v[128:131], v[200:203]
ds_read_b64_tr_b16 a[150:151], v235 offset:63488
v_fma_f32 v196, v196, v245, v253
v_mfma_f32_16x16x32_bf16 v[200:203], a[156:159], v[124:127], v[200:203]
ds_write_b64 v241, v[192:193] offset:0
v_mfma_f32_16x16x32_bf16 v[200:203], a[152:155], v[120:123], v[200:203]
v_fma_f32 v197, v197, v245, v253
v_cvt_pk_bf16_f32 v196, v196, v197
v_mfma_f32_16x16x32_bf16 v[204:207], a[152:155], v[168:171], v[204:207]
v_fma_f32 v198, v198, v245, v253
v_fma_f32 v199, v199, v245, v253
v_mfma_f32_16x16x32_bf16 v[204:207], a[156:159], v[172:175], v[204:207]
buffer_store_dwordx4 a[220:223], v239, s[24:27], s54 offen offset:128 sc1
v_mfma_f32_16x16x32_bf16 v[204:207], a[160:163], v[176:179], v[204:207]
buffer_load_dwordx4 v239, s[16:19], s58 offen lds
v_mfma_f32_16x16x32_bf16 v[204:207], a[164:167], v[180:183], v[204:207]
s_add_u32 m0, s69, s59
v_cvt_pk_bf16_f32 v197, v198, v199
v_fma_f32 v200, v200, v246, v254
v_mfma_f32_16x16x32_bf16 v[204:207], a[168:171], v[184:187], v[204:207]
ds_write_b64 v241, v[196:197] offset:8192
v_mfma_f32_16x16x32_bf16 v[204:207], a[172:175], v[188:191], v[204:207]
s_waitcnt lgkmcnt(2)
v_fma_f32 v201, v201, v246, v254
v_cvt_pk_bf16_f32 v210, v200, v201
v_mfma_f32_16x16x32_bf16 v[192:195], a[148:151], v[20:23], v[228:231]
v_fma_f32 v202, v202, v246, v254
v_fma_f32 v203, v203, v246, v254
v_mfma_f32_16x16x32_bf16 v[192:195], a[144:147], v[16:19], v[192:195]
ds_read_b64_tr_b16 a[152:153], v234 offset:0
v_cvt_pk_bf16_f32 v211, v202, v203
v_mfma_f32_16x16x32_bf16 v[192:195], a[140:143], v[12:15], v[192:195]
ds_read_b64_tr_b16 a[154:155], v234 offset:2048
v_mfma_f32_16x16x32_bf16 v[192:195], a[136:139], v[8:11], v[192:195]
ds_read_b64_tr_b16 a[156:157], v234 offset:4096
v_fma_f32 v204, v204, v247, v255
v_mfma_f32_16x16x32_bf16 v[192:195], a[132:135], v[4:7], v[192:195]
v_fma_f32 v205, v205, v247, v255
v_cvt_pk_bf16_f32 v218, v204, v205
v_mfma_f32_16x16x32_bf16 v[192:195], a[128:131], v[0:3], v[192:195]
ds_read_b64_tr_b16 a[158:159], v234 offset:6144
v_fma_f32 v206, v206, v247, v255
v_mfma_f32_16x16x32_bf16 v[196:199], a[128:131], v[48:51], v[228:231]
ds_read_b64_tr_b16 a[160:161], v234 offset:8192
v_fma_f32 v207, v207, v247, v255
v_mfma_f32_16x16x32_bf16 v[196:199], a[132:135], v[52:55], v[196:199]
ds_read_b64_tr_b16 a[162:163], v234 offset:10240
v_cvt_pk_bf16_f32 v219, v206, v207
v_mfma_f32_16x16x32_bf16 v[196:199], a[136:139], v[56:59], v[196:199]
v_mfma_f32_16x16x32_bf16 v[196:199], a[140:143], v[60:63], v[196:199]
ds_read_b64_tr_b16 a[164:165], v234 offset:12288
v_mfma_f32_16x16x32_bf16 v[196:199], a[144:147], v[64:67], v[196:199]
ds_read_b64_tr_b16 a[166:167], v234 offset:14336
v_mfma_f32_16x16x32_bf16 v[196:199], a[148:151], v[68:71], v[196:199]
ds_read_b64_tr_b16 a[168:169], v234 offset:16384
v_mfma_f32_16x16x32_bf16 v[200:203], a[148:151], v[116:119], v[228:231]
buffer_load_dwordx4 v239, s[16:19], s59 offen lds
v_mfma_f32_16x16x32_bf16 v[200:203], a[144:147], v[112:115], v[200:203]
ds_read_b64_tr_b16 a[170:171], v234 offset:18432
s_add_u32 m0, s69, s60
v_mfma_f32_16x16x32_bf16 v[200:203], a[140:143], v[108:111], v[200:203]
ds_read_b64_tr_b16 a[172:173], v234 offset:20480
v_mfma_f32_16x16x32_bf16 v[200:203], a[136:139], v[104:107], v[200:203]
ds_read_b64_tr_b16 a[174:175], v234 offset:22528
v_xor_b32 v234, 32, v234
v_mfma_f32_16x16x32_bf16 v[200:203], a[132:135], v[100:103], v[200:203]
ds_write_b64 v241, v[210:211] offset:16384
v_mfma_f32_16x16x32_bf16 v[200:203], a[128:131], v[96:99], v[200:203]
ds_write_b64 v241, v[218:219] offset:24576
v_mfma_f32_16x16x32_bf16 v[204:207], a[128:131], v[144:147], v[228:231]
buffer_store_dwordx4 a[224:227], v239, s[24:27], s55 offen offset:128 sc1
v_mfma_f32_16x16x32_bf16 v[204:207], a[132:135], v[148:151], v[204:207]
v_xor_b32 v235, 32, v235
v_mfma_f32_16x16x32_bf16 v[204:207], a[136:139], v[152:155], v[204:207]
v_mfma_f32_16x16x32_bf16 v[204:207], a[140:143], v[156:159], v[204:207]
v_mfma_f32_16x16x32_bf16 v[204:207], a[144:147], v[160:163], v[204:207]
v_mfma_f32_16x16x32_bf16 v[204:207], a[148:151], v[164:167], v[204:207]
s_waitcnt lgkmcnt(2)
v_mfma_f32_16x16x32_bf16 v[204:207], a[172:175], v[188:191], v[204:207]
buffer_load_dwordx4 v239, s[16:19], s60 offen lds
v_mfma_f32_16x16x32_bf16 v[204:207], a[168:171], v[184:187], v[204:207]
ds_read_b64_tr_b16 a[128:129], v235 offset:40960
s_add_u32 m0, s69, s61
v_mfma_f32_16x16x32_bf16 v[204:207], a[164:167], v[180:183], v[204:207]
ds_read_b64_tr_b16 a[130:131], v235 offset:43008
v_mfma_f32_16x16x32_bf16 v[204:207], a[160:163], v[176:179], v[204:207]
ds_read_b64_tr_b16 a[132:133], v235 offset:45056
v_mfma_f32_16x16x32_bf16 v[204:207], a[156:159], v[172:175], v[204:207]
v_mfma_f32_16x16x32_bf16 v[204:207], a[152:155], v[168:171], v[204:207]
ds_read_b64_tr_b16 a[134:135], v235 offset:47104
v_mfma_f32_16x16x32_bf16 v[200:203], a[152:155], v[120:123], v[200:203]
ds_read_b64_tr_b16 a[136:137], v235 offset:49152
v_mfma_f32_16x16x32_bf16 v[200:203], a[156:159], v[124:127], v[200:203]
ds_read_b64_tr_b16 a[138:139], v235 offset:51200
v_mfma_f32_16x16x32_bf16 v[200:203], a[160:163], v[128:131], v[200:203]
v_mfma_f32_16x16x32_bf16 v[200:203], a[164:167], v[132:135], v[200:203]
ds_read_b64_tr_b16 a[140:141], v235 offset:53248
v_fma_f32 v204, v204, v247, v255
v_mfma_f32_16x16x32_bf16 v[200:203], a[168:171], v[136:139], v[200:203]
ds_read_b64_tr_b16 a[142:143], v235 offset:55296
v_fma_f32 v205, v205, v247, v255
v_mfma_f32_16x16x32_bf16 v[200:203], a[172:175], v[140:143], v[200:203]
ds_read_b64_tr_b16 a[144:145], v235 offset:57344
v_cvt_pk_bf16_f32 v220, v204, v205
v_mfma_f32_16x16x32_bf16 v[196:199], a[172:175], v[92:95], v[196:199]
v_fma_f32 v206, v206, v247, v255
v_fma_f32 v207, v207, v247, v255
v_mfma_f32_16x16x32_bf16 v[196:199], a[168:171], v[88:91], v[196:199]
ds_read_b64_tr_b16 a[146:147], v235 offset:59392
v_cvt_pk_bf16_f32 v221, v206, v207
v_mfma_f32_16x16x32_bf16 v[196:199], a[164:167], v[84:87], v[196:199]
ds_read_b64_tr_b16 a[148:149], v235 offset:61440
v_mfma_f32_16x16x32_bf16 v[196:199], a[160:163], v[80:83], v[196:199]
ds_read_b64_tr_b16 a[150:151], v235 offset:63488
v_fma_f32 v200, v200, v246, v254
v_mfma_f32_16x16x32_bf16 v[196:199], a[156:159], v[76:79], v[196:199]
buffer_load_dwordx4 v239, s[16:19], s61 offen lds
v_mfma_f32_16x16x32_bf16 v[196:199], a[152:155], v[72:75], v[196:199]
ds_write_b64 v242, v[220:221] offset:24576
v_mfma_f32_16x16x32_bf16 v[192:195], a[152:155], v[24:27], v[192:195]
buffer_store_dwordx4 a[228:231], v239, s[24:27], s48 offen offset:256 sc1
v_mfma_f32_16x16x32_bf16 v[192:195], a[156:159], v[28:31], v[192:195]
s_add_u32 m0, s75, s56
v_fma_f32 v201, v201, v246, v254
v_cvt_pk_bf16_f32 v212, v200, v201
v_mfma_f32_16x16x32_bf16 v[192:195], a[160:163], v[32:35], v[192:195]
v_fma_f32 v202, v202, v246, v254
v_fma_f32 v203, v203, v246, v254
v_mfma_f32_16x16x32_bf16 v[192:195], a[164:167], v[36:39], v[192:195]
v_cvt_pk_bf16_f32 v213, v202, v203
v_fma_f32 v196, v196, v245, v253
v_mfma_f32_16x16x32_bf16 v[192:195], a[168:171], v[40:43], v[192:195]
ds_write_b64 v242, v[212:213] offset:16384
v_mfma_f32_16x16x32_bf16 v[192:195], a[172:175], v[44:47], v[192:195]
s_waitcnt lgkmcnt(2)
v_fma_f32 v197, v197, v245, v253
v_cvt_pk_bf16_f32 v196, v196, v197
v_mfma_f32_16x16x32_bf16 v[204:207], a[148:151], v[164:167], v[228:231]
v_fma_f32 v198, v198, v245, v253
v_fma_f32 v199, v199, v245, v253
v_mfma_f32_16x16x32_bf16 v[204:207], a[144:147], v[160:163], v[204:207]
ds_read_b64_tr_b16 a[152:153], v234 offset:0
v_cvt_pk_bf16_f32 v197, v198, v199
v_mfma_f32_16x16x32_bf16 v[204:207], a[140:143], v[156:159], v[204:207]
ds_read_b64_tr_b16 a[154:155], v234 offset:2048
v_mfma_f32_16x16x32_bf16 v[204:207], a[136:139], v[152:155], v[204:207]
ds_read_b64_tr_b16 a[156:157], v234 offset:4096
v_fma_f32 v192, v192, v244, v252
v_mfma_f32_16x16x32_bf16 v[204:207], a[132:135], v[148:151], v[204:207]
ds_write_b64 v242, v[196:197] offset:8192
v_mfma_f32_16x16x32_bf16 v[204:207], a[128:131], v[144:147], v[204:207]
ds_read_b64_tr_b16 a[158:159], v234 offset:6144
v_fma_f32 v193, v193, v244, v252
v_mfma_f32_16x16x32_bf16 v[200:203], a[128:131], v[96:99], v[228:231]
ds_read_b64_tr_b16 a[160:161], v234 offset:8192
v_cvt_pk_bf16_f32 v192, v192, v193
v_mfma_f32_16x16x32_bf16 v[200:203], a[132:135], v[100:103], v[200:203]
ds_read_b64_tr_b16 a[162:163], v234 offset:10240
v_fma_f32 v194, v194, v244, v252
v_mfma_f32_16x16x32_bf16 v[200:203], a[136:139], v[104:107], v[200:203]
v_fma_f32 v195, v195, v244, v252
v_cvt_pk_bf16_f32 v193, v194, v195
v_mfma_f32_16x16x32_bf16 v[200:203], a[140:143], v[108:111], v[200:203]
ds_read_b64_tr_b16 a[164:165], v234 offset:12288
v_mfma_f32_16x16x32_bf16 v[200:203], a[144:147], v[112:115], v[200:203]
ds_read_b64_tr_b16 a[166:167], v234 offset:14336
v_mfma_f32_16x16x32_bf16 v[200:203], a[148:151], v[116:119], v[200:203]
ds_read_b64_tr_b16 a[168:169], v234 offset:16384
v_mfma_f32_16x16x32_bf16 v[196:199], a[148:151], v[68:71], v[228:231]
s_add_u32 s16, s16, 49152
s_addc_u32 s17, s17, 0
v_mfma_f32_16x16x32_bf16 v[196:199], a[144:147], v[64:67], v[196:199]
ds_read_b64_tr_b16 a[170:171], v234 offset:18432
v_mfma_f32_16x16x32_bf16 v[196:199], a[140:143], v[60:63], v[196:199]
ds_read_b64_tr_b16 a[172:173], v234 offset:20480
v_mfma_f32_16x16x32_bf16 v[196:199], a[136:139], v[56:59], v[196:199]
ds_read_b64_tr_b16 a[174:175], v234 offset:22528
v_xor_b32 v234, 0x60, v234
v_mfma_f32_16x16x32_bf16 v[196:199], a[132:135], v[52:55], v[196:199]
ds_write_b64 v242, v[192:193] offset:0
v_mfma_f32_16x16x32_bf16 v[196:199], a[128:131], v[48:51], v[196:199]
buffer_store_dwordx4 a[232:235], v239, s[24:27], s49 offen offset:256 sc1
v_mfma_f32_16x16x32_bf16 v[192:195], a[128:131], v[0:3], v[228:231]
v_xor_b32 v235, 0x60, v235
v_mfma_f32_16x16x32_bf16 v[192:195], a[132:135], v[4:7], v[192:195]
v_mfma_f32_16x16x32_bf16 v[192:195], a[136:139], v[8:11], v[192:195]
v_mfma_f32_16x16x32_bf16 v[192:195], a[140:143], v[12:15], v[192:195]
v_mfma_f32_16x16x32_bf16 v[192:195], a[144:147], v[16:19], v[192:195]
v_mfma_f32_16x16x32_bf16 v[192:195], a[148:151], v[20:23], v[192:195]
s_waitcnt vmcnt(11) lgkmcnt(1)
v_mfma_f32_16x16x32_bf16 v[192:195], a[172:175], v[44:47], v[192:195]
s_barrier
v_mfma_f32_16x16x32_bf16 v[192:195], a[168:171], v[40:43], v[192:195]
ds_read_b128 a[128:131], v236 offset:24576
v_mfma_f32_16x16x32_bf16 v[192:195], a[164:167], v[36:39], v[192:195]
ds_read_b128 a[132:135], v237 offset:24576
v_mfma_f32_16x16x32_bf16 v[192:195], a[160:163], v[32:35], v[192:195]
ds_read_b128 a[136:139], v236 offset:25600
v_mfma_f32_16x16x32_bf16 v[192:195], a[156:159], v[28:31], v[192:195]
buffer_load_dwordx4 v239, s[92:95], s56 offen lds
v_mfma_f32_16x16x32_bf16 v[192:195], a[152:155], v[24:27], v[192:195]
ds_read_b128 a[140:143], v237 offset:25600
s_add_u32 m0, s75, s57
v_mfma_f32_16x16x32_bf16 v[196:199], a[152:155], v[72:75], v[196:199]
ds_read_b128 a[144:147], v236 offset:26624
v_mfma_f32_16x16x32_bf16 v[196:199], a[156:159], v[76:79], v[196:199]
ds_read_b128 a[148:151], v237 offset:26624
v_mfma_f32_16x16x32_bf16 v[196:199], a[160:163], v[80:83], v[196:199]
v_mfma_f32_16x16x32_bf16 v[196:199], a[164:167], v[84:87], v[196:199]
v_fma_f32 v192, v192, v244, v252
v_fma_f32 v193, v193, v244, v252
v_mfma_f32_16x16x32_bf16 v[196:199], a[168:171], v[88:91], v[196:199]
v_cvt_pk_bf16_f32 v192, v192, v193
v_fma_f32 v194, v194, v244, v252
v_mfma_f32_16x16x32_bf16 v[196:199], a[172:175], v[92:95], v[196:199]
v_fma_f32 v195, v195, v244, v252
v_cvt_pk_bf16_f32 v193, v194, v195
v_mfma_f32_16x16x32_bf16 v[200:203], a[172:175], v[140:143], v[200:203]
v_mfma_f32_16x16x32_bf16 v[200:203], a[168:171], v[136:139], v[200:203]
v_mfma_f32_16x16x32_bf16 v[200:203], a[164:167], v[132:135], v[200:203]
v_mfma_f32_16x16x32_bf16 v[200:203], a[160:163], v[128:131], v[200:203]
s_nop 1
v_fma_f32 v196, v196, v245, v253
v_fma_f32 v197, v197, v245, v253
v_mfma_f32_16x16x32_bf16 v[200:203], a[156:159], v[124:127], v[200:203]
ds_write_b64 v243, v[192:193] offset:0
v_mfma_f32_16x16x32_bf16 v[200:203], a[152:155], v[120:123], v[200:203]
v_cvt_pk_bf16_f32 v196, v196, v197
v_fma_f32 v198, v198, v245, v253
v_mfma_f32_16x16x32_bf16 v[204:207], a[152:155], v[168:171], v[204:207]
ds_read_b128 a[152:155], v236 offset:27648
v_fma_f32 v199, v199, v245, v253
v_mfma_f32_16x16x32_bf16 v[204:207], a[156:159], v[172:175], v[204:207]
ds_read_b128 a[156:159], v237 offset:27648
v_cvt_pk_bf16_f32 v197, v198, v199
v_mfma_f32_16x16x32_bf16 v[204:207], a[160:163], v[176:179], v[204:207]
ds_write_b64 v243, v[196:197] offset:8192
v_mfma_f32_16x16x32_bf16 v[204:207], a[164:167], v[180:183], v[204:207]
buffer_load_dwordx4 v239, s[92:95], s57 offen lds
v_mfma_f32_16x16x32_bf16 v[204:207], a[168:171], v[184:187], v[204:207]
buffer_store_dwordx4 a[236:239], v239, s[24:27], s50 offen offset:256 sc1
v_mfma_f32_16x16x32_bf16 v[204:207], a[172:175], v[188:191], v[204:207]
s_waitcnt lgkmcnt(4)
v_fma_f32 v200, v200, v246, v254
v_fma_f32 v201, v201, v246, v254
L_p1_1:
v_mfma_f32_16x16x32_bf16 v[40:43], a[128:131], a[0:3], 0
ds_read_b128 a[184:187], v248 offset:0
v_cvt_pk_bf16_f32 v214, v200, v201
v_mfma_f32_16x16x32_bf16 v[40:43], a[132:135], a[4:7], v[40:43]
ds_read_b128 a[160:163], v236 offset:32768
v_fma_f32 v202, v202, v246, v254
v_mfma_f32_16x16x32_bf16 v[40:43], a[136:139], a[8:11], v[40:43]
ds_read_b128 a[164:167], v237 offset:32768
v_fma_f32 v203, v203, v246, v254
v_mfma_f32_16x16x32_bf16 v[40:43], a[140:143], a[12:15], v[40:43]
ds_read_b128 a[188:191], v248 offset:4096
v_fma_f32 v204, v204, v247, v255
v_mfma_f32_16x16x32_bf16 v[40:43], a[144:147], a[16:19], v[40:43]
ds_read_b128 a[192:195], v248 offset:8192
v_fma_f32 v205, v205, v247, v255
v_mfma_f32_16x16x32_bf16 v[40:43], a[148:151], a[20:23], v[40:43]
ds_read_b128 a[196:199], v248 offset:12288
s_waitcnt lgkmcnt(7)
v_mfma_f32_16x16x32_bf16 v[40:43], a[152:155], a[24:27], v[40:43]
s_add_u32 m0, s75, s58
v_cvt_pk_bf16_f32 v222, v204, v205
v_fma_f32 v206, v206, v247, v255
v_mfma_f32_16x16x32_bf16 v[40:43], a[156:159], a[28:31], v[40:43]
v_cvt_pk_bf16_f32 v215, v202, v203
v_fma_f32 v207, v207, v247, v255
L_t1:
v_mfma_f32_16x16x32_bf16 v[88:91], a[156:159], a[60:63], 0
ds_write_b64 v243, v[214:215] offset:16384
v_mfma_f32_16x16x32_bf16 v[88:91], a[152:155], a[56:59], v[88:91]
ds_read_b128 a[168:171], v236 offset:33792
v_cvt_pk_bf16_f32 v223, v206, v207
v_mfma_f32_16x16x32_bf16 v[88:91], a[148:151], a[52:55], v[88:91]
ds_read_b128 a[172:175], v237 offset:33792
v_max3_f32 v184, v40, v41, v42
v_max_f32 v184, v184, v43
v_mov_b32 v185, v184
v_mfma_f32_16x16x32_bf16 v[88:91], a[144:147], a[48:51], v[88:91]
ds_write_b64 v243, v[222:223] offset:24576
v_permlane32_swap_b32 v184, v185
v_max_f32 v184, v184, v185
v_mov_b32 v185, v184
s_nop 1
v_permlane16_swap_b32 v184, v185
v_max_f32 v184, v184, v185
v_sub_f32 v228, s78, v184
v_mul_f32 v185, s41, v228
v_fma_f32 v40, v40, s41, v185
v_fma_f32 v41, v41, s41, v185
v_mfma_f32_16x16x32_bf16 v[88:91], a[140:143], a[44:47], v[88:91]
ds_read_b128 a[200:203], v248 offset:16384
v_exp_f32 v40, v40
v_mov_b32 v229, v228
v_mov_b32 v230, v228
v_mov_b32 v231, v228
v_mfma_f32_16x16x32_bf16 v[88:91], a[136:139], a[40:43], v[88:91]
ds_read_b128 a[204:207], v248 offset:20480
v_fma_f32 v42, v42, s41, v185
v_fma_f32 v43, v43, s41, v185
v_mfma_f32_16x16x32_bf16 v[88:91], a[132:135], a[36:39], v[88:91]
ds_read_b128 a[208:211], v248 offset:24576
v_exp_f32 v41, v41
v_mfma_f32_16x16x32_bf16 v[88:91], a[128:131], a[32:35], v[88:91]
ds_read_b128 a[212:215], v248 offset:28672
v_exp_f32 v42, v42
v_mfma_f32_16x16x32_bf16 v[136:139], a[128:131], a[64:67], 0
buffer_load_dwordx4 v239, s[92:95], s58 offen lds
v_exp_f32 v43, v43
v_mfma_f32_16x16x32_bf16 v[136:139], a[132:135], a[68:71], v[136:139]
ds_read_b128 v[192:195], v236 offset:34816
v_cvt_pk_bf16_f32 v0, v40, v41
v_max3_f32 v184, v88, v89, v90
v_max_f32 v184, v184, v91
v_mov_b32 v185, v184
v_mfma_f32_16x16x32_bf16 v[136:139], a[136:139], a[72:75], v[136:139]
ds_read_b128 v[196:199], v237 offset:34816
v_cvt_pk_bf16_f32 v1, v42, v43
v_permlane32_swap_b32 v184, v185
v_max_f32 v184, v184, v185
v_mov_b32 v185, v184
v_mfma_f32_16x16x32_bf16 v[136:139], a[140:143], a[76:79], v[136:139]
s_add_u32 m0, s75, s59
v_permlane16_swap_b32 v184, v185
v_max_f32 v184, v184, v185
v_sub_f32 v252, s78, v184
v_mul_f32 v185, s41, v252
v_fma_f32 v88, v88, s41, v185
v_fma_f32 v89, v89, s41, v185
v_mfma_f32_16x16x32_bf16 v[136:139], a[144:147], a[80:83], v[136:139]
buffer_store_dwordx4 a[240:243], v239, s[24:27], s51 offen offset:256 sc1
v_exp_f32 v88, v88
v_mov_b32 v253, v252
v_mov_b32 v254, v252
v_mov_b32 v255, v252
v_mfma_f32_16x16x32_bf16 v[136:139], a[148:151], a[84:87], v[136:139]
s_waitcnt lgkmcnt(12)
v_fma_f32 v90, v90, s41, v185
v_fma_f32 v91, v91, s41, v185
v_mfma_f32_16x16x32_bf16 v[136:139], a[152:155], a[88:91], v[136:139]
s_waitcnt lgkmcnt(10)
v_exp_f32 v89, v89
v_mfma_f32_16x16x32_bf16 v[136:139], a[156:159], a[92:95], v[136:139]
s_waitcnt lgkmcnt(4)
v_exp_f32 v90, v90
v_mfma_f32_16x16x32_bf16 v[40:43], a[156:159], a[124:127], 0
s_waitcnt lgkmcnt(2)
v_exp_f32 v91, v91
v_mfma_f32_16x16x32_bf16 v[40:43], a[152:155], a[120:123], v[40:43]
ds_read_b128 a[156:159], v237 offset:35840
v_cvt_pk_bf16_f32 v48, v88, v89
v_max3_f32 v184, v136, v137, v138
v_max_f32 v184, v184, v139
v_mov_b32 v185, v184
v_mfma_f32_16x16x32_bf16 v[40:43], a[148:151], a[116:119], v[40:43]
ds_read_b128 a[152:155], v236 offset:35840
v_cvt_pk_bf16_f32 v49, v90, v91
v_permlane32_swap_b32 v184, v185
v_max_f32 v184, v184, v185
v_mov_b32 v185, v184
v_mfma_f32_16x16x32_bf16 v[40:43], a[144:147], a[112:115], v[40:43]
s_nop 0
v_permlane16_swap_b32 v184, v185
v_max_f32 v184, v184, v185
v_sub_f32 v244, s78, v184
v_mul_f32 v185, s41, v244
v_fma_f32 v136, v136, s41, v185
v_fma_f32 v137, v137, s41, v185
v_mfma_f32_16x16x32_bf16 v[40:43], a[140:143], a[108:111], v[40:43]
v_exp_f32 v136, v136
v_mov_b32 v245, v244
v_mov_b32 v246, v244
v_mov_b32 v247, v244
v_mfma_f32_16x16x32_bf16 v[40:43], a[136:139], a[104:107], v[40:43]
v_fma_f32 v138, v138, s41, v185
v_fma_f32 v139, v139, s41, v185
v_mfma_f32_16x16x32_bf16 v[40:43], a[132:135], a[100:103], v[40:43]
v_exp_f32 v137, v137
v_mfma_f32_16x16x32_bf16 v[40:43], a[128:131], a[96:99], v[40:43]
s_waitcnt lgkmcnt(2)
v_exp_f32 v138, v138
v_mfma_f32_16x16x32_bf16 v[88:91], a[160:163], a[0:3], v[228:231]
v_exp_f32 v139, v139
v_mfma_f32_16x16x32_bf16 v[88:91], a[164:167], a[4:7], v[88:91]
ds_read_b128 a[128:131], v236 offset:40960
v_cvt_pk_bf16_f32 v96, v136, v137
s_nop 0
v_max3_f32 v184, v40, v41, v42
v_max_f32 v184, v184, v43
v_mov_b32 v185, v184
v_mfma_f32_16x16x32_bf16 v[88:91], a[168:171], a[8:11], v[88:91]
ds_read_b128 a[132:135], v237 offset:40960
v_cvt_pk_bf16_f32 v97, v138, v139
v_permlane32_swap_b32 v184, v185
v_max_f32 v184, v184, v185
v_mov_b32 v185, v184
v_mfma_f32_16x16x32_bf16 v[88:91], a[172:175], a[12:15], v[88:91]
buffer_load_dwordx4 v239, s[92:95], s59 offen lds
v_permlane16_swap_b32 v184, v185
v_max_f32 v184, v184, v185
v_sub_f32 v220, s78, v184
v_mul_f32 v185, s41, v220
v_fma_f32 v40, v40, s41, v185
v_fma_f32 v41, v41, s41, v185
v_mfma_f32_16x16x32_bf16 v[88:91], v[192:195], a[16:19], v[88:91]
s_add_u32 m0, s75, s60
v_exp_f32 v40, v40
v_mov_b32 v221, v220
v_mov_b32 v222, v220
v_mov_b32 v223, v220
v_mfma_f32_16x16x32_bf16 v[88:91], v[196:199], a[20:23], v[88:91]
s_waitcnt lgkmcnt(2)
v_fma_f32 v42, v42, s41, v185
v_fma_f32 v43, v43, s41, v185
v_mfma_f32_16x16x32_bf16 v[88:91], a[152:155], a[24:27], v[88:91]
v_exp_f32 v41, v41
v_mfma_f32_16x16x32_bf16 v[88:91], a[156:159], a[28:31], v[88:91]
v_exp_f32 v42, v42
v_mfma_f32_16x16x32_bf16 v[136:139], a[156:159], a[60:63], v[252:255]
v_exp_f32 v43, v43
v_mfma_f32_16x16x32_bf16 v[136:139], a[152:155], a[56:59], v[136:139]
ds_read_b128 a[136:139], v236 offset:41984
v_cvt_pk_bf16_f32 v144, v40, v41
v_mfma_f32_16x16x32_bf16 v[136:139], v[196:199], a[52:55], v[136:139]
ds_read_b128 a[140:143], v237 offset:41984
v_cvt_pk_bf16_f32 v145, v42, v43
v_mfma_f32_16x16x32_bf16 v[136:139], v[192:195], a[48:51], v[136:139]
buffer_store_dwordx4 a[244:247], v239, s[24:27], s52 offen offset:256 sc1
v_mul_f32 v88, s41, v88
v_mul_f32 v89, s41, v89
v_mfma_f32_16x16x32_bf16 v[136:139], a[172:175], a[44:47], v[136:139]
v_exp_f32 v88, v88
v_mfma_f32_16x16x32_bf16 v[136:139], a[168:171], a[40:43], v[136:139]
v_mul_f32 v90, s41, v90
v_mul_f32 v91, s41, v91
v_mfma_f32_16x16x32_bf16 v[136:139], a[164:167], a[36:39], v[136:139]
v_exp_f32 v89, v89
v_mfma_f32_16x16x32_bf16 v[136:139], a[160:163], a[32:35], v[136:139]
v_exp_f32 v90, v90
v_mfma_f32_16x16x32_bf16 v[40:43], a[160:163], a[64:67], v[244:247]
v_exp_f32 v91, v91
v_mfma_f32_16x16x32_bf16 v[40:43], a[164:167], a[68:71], v[40:43]
ds_read_b128 a[144:147], v236 offset:43008
v_cvt_pk_bf16_f32 v2, v88, v89
v_mfma_f32_16x16x32_bf16 v[40:43], a[168:171], a[72:75], v[40:43]
ds_read_b128 a[148:151], v237 offset:43008
v_cvt_pk_bf16_f32 v3, v90, v91
v_mfma_f32_16x16x32_bf16 v[40:43], a[172:175], a[76:79], v[40:43]
v_mul_f32 v136, s41, v136
v_mul_f32 v137, s41, v137
v_mfma_f32_16x16x32_bf16 v[40:43], v[192:195], a[80:83], v[40:43]
v_exp_f32 v136, v136
v_mfma_f32_16x16x32_bf16 v[40:43], v[196:199], a[84:87], v[40:43]
buffer_load_dwordx4 v239, s[92:95], s60 offen lds
v_mul_f32 v138, s41, v138
v_mul_f32 v139, s41, v139
v_mfma_f32_16x16x32_bf16 v[40:43], a[152:155], a[88:91], v[40:43]
s_add_u32 m0, s75, s61
v_exp_f32 v137, v137
v_mfma_f32_16x16x32_bf16 v[40:43], a[156:159], a[92:95], v[40:43]
v_exp_f32 v138, v138
v_mfma_f32_16x16x32_bf16 v[88:91], a[156:159], a[124:127], v[220:223]
v_exp_f32 v139, v139
v_mfma_f32_16x16x32_bf16 v[88:91], a[152:155], a[120:123], v[88:91]
ds_read_b128 a[156:159], v237 offset:44032
v_cvt_pk_bf16_f32 v50, v136, v137
v_mfma_f32_16x16x32_bf16 v[88:91], v[196:199], a[116:119], v[88:91]
ds_read_b128 a[152:155], v236 offset:44032
v_cvt_pk_bf16_f32 v51, v138, v139
v_mfma_f32_16x16x32_bf16 v[88:91], v[192:195], a[112:115], v[88:91]
v_mul_f32 v40, s41, v40
v_mul_f32 v41, s41, v41
v_mfma_f32_16x16x32_bf16 v[88:91], a[172:175], a[108:111], v[88:91]
v_exp_f32 v40, v40
v_mfma_f32_16x16x32_bf16 v[88:91], a[168:171], a[104:107], v[88:91]
v_mul_f32 v42, s41, v42
v_mul_f32 v43, s41, v43
v_mfma_f32_16x16x32_bf16 v[88:91], a[164:167], a[100:103], v[88:91]
v_exp_f32 v41, v41
v_mfma_f32_16x16x32_bf16 v[88:91], a[160:163], a[96:99], v[88:91]
s_waitcnt lgkmcnt(2)
v_exp_f32 v42, v42
v_mfma_f32_16x16x32_bf16 v[200:203], a[128:131], a[0:3], v[228:231]
v_exp_f32 v43, v43
v_mfma_f32_16x16x32_bf16 v[200:203], a[132:135], a[4:7], v[200:203]
ds_read_b128 a[160:163], v236 offset:49152
v_cvt_pk_bf16_f32 v98, v40, v41
v_mfma_f32_16x16x32_bf16 v[200:203], a[136:139], a[8:11], v[200:203]
ds_read_b128 a[164:167], v237 offset:49152
v_cvt_pk_bf16_f32 v99, v42, v43
v_mfma_f32_16x16x32_bf16 v[200:203], a[140:143], a[12:15], v[200:203]
buffer_store_dwordx4 a[248:251], v239, s[24:27], s53 offen offset:256 sc1
v_mul_f32 v88, s41, v88
v_mul_f32 v89, s41, v89
v_mfma_f32_16x16x32_bf16 v[200:203], a[144:147], a[16:19], v[200:203]
v_exp_f32 v88, v88
v_mfma_f32_16x16x32_bf16 v[200:203], a[148:151], a[20:23], v[200:203]
s_waitcnt lgkmcnt(2)
v_mul_f32 v90, s41, v90
v_mul_f32 v91, s41, v91
v_mfma_f32_16x16x32_bf16 v[200:203], a[152:155], a[24:27], v[200:203]
v_exp_f32 v89, v89
v_mfma_f32_16x16x32_bf16 v[200:203], a[156:159], a[28:31], v[200:203]
v_exp_f32 v90, v90
v_mfma_f32_16x16x32_bf16 v[208:211], a[252:255], v[0:3], 0
buffer_load_dwordx4 v239, s[92:95], s61 offen lds
v_mfma_f32_16x16x32_bf16 v[204:207], a[156:159], a[60:63], v[252:255]
s_add_u32 m0, s38, s56
v_exp_f32 v91, v91
v_mfma_f32_16x16x32_bf16 v[204:207], a[152:155], a[56:59], v[204:207]
ds_read_b128 a[168:171], v236 offset:50176
v_cvt_pk_bf16_f32 v146, v88, v89
v_mfma_f32_16x16x32_bf16 v[204:207], a[148:151], a[52:55], v[204:207]
ds_read_b128 a[172:175], v237 offset:50176
v_cvt_pk_bf16_f32 v147, v90, v91
v_mfma_f32_16x16x32_bf16 v[204:207], a[144:147], a[48:51], v[204:207]
s_add_u32 s92, s92, 49152
s_addc_u32 s93, s93, 0
v_mul_f32 v200, s41, v200
v_mul_f32 v201, s41, v201
v_mfma_f32_16x16x32_bf16 v[204:207], a[140:143], a[44:47], v[204:207]
v_exp_f32 v200, v200
v_mfma_f32_16x16x32_bf16 v[204:207], a[136:139], a[40:43], v[204:207]
v_mul_f32 v202, s41, v202
v_mul_f32 v203, s41, v203
v_mfma_f32_16x16x32_bf16 v[204:207], a[132:135], a[36:39], v[204:207]
v_exp_f32 v201, v201
v_mfma_f32_16x16x32_bf16 v[204:207], a[128:131], a[32:35], v[204:207]
v_exp_f32 v202, v202
v_mfma_f32_16x16x32_bf16 v[210:213], a[252:255], v[48:51], 0
buffer_load_dwordx4 v239, s[16:19], s56 offen lds
v_mfma_f32_16x16x32_bf16 v[224:227], a[128:131], a[64:67], v[244:247]
s_add_u32 m0, s38, s57
v_exp_f32 v203, v203
v_mfma_f32_16x16x32_bf16 v[224:227], a[132:135], a[68:71], v[224:227]
ds_read_b128 v[192:195], v236 offset:51200
v_cvt_pk_bf16_f32 v4, v200, v201
v_mfma_f32_16x16x32_bf16 v[224:227], a[136:139], a[72:75], v[224:227]
ds_read_b128 v[196:199], v237 offset:51200
v_cvt_pk_bf16_f32 v5, v202, v203
v_mfma_f32_16x16x32_bf16 v[224:227], a[140:143], a[76:79], v[224:227]
v_mul_f32 v204, s41, v204
v_mul_f32 v205, s41, v205
v_mfma_f32_16x16x32_bf16 v[224:227], a[144:147], a[80:83], v[224:227]
v_exp_f32 v204, v204
v_mfma_f32_16x16x32_bf16 v[224:227], a[148:151], a[84:87], v[224:227]
v_mul_f32 v206, s41, v206
v_mul_f32 v207, s41, v207
v_mfma_f32_16x16x32_bf16 v[224:227], a[152:155], a[88:91], v[224:227]
v_exp_f32 v205, v205
v_mfma_f32_16x16x32_bf16 v[224:227], a[156:159], a[92:95], v[224:227]
v_exp_f32 v206, v206
v_mfma_f32_16x16x32_bf16 v[212:215], a[252:255], v[96:99], 0
buffer_load_dwordx4 v239, s[16:19], s57 offen lds
v_mfma_f32_16x16x32_bf16 v[200:203], a[156:159], a[124:127], v[220:223]
buffer_store_dwordx4 a[176:179], v239, s[24:27], s54 offen offset:256 sc1
v_exp_f32 v207, v207
v_mfma_f32_16x16x32_bf16 v[200:203], a[152:155], a[120:123], v[200:203]
ds_read_b128 a[156:159], v237 offset:52224
v_cvt_pk_bf16_f32 v52, v204, v205
v_mfma_f32_16x16x32_bf16 v[200:203], a[148:151], a[116:119], v[200:203]
ds_read_b128 a[152:155], v236 offset:52224
v_cvt_pk_bf16_f32 v53, v206, v207
v_mfma_f32_16x16x32_bf16 v[200:203], a[144:147], a[112:115], v[200:203]
s_add_u32 m0, s38, s58
v_mul_f32 v224, s41, v224
v_mul_f32 v225, s41, v225
v_mfma_f32_16x16x32_bf16 v[200:203], a[140:143], a[108:111], v[200:203]
v_exp_f32 v224, v224
v_mfma_f32_16x16x32_bf16 v[200:203], a[136:139], a[104:107], v[200:203]
v_mul_f32 v226, s41, v226
v_mul_f32 v227, s41, v227
v_mfma_f32_16x16x32_bf16 v[200:203], a[132:135], a[100:103], v[200:203]
v_exp_f32 v225, v225
v_mfma_f32_16x16x32_bf16 v[200:203], a[128:131], a[96:99], v[200:203]
s_waitcnt lgkmcnt(2)
v_exp_f32 v226, v226
v_mfma_f32_16x16x32_bf16 v[204:207], a[160:163], a[0:3], v[228:231]
v_exp_f32 v227, v227
v_mfma_f32_16x16x32_bf16 v[204:207], a[164:167], a[4:7], v[204:207]
ds_read_b128 a[128:131], v236 offset:57344
v_cvt_pk_bf16_f32 v100, v224, v225
v_mfma_f32_16x16x32_bf16 v[204:207], a[168:171], a[8:11], v[204:207]
ds_read_b128 a[132:135], v237 offset:57344
v_cvt_pk_bf16_f32 v101, v226, v227
v_mfma_f32_16x16x32_bf16 v[204:207], a[172:175], a[12:15], v[204:207]
v_mul_f32 v200, s41, v200
v_mul_f32 v201, s41, v201
v_mfma_f32_16x16x32_bf16 v[204:207], v[192:195], a[16:19], v[204:207]
v_exp_f32 v200, v200
v_mfma_f32_16x16x32_bf16 v[204:207], v[196:199], a[20:23], v[204:207]
s_waitcnt lgkmcnt(2)
v_mul_f32 v202, s41, v202
v_mul_f32 v203, s41, v203
v_mfma_f32_16x16x32_bf16 v[204:207], a[152:155], a[24:27], v[204:207]
v_exp_f32 v201, v201
v_mfma_f32_16x16x32_bf16 v[204:207], a[156:159], a[28:31], v[204:207]
v_exp_f32 v202, v202
v_mfma_f32_16x16x32_bf16 v[214:217], a[252:255], v[144:147], 0
buffer_load_dwordx4 v239, s[16:19], s58 offen lds
v_mfma_f32_16x16x32_bf16 v[224:227], a[156:159], a[60:63], v[252:255]
s_add_u32 m0, s38, s59
v_exp_f32 v203, v203
v_mfma_f32_16x16x32_bf16 v[224:227], a[152:155], a[56:59], v[224:227]
ds_read_b128 a[136:139], v236 offset:58368
v_cvt_pk_bf16_f32 v148, v200, v201
v_mfma_f32_16x16x32_bf16 v[224:227], v[196:199], a[52:55], v[224:227]
ds_read_b128 a[140:143], v237 offset:58368
v_cvt_pk_bf16_f32 v149, v202, v203
v_mfma_f32_16x16x32_bf16 v[224:227], v[192:195], a[48:51], v[224:227]
v_mul_f32 v204, s41, v204
v_mul_f32 v205, s41, v205
v_mfma_f32_16x16x32_bf16 v[224:227], a[172:175], a[44:47], v[224:227]
v_exp_f32 v204, v204
v_mfma_f32_16x16x32_bf16 v[224:227], a[168:171], a[40:43], v[224:227]
buffer_store_dwordx4 a[180:183], v239, s[24:27], s55 offen offset:256 sc1
v_mul_f32 v206, s41, v206
v_mul_f32 v207, s41, v207
v_mfma_f32_16x16x32_bf16 v[224:227], a[164:167], a[36:39], v[224:227]
v_exp_f32 v205, v205
v_mfma_f32_16x16x32_bf16 v[224:227], a[160:163], a[32:35], v[224:227]
v_exp_f32 v206, v206
v_mfma_f32_16x16x32_bf16 v[200:203], a[160:163], a[64:67], v[244:247]
v_exp_f32 v207, v207
v_mfma_f32_16x16x32_bf16 v[200:203], a[164:167], a[68:71], v[200:203]
ds_read_b128 a[144:147], v236 offset:59392
v_cvt_pk_bf16_f32 v6, v204, v205
v_mfma_f32_16x16x32_bf16 v[200:203], a[168:171], a[72:75], v[200:203]
ds_read_b128 a[148:151], v237 offset:59392
v_cvt_pk_bf16_f32 v7, v206, v207
v_mfma_f32_16x16x32_bf16 v[200:203], a[172:175], a[76:79], v[200:203]
v_mul_f32 v224, s41, v224
v_mul_f32 v225, s41, v225
v_mfma_f32_16x16x32_bf16 v[200:203], v[192:195], a[80:83], v[200:203]
v_exp_f32 v224, v224
v_mfma_f32_16x16x32_bf16 v[200:203], v[196:199], a[84:87], v[200:203]
v_mul_f32 v226, s41, v226
v_mul_f32 v227, s41, v227
v_mfma_f32_16x16x32_bf16 v[200:203], a[152:155], a[88:91], v[200:203]
v_exp_f32 v225, v225
v_mfma_f32_16x16x32_bf16 v[200:203], a[156:159], a[92:95], v[200:203]
v_exp_f32 v226, v226
v_mfma_f32_16x16x32_bf16 v[208:211], a[252:255], v[4:7], v[208:211]
buffer_load_dwordx4 v239, s[16:19], s59 offen lds
v_mfma_f32_16x16x32_bf16 v[204:207], a[156:159], a[124:127], v[220:223]
s_add_u32 m0, s38, s60
v_exp_f32 v227, v227
v_mfma_f32_16x16x32_bf16 v[204:207], a[152:155], a[120:123], v[204:207]
ds_read_b128 a[156:159], v237 offset:60416
v_cvt_pk_bf16_f32 v54, v224, v225
v_mfma_f32_16x16x32_bf16 v[204:207], v[196:199], a[116:119], v[204:207]
ds_read_b128 a[152:155], v236 offset:60416
v_cvt_pk_bf16_f32 v55, v226, v227
v_mfma_f32_16x16x32_bf16 v[204:207], v[192:195], a[112:115], v[204:207]
v_mul_f32 v200, s41, v200
v_mul_f32 v201, s41, v201
v_mfma_f32_16x16x32_bf16 v[204:207], a[172:175], a[108:111], v[204:207]
v_exp_f32 v200, v200
v_mfma_f32_16x16x32_bf16 v[204:207], a[168:171], a[104:107], v[204:207]
v_mul_f32 v202, s41, v202
v_mul_f32 v203, s41, v203
v_mfma_f32_16x16x32_bf16 v[204:207], a[164:167], a[100:103], v[204:207]
v_exp_f32 v201, v201
v_mfma_f32_16x16x32_bf16 v[204:207], a[160:163], a[96:99], v[204:207]
s_waitcnt lgkmcnt(2)
v_exp_f32 v202, v202
v_mfma_f32_16x16x32_bf16 v[224:227], a[128:131], a[0:3], v[228:231]
v_exp_f32 v203, v203
v_mfma_f32_16x16x32_bf16 v[224:227], a[132:135], a[4:7], v[224:227]
ds_read_b128 a[160:163], v249 offset:8192
v_cvt_pk_bf16_f32 v102, v200, v201
v_mfma_f32_16x16x32_bf16 v[224:227], a[136:139], a[8:11], v[224:227]
ds_read_b128 a[164:167], v250 offset:8192
v_cvt_pk_bf16_f32 v103, v202, v203
v_mfma_f32_16x16x32_bf16 v[224:227], a[140:143], a[12:15], v[224:227]
v_mul_f32 v204, s41, v204
v_mul_f32 v205, s41, v205
v_mfma_f32_16x16x32_bf16 v[224:227], a[144:147], a[16:19], v[224:227]
buffer_store_dwordx4 a[184:187], v239, s[24:27], s48 offen offset:384 sc1
v_exp_f32 v204, v204
v_mfma_f32_16x16x32_bf16 v[224:227], a[148:151], a[20:23], v[224:227]
s_waitcnt lgkmcnt(2)
v_mul_f32 v206, s41, v206
v_mul_f32 v207, s41, v207
v_mfma_f32_16x16x32_bf16 v[224:227], a[152:155], a[24:27], v[224:227]
v_exp_f32 v205, v205
v_mfma_f32_16x16x32_bf16 v[224:227], a[156:159], a[28:31], v[224:227]
v_exp_f32 v206, v206
v_mfma_f32_16x16x32_bf16 v[210:213], a[252:255], v[52:55], v[210:213]
buffer_load_dwordx4 v239, s[16:19], s60 offen lds
v_mfma_f32_16x16x32_bf16 v[200:203], a[156:159], a[60:63], v[252:255]
s_add_u32 m0, s38, s61
v_exp_f32 v207, v207
v_mfma_f32_16x16x32_bf16 v[200:203], a[152:155], a[56:59], v[200:203]
ds_read_b128 a[168:171], v249 offset:9216
v_cvt_pk_bf16_f32 v150, v204, v205
v_mfma_f32_16x16x32_bf16 v[200:203], a[148:151], a[52:55], v[200:203]
ds_read_b128 a[172:175], v250 offset:9216
v_cvt_pk_bf16_f32 v151, v206, v207
v_mfma_f32_16x16x32_bf16 v[200:203], a[144:147], a[48:51], v[200:203]
v_mul_f32 v224, s41, v224
v_mul_f32 v225, s41, v225
v_mfma_f32_16x16x32_bf16 v[200:203], a[140:143], a[44:47], v[200:203]
v_exp_f32 v224, v224
v_mfma_f32_16x16x32_bf16 v[200:203], a[136:139], a[40:43], v[200:203]
v_mul_f32 v226, s41, v226
v_mul_f32 v227, s41, v227
v_mfma_f32_16x16x32_bf16 v[200:203], a[132:135], a[36:39], v[200:203]
v_exp_f32 v225, v225
v_mfma_f32_16x16x32_bf16 v[200:203], a[128:131], a[32:35], v[200:203]
v_exp_f32 v226, v226
v_mfma_f32_16x16x32_bf16 v[204:207], a[128:131], a[64:67], v[244:247]
v_exp_f32 v227, v227
v_mfma_f32_16x16x32_bf16 v[204:207], a[132:135], a[68:71], v[204:207]
ds_read_b128 v[192:195], v249 offset:10240
v_cvt_pk_bf16_f32 v8, v224, v225
v_mfma_f32_16x16x32_bf16 v[204:207], a[136:139], a[72:75], v[204:207]
ds_read_b128 v[196:199], v250 offset:10240
v_cvt_pk_bf16_f32 v9, v226, v227
v_mfma_f32_16x16x32_bf16 v[204:207], a[140:143], a[76:79], v[204:207]
v_mul_f32 v200, s41, v200
v_mul_f32 v201, s41, v201
v_mfma_f32_16x16x32_bf16 v[204:207], a[144:147], a[80:83], v[204:207]
v_exp_f32 v200, v200
v_mfma_f32_16x16x32_bf16 v[204:207], a[148:151], a[84:87], v[204:207]
v_mul_f32 v202, s41, v202
v_mul_f32 v203, s41, v203
v_mfma_f32_16x16x32_bf16 v[204:207], a[152:155], a[88:91], v[204:207]
v_exp_f32 v201, v201
v_mfma_f32_16x16x32_bf16 v[204:207], a[156:159], a[92:95], v[204:207]
v_exp_f32 v202, v202
v_mfma_f32_16x16x32_bf16 v[212:215], a[252:255], v[100:103], v[212:215]
buffer_load_dwordx4 v239, s[16:19], s61 offen lds
v_mfma_f32_16x16x32_bf16 v[224:227], a[156:159], a[124:127], v[220:223]
s_add_u32 m0, s39, s56
v_exp_f32 v203, v203
v_mfma_f32_16x16x32_bf16 v[224:227], a[152:155], a[120:123], v[224:227]
ds_read_b128 a[156:159], v250 offset:11264
v_cvt_pk_bf16_f32 v56, v200, v201
v_mfma_f32_16x16x32_bf16 v[224:227], a[148:151], a[116:119], v[224:227]
ds_read_b128 a[152:155], v249 offset:11264
v_cvt_pk_bf16_f32 v57, v202, v203
v_mfma_f32_16x16x32_bf16 v[224:227], a[144:147], a[112:115], v[224:227]
buffer_store_dwordx4 a[188:191], v239, s[24:27], s49 offen offset:384 sc1
v_mul_f32 v204, s41, v204
v_mul_f32 v205, s41, v205
v_mfma_f32_16x16x32_bf16 v[224:227], a[140:143], a[108:111], v[224:227]
s_add_u32 s16, s16, 49152
s_addc_u32 s17, s17, 0
v_exp_f32 v204, v204
v_mfma_f32_16x16x32_bf16 v[224:227], a[136:139], a[104:107], v[224:227]
v_mul_f32 v206, s41, v206
v_mul_f32 v207, s41, v207
v_mfma_f32_16x16x32_bf16 v[224:227], a[132:135], a[100:103], v[224:227]
v_exp_f32 v205, v205
v_mfma_f32_16x16x32_bf16 v[224:227], a[128:131], a[96:99], v[224:227]
s_waitcnt vmcnt(10) lgkmcnt(0)
v_exp_f32 v206, v206
v_mfma_f32_16x16x32_bf16 v[200:203], a[160:163], a[0:3], v[228:231]
s_barrier
v_exp_f32 v207, v207
v_mfma_f32_16x16x32_bf16 v[200:203], a[164:167], a[4:7], v[200:203]
ds_read_b128 a[128:131], v249 offset:16384
v_cvt_pk_bf16_f32 v104, v204, v205
v_mfma_f32_16x16x32_bf16 v[200:203], a[168:171], a[8:11], v[200:203]
ds_read_b128 a[132:135], v250 offset:16384
v_cvt_pk_bf16_f32 v105, v206, v207
v_mfma_f32_16x16x32_bf16 v[200:203], a[172:175], a[12:15], v[200:203]
v_mul_f32 v224, s41, v224
v_mul_f32 v225, s41, v225
v_mfma_f32_16x16x32_bf16 v[200:203], v[192:195], a[16:19], v[200:203]
v_exp_f32 v224, v224
v_mfma_f32_16x16x32_bf16 v[200:203], v[196:199], a[20:23], v[200:203]
v_mul_f32 v226, s41, v226
v_mul_f32 v227, s41, v227
v_mfma_f32_16x16x32_bf16 v[200:203], a[152:155], a[24:27], v[200:203]
v_exp_f32 v225, v225
v_mfma_f32_16x16x32_bf16 v[200:203], a[156:159], a[28:31], v[200:203]
v_exp_f32 v226, v226
v_mfma_f32_16x16x32_bf16 v[214:217], a[252:255], v[148:151], v[214:217]
buffer_load_dwordx4 v239, s[92:95], s56 offen lds
v_mfma_f32_16x16x32_bf16 v[204:207], a[156:159], a[60:63], v[252:255]
s_add_u32 m0, s39, s57
v_exp_f32 v227, v227
v_mfma_f32_16x16x32_bf16 v[204:207], a[152:155], a[56:59], v[204:207]
ds_read_b128 a[136:139], v249 offset:17408
v_cvt_pk_bf16_f32 v152, v224, v225
v_mfma_f32_16x16x32_bf16 v[204:207], v[196:199], a[52:55], v[204:207]
ds_read_b128 a[140:143], v250 offset:17408
v_cvt_pk_bf16_f32 v153, v226, v227
v_mfma_f32_16x16x32_bf16 v[204:207], v[192:195], a[48:51], v[204:207]
buffer_store_dwordx4 a[192:195], v239, s[24:27], s50 offen offset:384 sc1
v_mul_f32 v200, s41, v200
v_mul_f32 v201, s41, v201
v_mfma_f32_16x16x32_bf16 v[204:207], a[172:175], a[44:47], v[204:207]
v_exp_f32 v200, v200
v_mfma_f32_16x16x32_bf16 v[204:207], a[168:171], a[40:43], v[204:207]
v_mul_f32 v202, s41, v202
v_mul_f32 v203, s41, v203
v_mfma_f32_16x16x32_bf16 v[204:207], a[164:167], a[36:39], v[204:207]
v_exp_f32 v201, v201
v_mfma_f32_16x16x32_bf16 v[204:207], a[160:163], a[32:35], v[204:207]
v_exp_f32 v202, v202
v_mfma_f32_16x16x32_bf16 v[224:227], a[160:163], a[64:67], v[244:247]
v_exp_f32 v203, v203
v_mfma_f32_16x16x32_bf16 v[224:227], a[164:167], a[68:71], v[224:227]
ds_read_b128 a[144:147], v249 offset:18432
v_cvt_pk_bf16_f32 v10, v200, v201
v_mfma_f32_16x16x32_bf16 v[224:227], a[168:171], a[72:75], v[224:227]
ds_read_b128 a[148:151], v250 offset:18432
v_cvt_pk_bf16_f32 v11, v202, v203
v_mfma_f32_16x16x32_bf16 v[224:227], a[172:175], a[76:79], v[224:227]
v_mul_f32 v204, s41, v204
v_mul_f32 v205, s41, v205
v_mfma_f32_16x16x32_bf16 v[224:227], v[192:195], a[80:83], v[224:227]
v_exp_f32 v204, v204
v_mfma_f32_16x16x32_bf16 v[224:227], v[196:199], a[84:87], v[224:227]
v_mul_f32 v206, s41, v206
v_mul_f32 v207, s41, v207
v_mfma_f32_16x16x32_bf16 v[224:227], a[152:155], a[88:91], v[224:227]
v_exp_f32 v205, v205
v_mfma_f32_16x16x32_bf16 v[224:227], a[156:159], a[92:95], v[224:227]
v_exp_f32 v206, v206
v_mfma_f32_16x16x32_bf16 v[208:211], a[252:255], v[8:11], v[208:211]
buffer_load_dwordx4 v239, s[92:95], s57 offen lds
v_mfma_f32_16x16x32_bf16 v[200:203], a[156:159], a[124:127], v[220:223]
s_add_u32 m0, s39, s58
v_exp_f32 v207, v207
v_mfma_f32_16x16x32_bf16 v[200:203], a[152:155], a[120:123], v[200:203]
ds_read_b128 a[156:159], v250 offset:19456
v_cvt_pk_bf16_f32 v58, v204, v205
v_mfma_f32_16x16x32_bf16 v[200:203], v[196:199], a[116:119], v[200:203]
ds_read_b128 a[152:155], v249 offset:19456
v_cvt_pk_bf16_f32 v59, v206, v207
v_mfma_f32_16x16x32_bf16 v[200:203], v[192:195], a[112:115], v[200:203]
v_mul_f32 v224, s41, v224
v_mul_f32 v225, s41, v225
v_mfma_f32_16x16x32_bf16 v[200:203], a[172:175], a[108:111], v[200:203]
v_exp_f32 v224, v224
v_mfma_f32_16x16x32_bf16 v[200:203], a[168:171], a[104:107], v[200:203]
v_mul_f32 v226, s41, v226
v_mul_f32 v227, s41, v227
v_mfma_f32_16x16x32_bf16 v[200:203], a[164:167], a[100:103], v[200:203]
v_exp_f32 v225, v225
v_mfma_f32_16x16x32_bf16 v[200:203], a[160:163], a[96:99], v[200:203]
s_waitcnt lgkmcnt(2)
v_exp_f32 v226, v226
v_mfma_f32_16x16x32_bf16 v[204:207], a[128:131], a[0:3], v[228:231]
v_exp_f32 v227, v227
v_mfma_f32_16x16x32_bf16 v[204:207], a[132:135], a[4:7], v[204:207]
ds_read_b128 a[160:163], v249 offset:24576
v_cvt_pk_bf16_f32 v106, v224, v225
v_mfma_f32_16x16x32_bf16 v[204:207], a[136:139], a[8:11], v[204:207]
ds_read_b128 a[164:167], v250 offset:24576
v_cvt_pk_bf16_f32 v107, v226, v227
v_mfma_f32_16x16x32_bf16 v[204:207], a[140:143], a[12:15], v[204:207]
v_mul_f32 v200, s41, v200
v_mul_f32 v201, s41, v201
v_mfma_f32_16x16x32_bf16 v[204:207], a[144:147], a[16:19], v[204:207]
v_exp_f32 v200, v200
v_mfma_f32_16x16x32_bf16 v[204:207], a[148:151], a[20:23], v[204:207]
s_waitcnt lgkmcnt(2)
v_mul_f32 v202, s41, v202
v_mul_f32 v203, s41, v203
v_mfma_f32_16x16x32_bf16 v[204:207], a[152:155], a[24:27], v[204:207]
v_exp_f32 v201, v201
v_mfma_f32_16x16x32_bf16 v[204:207], a[156:159], a[28:31], v[204:207]
v_exp_f32 v202, v202
v_mfma_f32_16x16x32_bf16 v[210:213], a[252:255], v[56:59], v[210:213]
buffer_load_dwordx4 v239, s[92:95], s58 offen lds
v_mfma_f32_16x16x32_bf16 v[224:227], a[156:159], a[60:63], v[252:255]
s_add_u32 m0, s39, s59
v_exp_f32 v203, v203
v_mfma_f32_16x16x32_bf16 v[224:227], a[152:155], a[56:59], v[224:227]
ds_read_b128 a[168:171], v249 offset:25600
v_cvt_pk_bf16_f32 v154, v200, v201
v_mfma_f32_16x16x32_bf16 v[224:227], a[148:151], a[52:55], v[224:227]
ds_read_b128 a[172:175], v250 offset:25600
v_cvt_pk_bf16_f32 v155, v202, v203
v_mfma_f32_16x16x32_bf16 v[224:227], a[144:147], a[48:51], v[224:227]
buffer_store_dwordx4 a[196:199], v239, s[24:27], s51 offen offset:384 sc1
v_mul_f32 v204, s41, v204
v_mul_f32 v205, s41, v205
v_mfma_f32_16x16x32_bf16 v[224:227], a[140:143], a[44:47], v[224:227]
v_exp_f32 v204, v204
v_mfma_f32_16x16x32_bf16 v[224:227], a[136:139], a[40:43], v[224:227]
v_mul_f32 v206, s41, v206
v_mul_f32 v207, s41, v207
v_mfma_f32_16x16x32_bf16 v[224:227], a[132:135], a[36:39], v[224:227]
v_exp_f32 v205, v205
v_mfma_f32_16x16x32_bf16 v[224:227], a[128:131], a[32:35], v[224:227]
v_exp_f32 v206, v206
v_mfma_f32_16x16x32_bf16 v[200:203], a[128:131], a[64:67], v[244:247]
v_exp_f32 v207, v207
v_mfma_f32_16x16x32_bf16 v[200:203], a[132:135], a[68:71], v[200:203]
ds_read_b128 v[192:195], v249 offset:26624
v_cvt_pk_bf16_f32 v12, v204, v205
v_mfma_f32_16x16x32_bf16 v[200:203], a[136:139], a[72:75], v[200:203]
ds_read_b128 v[196:199], v250 offset:26624
v_cvt_pk_bf16_f32 v13, v206, v207
v_mfma_f32_16x16x32_bf16 v[200:203], a[140:143], a[76:79], v[200:203]
v_mul_f32 v224, s41, v224
v_mul_f32 v225, s41, v225
v_mfma_f32_16x16x32_bf16 v[200:203], a[144:147], a[80:83], v[200:203]
v_exp_f32 v224, v224
v_mfma_f32_16x16x32_bf16 v[200:203], a[148:151], a[84:87], v[200:203]
v_mul_f32 v226, s41, v226
v_mul_f32 v227, s41, v227
v_mfma_f32_16x16x32_bf16 v[200:203], a[152:155], a[88:91], v[200:203]
v_exp_f32 v225, v225
v_mfma_f32_16x16x32_bf16 v[200:203], a[156:159], a[92:95], v[200:203]
v_exp_f32 v226, v226
v_mfma_f32_16x16x32_bf16 v[212:215], a[252:255], v[104:107], v[212:215]
buffer_load_dwordx4 v239, s[92:95], s59 offen lds
v_mfma_f32_16x16x32_bf16 v[204:207], a[156:159], a[124:127], v[220:223]
s_add_u32 m0, s39, s60
v_exp_f32 v227, v227
v_mfma_f32_16x16x32_bf16 v[204:207], a[152:155], a[120:123], v[204:207]
ds_read_b128 a[156:159], v250 offset:27648
v_cvt_pk_bf16_f32 v60, v224, v225
v_mfma_f32_16x16x32_bf16 v[204:207], a[148:151], a[116:119], v[204:207]
ds_read_b128 a[152:155], v249 offset:27648
v_cvt_pk_bf16_f32 v61, v226, v227
v_mfma_f32_16x16x32_bf16 v[204:207], a[144:147], a[112:115], v[204:207]
v_mul_f32 v200, s41, v200
v_mul_f32 v201, s41, v201
v_mfma_f32_16x16x32_bf16 v[204:207], a[140:143], a[108:111], v[204:207]
v_exp_f32 v200, v200
v_mfma_f32_16x16x32_bf16 v[204:207], a[136:139], a[104:107], v[204:207]
v_mul_f32 v202, s41, v202
v_mul_f32 v203, s41, v203
v_mfma_f32_16x16x32_bf16 v[204:207], a[132:135], a[100:103], v[204:207]
v_exp_f32 v201, v201
v_mfma_f32_16x16x32_bf16 v[204:207], a[128:131], a[96:99], v[204:207]
s_waitcnt lgkmcnt(2)
v_exp_f32 v202, v202
v_mfma_f32_16x16x32_bf16 v[224:227], a[160:163], a[0:3], v[228:231]
v_exp_f32 v203, v203
v_mfma_f32_16x16x32_bf16 v[224:227], a[164:167], a[4:7], v[224:227]
ds_read_b128 a[128:131], v249 offset:32768
v_cvt_pk_bf16_f32 v108, v200, v201
v_mfma_f32_16x16x32_bf16 v[224:227], a[168:171], a[8:11], v[224:227]
ds_read_b128 a[132:135], v250 offset:32768
v_cvt_pk_bf16_f32 v109, v202, v203
v_mfma_f32_16x16x32_bf16 v[224:227], a[172:175], a[12:15], v[224:227]
v_mul_f32 v204, s41, v204
v_mul_f32 v205, s41, v205
v_mfma_f32_16x16x32_bf16 v[224:227], v[192:195], a[16:19], v[224:227]
v_exp_f32 v204, v204
v_mfma_f32_16x16x32_bf16 v[224:227], v[196:199], a[20:23], v[224:227]
s_waitcnt lgkmcnt(2)
v_mul_f32 v206, s41, v206
v_mul_f32 v207, s41, v207
v_mfma_f32_16x16x32_bf16 v[224:227], a[152:155], a[24:27], v[224:227]
v_exp_f32 v205, v205
v_mfma_f32_16x16x32_bf16 v[224:227], a[156:159], a[28:31], v[224:227]
v_exp_f32 v206, v206
v_mfma_f32_16x16x32_bf16 v[214:217], a[252:255], v[152:155], v[214:217]
buffer_load_dwordx4 v239, s[92:95], s60 offen lds
v_mfma_f32_16x16x32_bf16 v[200:203], a[156:159], a[60:63], v[252:255]
buffer_store_dwordx4 a[200:203], v239, s[24:27], s52 offen offset:384 sc1
v_exp_f32 v207, v207
v_mfma_f32_16x16x32_bf16 v[200:203], a[152:155], a[56:59], v[200:203]
ds_read_b128 a[136:139], v249 offset:33792
v_cvt_pk_bf16_f32 v156, v204, v205
v_mfma_f32_16x16x32_bf16 v[200:203], v[196:199], a[52:55], v[200:203]
ds_read_b128 a[140:143], v250 offset:33792
v_cvt_pk_bf16_f32 v157, v206, v207
v_mfma_f32_16x16x32_bf16 v[200:203], v[192:195], a[48:51], v[200:203]
s_add_u32 m0, s39, s61
v_mul_f32 v224, s41, v224
v_mul_f32 v225, s41, v225
v_mfma_f32_16x16x32_bf16 v[200:203], a[172:175], a[44:47], v[200:203]
v_exp_f32 v224, v224
v_mfma_f32_16x16x32_bf16 v[200:203], a[168:171], a[40:43], v[200:203]
v_mul_f32 v226, s41, v226
v_mul_f32 v227, s41, v227
v_mfma_f32_16x16x32_bf16 v[200:203], a[164:167], a[36:39], v[200:203]
v_exp_f32 v225, v225
v_mfma_f32_16x16x32_bf16 v[200:203], a[160:163], a[32:35], v[200:203]
v_exp_f32 v226, v226
v_mfma_f32_16x16x32_bf16 v[204:207], a[160:163], a[64:67], v[244:247]
v_exp_f32 v227, v227
v_mfma_f32_16x16x32_bf16 v[204:207], a[164:167], a[68:71], v[204:207]
ds_read_b128 a[144:147], v249 offset:34816
v_cvt_pk_bf16_f32 v14, v224, v225
v_mfma_f32_16x16x32_bf16 v[204:207], a[168:171], a[72:75], v[204:207]
ds_read_b128 a[148:151], v250 offset:34816
v_cvt_pk_bf16_f32 v15, v226, v227
v_mfma_f32_16x16x32_bf16 v[204:207], a[172:175], a[76:79], v[204:207]
v_mul_f32 v200, s41, v200
v_mul_f32 v201, s41, v201
v_mfma_f32_16x16x32_bf16 v[204:207], v[192:195], a[80:83], v[204:207]
v_exp_f32 v200, v200
v_mfma_f32_16x16x32_bf16 v[204:207], v[196:199], a[84:87], v[204:207]
v_mul_f32 v202, s41, v202
v_mul_f32 v203, s41, v203
v_mfma_f32_16x16x32_bf16 v[204:207], a[152:155], a[88:91], v[204:207]
v_exp_f32 v201, v201
v_mfma_f32_16x16x32_bf16 v[204:207], a[156:159], a[92:95], v[204:207]
v_exp_f32 v202, v202
v_mfma_f32_16x16x32_bf16 v[208:211], a[252:255], v[12:15], v[208:211]
buffer_load_dwordx4 v239, s[92:95], s61 offen lds
v_mfma_f32_16x16x32_bf16 v[224:227], a[156:159], a[124:127], v[220:223]
s_add_u32 m0, s40, s56
v_exp_f32 v203, v203
v_mfma_f32_16x16x32_bf16 v[224:227], a[152:155], a[120:123], v[224:227]
ds_read_b128 a[156:159], v250 offset:35840
v_cvt_pk_bf16_f32 v62, v200, v201
v_mfma_f32_16x16x32_bf16 v[224:227], v[196:199], a[116:119], v[224:227]
ds_read_b128 a[152:155], v249 offset:35840
v_cvt_pk_bf16_f32 v63, v202, v203
v_mfma_f32_16x16x32_bf16 v[224:227], v[192:195], a[112:115], v[224:227]
s_add_u32 s92, s92, 49152
s_addc_u32 s93, s93, 0
v_mul_f32 v204, s41, v204
v_mul_f32 v205, s41, v205
v_mfma_f32_16x16x32_bf16 v[224:227], a[172:175], a[108:111], v[224:227]
v_exp_f32 v204, v204
v_mfma_f32_16x16x32_bf16 v[224:227], a[168:171], a[104:107], v[224:227]
v_mul_f32 v206, s41, v206
v_mul_f32 v207, s41, v207
v_mfma_f32_16x16x32_bf16 v[224:227], a[164:167], a[100:103], v[224:227]
v_exp_f32 v205, v205
v_mfma_f32_16x16x32_bf16 v[224:227], a[160:163], a[96:99], v[224:227]
s_waitcnt lgkmcnt(2)
v_exp_f32 v206, v206
v_mfma_f32_16x16x32_bf16 v[200:203], a[128:131], a[0:3], v[228:231]
v_exp_f32 v207, v207
v_mfma_f32_16x16x32_bf16 v[200:203], a[132:135], a[4:7], v[200:203]
ds_read_b128 a[160:163], v249 offset:40960
v_cvt_pk_bf16_f32 v110, v204, v205
v_mfma_f32_16x16x32_bf16 v[200:203], a[136:139], a[8:11], v[200:203]
ds_read_b128 a[164:167], v250 offset:40960
v_cvt_pk_bf16_f32 v111, v206, v207
v_mfma_f32_16x16x32_bf16 v[200:203], a[140:143], a[12:15], v[200:203]
v_mul_f32 v224, s41, v224
v_mul_f32 v225, s41, v225
v_mfma_f32_16x16x32_bf16 v[200:203], a[144:147], a[16:19], v[200:203]
v_exp_f32 v224, v224
v_mfma_f32_16x16x32_bf16 v[200:203], a[148:151], a[20:23], v[200:203]
s_waitcnt lgkmcnt(2)
v_mul_f32 v226, s41, v226
v_mul_f32 v227, s41, v227
v_mfma_f32_16x16x32_bf16 v[200:203], a[152:155], a[24:27], v[200:203]
v_exp_f32 v225, v225
v_mfma_f32_16x16x32_bf16 v[200:203], a[156:159], a[28:31], v[200:203]
v_exp_f32 v226, v226
v_mfma_f32_16x16x32_bf16 v[210:213], a[252:255], v[60:63], v[210:213]
buffer_load_dwordx4 v239, s[16:19], s56 offen lds
v_mfma_f32_16x16x32_bf16 v[204:207], a[156:159], a[60:63], v[252:255]
buffer_store_dwordx4 a[204:207], v239, s[24:27], s53 offen offset:384 sc1
v_exp_f32 v227, v227
v_mfma_f32_16x16x32_bf16 v[204:207], a[152:155], a[56:59], v[204:207]
ds_read_b128 a[168:171], v249 offset:41984
v_cvt_pk_bf16_f32 v158, v224, v225
v_mfma_f32_16x16x32_bf16 v[204:207], a[148:151], a[52:55], v[204:207]
ds_read_b128 a[172:175], v250 offset:41984
v_cvt_pk_bf16_f32 v159, v226, v227
v_mfma_f32_16x16x32_bf16 v[204:207], a[144:147], a[48:51], v[204:207]
s_add_u32 m0, s40, s57
v_mul_f32 v200, s41, v200
v_mul_f32 v201, s41, v201
v_mfma_f32_16x16x32_bf16 v[204:207], a[140:143], a[44:47], v[204:207]
v_exp_f32 v200, v200
v_mfma_f32_16x16x32_bf16 v[204:207], a[136:139], a[40:43], v[204:207]
v_mul_f32 v202, s41, v202
v_mul_f32 v203, s41, v203
v_mfma_f32_16x16x32_bf16 v[204:207], a[132:135], a[36:39], v[204:207]
v_exp_f32 v201, v201
v_mfma_f32_16x16x32_bf16 v[204:207], a[128:131], a[32:35], v[204:207]
v_exp_f32 v202, v202
v_mfma_f32_16x16x32_bf16 v[224:227], a[128:131], a[64:67], v[244:247]
v_exp_f32 v203, v203
v_mfma_f32_16x16x32_bf16 v[224:227], a[132:135], a[68:71], v[224:227]
ds_read_b128 v[192:195], v249 offset:43008
v_cvt_pk_bf16_f32 v16, v200, v201
v_mfma_f32_16x16x32_bf16 v[224:227], a[136:139], a[72:75], v[224:227]
ds_read_b128 v[196:199], v250 offset:43008
v_cvt_pk_bf16_f32 v17, v202, v203
v_mfma_f32_16x16x32_bf16 v[224:227], a[140:143], a[76:79], v[224:227]
v_mul_f32 v204, s41, v204
v_mul_f32 v205, s41, v205
v_mfma_f32_16x16x32_bf16 v[224:227], a[144:147], a[80:83], v[224:227]
v_exp_f32 v204, v204
v_mfma_f32_16x16x32_bf16 v[224:227], a[148:151], a[84:87], v[224:227]
v_mul_f32 v206, s41, v206
v_mul_f32 v207, s41, v207
v_mfma_f32_16x16x32_bf16 v[224:227], a[152:155], a[88:91], v[224:227]
v_exp_f32 v205, v205
v_mfma_f32_16x16x32_bf16 v[224:227], a[156:159], a[92:95], v[224:227]
v_exp_f32 v206, v206
v_mfma_f32_16x16x32_bf16 v[212:215], a[252:255], v[108:111], v[212:215]
buffer_load_dwordx4 v239, s[16:19], s57 offen lds
v_mfma_f32_16x16x32_bf16 v[200:203], a[156:159], a[124:127], v[220:223]
s_add_u32 m0, s40, s58
v_exp_f32 v207, v207
v_mfma_f32_16x16x32_bf16 v[200:203], a[152:155], a[120:123], v[200:203]
ds_read_b128 a[156:159], v250 offset:44032
v_cvt_pk_bf16_f32 v64, v204, v205
v_mfma_f32_16x16x32_bf16 v[200:203], a[148:151], a[116:119], v[200:203]
ds_read_b128 a[152:155], v249 offset:44032
v_cvt_pk_bf16_f32 v65, v206, v207
v_mfma_f32_16x16x32_bf16 v[200:203], a[144:147], a[112:115], v[200:203]
v_mul_f32 v224, s41, v224
v_mul_f32 v225, s41, v225
v_mfma_f32_16x16x32_bf16 v[200:203], a[140:143], a[108:111], v[200:203]
v_exp_f32 v224, v224
v_mfma_f32_16x16x32_bf16 v[200:203], a[136:139], a[104:107], v[200:203]
v_mul_f32 v226, s41, v226
v_mul_f32 v227, s41, v227
v_mfma_f32_16x16x32_bf16 v[200:203], a[132:135], a[100:103], v[200:203]
v_exp_f32 v225, v225
v_mfma_f32_16x16x32_bf16 v[200:203], a[128:131], a[96:99], v[200:203]
s_waitcnt lgkmcnt(2)
v_exp_f32 v226, v226
v_mfma_f32_16x16x32_bf16 v[204:207], a[160:163], a[0:3], v[228:231]
v_exp_f32 v227, v227
v_mfma_f32_16x16x32_bf16 v[204:207], a[164:167], a[4:7], v[204:207]
ds_read_b128 a[128:131], v249 offset:49152
v_cvt_pk_bf16_f32 v112, v224, v225
v_mfma_f32_16x16x32_bf16 v[204:207], a[168:171], a[8:11], v[204:207]
ds_read_b128 a[132:135], v250 offset:49152
v_cvt_pk_bf16_f32 v113, v226, v227
v_mfma_f32_16x16x32_bf16 v[204:207], a[172:175], a[12:15], v[204:207]
v_mul_f32 v200, s41, v200
v_mul_f32 v201, s41, v201
v_mfma_f32_16x16x32_bf16 v[204:207], v[192:195], a[16:19], v[204:207]
v_exp_f32 v200, v200
v_mfma_f32_16x16x32_bf16 v[204:207], v[196:199], a[20:23], v[204:207]
s_waitcnt lgkmcnt(2)
v_mul_f32 v202, s41, v202
v_mul_f32 v203, s41, v203
v_mfma_f32_16x16x32_bf16 v[204:207], a[152:155], a[24:27], v[204:207]
v_exp_f32 v201, v201
v_mfma_f32_16x16x32_bf16 v[204:207], a[156:159], a[28:31], v[204:207]
v_exp_f32 v202, v202
v_mfma_f32_16x16x32_bf16 v[214:217], a[252:255], v[156:159], v[214:217]
buffer_load_dwordx4 v239, s[16:19], s58 offen lds
v_mfma_f32_16x16x32_bf16 v[224:227], a[156:159], a[60:63], v[252:255]
buffer_store_dwordx4 a[208:211], v239, s[24:27], s54 offen offset:384 sc1
v_exp_f32 v203, v203
v_mfma_f32_16x16x32_bf16 v[224:227], a[152:155], a[56:59], v[224:227]
ds_read_b128 a[136:139], v249 offset:50176
v_cvt_pk_bf16_f32 v160, v200, v201
v_mfma_f32_16x16x32_bf16 v[224:227], v[196:199], a[52:55], v[224:227]
ds_read_b128 a[140:143], v250 offset:50176
v_cvt_pk_bf16_f32 v161, v202, v203
v_mfma_f32_16x16x32_bf16 v[224:227], v[192:195], a[48:51], v[224:227]
s_add_u32 m0, s40, s59
v_mul_f32 v204, s41, v204
v_mul_f32 v205, s41, v205
v_mfma_f32_16x16x32_bf16 v[224:227], a[172:175], a[44:47], v[224:227]
v_exp_f32 v204, v204
v_mfma_f32_16x16x32_bf16 v[224:227], a[168:171], a[40:43], v[224:227]
v_mul_f32 v206, s41, v206
v_mul_f32 v207, s41, v207
v_mfma_f32_16x16x32_bf16 v[224:227], a[164:167], a[36:39], v[224:227]
v_exp_f32 v205, v205
v_mfma_f32_16x16x32_bf16 v[224:227], a[160:163], a[32:35], v[224:227]
v_exp_f32 v206, v206
v_mfma_f32_16x16x32_bf16 v[200:203], a[160:163], a[64:67], v[244:247]
v_exp_f32 v207, v207
v_mfma_f32_16x16x32_bf16 v[200:203], a[164:167], a[68:71], v[200:203]
ds_read_b128 a[144:147], v249 offset:51200
v_cvt_pk_bf16_f32 v18, v204, v205
v_mfma_f32_16x16x32_bf16 v[200:203], a[168:171], a[72:75], v[200:203]
ds_read_b128 a[148:151], v250 offset:51200
v_cvt_pk_bf16_f32 v19, v206, v207
v_mfma_f32_16x16x32_bf16 v[200:203], a[172:175], a[76:79], v[200:203]
v_mul_f32 v224, s41, v224
v_mul_f32 v225, s41, v225
v_mfma_f32_16x16x32_bf16 v[200:203], v[192:195], a[80:83], v[200:203]
v_exp_f32 v224, v224
v_mfma_f32_16x16x32_bf16 v[200:203], v[196:199], a[84:87], v[200:203]
v_mul_f32 v226, s41, v226
v_mul_f32 v227, s41, v227
v_mfma_f32_16x16x32_bf16 v[200:203], a[152:155], a[88:91], v[200:203]
v_exp_f32 v225, v225
v_mfma_f32_16x16x32_bf16 v[200:203], a[156:159], a[92:95], v[200:203]
v_exp_f32 v226, v226
v_mfma_f32_16x16x32_bf16 v[208:211], a[252:255], v[16:19], v[208:211]
buffer_load_dwordx4 v239, s[16:19], s59 offen lds
v_mfma_f32_16x16x32_bf16 v[204:207], a[156:159], a[124:127], v[220:223]
s_add_u32 m0, s40, s60
v_exp_f32 v227, v227
v_mfma_f32_16x16x32_bf16 v[204:207], a[152:155], a[120:123], v[204:207]
ds_read_b128 a[156:159], v250 offset:52224
v_cvt_pk_bf16_f32 v66, v224, v225
v_mfma_f32_16x16x32_bf16 v[204:207], v[196:199], a[116:119], v[204:207]
ds_read_b128 a[152:155], v249 offset:52224
v_cvt_pk_bf16_f32 v67, v226, v227
v_mfma_f32_16x16x32_bf16 v[204:207], v[192:195], a[112:115], v[204:207]
v_mul_f32 v200, s41, v200
v_mul_f32 v201, s41, v201
v_mfma_f32_16x16x32_bf16 v[204:207], a[172:175], a[108:111], v[204:207]
v_exp_f32 v200, v200
v_mfma_f32_16x16x32_bf16 v[204:207], a[168:171], a[104:107], v[204:207]
v_mul_f32 v202, s41, v202
v_mul_f32 v203, s41, v203
v_mfma_f32_16x16x32_bf16 v[204:207], a[164:167], a[100:103], v[204:207]
v_exp_f32 v201, v201
v_mfma_f32_16x16x32_bf16 v[204:207], a[160:163], a[96:99], v[204:207]
s_waitcnt lgkmcnt(2)
v_exp_f32 v202, v202
v_mfma_f32_16x16x32_bf16 v[224:227], a[128:131], a[0:3], v[228:231]
v_exp_f32 v203, v203
v_mfma_f32_16x16x32_bf16 v[224:227], a[132:135], a[4:7], v[224:227]
ds_read_b128 a[160:163], v249 offset:57344
v_cvt_pk_bf16_f32 v114, v200, v201
v_mfma_f32_16x16x32_bf16 v[224:227], a[136:139], a[8:11], v[224:227]
ds_read_b128 a[164:167], v250 offset:57344
v_cvt_pk_bf16_f32 v115, v202, v203
v_mfma_f32_16x16x32_bf16 v[224:227], a[140:143], a[12:15], v[224:227]
v_mul_f32 v204, s41, v204
v_mul_f32 v205, s41, v205
v_mfma_f32_16x16x32_bf16 v[224:227], a[144:147], a[16:19], v[224:227]
v_exp_f32 v204, v204
v_mfma_f32_16x16x32_bf16 v[224:227], a[148:151], a[20:23], v[224:227]
s_waitcnt lgkmcnt(2)
v_mul_f32 v206, s41, v206
v_mul_f32 v207, s41, v207
v_mfma_f32_16x16x32_bf16 v[224:227], a[152:155], a[24:27], v[224:227]
v_exp_f32 v205, v205
v_mfma_f32_16x16x32_bf16 v[224:227], a[156:159], a[28:31], v[224:227]
buffer_store_dwordx4 a[212:215], v239, s[24:27], s55 offen offset:384 sc1
v_exp_f32 v206, v206
v_mfma_f32_16x16x32_bf16 v[210:213], a[252:255], v[64:67], v[210:213]
buffer_load_dwordx4 v239, s[16:19], s60 offen lds
v_mfma_f32_16x16x32_bf16 v[200:203], a[156:159], a[60:63], v[252:255]
s_add_u32 m0, s40, s61
v_exp_f32 v207, v207
v_mfma_f32_16x16x32_bf16 v[200:203], a[152:155], a[56:59], v[200:203]
ds_read_b128 a[168:171], v249 offset:58368
v_cvt_pk_bf16_f32 v162, v204, v205
v_mfma_f32_16x16x32_bf16 v[200:203], a[148:151], a[52:55], v[200:203]
ds_read_b128 a[172:175], v250 offset:58368
v_cvt_pk_bf16_f32 v163, v206, v207
v_mfma_f32_16x16x32_bf16 v[200:203], a[144:147], a[48:51], v[200:203]
s_add_u32 s24, s10, s45
s_addc_u32 s25, s11, 0
v_mul_f32 v224, s41, v224
v_mul_f32 v225, s41, v225
v_mfma_f32_16x16x32_bf16 v[200:203], a[140:143], a[44:47], v[200:203]
v_exp_f32 v224, v224
v_mfma_f32_16x16x32_bf16 v[200:203], a[136:139], a[40:43], v[200:203]
v_mul_f32 v226, s41, v226
v_mul_f32 v227, s41, v227
v_mfma_f32_16x16x32_bf16 v[200:203], a[132:135], a[36:39], v[200:203]
v_exp_f32 v225, v225
v_mfma_f32_16x16x32_bf16 v[200:203], a[128:131], a[32:35], v[200:203]
v_exp_f32 v226, v226
v_mfma_f32_16x16x32_bf16 v[204:207], a[128:131], a[64:67], v[244:247]
v_exp_f32 v227, v227
v_mfma_f32_16x16x32_bf16 v[204:207], a[132:135], a[68:71], v[204:207]
ds_read_b128 v[192:195], v249 offset:59392
v_cvt_pk_bf16_f32 v20, v224, v225
v_mfma_f32_16x16x32_bf16 v[204:207], a[136:139], a[72:75], v[204:207]
ds_read_b128 v[196:199], v250 offset:59392
v_cvt_pk_bf16_f32 v21, v226, v227
v_mfma_f32_16x16x32_bf16 v[204:207], a[140:143], a[76:79], v[204:207]
v_mul_f32 v200, s41, v200
v_mul_f32 v201, s41, v201
v_mfma_f32_16x16x32_bf16 v[204:207], a[144:147], a[80:83], v[204:207]
v_exp_f32 v200, v200
v_mfma_f32_16x16x32_bf16 v[204:207], a[148:151], a[84:87], v[204:207]
v_mul_f32 v202, s41, v202
v_mul_f32 v203, s41, v203
v_mfma_f32_16x16x32_bf16 v[204:207], a[152:155], a[88:91], v[204:207]
v_exp_f32 v201, v201
v_mfma_f32_16x16x32_bf16 v[204:207], a[156:159], a[92:95], v[204:207]
v_exp_f32 v202, v202
v_mfma_f32_16x16x32_bf16 v[212:215], a[252:255], v[112:115], v[212:215]
buffer_load_dwordx4 v239, s[16:19], s61 offen lds
v_mfma_f32_16x16x32_bf16 v[224:227], a[156:159], a[124:127], v[220:223]
s_add_u32 m0, s46, 24576
v_exp_f32 v203, v203
v_mfma_f32_16x16x32_bf16 v[224:227], a[152:155], a[120:123], v[224:227]
ds_read_b128 a[156:159], v250 offset:60416
v_cvt_pk_bf16_f32 v68, v200, v201
v_mfma_f32_16x16x32_bf16 v[224:227], a[148:151], a[116:119], v[224:227]
ds_read_b128 a[152:155], v249 offset:60416
v_cvt_pk_bf16_f32 v69, v202, v203
v_mfma_f32_16x16x32_bf16 v[224:227], a[144:147], a[112:115], v[224:227]
s_mov_b32 s18, 85632
v_mul_f32 v204, s41, v204
v_mul_f32 v205, s41, v205
v_mfma_f32_16x16x32_bf16 v[224:227], a[140:143], a[108:111], v[224:227]
s_add_u32 s16, s72, s36
s_addc_u32 s17, s73, 0
v_exp_f32 v204, v204
v_mfma_f32_16x16x32_bf16 v[224:227], a[136:139], a[104:107], v[224:227]
v_mul_f32 v206, s41, v206
v_mul_f32 v207, s41, v207
v_mfma_f32_16x16x32_bf16 v[224:227], a[132:135], a[100:103], v[224:227]
v_exp_f32 v205, v205
v_mfma_f32_16x16x32_bf16 v[224:227], a[128:131], a[96:99], v[224:227]
s_waitcnt vmcnt(9) lgkmcnt(0)
v_exp_f32 v206, v206
v_mfma_f32_16x16x32_bf16 v[200:203], a[160:163], a[0:3], v[228:231]
s_barrier
v_exp_f32 v207, v207
v_mfma_f32_16x16x32_bf16 v[200:203], a[164:167], a[4:7], v[200:203]
ds_read_b128 a[128:131], v236 offset:0
v_cvt_pk_bf16_f32 v116, v204, v205
v_mfma_f32_16x16x32_bf16 v[200:203], a[168:171], a[8:11], v[200:203]
ds_read_b128 a[132:135], v237 offset:0
v_cvt_pk_bf16_f32 v117, v206, v207
v_mfma_f32_16x16x32_bf16 v[200:203], a[172:175], a[12:15], v[200:203]
buffer_load_dwordx4 v239, s[20:23], s48 offen offset:0 nt lds
v_mul_f32 v224, s41, v224
v_mul_f32 v225, s41, v225
v_mfma_f32_16x16x32_bf16 v[200:203], v[192:195], a[16:19], v[200:203]
s_add_u32 m0, s69, s56
v_exp_f32 v224, v224
v_mfma_f32_16x16x32_bf16 v[200:203], v[196:199], a[20:23], v[200:203]
v_mul_f32 v226, s41, v226
v_mul_f32 v227, s41, v227
v_mfma_f32_16x16x32_bf16 v[200:203], a[152:155], a[24:27], v[200:203]
v_exp_f32 v225, v225
v_mfma_f32_16x16x32_bf16 v[200:203], a[156:159], a[28:31], v[200:203]
v_exp_f32 v226, v226
v_mfma_f32_16x16x32_bf16 v[214:217], a[252:255], v[160:163], v[214:217]
buffer_load_dwordx4 v239, s[92:95], s56 offen lds
v_mfma_f32_16x16x32_bf16 v[204:207], a[156:159], a[60:63], v[252:255]
s_add_u32 m0, s46, 28672
v_exp_f32 v227, v227
v_mfma_f32_16x16x32_bf16 v[204:207], a[152:155], a[56:59], v[204:207]
ds_read_b128 a[136:139], v236 offset:1024
v_cvt_pk_bf16_f32 v164, v224, v225
v_mfma_f32_16x16x32_bf16 v[204:207], v[196:199], a[52:55], v[204:207]
ds_read_b128 a[140:143], v237 offset:1024
v_cvt_pk_bf16_f32 v165, v226, v227
v_mfma_f32_16x16x32_bf16 v[204:207], v[192:195], a[48:51], v[204:207]
v_mul_f32 v200, s41, v200
v_mul_f32 v201, s41, v201
v_mfma_f32_16x16x32_bf16 v[204:207], a[172:175], a[44:47], v[204:207]
v_exp_f32 v200, v200
v_mfma_f32_16x16x32_bf16 v[204:207], a[168:171], a[40:43], v[204:207]
v_mul_f32 v202, s41, v202
v_mul_f32 v203, s41, v203
v_mfma_f32_16x16x32_bf16 v[204:207], a[164:167], a[36:39], v[204:207]
v_exp_f32 v201, v201
v_mfma_f32_16x16x32_bf16 v[204:207], a[160:163], a[32:35], v[204:207]
v_exp_f32 v202, v202
v_mfma_f32_16x16x32_bf16 v[224:227], a[160:163], a[64:67], v[244:247]
buffer_load_dwordx4 v239, s[20:23], s49 offen offset:0 nt lds
v_exp_f32 v203, v203
v_mfma_f32_16x16x32_bf16 v[224:227], a[164:167], a[68:71], v[224:227]
ds_read_b128 a[144:147], v236 offset:2048
v_cvt_pk_bf16_f32 v22, v200, v201
v_mfma_f32_16x16x32_bf16 v[224:227], a[168:171], a[72:75], v[224:227]
ds_read_b128 a[148:151], v237 offset:2048
v_cvt_pk_bf16_f32 v23, v202, v203
v_mfma_f32_16x16x32_bf16 v[224:227], a[172:175], a[76:79], v[224:227]
s_add_u32 m0, s69, s57
v_mul_f32 v204, s41, v204
v_mul_f32 v205, s41, v205
v_mfma_f32_16x16x32_bf16 v[224:227], v[192:195], a[80:83], v[224:227]
v_exp_f32 v204, v204
v_mfma_f32_16x16x32_bf16 v[224:227], v[196:199], a[84:87], v[224:227]
v_mul_f32 v206, s41, v206
v_mul_f32 v207, s41, v207
v_mfma_f32_16x16x32_bf16 v[224:227], a[152:155], a[88:91], v[224:227]
v_exp_f32 v205, v205
v_mfma_f32_16x16x32_bf16 v[224:227], a[156:159], a[92:95], v[224:227]
v_exp_f32 v206, v206
v_mfma_f32_16x16x32_bf16 v[208:211], a[252:255], v[20:23], v[208:211]
buffer_load_dwordx4 v239, s[92:95], s57 offen lds
v_mfma_f32_16x16x32_bf16 v[200:203], a[156:159], a[124:127], v[220:223]
s_add_u32 m0, s69, s58
v_exp_f32 v207, v207
v_mfma_f32_16x16x32_bf16 v[200:203], a[152:155], a[120:123], v[200:203]
ds_read_b128 a[156:159], v237 offset:3072
v_cvt_pk_bf16_f32 v70, v204, v205
v_mfma_f32_16x16x32_bf16 v[200:203], v[196:199], a[116:119], v[200:203]
ds_read_b128 a[152:155], v236 offset:3072
v_cvt_pk_bf16_f32 v71, v206, v207
v_mfma_f32_16x16x32_bf16 v[200:203], v[192:195], a[112:115], v[200:203]
s_add_u32 s74, s101, L_t2-L_pc2
v_mul_f32 v224, s41, v224
v_mul_f32 v225, s41, v225
v_mfma_f32_16x16x32_bf16 v[200:203], a[172:175], a[108:111], v[200:203]
s_getpc_b64 s[28:29]
L_pc2:
s_add_u32 s28, s28, s74
s_addc_u32 s29, s29, 0
v_exp_f32 v224, v224
v_mfma_f32_16x16x32_bf16 v[200:203], a[168:171], a[104:107], v[200:203]
global_load_dword v251, v239, s[28:29]
v_mul_f32 v226, s41, v226
v_mul_f32 v227, s41, v227
v_mfma_f32_16x16x32_bf16 v[200:203], a[164:167], a[100:103], v[200:203]
v_exp_f32 v225, v225
v_mfma_f32_16x16x32_bf16 v[200:203], a[160:163], a[96:99], v[200:203]
s_waitcnt lgkmcnt(2)
v_exp_f32 v226, v226
v_mfma_f32_16x16x32_bf16 v[204:207], a[128:131], a[0:3], v[228:231]
v_exp_f32 v227, v227
v_mfma_f32_16x16x32_bf16 v[204:207], a[132:135], a[4:7], v[204:207]
ds_read_b128 a[160:163], v236 offset:8192
v_cvt_pk_bf16_f32 v118, v224, v225
v_mfma_f32_16x16x32_bf16 v[204:207], a[136:139], a[8:11], v[204:207]
ds_read_b128 a[164:167], v237 offset:8192
v_cvt_pk_bf16_f32 v119, v226, v227
v_mfma_f32_16x16x32_bf16 v[204:207], a[140:143], a[12:15], v[204:207]
v_mul_f32 v200, s41, v200
v_mul_f32 v201, s41, v201
v_mfma_f32_16x16x32_bf16 v[204:207], a[144:147], a[16:19], v[204:207]
v_exp_f32 v200, v200
v_mfma_f32_16x16x32_bf16 v[204:207], a[148:151], a[20:23], v[204:207]
s_waitcnt lgkmcnt(2)
v_mul_f32 v202, s41, v202
v_mul_f32 v203, s41, v203
v_mfma_f32_16x16x32_bf16 v[204:207], a[152:155], a[24:27], v[204:207]
v_exp_f32 v201, v201
v_mfma_f32_16x16x32_bf16 v[204:207], a[156:159], a[28:31], v[204:207]
v_exp_f32 v202, v202
v_mfma_f32_16x16x32_bf16 v[210:213], a[252:255], v[68:71], v[210:213]
buffer_load_dwordx4 v239, s[92:95], s58 offen lds
v_mfma_f32_16x16x32_bf16 v[224:227], a[156:159], a[60:63], v[252:255]
s_add_u32 m0, s69, s59
v_exp_f32 v203, v203
v_mfma_f32_16x16x32_bf16 v[224:227], a[152:155], a[56:59], v[224:227]
ds_read_b128 a[168:171], v236 offset:9216
v_cvt_pk_bf16_f32 v166, v200, v201
v_mfma_f32_16x16x32_bf16 v[224:227], a[148:151], a[52:55], v[224:227]
ds_read_b128 a[172:175], v237 offset:9216
v_cvt_pk_bf16_f32 v167, v202, v203
v_mfma_f32_16x16x32_bf16 v[224:227], a[144:147], a[48:51], v[224:227]
v_mul_f32 v204, s41, v204
v_mul_f32 v205, s41, v205
v_mfma_f32_16x16x32_bf16 v[224:227], a[140:143], a[44:47], v[224:227]
v_exp_f32 v204, v204
v_mfma_f32_16x16x32_bf16 v[224:227], a[136:139], a[40:43], v[224:227]
v_mul_f32 v206, s41, v206
v_mul_f32 v207, s41, v207
v_mfma_f32_16x16x32_bf16 v[224:227], a[132:135], a[36:39], v[224:227]
v_exp_f32 v205, v205
v_mfma_f32_16x16x32_bf16 v[224:227], a[128:131], a[32:35], v[224:227]
v_exp_f32 v206, v206
v_mfma_f32_16x16x32_bf16 v[200:203], a[128:131], a[64:67], v[244:247]
v_exp_f32 v207, v207
v_mfma_f32_16x16x32_bf16 v[200:203], a[132:135], a[68:71], v[200:203]
ds_read_b128 v[192:195], v236 offset:10240
v_cvt_pk_bf16_f32 v24, v204, v205
v_mfma_f32_16x16x32_bf16 v[200:203], a[136:139], a[72:75], v[200:203]
ds_read_b128 v[196:199], v237 offset:10240
v_cvt_pk_bf16_f32 v25, v206, v207
v_mfma_f32_16x16x32_bf16 v[200:203], a[140:143], a[76:79], v[200:203]
v_mul_f32 v224, s41, v224
v_mul_f32 v225, s41, v225
v_mfma_f32_16x16x32_bf16 v[200:203], a[144:147], a[80:83], v[200:203]
v_exp_f32 v224, v224
v_mfma_f32_16x16x32_bf16 v[200:203], a[148:151], a[84:87], v[200:203]
v_mul_f32 v226, s41, v226
v_mul_f32 v227, s41, v227
v_mfma_f32_16x16x32_bf16 v[200:203], a[152:155], a[88:91], v[200:203]
v_exp_f32 v225, v225
v_mfma_f32_16x16x32_bf16 v[200:203], a[156:159], a[92:95], v[200:203]
v_exp_f32 v226, v226
v_mfma_f32_16x16x32_bf16 v[212:215], a[252:255], v[116:119], v[212:215]
buffer_load_dwordx4 v239, s[92:95], s59 offen lds
v_mfma_f32_16x16x32_bf16 v[204:207], a[156:159], a[124:127], v[220:223]
s_add_u32 m0, s46, 32640
v_exp_f32 v227, v227
v_mfma_f32_16x16x32_bf16 v[204:207], a[152:155], a[120:123], v[204:207]
ds_read_b128 a[156:159], v237 offset:11264
v_cvt_pk_bf16_f32 v72, v224, v225
v_mfma_f32_16x16x32_bf16 v[204:207], a[148:151], a[116:119], v[204:207]
ds_read_b128 a[152:155], v236 offset:11264
v_cvt_pk_bf16_f32 v73, v226, v227
v_mfma_f32_16x16x32_bf16 v[204:207], a[144:147], a[112:115], v[204:207]
buffer_load_dwordx4 v239, s[20:23], s48 offen offset:128 nt lds
v_mul_f32 v200, s41, v200
v_mul_f32 v201, s41, v201
v_mfma_f32_16x16x32_bf16 v[204:207], a[140:143], a[108:111], v[204:207]
s_add_u32 m0, s69, s60
v_exp_f32 v200, v200
v_mfma_f32_16x16x32_bf16 v[204:207], a[136:139], a[104:107], v[204:207]
v_mul_f32 v202, s41, v202
v_mul_f32 v203, s41, v203
v_mfma_f32_16x16x32_bf16 v[204:207], a[132:135], a[100:103], v[204:207]
v_exp_f32 v201, v201
v_mfma_f32_16x16x32_bf16 v[204:207], a[128:131], a[96:99], v[204:207]
s_waitcnt lgkmcnt(2)
v_exp_f32 v202, v202
v_mfma_f32_16x16x32_bf16 v[224:227], a[160:163], a[0:3], v[228:231]
v_exp_f32 v203, v203
v_mfma_f32_16x16x32_bf16 v[224:227], a[164:167], a[4:7], v[224:227]
ds_read_b128 a[128:131], v236 offset:16384
v_cvt_pk_bf16_f32 v120, v200, v201
v_mfma_f32_16x16x32_bf16 v[224:227], a[168:171], a[8:11], v[224:227]
ds_read_b128 a[132:135], v237 offset:16384
v_cvt_pk_bf16_f32 v121, v202, v203
v_mfma_f32_16x16x32_bf16 v[224:227], a[172:175], a[12:15], v[224:227]
v_mul_f32 v204, s41, v204
v_mul_f32 v205, s41, v205
v_mfma_f32_16x16x32_bf16 v[224:227], v[192:195], a[16:19], v[224:227]
v_exp_f32 v204, v204
v_mfma_f32_16x16x32_bf16 v[224:227], v[196:199], a[20:23], v[224:227]
s_waitcnt lgkmcnt(2)
v_mul_f32 v206, s41, v206
v_mul_f32 v207, s41, v207
v_mfma_f32_16x16x32_bf16 v[224:227], a[152:155], a[24:27], v[224:227]
v_exp_f32 v205, v205
v_mfma_f32_16x16x32_bf16 v[224:227], a[156:159], a[28:31], v[224:227]
v_exp_f32 v206, v206
v_mfma_f32_16x16x32_bf16 v[214:217], a[252:255], v[164:167], v[214:217]
buffer_load_dwordx4 v239, s[92:95], s60 offen lds
v_mfma_f32_16x16x32_bf16 v[200:203], a[156:159], a[60:63], v[252:255]
s_add_u32 m0, s46, 36736
v_exp_f32 v207, v207
v_mfma_f32_16x16x32_bf16 v[200:203], a[152:155], a[56:59], v[200:203]
ds_read_b128 a[136:139], v236 offset:17408
v_cvt_pk_bf16_f32 v168, v204, v205
v_mfma_f32_16x16x32_bf16 v[200:203], v[196:199], a[52:55], v[200:203]
ds_read_b128 a[140:143], v237 offset:17408
v_cvt_pk_bf16_f32 v169, v206, v207
v_mfma_f32_16x16x32_bf16 v[200:203], v[192:195], a[48:51], v[200:203]
buffer_load_dwordx4 v239, s[20:23], s49 offen offset:128 nt lds
v_mul_f32 v224, s41, v224
v_mul_f32 v225, s41, v225
v_mfma_f32_16x16x32_bf16 v[200:203], a[172:175], a[44:47], v[200:203]
s_add_u32 m0, s69, s61
v_exp_f32 v224, v224
v_mfma_f32_16x16x32_bf16 v[200:203], a[168:171], a[40:43], v[200:203]
v_mul_f32 v226, s41, v226
v_mul_f32 v227, s41, v227
v_mfma_f32_16x16x32_bf16 v[200:203], a[164:167], a[36:39], v[200:203]
v_exp_f32 v225, v225
v_mfma_f32_16x16x32_bf16 v[200:203], a[160:163], a[32:35], v[200:203]
v_exp_f32 v226, v226
v_mfma_f32_16x16x32_bf16 v[204:207], a[160:163], a[64:67], v[244:247]
v_exp_f32 v227, v227
v_mfma_f32_16x16x32_bf16 v[204:207], a[164:167], a[68:71], v[204:207]
ds_read_b128 a[144:147], v236 offset:18432
v_cvt_pk_bf16_f32 v26, v224, v225
v_mfma_f32_16x16x32_bf16 v[204:207], a[168:171], a[72:75], v[204:207]
ds_read_b128 a[148:151], v237 offset:18432
v_cvt_pk_bf16_f32 v27, v226, v227
v_mfma_f32_16x16x32_bf16 v[204:207], a[172:175], a[76:79], v[204:207]
v_mul_f32 v200, s41, v200
v_mul_f32 v201, s41, v201
v_mfma_f32_16x16x32_bf16 v[204:207], v[192:195], a[80:83], v[204:207]
v_exp_f32 v200, v200
v_mfma_f32_16x16x32_bf16 v[204:207], v[196:199], a[84:87], v[204:207]
v_mul_f32 v202, s41, v202
v_mul_f32 v203, s41, v203
v_mfma_f32_16x16x32_bf16 v[204:207], a[152:155], a[88:91], v[204:207]
v_exp_f32 v201, v201
v_mfma_f32_16x16x32_bf16 v[204:207], a[156:159], a[92:95], v[204:207]
v_exp_f32 v202, v202
v_mfma_f32_16x16x32_bf16 v[208:211], a[252:255], v[24:27], v[208:211]
buffer_load_dwordx4 v239, s[92:95], s61 offen lds
v_mfma_f32_16x16x32_bf16 v[224:227], a[156:159], a[124:127], v[220:223]
s_add_u32 m0, s75, s56
v_exp_f32 v203, v203
v_mfma_f32_16x16x32_bf16 v[224:227], a[152:155], a[120:123], v[224:227]
ds_read_b128 a[156:159], v237 offset:19456
v_cvt_pk_bf16_f32 v74, v200, v201
v_mfma_f32_16x16x32_bf16 v[224:227], v[196:199], a[116:119], v[224:227]
ds_read_b128 a[152:155], v236 offset:19456
v_cvt_pk_bf16_f32 v75, v202, v203
v_mfma_f32_16x16x32_bf16 v[224:227], v[192:195], a[112:115], v[224:227]
s_mov_b32 s94, 85632
v_mul_f32 v204, s41, v204
v_mul_f32 v205, s41, v205
v_mfma_f32_16x16x32_bf16 v[224:227], a[172:175], a[108:111], v[224:227]
s_add_u32 s68, s36, 98304
v_exp_f32 v204, v204
v_mfma_f32_16x16x32_bf16 v[224:227], a[168:171], a[104:107], v[224:227]
s_add_u32 s92, s72, s68
s_addc_u32 s93, s73, 0
v_mul_f32 v206, s41, v206
v_mul_f32 v207, s41, v207
v_mfma_f32_16x16x32_bf16 v[224:227], a[164:167], a[100:103], v[224:227]
v_exp_f32 v205, v205
v_mfma_f32_16x16x32_bf16 v[224:227], a[160:163], a[96:99], v[224:227]
s_waitcnt lgkmcnt(2)
v_exp_f32 v206, v206
v_mfma_f32_16x16x32_bf16 v[200:203], a[128:131], a[0:3], v[228:231]
v_exp_f32 v207, v207
v_mfma_f32_16x16x32_bf16 v[200:203], a[132:135], a[4:7], v[200:203]
ds_read_b128 a[160:163], v236 offset:24576
v_cvt_pk_bf16_f32 v122, v204, v205
v_mfma_f32_16x16x32_bf16 v[200:203], a[136:139], a[8:11], v[200:203]
ds_read_b128 a[164:167], v237 offset:24576
v_cvt_pk_bf16_f32 v123, v206, v207
v_mfma_f32_16x16x32_bf16 v[200:203], a[140:143], a[12:15], v[200:203]
v_mul_f32 v224, s41, v224
v_mul_f32 v225, s41, v225
v_mfma_f32_16x16x32_bf16 v[200:203], a[144:147], a[16:19], v[200:203]
v_exp_f32 v224, v224
v_mfma_f32_16x16x32_bf16 v[200:203], a[148:151], a[20:23], v[200:203]
s_waitcnt lgkmcnt(2)
v_mul_f32 v226, s41, v226
v_mul_f32 v227, s41, v227
v_mfma_f32_16x16x32_bf16 v[200:203], a[152:155], a[24:27], v[200:203]
v_exp_f32 v225, v225
v_mfma_f32_16x16x32_bf16 v[200:203], a[156:159], a[28:31], v[200:203]
v_exp_f32 v226, v226
v_mfma_f32_16x16x32_bf16 v[210:213], a[252:255], v[72:75], v[210:213]
buffer_load_dwordx4 v239, s[16:19], s62 offen lds
v_mfma_f32_16x16x32_bf16 v[204:207], a[156:159], a[60:63], v[252:255]
s_add_u32 m0, s46, 16128
v_exp_f32 v227, v227
v_mfma_f32_16x16x32_bf16 v[204:207], a[152:155], a[56:59], v[204:207]
ds_read_b128 a[168:171], v236 offset:25600
v_cvt_pk_bf16_f32 v170, v224, v225
v_mfma_f32_16x16x32_bf16 v[204:207], a[148:151], a[52:55], v[204:207]
ds_read_b128 a[172:175], v237 offset:25600
v_cvt_pk_bf16_f32 v171, v226, v227
v_mfma_f32_16x16x32_bf16 v[204:207], a[144:147], a[48:51], v[204:207]
v_mul_f32 v200, s41, v200
v_mul_f32 v201, s41, v201
v_mfma_f32_16x16x32_bf16 v[204:207], a[140:143], a[44:47], v[204:207]
v_exp_f32 v200, v200
v_mfma_f32_16x16x32_bf16 v[204:207], a[136:139], a[40:43], v[204:207]
v_mul_f32 v202, s41, v202
v_mul_f32 v203, s41, v203
v_mfma_f32_16x16x32_bf16 v[204:207], a[132:135], a[36:39], v[204:207]
v_exp_f32 v201, v201
v_mfma_f32_16x16x32_bf16 v[204:207], a[128:131], a[32:35], v[204:207]
v_exp_f32 v202, v202
v_mfma_f32_16x16x32_bf16 v[224:227], a[128:131], a[64:67], v[244:247]
v_exp_f32 v203, v203
v_mfma_f32_16x16x32_bf16 v[224:227], a[132:135], a[68:71], v[224:227]
ds_read_b128 v[192:195], v236 offset:26624
v_cvt_pk_bf16_f32 v28, v200, v201
v_mfma_f32_16x16x32_bf16 v[224:227], a[136:139], a[72:75], v[224:227]
ds_read_b128 v[196:199], v237 offset:26624
v_cvt_pk_bf16_f32 v29, v202, v203
v_mfma_f32_16x16x32_bf16 v[224:227], a[140:143], a[76:79], v[224:227]
v_mul_f32 v204, s41, v204
v_mul_f32 v205, s41, v205
v_mfma_f32_16x16x32_bf16 v[224:227], a[144:147], a[80:83], v[224:227]
s_waitcnt vmcnt(9)
v_exp_f32 v204, v204
v_mfma_f32_16x16x32_bf16 v[224:227], a[148:151], a[84:87], v[224:227]
buffer_load_dwordx4 v239, s[20:23], s48 offen offset:256 nt lds
v_mul_f32 v206, s41, v206
v_mul_f32 v207, s41, v207
v_mfma_f32_16x16x32_bf16 v[224:227], a[152:155], a[88:91], v[224:227]
ds_read_b128 a[216:219], v232 offset:24576
v_exp_f32 v205, v205
v_mfma_f32_16x16x32_bf16 v[224:227], a[156:159], a[92:95], v[224:227]
s_add_u32 m0, s75, s57
v_exp_f32 v206, v206
v_mfma_f32_16x16x32_bf16 v[212:215], a[252:255], v[120:123], v[212:215]
buffer_load_dwordx4 v239, s[16:19], s63 offen lds
v_mfma_f32_16x16x32_bf16 v[200:203], a[156:159], a[124:127], v[220:223]
ds_read_b128 a[220:223], v233 offset:24576
v_exp_f32 v207, v207
v_mfma_f32_16x16x32_bf16 v[200:203], a[152:155], a[120:123], v[200:203]
ds_read_b128 a[156:159], v237 offset:27648
v_cvt_pk_bf16_f32 v76, v204, v205
v_mfma_f32_16x16x32_bf16 v[200:203], a[148:151], a[116:119], v[200:203]
ds_read_b128 a[152:155], v236 offset:27648
v_cvt_pk_bf16_f32 v77, v206, v207
v_mfma_f32_16x16x32_bf16 v[200:203], a[144:147], a[112:115], v[200:203]
s_add_u32 m0, s46, 20224
v_mul_f32 v224, s41, v224
v_mul_f32 v225, s41, v225
v_mfma_f32_16x16x32_bf16 v[200:203], a[140:143], a[108:111], v[200:203]
v_exp_f32 v224, v224
v_mfma_f32_16x16x32_bf16 v[200:203], a[136:139], a[104:107], v[200:203]
s_waitcnt lgkmcnt(2)
v_mul_f32 v226, s41, v226
v_mul_f32 v227, s41, v227
v_mfma_f32_16x16x32_bf16 v[200:203], a[132:135], a[100:103], v[200:203]
v_exp_f32 v225, v225
v_mfma_f32_16x16x32_bf16 v[200:203], a[128:131], a[96:99], v[200:203]
s_waitcnt lgkmcnt(4)
v_exp_f32 v226, v226
v_mfma_f32_16x16x32_bf16 v[204:207], a[160:163], a[0:3], v[228:231]
v_exp_f32 v227, v227
v_mfma_f32_16x16x32_bf16 v[204:207], a[164:167], a[4:7], v[204:207]
ds_read_b128 a[128:131], v236 offset:32768
v_cvt_pk_bf16_f32 v124, v224, v225
v_mfma_f32_16x16x32_bf16 v[204:207], a[168:171], a[8:11], v[204:207]
ds_read_b128 a[132:135], v237 offset:32768
v_cvt_pk_bf16_f32 v125, v226, v227
v_mfma_f32_16x16x32_bf16 v[204:207], a[172:175], a[12:15], v[204:207]
v_mul_f32 v200, s41, v200
v_mul_f32 v201, s41, v201
v_mfma_f32_16x16x32_bf16 v[204:207], v[192:195], a[16:19], v[204:207]
buffer_load_dwordx4 v239, s[20:23], s49 offen offset:256 nt lds
v_exp_f32 v200, v200
v_mfma_f32_16x16x32_bf16 v[204:207], v[196:199], a[20:23], v[204:207]
s_waitcnt lgkmcnt(2)
v_mul_f32 v202, s41, v202
v_mul_f32 v203, s41, v203
v_mfma_f32_16x16x32_bf16 v[204:207], a[152:155], a[24:27], v[204:207]
s_add_u32 m0, s75, s58
v_exp_f32 v201, v201
v_mfma_f32_16x16x32_bf16 v[204:207], a[156:159], a[28:31], v[204:207]
v_exp_f32 v202, v202
v_mfma_f32_16x16x32_bf16 v[214:217], a[252:255], v[168:171], v[214:217]
buffer_load_dwordx4 v239, s[16:19], s64 offen lds
v_mfma_f32_16x16x32_bf16 v[224:227], a[156:159], a[60:63], v[252:255]
s_add_u32 m0, s75, s59
v_exp_f32 v203, v203
v_mfma_f32_16x16x32_bf16 v[224:227], a[152:155], a[56:59], v[224:227]
ds_read_b128 a[136:139], v236 offset:33792
v_cvt_pk_bf16_f32 v172, v200, v201
v_mfma_f32_16x16x32_bf16 v[224:227], v[196:199], a[52:55], v[224:227]
ds_read_b128 a[140:143], v237 offset:33792
v_cvt_pk_bf16_f32 v173, v202, v203
v_mfma_f32_16x16x32_bf16 v[224:227], v[192:195], a[48:51], v[224:227]
v_mul_f32 v204, s41, v204
v_mul_f32 v205, s41, v205
v_mfma_f32_16x16x32_bf16 v[224:227], a[172:175], a[44:47], v[224:227]
v_exp_f32 v204, v204
v_mfma_f32_16x16x32_bf16 v[224:227], a[168:171], a[40:43], v[224:227]
v_mul_f32 v206, s41, v206
v_mul_f32 v207, s41, v207
v_mfma_f32_16x16x32_bf16 v[224:227], a[164:167], a[36:39], v[224:227]
v_exp_f32 v205, v205
v_mfma_f32_16x16x32_bf16 v[224:227], a[160:163], a[32:35], v[224:227]
v_exp_f32 v206, v206
v_mfma_f32_16x16x32_bf16 v[200:203], a[160:163], a[64:67], v[244:247]
v_exp_f32 v207, v207
v_mfma_f32_16x16x32_bf16 v[200:203], a[164:167], a[68:71], v[200:203]
ds_read_b128 a[144:147], v236 offset:34816
v_cvt_pk_bf16_f32 v30, v204, v205
v_mfma_f32_16x16x32_bf16 v[200:203], a[168:171], a[72:75], v[200:203]
ds_read_b128 a[148:151], v237 offset:34816
v_cvt_pk_bf16_f32 v31, v206, v207
v_mfma_f32_16x16x32_bf16 v[200:203], a[172:175], a[76:79], v[200:203]
v_mul_f32 v224, s41, v224
v_mul_f32 v225, s41, v225
v_mfma_f32_16x16x32_bf16 v[200:203], v[192:195], a[80:83], v[200:203]
v_exp_f32 v224, v224
v_mfma_f32_16x16x32_bf16 v[200:203], v[196:199], a[84:87], v[200:203]
v_mul_f32 v226, s41, v226
v_mul_f32 v227, s41, v227
v_mfma_f32_16x16x32_bf16 v[200:203], a[152:155], a[88:91], v[200:203]
v_exp_f32 v225, v225
v_mfma_f32_16x16x32_bf16 v[200:203], a[156:159], a[92:95], v[200:203]
v_exp_f32 v226, v226
v_mfma_f32_16x16x32_bf16 v[208:211], a[252:255], v[28:31], v[208:211]
buffer_load_dwordx4 v239, s[16:19], s65 offen lds
v_mfma_f32_16x16x32_bf16 v[204:207], a[156:159], a[124:127], v[220:223]
s_add_u32 m0, s75, s60
v_exp_f32 v227, v227
v_mfma_f32_16x16x32_bf16 v[204:207], a[152:155], a[120:123], v[204:207]
ds_read_b128 a[156:159], v237 offset:35840
v_cvt_pk_bf16_f32 v78, v224, v225
v_mfma_f32_16x16x32_bf16 v[204:207], v[196:199], a[116:119], v[204:207]
ds_read_b128 a[152:155], v236 offset:35840
v_cvt_pk_bf16_f32 v79, v226, v227
v_mfma_f32_16x16x32_bf16 v[204:207], v[192:195], a[112:115], v[204:207]
v_mul_f32 v200, s41, v200
v_mul_f32 v201, s41, v201
v_mfma_f32_16x16x32_bf16 v[204:207], a[172:175], a[108:111], v[204:207]
v_exp_f32 v200, v200
v_mfma_f32_16x16x32_bf16 v[204:207], a[168:171], a[104:107], v[204:207]
v_mul_f32 v202, s41, v202
v_mul_f32 v203, s41, v203
v_mfma_f32_16x16x32_bf16 v[204:207], a[164:167], a[100:103], v[204:207]
v_exp_f32 v201, v201
v_mfma_f32_16x16x32_bf16 v[204:207], a[160:163], a[96:99], v[204:207]
s_waitcnt lgkmcnt(2)
v_exp_f32 v202, v202
v_mfma_f32_16x16x32_bf16 v[224:227], a[128:131], a[0:3], v[228:231]
v_exp_f32 v203, v203
v_mfma_f32_16x16x32_bf16 v[224:227], a[132:135], a[4:7], v[224:227]
ds_read_b128 a[160:163], v236 offset:40960
v_cvt_pk_bf16_f32 v126, v200, v201
v_mfma_f32_16x16x32_bf16 v[224:227], a[136:139], a[8:11], v[224:227]
ds_read_b128 a[164:167], v237 offset:40960
v_cvt_pk_bf16_f32 v127, v202, v203
v_mfma_f32_16x16x32_bf16 v[224:227], a[140:143], a[12:15], v[224:227]
v_mul_f32 v204, s41, v204
v_mul_f32 v205, s41, v205
v_mfma_f32_16x16x32_bf16 v[224:227], a[144:147], a[16:19], v[224:227]
v_exp_f32 v204, v204
v_mfma_f32_16x16x32_bf16 v[224:227], a[148:151], a[20:23], v[224:227]
s_waitcnt lgkmcnt(2)
v_mul_f32 v206, s41, v206
v_mul_f32 v207, s41, v207
v_mfma_f32_16x16x32_bf16 v[224:227], a[152:155], a[24:27], v[224:227]
v_exp_f32 v205, v205
v_mfma_f32_16x16x32_bf16 v[224:227], a[156:159], a[28:31], v[224:227]
v_exp_f32 v206, v206
v_mfma_f32_16x16x32_bf16 v[210:213], a[252:255], v[76:79], v[210:213]
buffer_load_dwordx4 v239, s[16:19], s66 offen lds
v_mfma_f32_16x16x32_bf16 v[200:203], a[156:159], a[60:63], v[252:255]
s_add_u32 m0, s46, 24192
v_exp_f32 v207, v207
v_mfma_f32_16x16x32_bf16 v[200:203], a[152:155], a[56:59], v[200:203]
ds_read_b128 a[168:171], v236 offset:41984
v_cvt_pk_bf16_f32 v174, v204, v205
v_mfma_f32_16x16x32_bf16 v[200:203], a[148:151], a[52:55], v[200:203]
ds_read_b128 a[172:175], v237 offset:41984
v_cvt_pk_bf16_f32 v175, v206, v207
v_mfma_f32_16x16x32_bf16 v[200:203], a[144:147], a[48:51], v[200:203]
v_mul_f32 v224, s41, v224
v_mul_f32 v225, s41, v225
v_mfma_f32_16x16x32_bf16 v[200:203], a[140:143], a[44:47], v[200:203]
v_exp_f32 v224, v224
v_mfma_f32_16x16x32_bf16 v[200:203], a[136:139], a[40:43], v[200:203]
s_waitcnt vmcnt(8)
v_mul_f32 v226, s41, v226
v_mul_f32 v227, s41, v227
v_mfma_f32_16x16x32_bf16 v[200:203], a[132:135], a[36:39], v[200:203]
buffer_load_dwordx4 v239, s[20:23], s48 offen offset:384 nt lds
v_exp_f32 v225, v225
v_mfma_f32_16x16x32_bf16 v[200:203], a[128:131], a[32:35], v[200:203]
ds_read_b128 a[224:227], v232 offset:32768
v_exp_f32 v226, v226
v_mfma_f32_16x16x32_bf16 v[204:207], a[128:131], a[64:67], v[244:247]
ds_read_b128 a[228:231], v233 offset:32768
v_exp_f32 v227, v227
v_mfma_f32_16x16x32_bf16 v[204:207], a[132:135], a[68:71], v[204:207]
ds_read_b128 v[192:195], v236 offset:43008
v_cvt_pk_bf16_f32 v32, v224, v225
v_mfma_f32_16x16x32_bf16 v[204:207], a[136:139], a[72:75], v[204:207]
ds_read_b128 v[196:199], v237 offset:43008
v_cvt_pk_bf16_f32 v33, v226, v227
v_mfma_f32_16x16x32_bf16 v[204:207], a[140:143], a[76:79], v[204:207]
s_add_u32 m0, s75, s61
v_mul_f32 v200, s41, v200
v_mul_f32 v201, s41, v201
v_mfma_f32_16x16x32_bf16 v[204:207], a[144:147], a[80:83], v[204:207]
v_exp_f32 v200, v200
v_mfma_f32_16x16x32_bf16 v[204:207], a[148:151], a[84:87], v[204:207]
s_waitcnt lgkmcnt(2)
v_mul_f32 v202, s41, v202
v_mul_f32 v203, s41, v203
v_mfma_f32_16x16x32_bf16 v[204:207], a[152:155], a[88:91], v[204:207]
v_exp_f32 v201, v201
v_mfma_f32_16x16x32_bf16 v[204:207], a[156:159], a[92:95], v[204:207]
v_exp_f32 v202, v202
v_mfma_f32_16x16x32_bf16 v[212:215], a[252:255], v[124:127], v[212:215]
buffer_load_dwordx4 v239, s[16:19], s67 offen lds
v_mfma_f32_16x16x32_bf16 v[224:227], a[156:159], a[124:127], v[220:223]
s_add_u32 m0, s46, 28288
v_exp_f32 v203, v203
v_mfma_f32_16x16x32_bf16 v[224:227], a[152:155], a[120:123], v[224:227]
ds_read_b128 a[156:159], v237 offset:44032
v_cvt_pk_bf16_f32 v80, v200, v201
v_mfma_f32_16x16x32_bf16 v[224:227], a[148:151], a[116:119], v[224:227]
ds_read_b128 a[152:155], v236 offset:44032
v_cvt_pk_bf16_f32 v81, v202, v203
v_mfma_f32_16x16x32_bf16 v[224:227], a[144:147], a[112:115], v[224:227]
s_add_u32 s16, s16, 128
s_addc_u32 s17, s17, 0
v_mul_f32 v204, s41, v204
v_mul_f32 v205, s41, v205
v_mfma_f32_16x16x32_bf16 v[224:227], a[140:143], a[108:111], v[224:227]
v_exp_f32 v204, v204
v_mfma_f32_16x16x32_bf16 v[224:227], a[136:139], a[104:107], v[224:227]
buffer_load_dwordx4 v239, s[20:23], s49 offen offset:384 nt lds
v_mul_f32 v206, s41, v206
v_mul_f32 v207, s41, v207
v_mfma_f32_16x16x32_bf16 v[224:227], a[132:135], a[100:103], v[224:227]
s_add_u32 m0, s38, s56
v_exp_f32 v205, v205
v_mfma_f32_16x16x32_bf16 v[224:227], a[128:131], a[96:99], v[224:227]
s_waitcnt vmcnt(10) lgkmcnt(0)
v_exp_f32 v206, v206
v_mfma_f32_16x16x32_bf16 v[200:203], a[160:163], a[0:3], v[228:231]
s_barrier
v_exp_f32 v207, v207
v_mfma_f32_16x16x32_bf16 v[200:203], a[164:167], a[4:7], v[200:203]
ds_read_b128 a[128:131], v236 offset:49152
v_cvt_pk_bf16_f32 v128, v204, v205
v_mfma_f32_16x16x32_bf16 v[200:203], a[168:171], a[8:11], v[200:203]
ds_read_b128 a[132:135], v237 offset:49152
v_cvt_pk_bf16_f32 v129, v206, v207
v_mfma_f32_16x16x32_bf16 v[200:203], a[172:175], a[12:15], v[200:203]
v_mul_f32 v224, s41, v224
v_mul_f32 v225, s41, v225
v_mfma_f32_16x16x32_bf16 v[200:203], v[192:195], a[16:19], v[200:203]
v_exp_f32 v224, v224
v_mfma_f32_16x16x32_bf16 v[200:203], v[196:199], a[20:23], v[200:203]
v_mul_f32 v226, s41, v226
v_mul_f32 v227, s41, v227
v_mfma_f32_16x16x32_bf16 v[200:203], a[152:155], a[24:27], v[200:203]
v_exp_f32 v225, v225
v_mfma_f32_16x16x32_bf16 v[200:203], a[156:159], a[28:31], v[200:203]
v_exp_f32 v226, v226
v_mfma_f32_16x16x32_bf16 v[214:217], a[252:255], v[172:175], v[214:217]
buffer_load_dwordx4 v239, s[92:95], s62 offen lds
v_mfma_f32_16x16x32_bf16 v[204:207], a[156:159], a[60:63], v[252:255]
s_add_u32 m0, s38, s57
v_exp_f32 v227, v227
v_mfma_f32_16x16x32_bf16 v[204:207], a[152:155], a[56:59], v[204:207]
ds_read_b128 a[136:139], v236 offset:50176
v_cvt_pk_bf16_f32 v176, v224, v225
v_mfma_f32_16x16x32_bf16 v[204:207], v[196:199], a[52:55], v[204:207]
ds_read_b128 a[140:143], v237 offset:50176
v_cvt_pk_bf16_f32 v177, v226, v227
v_mfma_f32_16x16x32_bf16 v[204:207], v[192:195], a[48:51], v[204:207]
v_mul_f32 v200, s41, v200
v_mul_f32 v201, s41, v201
v_mfma_f32_16x16x32_bf16 v[204:207], a[172:175], a[44:47], v[204:207]
v_exp_f32 v200, v200
v_mfma_f32_16x16x32_bf16 v[204:207], a[168:171], a[40:43], v[204:207]
v_mul_f32 v202, s41, v202
v_mul_f32 v203, s41, v203
v_mfma_f32_16x16x32_bf16 v[204:207], a[164:167], a[36:39], v[204:207]
v_exp_f32 v201, v201
v_mfma_f32_16x16x32_bf16 v[204:207], a[160:163], a[32:35], v[204:207]
v_exp_f32 v202, v202
v_mfma_f32_16x16x32_bf16 v[224:227], a[160:163], a[64:67], v[244:247]
v_exp_f32 v203, v203
v_mfma_f32_16x16x32_bf16 v[224:227], a[164:167], a[68:71], v[224:227]
ds_read_b128 a[144:147], v236 offset:51200
v_cvt_pk_bf16_f32 v34, v200, v201
v_mfma_f32_16x16x32_bf16 v[224:227], a[168:171], a[72:75], v[224:227]
ds_read_b128 a[148:151], v237 offset:51200
v_cvt_pk_bf16_f32 v35, v202, v203
v_mfma_f32_16x16x32_bf16 v[224:227], a[172:175], a[76:79], v[224:227]
v_mul_f32 v204, s41, v204
v_mul_f32 v205, s41, v205
v_mfma_f32_16x16x32_bf16 v[224:227], v[192:195], a[80:83], v[224:227]
v_exp_f32 v204, v204
v_mfma_f32_16x16x32_bf16 v[224:227], v[196:199], a[84:87], v[224:227]
v_mul_f32 v206, s41, v206
v_mul_f32 v207, s41, v207
v_mfma_f32_16x16x32_bf16 v[224:227], a[152:155], a[88:91], v[224:227]
v_exp_f32 v205, v205
v_mfma_f32_16x16x32_bf16 v[224:227], a[156:159], a[92:95], v[224:227]
v_exp_f32 v206, v206
v_mfma_f32_16x16x32_bf16 v[208:211], a[252:255], v[32:35], v[208:211]
buffer_load_dwordx4 v239, s[92:95], s63 offen lds
v_mfma_f32_16x16x32_bf16 v[200:203], a[156:159], a[124:127], v[220:223]
s_add_u32 m0, s38, s58
v_exp_f32 v207, v207
v_mfma_f32_16x16x32_bf16 v[200:203], a[152:155], a[120:123], v[200:203]
ds_read_b128 a[156:159], v237 offset:52224
v_cvt_pk_bf16_f32 v82, v204, v205
v_mfma_f32_16x16x32_bf16 v[200:203], v[196:199], a[116:119], v[200:203]
ds_read_b128 a[152:155], v236 offset:52224
v_cvt_pk_bf16_f32 v83, v206, v207
v_mfma_f32_16x16x32_bf16 v[200:203], v[192:195], a[112:115], v[200:203]
v_mul_f32 v224, s41, v224
v_mul_f32 v225, s41, v225
v_mfma_f32_16x16x32_bf16 v[200:203], a[172:175], a[108:111], v[200:203]
v_exp_f32 v224, v224
v_mfma_f32_16x16x32_bf16 v[200:203], a[168:171], a[104:107], v[200:203]
v_mul_f32 v226, s41, v226
v_mul_f32 v227, s41, v227
v_mfma_f32_16x16x32_bf16 v[200:203], a[164:167], a[100:103], v[200:203]
v_exp_f32 v225, v225
v_mfma_f32_16x16x32_bf16 v[200:203], a[160:163], a[96:99], v[200:203]
s_waitcnt lgkmcnt(2)
v_exp_f32 v226, v226
v_mfma_f32_16x16x32_bf16 v[204:207], a[128:131], a[0:3], v[228:231]
v_exp_f32 v227, v227
v_mfma_f32_16x16x32_bf16 v[204:207], a[132:135], a[4:7], v[204:207]
ds_read_b128 a[160:163], v236 offset:57344
v_cvt_pk_bf16_f32 v130, v224, v225
v_mfma_f32_16x16x32_bf16 v[204:207], a[136:139], a[8:11], v[204:207]
ds_read_b128 a[164:167], v237 offset:57344
v_cvt_pk_bf16_f32 v131, v226, v227
v_mfma_f32_16x16x32_bf16 v[204:207], a[140:143], a[12:15], v[204:207]
v_mul_f32 v200, s41, v200
v_mul_f32 v201, s41, v201
v_mfma_f32_16x16x32_bf16 v[204:207], a[144:147], a[16:19], v[204:207]
v_exp_f32 v200, v200
v_mfma_f32_16x16x32_bf16 v[204:207], a[148:151], a[20:23], v[204:207]
s_waitcnt lgkmcnt(2)
v_mul_f32 v202, s41, v202
v_mul_f32 v203, s41, v203
v_mfma_f32_16x16x32_bf16 v[204:207], a[152:155], a[24:27], v[204:207]
v_exp_f32 v201, v201
v_mfma_f32_16x16x32_bf16 v[204:207], a[156:159], a[28:31], v[204:207]
v_exp_f32 v202, v202
v_mfma_f32_16x16x32_bf16 v[210:213], a[252:255], v[80:83], v[210:213]
buffer_load_dwordx4 v239, s[92:95], s64 offen lds
v_mfma_f32_16x16x32_bf16 v[224:227], a[156:159], a[60:63], v[252:255]
s_add_u32 m0, s46, 32768
v_exp_f32 v203, v203
v_mfma_f32_16x16x32_bf16 v[224:227], a[152:155], a[56:59], v[224:227]
ds_read_b128 a[168:171], v236 offset:58368
v_cvt_pk_bf16_f32 v178, v200, v201
v_mfma_f32_16x16x32_bf16 v[224:227], a[148:151], a[52:55], v[224:227]
ds_read_b128 a[172:175], v237 offset:58368
v_cvt_pk_bf16_f32 v179, v202, v203
v_mfma_f32_16x16x32_bf16 v[224:227], a[144:147], a[48:51], v[224:227]
buffer_load_dwordx4 v239, s[20:23], s50 offen offset:0 nt lds
v_mul_f32 v204, s41, v204
v_mul_f32 v205, s41, v205
v_mfma_f32_16x16x32_bf16 v[224:227], a[140:143], a[44:47], v[224:227]
s_add_u32 m0, s38, s59
v_exp_f32 v204, v204
v_mfma_f32_16x16x32_bf16 v[224:227], a[136:139], a[40:43], v[224:227]
s_waitcnt vmcnt(10)
v_mul_f32 v206, s41, v206
v_mul_f32 v207, s41, v207
v_mfma_f32_16x16x32_bf16 v[224:227], a[132:135], a[36:39], v[224:227]
ds_read_b128 a[232:235], v232 offset:16384
v_exp_f32 v205, v205
v_mfma_f32_16x16x32_bf16 v[224:227], a[128:131], a[32:35], v[224:227]
ds_read_b128 a[236:239], v233 offset:16384
v_exp_f32 v206, v206
v_mfma_f32_16x16x32_bf16 v[200:203], a[128:131], a[64:67], v[244:247]
v_exp_f32 v207, v207
v_mfma_f32_16x16x32_bf16 v[200:203], a[132:135], a[68:71], v[200:203]
ds_read_b128 v[192:195], v236 offset:59392
v_cvt_pk_bf16_f32 v36, v204, v205
v_mfma_f32_16x16x32_bf16 v[200:203], a[136:139], a[72:75], v[200:203]
ds_read_b128 v[196:199], v237 offset:59392
v_cvt_pk_bf16_f32 v37, v206, v207
v_mfma_f32_16x16x32_bf16 v[200:203], a[140:143], a[76:79], v[200:203]
v_mul_f32 v224, s41, v224
v_mul_f32 v225, s41, v225
v_mfma_f32_16x16x32_bf16 v[200:203], a[144:147], a[80:83], v[200:203]
s_waitcnt lgkmcnt(2)
v_exp_f32 v224, v224
v_mfma_f32_16x16x32_bf16 v[200:203], a[148:151], a[84:87], v[200:203]
v_mul_f32 v226, s41, v226
v_mul_f32 v227, s41, v227
v_mfma_f32_16x16x32_bf16 v[200:203], a[152:155], a[88:91], v[200:203]
v_exp_f32 v225, v225
v_mfma_f32_16x16x32_bf16 v[200:203], a[156:159], a[92:95], v[200:203]
v_exp_f32 v226, v226
v_mfma_f32_16x16x32_bf16 v[212:215], a[252:255], v[128:131], v[212:215]
buffer_load_dwordx4 v239, s[92:95], s65 offen lds
v_mfma_f32_16x16x32_bf16 v[204:207], a[156:159], a[124:127], v[220:223]
s_add_u32 m0, s46, 36864
v_exp_f32 v227, v227
v_mfma_f32_16x16x32_bf16 v[204:207], a[152:155], a[120:123], v[204:207]
ds_read_b128 a[156:159], v237 offset:60416
v_cvt_pk_bf16_f32 v84, v224, v225
v_mfma_f32_16x16x32_bf16 v[204:207], a[148:151], a[116:119], v[204:207]
ds_read_b128 a[152:155], v236 offset:60416
v_cvt_pk_bf16_f32 v85, v226, v227
v_mfma_f32_16x16x32_bf16 v[204:207], a[144:147], a[112:115], v[204:207]
buffer_load_dwordx4 v239, s[20:23], s51 offen offset:0 nt lds
v_mul_f32 v200, s41, v200
v_mul_f32 v201, s41, v201
v_mfma_f32_16x16x32_bf16 v[204:207], a[140:143], a[108:111], v[204:207]
s_add_u32 m0, s38, s60
v_exp_f32 v200, v200
v_mfma_f32_16x16x32_bf16 v[204:207], a[136:139], a[104:107], v[204:207]
v_mul_f32 v202, s41, v202
v_mul_f32 v203, s41, v203
v_mfma_f32_16x16x32_bf16 v[204:207], a[132:135], a[100:103], v[204:207]
v_exp_f32 v201, v201
v_mfma_f32_16x16x32_bf16 v[204:207], a[128:131], a[96:99], v[204:207]
s_waitcnt lgkmcnt(2)
v_exp_f32 v202, v202
v_mfma_f32_16x16x32_bf16 v[224:227], a[160:163], a[0:3], v[228:231]
v_exp_f32 v203, v203
v_mfma_f32_16x16x32_bf16 v[224:227], a[164:167], a[4:7], v[224:227]
ds_read_b128 a[128:131], v249 offset:8192
v_cvt_pk_bf16_f32 v132, v200, v201
v_mfma_f32_16x16x32_bf16 v[224:227], a[168:171], a[8:11], v[224:227]
ds_read_b128 a[132:135], v250 offset:8192
v_cvt_pk_bf16_f32 v133, v202, v203
v_mfma_f32_16x16x32_bf16 v[224:227], a[172:175], a[12:15], v[224:227]
v_mul_f32 v204, s41, v204
v_mul_f32 v205, s41, v205
v_mfma_f32_16x16x32_bf16 v[224:227], v[192:195], a[16:19], v[224:227]
v_exp_f32 v204, v204
v_mfma_f32_16x16x32_bf16 v[224:227], v[196:199], a[20:23], v[224:227]
s_waitcnt lgkmcnt(2)
v_mul_f32 v206, s41, v206
v_mul_f32 v207, s41, v207
v_mfma_f32_16x16x32_bf16 v[224:227], a[152:155], a[24:27], v[224:227]
v_exp_f32 v205, v205
v_mfma_f32_16x16x32_bf16 v[224:227], a[156:159], a[28:31], v[224:227]
v_exp_f32 v206, v206
v_mfma_f32_16x16x32_bf16 v[214:217], a[252:255], v[176:179], v[214:217]
buffer_load_dwordx4 v239, s[92:95], s66 offen lds
v_mfma_f32_16x16x32_bf16 v[200:203], a[156:159], a[60:63], v[252:255]
s_add_u32 m0, s38, s61
v_exp_f32 v207, v207
v_mfma_f32_16x16x32_bf16 v[200:203], a[152:155], a[56:59], v[200:203]
ds_read_b128 a[136:139], v249 offset:9216
v_cvt_pk_bf16_f32 v180, v204, v205
v_mfma_f32_16x16x32_bf16 v[200:203], v[196:199], a[52:55], v[200:203]
ds_read_b128 a[140:143], v250 offset:9216
v_cvt_pk_bf16_f32 v181, v206, v207
v_mfma_f32_16x16x32_bf16 v[200:203], v[192:195], a[48:51], v[200:203]
v_mul_f32 v224, s41, v224
v_mul_f32 v225, s41, v225
v_mfma_f32_16x16x32_bf16 v[200:203], a[172:175], a[44:47], v[200:203]
v_exp_f32 v224, v224
v_mfma_f32_16x16x32_bf16 v[200:203], a[168:171], a[40:43], v[200:203]
v_mul_f32 v226, s41, v226
v_mul_f32 v227, s41, v227
v_mfma_f32_16x16x32_bf16 v[200:203], a[164:167], a[36:39], v[200:203]
v_exp_f32 v225, v225
v_mfma_f32_16x16x32_bf16 v[200:203], a[160:163], a[32:35], v[200:203]
v_exp_f32 v226, v226
v_mfma_f32_16x16x32_bf16 v[204:207], a[160:163], a[64:67], v[244:247]
v_exp_f32 v227, v227
v_mfma_f32_16x16x32_bf16 v[204:207], a[164:167], a[68:71], v[204:207]
ds_read_b128 a[144:147], v249 offset:10240
v_cvt_pk_bf16_f32 v38, v224, v225
v_mfma_f32_16x16x32_bf16 v[204:207], a[168:171], a[72:75], v[204:207]
ds_read_b128 a[148:151], v250 offset:10240
v_cvt_pk_bf16_f32 v39, v226, v227
v_mfma_f32_16x16x32_bf16 v[204:207], a[172:175], a[76:79], v[204:207]
v_mul_f32 v200, s41, v200
v_mul_f32 v201, s41, v201
v_mfma_f32_16x16x32_bf16 v[204:207], v[192:195], a[80:83], v[204:207]
v_exp_f32 v200, v200
v_mfma_f32_16x16x32_bf16 v[204:207], v[196:199], a[84:87], v[204:207]
v_mul_f32 v202, s41, v202
v_mul_f32 v203, s41, v203
v_mfma_f32_16x16x32_bf16 v[204:207], a[152:155], a[88:91], v[204:207]
v_exp_f32 v201, v201
v_mfma_f32_16x16x32_bf16 v[204:207], a[156:159], a[92:95], v[204:207]
v_exp_f32 v202, v202
v_mfma_f32_16x16x32_bf16 v[208:211], a[252:255], v[36:39], v[208:211]
buffer_load_dwordx4 v239, s[92:95], s67 offen lds
v_mfma_f32_16x16x32_bf16 v[224:227], a[156:159], a[124:127], v[220:223]
s_add_u32 m0, s46, 16256
v_exp_f32 v203, v203
v_mfma_f32_16x16x32_bf16 v[224:227], a[152:155], a[120:123], v[224:227]
ds_read_b128 a[156:159], v250 offset:11264
v_cvt_pk_bf16_f32 v86, v200, v201
v_mfma_f32_16x16x32_bf16 v[224:227], v[196:199], a[116:119], v[224:227]
ds_read_b128 a[152:155], v249 offset:11264
v_cvt_pk_bf16_f32 v87, v202, v203
v_mfma_f32_16x16x32_bf16 v[224:227], v[192:195], a[112:115], v[224:227]
s_add_u32 s92, s92, 128
s_addc_u32 s93, s93, 0
v_mul_f32 v204, s41, v204
v_mul_f32 v205, s41, v205
v_mfma_f32_16x16x32_bf16 v[224:227], a[172:175], a[108:111], v[224:227]
v_exp_f32 v204, v204
v_mfma_f32_16x16x32_bf16 v[224:227], a[168:171], a[104:107], v[224:227]
v_mul_f32 v206, s41, v206
v_mul_f32 v207, s41, v207
v_mfma_f32_16x16x32_bf16 v[224:227], a[164:167], a[100:103], v[224:227]
v_exp_f32 v205, v205
v_mfma_f32_16x16x32_bf16 v[224:227], a[160:163], a[96:99], v[224:227]
s_waitcnt lgkmcnt(2)
v_exp_f32 v206, v206
v_mfma_f32_16x16x32_bf16 v[200:203], a[128:131], a[0:3], v[228:231]
v_exp_f32 v207, v207
v_mfma_f32_16x16x32_bf16 v[200:203], a[132:135], a[4:7], v[200:203]
ds_read_b128 a[160:163], v249 offset:16384
v_cvt_pk_bf16_f32 v134, v204, v205
v_mfma_f32_16x16x32_bf16 v[200:203], a[136:139], a[8:11], v[200:203]
ds_read_b128 a[164:167], v250 offset:16384
v_cvt_pk_bf16_f32 v135, v206, v207
v_mfma_f32_16x16x32_bf16 v[200:203], a[140:143], a[12:15], v[200:203]
buffer_load_dwordx4 v239, s[20:23], s50 offen offset:128 nt lds
v_mul_f32 v224, s41, v224
v_mul_f32 v225, s41, v225
v_mfma_f32_16x16x32_bf16 v[200:203], a[144:147], a[16:19], v[200:203]
s_add_u32 m0, s39, s56
v_exp_f32 v224, v224
v_mfma_f32_16x16x32_bf16 v[200:203], a[148:151], a[20:23], v[200:203]
s_waitcnt lgkmcnt(2)
v_mul_f32 v226, s41, v226
v_mul_f32 v227, s41, v227
v_mfma_f32_16x16x32_bf16 v[200:203], a[152:155], a[24:27], v[200:203]
s_waitcnt vmcnt(9)
v_exp_f32 v225, v225
v_mfma_f32_16x16x32_bf16 v[200:203], a[156:159], a[28:31], v[200:203]
ds_read_b128 a[240:243], v232 offset:24576
v_exp_f32 v226, v226
v_mfma_f32_16x16x32_bf16 v[210:213], a[252:255], v[84:87], v[210:213]
buffer_load_dwordx4 v239, s[16:19], s62 offen lds
v_mfma_f32_16x16x32_bf16 v[204:207], a[156:159], a[60:63], v[252:255]
ds_read_b128 a[244:247], v233 offset:24576
v_exp_f32 v227, v227
v_mfma_f32_16x16x32_bf16 v[204:207], a[152:155], a[56:59], v[204:207]
ds_read_b128 a[168:171], v249 offset:17408
v_cvt_pk_bf16_f32 v182, v224, v225
v_mfma_f32_16x16x32_bf16 v[204:207], a[148:151], a[52:55], v[204:207]
ds_read_b128 a[172:175], v250 offset:17408
v_cvt_pk_bf16_f32 v183, v226, v227
v_mfma_f32_16x16x32_bf16 v[204:207], a[144:147], a[48:51], v[204:207]
s_add_u32 m0, s46, 20352
v_mul_f32 v200, s41, v200
v_mul_f32 v201, s41, v201
v_mfma_f32_16x16x32_bf16 v[204:207], a[140:143], a[44:47], v[204:207]
v_exp_f32 v200, v200
v_mfma_f32_16x16x32_bf16 v[204:207], a[136:139], a[40:43], v[204:207]
s_waitcnt lgkmcnt(2)
v_mul_f32 v202, s41, v202
v_mul_f32 v203, s41, v203
v_mfma_f32_16x16x32_bf16 v[204:207], a[132:135], a[36:39], v[204:207]
v_exp_f32 v201, v201
v_mfma_f32_16x16x32_bf16 v[204:207], a[128:131], a[32:35], v[204:207]
v_exp_f32 v202, v202
v_mfma_f32_16x16x32_bf16 v[224:227], a[128:131], a[64:67], v[244:247]
v_exp_f32 v203, v203
v_mfma_f32_16x16x32_bf16 v[224:227], a[132:135], a[68:71], v[224:227]
ds_read_b128 v[192:195], v249 offset:18432
v_cvt_pk_bf16_f32 v40, v200, v201
v_mfma_f32_16x16x32_bf16 v[224:227], a[136:139], a[72:75], v[224:227]
ds_read_b128 v[196:199], v250 offset:18432
v_cvt_pk_bf16_f32 v41, v202, v203
v_mfma_f32_16x16x32_bf16 v[224:227], a[140:143], a[76:79], v[224:227]
buffer_load_dwordx4 v239, s[20:23], s51 offen offset:128 nt lds
v_mul_f32 v204, s41, v204
v_mul_f32 v205, s41, v205
v_mfma_f32_16x16x32_bf16 v[224:227], a[144:147], a[80:83], v[224:227]
s_add_u32 m0, s39, s57
v_exp_f32 v204, v204
v_mfma_f32_16x16x32_bf16 v[224:227], a[148:151], a[84:87], v[224:227]
v_mul_f32 v206, s41, v206
v_mul_f32 v207, s41, v207
v_mfma_f32_16x16x32_bf16 v[224:227], a[152:155], a[88:91], v[224:227]
v_exp_f32 v205, v205
v_mfma_f32_16x16x32_bf16 v[224:227], a[156:159], a[92:95], v[224:227]
v_exp_f32 v206, v206
v_mfma_f32_16x16x32_bf16 v[212:215], a[252:255], v[132:135], v[212:215]
buffer_load_dwordx4 v239, s[16:19], s63 offen lds
v_mfma_f32_16x16x32_bf16 v[200:203], a[156:159], a[124:127], v[220:223]
s_add_u32 m0, s39, s58
v_exp_f32 v207, v207
v_mfma_f32_16x16x32_bf16 v[200:203], a[152:155], a[120:123], v[200:203]
ds_read_b128 a[156:159], v250 offset:19456
v_cvt_pk_bf16_f32 v88, v204, v205
v_mfma_f32_16x16x32_bf16 v[200:203], a[148:151], a[116:119], v[200:203]
ds_read_b128 a[152:155], v249 offset:19456
v_cvt_pk_bf16_f32 v89, v206, v207
v_mfma_f32_16x16x32_bf16 v[200:203], a[144:147], a[112:115], v[200:203]
v_mul_f32 v224, s41, v224
v_mul_f32 v225, s41, v225
v_mfma_f32_16x16x32_bf16 v[200:203], a[140:143], a[108:111], v[200:203]
v_exp_f32 v224, v224
v_mfma_f32_16x16x32_bf16 v[200:203], a[136:139], a[104:107], v[200:203]
v_mul_f32 v226, s41, v226
v_mul_f32 v227, s41, v227
v_mfma_f32_16x16x32_bf16 v[200:203], a[132:135], a[100:103], v[200:203]
v_exp_f32 v225, v225
v_mfma_f32_16x16x32_bf16 v[200:203], a[128:131], a[96:99], v[200:203]
s_waitcnt lgkmcnt(2)
v_exp_f32 v226, v226
v_mfma_f32_16x16x32_bf16 v[204:207], a[160:163], a[0:3], v[228:231]
v_exp_f32 v227, v227
v_mfma_f32_16x16x32_bf16 v[204:207], a[164:167], a[4:7], v[204:207]
ds_read_b128 a[128:131], v249 offset:24576
v_cvt_pk_bf16_f32 v136, v224, v225
v_mfma_f32_16x16x32_bf16 v[204:207], a[168:171], a[8:11], v[204:207]
ds_read_b128 a[132:135], v250 offset:24576
v_cvt_pk_bf16_f32 v137, v226, v227
v_mfma_f32_16x16x32_bf16 v[204:207], a[172:175], a[12:15], v[204:207]
v_mul_f32 v200, s41, v200
v_mul_f32 v201, s41, v201
v_mfma_f32_16x16x32_bf16 v[204:207], v[192:195], a[16:19], v[204:207]
v_exp_f32 v200, v200
v_mfma_f32_16x16x32_bf16 v[204:207], v[196:199], a[20:23], v[204:207]
s_waitcnt lgkmcnt(2)
v_mul_f32 v202, s41, v202
v_mul_f32 v203, s41, v203
v_mfma_f32_16x16x32_bf16 v[204:207], a[152:155], a[24:27], v[204:207]
v_exp_f32 v201, v201
v_mfma_f32_16x16x32_bf16 v[204:207], a[156:159], a[28:31], v[204:207]
v_exp_f32 v202, v202
v_mfma_f32_16x16x32_bf16 v[214:217], a[252:255], v[180:183], v[214:217]
buffer_load_dwordx4 v239, s[16:19], s64 offen lds
v_mfma_f32_16x16x32_bf16 v[224:227], a[156:159], a[60:63], v[252:255]
s_add_u32 m0, s39, s59
v_exp_f32 v203, v203
v_mfma_f32_16x16x32_bf16 v[224:227], a[152:155], a[56:59], v[224:227]
ds_read_b128 a[136:139], v249 offset:25600
v_cvt_pk_bf16_f32 v184, v200, v201
v_mfma_f32_16x16x32_bf16 v[224:227], v[196:199], a[52:55], v[224:227]
ds_read_b128 a[140:143], v250 offset:25600
v_cvt_pk_bf16_f32 v185, v202, v203
v_mfma_f32_16x16x32_bf16 v[224:227], v[192:195], a[48:51], v[224:227]
v_mul_f32 v204, s41, v204
v_mul_f32 v205, s41, v205
v_mfma_f32_16x16x32_bf16 v[224:227], a[172:175], a[44:47], v[224:227]
v_exp_f32 v204, v204
v_mfma_f32_16x16x32_bf16 v[224:227], a[168:171], a[40:43], v[224:227]
v_mul_f32 v206, s41, v206
v_mul_f32 v207, s41, v207
v_mfma_f32_16x16x32_bf16 v[224:227], a[164:167], a[36:39], v[224:227]
v_exp_f32 v205, v205
v_mfma_f32_16x16x32_bf16 v[224:227], a[160:163], a[32:35], v[224:227]
v_exp_f32 v206, v206
v_mfma_f32_16x16x32_bf16 v[200:203], a[160:163], a[64:67], v[244:247]
v_exp_f32 v207, v207
v_mfma_f32_16x16x32_bf16 v[200:203], a[164:167], a[68:71], v[200:203]
ds_read_b128 a[144:147], v249 offset:26624
v_cvt_pk_bf16_f32 v42, v204, v205
v_mfma_f32_16x16x32_bf16 v[200:203], a[168:171], a[72:75], v[200:203]
ds_read_b128 a[148:151], v250 offset:26624
v_cvt_pk_bf16_f32 v43, v206, v207
v_mfma_f32_16x16x32_bf16 v[200:203], a[172:175], a[76:79], v[200:203]
v_mul_f32 v224, s41, v224
v_mul_f32 v225, s41, v225
v_mfma_f32_16x16x32_bf16 v[200:203], v[192:195], a[80:83], v[200:203]
v_exp_f32 v224, v224
v_mfma_f32_16x16x32_bf16 v[200:203], v[196:199], a[84:87], v[200:203]
v_mul_f32 v226, s41, v226
v_mul_f32 v227, s41, v227
v_mfma_f32_16x16x32_bf16 v[200:203], a[152:155], a[88:91], v[200:203]
v_exp_f32 v225, v225
v_mfma_f32_16x16x32_bf16 v[200:203], a[156:159], a[92:95], v[200:203]
v_exp_f32 v226, v226
v_mfma_f32_16x16x32_bf16 v[208:211], a[252:255], v[40:43], v[208:211]
buffer_load_dwordx4 v239, s[16:19], s65 offen lds
v_mfma_f32_16x16x32_bf16 v[204:207], a[156:159], a[124:127], v[220:223]
s_add_u32 m0, s46, 24320
v_exp_f32 v227, v227
v_mfma_f32_16x16x32_bf16 v[204:207], a[152:155], a[120:123], v[204:207]
ds_read_b128 a[156:159], v250 offset:27648
v_cvt_pk_bf16_f32 v90, v224, v225
v_mfma_f32_16x16x32_bf16 v[204:207], v[196:199], a[116:119], v[204:207]
ds_read_b128 a[152:155], v249 offset:27648
v_cvt_pk_bf16_f32 v91, v226, v227
v_mfma_f32_16x16x32_bf16 v[204:207], v[192:195], a[112:115], v[204:207]
s_waitcnt vmcnt(8)
v_mul_f32 v200, s41, v200
v_mul_f32 v201, s41, v201
v_mfma_f32_16x16x32_bf16 v[204:207], a[172:175], a[108:111], v[204:207]
buffer_load_dwordx4 v239, s[20:23], s50 offen offset:256 nt lds
v_exp_f32 v200, v200
v_mfma_f32_16x16x32_bf16 v[204:207], a[168:171], a[104:107], v[204:207]
ds_read_b128 a[248:251], v232 offset:32768
v_mul_f32 v202, s41, v202
v_mul_f32 v203, s41, v203
v_mfma_f32_16x16x32_bf16 v[204:207], a[164:167], a[100:103], v[204:207]
ds_read_b128 a[176:179], v233 offset:32768
v_exp_f32 v201, v201
v_mfma_f32_16x16x32_bf16 v[204:207], a[160:163], a[96:99], v[204:207]
s_waitcnt lgkmcnt(4)
v_exp_f32 v202, v202
v_mfma_f32_16x16x32_bf16 v[224:227], a[128:131], a[0:3], v[228:231]
s_add_u32 m0, s39, s60
v_exp_f32 v203, v203
v_mfma_f32_16x16x32_bf16 v[224:227], a[132:135], a[4:7], v[224:227]
ds_read_b128 a[160:163], v249 offset:32768
v_cvt_pk_bf16_f32 v138, v200, v201
v_mfma_f32_16x16x32_bf16 v[224:227], a[136:139], a[8:11], v[224:227]
ds_read_b128 a[164:167], v250 offset:32768
v_cvt_pk_bf16_f32 v139, v202, v203
v_mfma_f32_16x16x32_bf16 v[224:227], a[140:143], a[12:15], v[224:227]
s_waitcnt lgkmcnt(2)
v_mul_f32 v204, s41, v204
v_mul_f32 v205, s41, v205
v_mfma_f32_16x16x32_bf16 v[224:227], a[144:147], a[16:19], v[224:227]
v_exp_f32 v204, v204
v_mfma_f32_16x16x32_bf16 v[224:227], a[148:151], a[20:23], v[224:227]
s_waitcnt lgkmcnt(4)
v_mul_f32 v206, s41, v206
v_mul_f32 v207, s41, v207
v_mfma_f32_16x16x32_bf16 v[224:227], a[152:155], a[24:27], v[224:227]
v_exp_f32 v205, v205
v_mfma_f32_16x16x32_bf16 v[224:227], a[156:159], a[28:31], v[224:227]
v_exp_f32 v206, v206
v_mfma_f32_16x16x32_bf16 v[210:213], a[252:255], v[88:91], v[210:213]
buffer_load_dwordx4 v239, s[16:19], s66 offen lds
v_mfma_f32_16x16x32_bf16 v[200:203], a[156:159], a[60:63], v[252:255]
s_add_u32 m0, s46, 28416
v_exp_f32 v207, v207
v_mfma_f32_16x16x32_bf16 v[200:203], a[152:155], a[56:59], v[200:203]
ds_read_b128 a[168:171], v249 offset:33792
v_cvt_pk_bf16_f32 v186, v204, v205
v_mfma_f32_16x16x32_bf16 v[200:203], a[148:151], a[52:55], v[200:203]
ds_read_b128 a[172:175], v250 offset:33792
v_cvt_pk_bf16_f32 v187, v206, v207
v_mfma_f32_16x16x32_bf16 v[200:203], a[144:147], a[48:51], v[200:203]
buffer_load_dwordx4 v239, s[20:23], s51 offen offset:256 nt lds
v_mul_f32 v224, s41, v224
v_mul_f32 v225, s41, v225
v_mfma_f32_16x16x32_bf16 v[200:203], a[140:143], a[44:47], v[200:203]
s_add_u32 m0, s39, s61
v_exp_f32 v224, v224
v_mfma_f32_16x16x32_bf16 v[200:203], a[136:139], a[40:43], v[200:203]
v_mul_f32 v226, s41, v226
v_mul_f32 v227, s41, v227
v_mfma_f32_16x16x32_bf16 v[200:203], a[132:135], a[36:39], v[200:203]
v_exp_f32 v225, v225
v_mfma_f32_16x16x32_bf16 v[200:203], a[128:131], a[32:35], v[200:203]
v_exp_f32 v226, v226
v_mfma_f32_16x16x32_bf16 v[204:207], a[128:131], a[64:67], v[244:247]
v_exp_f32 v227, v227
v_mfma_f32_16x16x32_bf16 v[204:207], a[132:135], a[68:71], v[204:207]
ds_read_b128 v[192:195], v249 offset:34816
v_cvt_pk_bf16_f32 v44, v224, v225
v_mfma_f32_16x16x32_bf16 v[204:207], a[136:139], a[72:75], v[204:207]
ds_read_b128 v[196:199], v250 offset:34816
v_cvt_pk_bf16_f32 v45, v226, v227
v_mfma_f32_16x16x32_bf16 v[204:207], a[140:143], a[76:79], v[204:207]
v_mul_f32 v200, s41, v200
v_mul_f32 v201, s41, v201
v_mfma_f32_16x16x32_bf16 v[204:207], a[144:147], a[80:83], v[204:207]
v_exp_f32 v200, v200
v_mfma_f32_16x16x32_bf16 v[204:207], a[148:151], a[84:87], v[204:207]
v_mul_f32 v202, s41, v202
v_mul_f32 v203, s41, v203
v_mfma_f32_16x16x32_bf16 v[204:207], a[152:155], a[88:91], v[204:207]
v_exp_f32 v201, v201
v_mfma_f32_16x16x32_bf16 v[204:207], a[156:159], a[92:95], v[204:207]
v_exp_f32 v202, v202
v_mfma_f32_16x16x32_bf16 v[212:215], a[252:255], v[136:139], v[212:215]
buffer_load_dwordx4 v239, s[16:19], s67 offen lds
v_mfma_f32_16x16x32_bf16 v[224:227], a[156:159], a[124:127], v[220:223]
s_add_u32 m0, s46, 32384
v_exp_f32 v203, v203
v_mfma_f32_16x16x32_bf16 v[224:227], a[152:155], a[120:123], v[224:227]
ds_read_b128 a[156:159], v250 offset:35840
v_cvt_pk_bf16_f32 v92, v200, v201
v_mfma_f32_16x16x32_bf16 v[224:227], a[148:151], a[116:119], v[224:227]
ds_read_b128 a[152:155], v249 offset:35840
v_cvt_pk_bf16_f32 v93, v202, v203
v_mfma_f32_16x16x32_bf16 v[224:227], a[144:147], a[112:115], v[224:227]
s_add_u32 s16, s16, 128
s_addc_u32 s17, s17, 0
v_mul_f32 v204, s41, v204
v_mul_f32 v205, s41, v205
v_mfma_f32_16x16x32_bf16 v[224:227], a[140:143], a[108:111], v[224:227]
v_exp_f32 v204, v204
v_mfma_f32_16x16x32_bf16 v[224:227], a[136:139], a[104:107], v[224:227]
v_mul_f32 v206, s41, v206
v_mul_f32 v207, s41, v207
v_mfma_f32_16x16x32_bf16 v[224:227], a[132:135], a[100:103], v[224:227]
v_exp_f32 v205, v205
v_mfma_f32_16x16x32_bf16 v[224:227], a[128:131], a[96:99], v[224:227]
s_waitcnt vmcnt(10) lgkmcnt(0)
v_exp_f32 v206, v206
v_mfma_f32_16x16x32_bf16 v[200:203], a[160:163], a[0:3], v[228:231]
s_barrier
v_exp_f32 v207, v207
v_mfma_f32_16x16x32_bf16 v[200:203], a[164:167], a[4:7], v[200:203]
ds_read_b64_tr_b16 a[128:129], v235 offset:40960
v_cvt_pk_bf16_f32 v140, v204, v205
v_mfma_f32_16x16x32_bf16 v[200:203], a[168:171], a[8:11], v[200:203]
ds_read_b64_tr_b16 a[130:131], v235 offset:43008
v_cvt_pk_bf16_f32 v141, v206, v207
v_mfma_f32_16x16x32_bf16 v[200:203], a[172:175], a[12:15], v[200:203]
v_mul_f32 v224, s41, v224
v_mul_f32 v225, s41, v225
v_mfma_f32_16x16x32_bf16 v[200:203], v[192:195], a[16:19], v[200:203]
v_exp_f32 v224, v224
v_mfma_f32_16x16x32_bf16 v[200:203], v[196:199], a[20:23], v[200:203]
v_mul_f32 v226, s41, v226
v_mul_f32 v227, s41, v227
v_mfma_f32_16x16x32_bf16 v[200:203], a[152:155], a[24:27], v[200:203]
v_exp_f32 v225, v225
v_mfma_f32_16x16x32_bf16 v[200:203], a[156:159], a[28:31], v[200:203]
v_exp_f32 v226, v226
v_mfma_f32_16x16x32_bf16 v[214:217], a[252:255], v[184:187], v[214:217]
ds_read_b64_tr_b16 a[132:133], v235 offset:45056
v_mfma_f32_16x16x32_bf16 v[204:207], a[156:159], a[60:63], v[252:255]
v_exp_f32 v227, v227
v_mfma_f32_16x16x32_bf16 v[204:207], a[152:155], a[56:59], v[204:207]
ds_read_b64_tr_b16 a[134:135], v235 offset:47104
v_cvt_pk_bf16_f32 v188, v224, v225
v_mfma_f32_16x16x32_bf16 v[204:207], v[196:199], a[52:55], v[204:207]
ds_read_b64_tr_b16 a[136:137], v235 offset:49152
v_cvt_pk_bf16_f32 v189, v226, v227
v_mfma_f32_16x16x32_bf16 v[204:207], v[192:195], a[48:51], v[204:207]
v_mul_f32 v200, s41, v200
v_mul_f32 v201, s41, v201
v_mfma_f32_16x16x32_bf16 v[204:207], a[172:175], a[44:47], v[204:207]
v_exp_f32 v200, v200
v_mfma_f32_16x16x32_bf16 v[204:207], a[168:171], a[40:43], v[204:207]
ds_read_b64_tr_b16 a[138:139], v235 offset:51200
v_mul_f32 v202, s41, v202
v_mul_f32 v203, s41, v203
v_mfma_f32_16x16x32_bf16 v[204:207], a[164:167], a[36:39], v[204:207]
v_exp_f32 v201, v201
v_mfma_f32_16x16x32_bf16 v[204:207], a[160:163], a[32:35], v[204:207]
v_exp_f32 v202, v202
v_mfma_f32_16x16x32_bf16 v[224:227], a[160:163], a[64:67], v[244:247]
v_exp_f32 v203, v203
v_mfma_f32_16x16x32_bf16 v[224:227], a[164:167], a[68:71], v[224:227]
ds_read_b64_tr_b16 a[140:141], v235 offset:53248
v_cvt_pk_bf16_f32 v46, v200, v201
v_mfma_f32_16x16x32_bf16 v[224:227], a[168:171], a[72:75], v[224:227]
ds_read_b64_tr_b16 a[142:143], v235 offset:55296
v_cvt_pk_bf16_f32 v47, v202, v203
v_mfma_f32_16x16x32_bf16 v[224:227], a[172:175], a[76:79], v[224:227]
v_mul_f32 v204, s41, v204
v_mul_f32 v205, s41, v205
L_t2:
v_mfma_f32_16x16x32_bf16 v[224:227], v[192:195], a[80:83], v[224:227]
v_exp_f32 v204, v204
v_mfma_f32_16x16x32_bf16 v[224:227], v[196:199], a[84:87], v[224:227]
ds_read_b64_tr_b16 a[144:145], v235 offset:57344
v_mul_f32 v206, s41, v206
v_mul_f32 v207, s41, v207
v_mfma_f32_16x16x32_bf16 v[224:227], a[152:155], a[88:91], v[224:227]
v_exp_f32 v205, v205
v_mfma_f32_16x16x32_bf16 v[224:227], a[156:159], a[92:95], v[224:227]
buffer_load_dwordx4 v239, s[20:23], s50 offen offset:384 nt lds
v_exp_f32 v206, v206
v_mfma_f32_16x16x32_bf16 v[208:211], a[252:255], v[44:47], v[208:211]
ds_read_b64_tr_b16 a[146:147], v235 offset:59392
s_add_u32 m0, s46, 36480
v_mfma_f32_16x16x32_bf16 v[200:203], a[156:159], a[124:127], v[220:223]
v_exp_f32 v207, v207
v_mfma_f32_16x16x32_bf16 v[200:203], a[152:155], a[120:123], v[200:203]
ds_read_b64_tr_b16 a[148:149], v235 offset:61440
v_cvt_pk_bf16_f32 v94, v204, v205
v_mfma_f32_16x16x32_bf16 v[200:203], v[196:199], a[116:119], v[200:203]
ds_read_b64_tr_b16 a[150:151], v235 offset:63488
v_cvt_pk_bf16_f32 v95, v206, v207
v_mfma_f32_16x16x32_bf16 v[200:203], v[192:195], a[112:115], v[200:203]
v_mul_f32 v224, s41, v224
v_mul_f32 v225, s41, v225
v_mfma_f32_16x16x32_bf16 v[200:203], a[172:175], a[108:111], v[200:203]
v_exp_f32 v224, v224
v_mfma_f32_16x16x32_bf16 v[200:203], a[168:171], a[104:107], v[200:203]
v_mul_f32 v226, s41, v226
v_mul_f32 v227, s41, v227
v_mfma_f32_16x16x32_bf16 v[200:203], a[164:167], a[100:103], v[200:203]
v_exp_f32 v225, v225
v_mfma_f32_16x16x32_bf16 v[200:203], a[160:163], a[96:99], v[200:203]
v_exp_f32 v226, v226
v_mfma_f32_16x16x32_bf16 v[210:213], a[252:255], v[92:95], v[210:213]
s_waitcnt lgkmcnt(0)
v_exp_f32 v227, v227
L_p2_1:
v_mfma_f32_16x16x32_bf16 v[192:195], a[148:151], v[20:23], 0
ds_read_b64_tr_b16 a[152:153], v234 offset:0
v_cvt_pk_bf16_f32 v142, v224, v225
v_mfma_f32_16x16x32_bf16 v[192:195], a[144:147], v[16:19], v[192:195]
ds_read_b64_tr_b16 a[154:155], v234 offset:2048
v_cvt_pk_bf16_f32 v143, v226, v227
v_mfma_f32_16x16x32_bf16 v[192:195], a[140:143], v[12:15], v[192:195]
v_mul_f32 v200, s41, v200
v_mul_f32 v201, s41, v201
v_mfma_f32_16x16x32_bf16 v[192:195], a[136:139], v[8:11], v[192:195]
v_exp_f32 v200, v200
v_mfma_f32_16x16x32_bf16 v[192:195], a[132:135], v[4:7], v[192:195]
v_mul_f32 v202, s41, v202
v_mul_f32 v203, s41, v203
v_mfma_f32_16x16x32_bf16 v[192:195], a[128:131], v[0:3], v[192:195]
buffer_load_dwordx4 v239, s[20:23], s51 offen offset:384 nt lds
v_exp_f32 v201, v201
v_mfma_f32_16x16x32_bf16 v[212:215], a[252:255], v[140:143], v[212:215]
s_add_u32 m0, s40, s56
v_exp_f32 v202, v202
v_mfma_f32_16x16x32_bf16 v[196:199], a[128:131], v[48:51], 0
v_exp_f32 v203, v203
v_mfma_f32_16x16x32_bf16 v[196:199], a[132:135], v[52:55], v[196:199]
ds_read_b64_tr_b16 a[156:157], v234 offset:4096
v_cvt_pk_bf16_f32 v190, v200, v201
v_mfma_f32_16x16x32_bf16 v[196:199], a[136:139], v[56:59], v[196:199]
ds_read_b64_tr_b16 a[158:159], v234 offset:6144
v_cvt_pk_bf16_f32 v191, v202, v203
v_mfma_f32_16x16x32_bf16 v[196:199], a[140:143], v[60:63], v[196:199]
ds_read_b64_tr_b16 a[160:161], v234 offset:8192
v_add_f32 v224, v208, v210
v_mfma_f32_16x16x32_bf16 v[196:199], a[144:147], v[64:67], v[196:199]
ds_read_b64_tr_b16 a[162:163], v234 offset:10240
v_add_f32 v224, v224, v212
v_mfma_f32_16x16x32_bf16 v[196:199], a[148:151], v[68:71], v[196:199]
buffer_load_dwordx4 v239, s[92:95], s62 offen lds
v_mfma_f32_16x16x32_bf16 v[214:217], a[252:255], v[188:191], v[214:217]
s_add_u32 m0, s40, s57
v_min3_f32 v225, v208, v210, v212
v_mfma_f32_16x16x32_bf16 v[200:203], a[148:151], v[116:119], 0
ds_read_b64_tr_b16 a[164:165], v234 offset:12288
v_mfma_f32_16x16x32_bf16 v[200:203], a[144:147], v[112:115], v[200:203]
ds_read_b64_tr_b16 a[166:167], v234 offset:14336
v_mfma_f32_16x16x32_bf16 v[200:203], a[140:143], v[108:111], v[200:203]
ds_read_b64_tr_b16 a[168:169], v234 offset:16384
v_add_f32 v224, v224, v214
v_mfma_f32_16x16x32_bf16 v[200:203], a[136:139], v[104:107], v[200:203]
ds_read_b64_tr_b16 a[170:171], v234 offset:18432
v_cmp_ngt_f32 vcc, s42, v224
v_mfma_f32_16x16x32_bf16 v[200:203], a[132:135], v[100:103], v[200:203]
ds_read_b64_tr_b16 a[172:173], v234 offset:20480
v_min_f32 v225, v225, v214
v_mfma_f32_16x16x32_bf16 v[200:203], a[128:131], v[96:99], v[200:203]
ds_read_b64_tr_b16 a[174:175], v234 offset:22528
v_cmp_gt_f32_e64 s[98:99], s100, v225
v_mfma_f32_16x16x32_bf16 v[204:207], a[128:131], v[144:147], 0
buffer_load_dwordx4 v239, s[92:95], s63 offen lds
v_mfma_f32_16x16x32_bf16 v[204:207], a[132:135], v[148:151], v[204:207]
s_or_b64 vcc, vcc, s[98:99]
v_xor_b32 v234, 32, v234
v_xor_b32 v235, 32, v235
v_mfma_f32_16x16x32_bf16 v[204:207], a[136:139], v[152:155], v[204:207]
s_add_u32 m0, s40, s58
v_mfma_f32_16x16x32_bf16 v[204:207], a[140:143], v[156:159], v[204:207]
v_mfma_f32_16x16x32_bf16 v[204:207], a[144:147], v[160:163], v[204:207]
v_mfma_f32_16x16x32_bf16 v[204:207], a[148:151], v[164:167], v[204:207]
s_waitcnt lgkmcnt(0)
s_cbranch_vccnz L_fb1
L_back1:
v_mfma_f32_16x16x32_bf16 v[204:207], a[172:175], v[188:191], v[204:207]
s_waitcnt vmcnt(11)
v_rcp_f32 v247, v214
v_mfma_f32_16x16x32_bf16 v[204:207], a[168:171], v[184:187], v[204:207]
ds_read_b64_tr_b16 a[128:129], v235 offset:40960
v_accvgpr_mov_b32 a0, a216
v_mfma_f32_16x16x32_bf16 v[204:207], a[164:167], v[180:183], v[204:207]
ds_read_b64_tr_b16 a[130:131], v235 offset:43008
v_accvgpr_mov_b32 a1, a217
v_mfma_f32_16x16x32_bf16 v[204:207], a[160:163], v[176:179], v[204:207]
ds_read_b64_tr_b16 a[132:133], v235 offset:45056
v_accvgpr_mov_b32 a2, a218
v_mfma_f32_16x16x32_bf16 v[204:207], a[156:159], v[172:175], v[204:207]
ds_read_b128 a[40:43], v232 offset:16384
v_accvgpr_mov_b32 a3, a219
v_mfma_f32_16x16x32_bf16 v[204:207], a[152:155], v[168:171], v[204:207]
ds_read_b64_tr_b16 a[134:135], v235 offset:47104
v_accvgpr_mov_b32 a4, a220
v_mfma_f32_16x16x32_bf16 v[200:203], a[152:155], v[120:123], v[200:203]
ds_read_b64_tr_b16 a[136:137], v235 offset:49152
v_accvgpr_mov_b32 a5, a221
v_mfma_f32_16x16x32_bf16 v[200:203], a[156:159], v[124:127], v[200:203]
ds_read_b64_tr_b16 a[138:139], v235 offset:51200
v_accvgpr_mov_b32 a6, a222
v_mfma_f32_16x16x32_bf16 v[200:203], a[160:163], v[128:131], v[200:203]
buffer_load_dwordx4 v239, s[92:95], s64 offen lds
v_mfma_f32_16x16x32_bf16 v[200:203], a[164:167], v[132:135], v[200:203]
ds_read_b64_tr_b16 a[140:141], v235 offset:53248
v_max3_f32 v228, |v204|, |v205|, |v206|
v_mfma_f32_16x16x32_bf16 v[200:203], a[168:171], v[136:139], v[200:203]
ds_read_b64_tr_b16 a[142:143], v235 offset:55296
v_mul_f32 v204, v247, v204
v_mfma_f32_16x16x32_bf16 v[200:203], a[172:175], v[140:143], v[200:203]
ds_read_b64_tr_b16 a[144:145], v235 offset:57344
v_mul_f32 v205, v247, v205
v_mfma_f32_16x16x32_bf16 v[196:199], a[172:175], v[92:95], v[196:199]
s_add_u32 m0, s40, s59
v_rcp_f32 v246, v212
v_mfma_f32_16x16x32_bf16 v[196:199], a[168:171], v[88:91], v[196:199]
ds_read_b64_tr_b16 a[146:147], v235 offset:59392
v_rcp_f32 v244, v208
v_rcp_f32 v245, v210
v_mfma_f32_16x16x32_bf16 v[196:199], a[164:167], v[84:87], v[196:199]
ds_read_b64_tr_b16 a[148:149], v235 offset:61440
v_cvt_pk_bf16_f32 v216, v204, v205
v_mfma_f32_16x16x32_bf16 v[196:199], a[160:163], v[80:83], v[196:199]
ds_read_b64_tr_b16 a[150:151], v235 offset:63488
v_mul_f32 v206, v247, v206
v_mfma_f32_16x16x32_bf16 v[196:199], a[156:159], v[76:79], v[196:199]
ds_read_b128 a[44:47], v233 offset:16384
v_max_f32_e64 v228, v228, |v207|
v_mfma_f32_16x16x32_bf16 v[196:199], a[152:155], v[72:75], v[196:199]
buffer_load_dwordx4 v239, s[92:95], s65 offen lds
v_mfma_f32_16x16x32_bf16 v[192:195], a[152:155], v[24:27], v[192:195]
s_add_u32 m0, s46, 16384
v_mul_f32 v207, v247, v207
v_cvt_pk_bf16_f32 v217, v206, v207
v_mfma_f32_16x16x32_bf16 v[192:195], a[156:159], v[28:31], v[192:195]
v_max3_f32 v229, |v200|, |v201|, |v202|
v_mul_f32 v200, v246, v200
v_mfma_f32_16x16x32_bf16 v[192:195], a[160:163], v[32:35], v[192:195]
v_mul_f32 v201, v246, v201
v_cvt_pk_bf16_f32 v208, v200, v201
v_mfma_f32_16x16x32_bf16 v[192:195], a[164:167], v[36:39], v[192:195]
s_waitcnt lgkmcnt(0)
v_mul_f32 v202, v246, v202
v_max_f32_e64 v229, v229, |v203|
v_mfma_f32_16x16x32_bf16 v[192:195], a[168:171], v[40:43], v[192:195]
v_mul_f32 v203, v246, v203
v_cvt_pk_bf16_f32 v209, v202, v203
v_mfma_f32_16x16x32_bf16 v[192:195], a[172:175], v[44:47], v[192:195]
s_waitcnt lgkmcnt(1)
v_min_f32 v228, v228, v229
v_max3_f32 v229, |v196|, |v197|, |v198|
v_mfma_f32_16x16x32_bf16 v[204:207], a[148:151], v[164:167], 0
buffer_load_dwordx4 v239, s[20:23], s52 offen offset:0 nt lds
v_mfma_f32_16x16x32_bf16 v[204:207], a[144:147], v[160:163], v[204:207]
ds_read_b64_tr_b16 a[152:153], v234 offset:0
v_mul_f32 v196, v245, v196
v_mfma_f32_16x16x32_bf16 v[204:207], a[140:143], v[156:159], v[204:207]
ds_read_b64_tr_b16 a[154:155], v234 offset:2048
v_mul_f32 v197, v245, v197
v_mfma_f32_16x16x32_bf16 v[204:207], a[136:139], v[152:155], v[204:207]
ds_read_b64_tr_b16 a[156:157], v234 offset:4096
v_cvt_pk_bf16_f32 v226, v196, v197
v_mfma_f32_16x16x32_bf16 v[204:207], a[132:135], v[148:151], v[204:207]
s_add_u32 m0, s40, s60
v_mul_f32 v198, v245, v198
v_max_f32_e64 v229, v229, |v199|
v_mfma_f32_16x16x32_bf16 v[204:207], a[128:131], v[144:147], v[204:207]
ds_read_b64_tr_b16 a[158:159], v234 offset:6144
v_mul_f32 v199, v245, v199
v_mfma_f32_16x16x32_bf16 v[200:203], a[128:131], v[96:99], 0
ds_read_b64_tr_b16 a[160:161], v234 offset:8192
v_cvt_pk_bf16_f32 v227, v198, v199
v_mfma_f32_16x16x32_bf16 v[200:203], a[132:135], v[100:103], v[200:203]
ds_read_b64_tr_b16 a[162:163], v234 offset:10240
v_min_f32 v228, v228, v229
v_mfma_f32_16x16x32_bf16 v[200:203], a[136:139], v[104:107], v[200:203]
buffer_load_dwordx4 v239, s[92:95], s66 offen lds
v_mfma_f32_16x16x32_bf16 v[200:203], a[140:143], v[108:111], v[200:203]
ds_read_b64_tr_b16 a[164:165], v234 offset:12288
v_max3_f32 v229, |v192|, |v193|, |v194|
v_mfma_f32_16x16x32_bf16 v[200:203], a[144:147], v[112:115], v[200:203]
ds_read_b64_tr_b16 a[166:167], v234 offset:14336
v_mul_f32 v192, v244, v192
v_mfma_f32_16x16x32_bf16 v[200:203], a[148:151], v[116:119], v[200:203]
ds_read_b64_tr_b16 a[168:169], v234 offset:16384
v_mul_f32 v193, v244, v193
v_mfma_f32_16x16x32_bf16 v[196:199], a[148:151], v[68:71], 0
s_add_u32 m0, s46, 20480
v_cvt_pk_bf16_f32 v224, v192, v193
v_mul_f32 v194, v244, v194
v_mfma_f32_16x16x32_bf16 v[196:199], a[144:147], v[64:67], v[196:199]
ds_read_b64_tr_b16 a[170:171], v234 offset:18432
v_max_f32_e64 v229, v229, |v195|
v_mfma_f32_16x16x32_bf16 v[196:199], a[140:143], v[60:63], v[196:199]
ds_read_b64_tr_b16 a[172:173], v234 offset:20480
v_mul_f32 v195, v244, v195
v_mfma_f32_16x16x32_bf16 v[196:199], a[136:139], v[56:59], v[196:199]
ds_read_b64_tr_b16 a[174:175], v234 offset:22528
v_cvt_pk_bf16_f32 v225, v194, v195
v_mfma_f32_16x16x32_bf16 v[196:199], a[132:135], v[52:55], v[196:199]
buffer_load_dwordx4 v239, s[20:23], s53 offen offset:0 nt lds
v_mfma_f32_16x16x32_bf16 v[196:199], a[128:131], v[48:51], v[196:199]
s_add_u32 m0, s40, s61
v_min_f32 v228, v228, v229
v_xor_b32 v234, 0x60, v234
v_mfma_f32_16x16x32_bf16 v[192:195], a[128:131], v[0:3], 0
buffer_load_dwordx4 v239, s[92:95], s67 offen lds
v_mfma_f32_16x16x32_bf16 v[192:195], a[132:135], v[4:7], v[192:195]
ds_write_b64 v240, v[224:225] offset:0
v_mfma_f32_16x16x32_bf16 v[192:195], a[136:139], v[8:11], v[192:195]
ds_write_b64 v240, v[226:227] offset:8192
v_mfma_f32_16x16x32_bf16 v[192:195], a[140:143], v[12:15], v[192:195]
s_add_u32 m0, s69, s56
v_xor_b32 v235, 0x60, v235
v_cmp_gt_f32 vcc, s79, v228
v_mfma_f32_16x16x32_bf16 v[192:195], a[144:147], v[16:19], v[192:195]
s_waitcnt vmcnt(11)
v_mul_f32 v228, 0x40800000, v228
v_accvgpr_mov_b32 a7, a223
v_mfma_f32_16x16x32_bf16 v[192:195], a[148:151], v[20:23], v[192:195]
s_waitcnt lgkmcnt(2)
v_cndmask_b32 v228, 0, v228, vcc
v_mov_b32 v229, v228
v_mfma_f32_16x16x32_bf16 v[192:195], a[172:175], v[44:47], v[192:195]
ds_read_b128 a[48:51], v232 offset:24576
v_mov_b32 v230, v228
v_mfma_f32_16x16x32_bf16 v[192:195], a[168:171], v[40:43], v[192:195]
ds_read_b64_tr_b16 a[128:129], v235 offset:40960
v_mov_b32 v231, v228
v_mfma_f32_16x16x32_bf16 v[192:195], a[164:167], v[36:39], v[192:195]
ds_read_b64_tr_b16 a[130:131], v235 offset:43008
v_mul_f32_e64 v252, -v228, v244
v_mfma_f32_16x16x32_bf16 v[192:195], a[160:163], v[32:35], v[192:195]
ds_read_b64_tr_b16 a[132:133], v235 offset:45056
v_mul_f32_e64 v253, -v228, v245
v_mfma_f32_16x16x32_bf16 v[192:195], a[156:159], v[28:31], v[192:195]
buffer_load_dwordx4 v239, s[16:19], s62 offen lds
v_mfma_f32_16x16x32_bf16 v[192:195], a[152:155], v[24:27], v[192:195]
ds_read_b64_tr_b16 a[134:135], v235 offset:47104
s_add_u32 m0, s69, s57
v_mfma_f32_16x16x32_bf16 v[196:199], a[152:155], v[72:75], v[196:199]
ds_read_b64_tr_b16 a[136:137], v235 offset:49152
v_mul_f32_e64 v254, -v228, v246
v_mfma_f32_16x16x32_bf16 v[196:199], a[156:159], v[76:79], v[196:199]
ds_read_b64_tr_b16 a[138:139], v235 offset:51200
v_mul_f32_e64 v255, -v228, v247
v_mfma_f32_16x16x32_bf16 v[196:199], a[160:163], v[80:83], v[196:199]
ds_read_b128 a[52:55], v233 offset:24576
v_accvgpr_mov_b32 a8, a224
v_mfma_f32_16x16x32_bf16 v[196:199], a[164:167], v[84:87], v[196:199]
ds_read_b64_tr_b16 a[140:141], v235 offset:53248
v_mul_f32 v192, v244, v192
v_mfma_f32_16x16x32_bf16 v[196:199], a[168:171], v[88:91], v[196:199]
ds_read_b64_tr_b16 a[142:143], v235 offset:55296
v_mul_f32 v193, v244, v193
v_mfma_f32_16x16x32_bf16 v[196:199], a[172:175], v[92:95], v[196:199]
ds_read_b64_tr_b16 a[144:145], v235 offset:57344
v_cvt_pk_bf16_f32 v192, v192, v193
v_mfma_f32_16x16x32_bf16 v[200:203], a[172:175], v[140:143], v[200:203]
v_mul_f32 v194, v244, v194
v_mul_f32 v195, v244, v195
v_mfma_f32_16x16x32_bf16 v[200:203], a[168:171], v[136:139], v[200:203]
ds_read_b64_tr_b16 a[146:147], v235 offset:59392
v_cvt_pk_bf16_f32 v193, v194, v195
v_mfma_f32_16x16x32_bf16 v[200:203], a[164:167], v[132:135], v[200:203]
ds_read_b64_tr_b16 a[148:149], v235 offset:61440
s_waitcnt lgkmcnt(5)
v_mfma_f32_16x16x32_bf16 v[200:203], a[160:163], v[128:131], v[200:203]
ds_read_b64_tr_b16 a[150:151], v235 offset:63488
v_mul_f32 v196, v245, v196
v_mfma_f32_16x16x32_bf16 v[200:203], a[156:159], v[124:127], v[200:203]
ds_write_b64 v241, v[192:193] offset:0
v_mfma_f32_16x16x32_bf16 v[200:203], a[152:155], v[120:123], v[200:203]
buffer_load_dwordx4 v239, s[16:19], s63 offen lds
v_mfma_f32_16x16x32_bf16 v[204:207], a[152:155], v[168:171], v[204:207]
s_add_u32 m0, s69, s58
v_mul_f32 v197, v245, v197
v_cvt_pk_bf16_f32 v196, v196, v197
v_mfma_f32_16x16x32_bf16 v[204:207], a[156:159], v[172:175], v[204:207]
v_mul_f32 v198, v245, v198
v_mul_f32 v199, v245, v199
v_mfma_f32_16x16x32_bf16 v[204:207], a[160:163], v[176:179], v[204:207]
s_add_u32 s92, s92, 128
s_addc_u32 s93, s93, 0
v_cvt_pk_bf16_f32 v197, v198, v199
v_mfma_f32_16x16x32_bf16 v[204:207], a[164:167], v[180:183], v[204:207]
ds_write_b64 v241, v[196:197] offset:8192
v_mfma_f32_16x16x32_bf16 v[204:207], a[168:171], v[184:187], v[204:207]
v_mul_f32 v200, v246, v200
v_mul_f32 v201, v246, v201
v_mfma_f32_16x16x32_bf16 v[204:207], a[172:175], v[188:191], v[204:207]
s_waitcnt lgkmcnt(2)
v_cvt_pk_bf16_f32 v210, v200, v201
v_mul_f32 v202, v246, v202
v_mfma_f32_16x16x32_bf16 v[192:195], a[148:151], v[20:23], v[228:231]
v_mul_f32 v203, v246, v203
v_cvt_pk_bf16_f32 v211, v202, v203
v_mfma_f32_16x16x32_bf16 v[192:195], a[144:147], v[16:19], v[192:195]
ds_read_b64_tr_b16 a[152:153], v234 offset:0
v_accvgpr_mov_b32 a9, a225
v_mfma_f32_16x16x32_bf16 v[192:195], a[140:143], v[12:15], v[192:195]
ds_read_b64_tr_b16 a[154:155], v234 offset:2048
v_accvgpr_mov_b32 a10, a226
v_mfma_f32_16x16x32_bf16 v[192:195], a[136:139], v[8:11], v[192:195]
ds_read_b64_tr_b16 a[156:157], v234 offset:4096
v_mul_f32 v204, v247, v204
v_mfma_f32_16x16x32_bf16 v[192:195], a[132:135], v[4:7], v[192:195]
buffer_load_dwordx4 v239, s[16:19], s64 offen lds
v_mfma_f32_16x16x32_bf16 v[192:195], a[128:131], v[0:3], v[192:195]
ds_read_b64_tr_b16 a[158:159], v234 offset:6144
v_mul_f32 v205, v247, v205
v_mfma_f32_16x16x32_bf16 v[196:199], a[128:131], v[48:51], v[228:231]
ds_read_b64_tr_b16 a[160:161], v234 offset:8192
v_cvt_pk_bf16_f32 v218, v204, v205
v_mfma_f32_16x16x32_bf16 v[196:199], a[132:135], v[52:55], v[196:199]
ds_read_b64_tr_b16 a[162:163], v234 offset:10240
v_mul_f32 v206, v247, v206
v_mfma_f32_16x16x32_bf16 v[196:199], a[136:139], v[56:59], v[196:199]
s_add_u32 m0, s46, 24448
v_mul_f32 v207, v247, v207
v_cvt_pk_bf16_f32 v219, v206, v207
v_mfma_f32_16x16x32_bf16 v[196:199], a[140:143], v[60:63], v[196:199]
ds_read_b64_tr_b16 a[164:165], v234 offset:12288
v_accvgpr_mov_b32 a11, a227
v_mfma_f32_16x16x32_bf16 v[196:199], a[144:147], v[64:67], v[196:199]
ds_read_b64_tr_b16 a[166:167], v234 offset:14336
v_accvgpr_mov_b32 a12, a228
v_mfma_f32_16x16x32_bf16 v[196:199], a[148:151], v[68:71], v[196:199]
ds_read_b64_tr_b16 a[168:169], v234 offset:16384
v_accvgpr_mov_b32 a13, a229
v_mfma_f32_16x16x32_bf16 v[200:203], a[148:151], v[116:119], v[228:231]
v_accvgpr_mov_b32 a14, a230
v_accvgpr_mov_b32 a15, a231
v_mfma_f32_16x16x32_bf16 v[200:203], a[144:147], v[112:115], v[200:203]
ds_read_b64_tr_b16 a[170:171], v234 offset:18432
s_waitcnt vmcnt(11)
v_mfma_f32_16x16x32_bf16 v[200:203], a[140:143], v[108:111], v[200:203]
ds_read_b64_tr_b16 a[172:173], v234 offset:20480
v_accvgpr_mov_b32 a16, a232
v_mfma_f32_16x16x32_bf16 v[200:203], a[136:139], v[104:107], v[200:203]
ds_read_b64_tr_b16 a[174:175], v234 offset:22528
v_xor_b32 v234, 32, v234
v_mfma_f32_16x16x32_bf16 v[200:203], a[132:135], v[100:103], v[200:203]
buffer_load_dwordx4 v239, s[20:23], s52 offen offset:128 nt lds
v_mfma_f32_16x16x32_bf16 v[200:203], a[128:131], v[96:99], v[200:203]
ds_read_b128 a[56:59], v232 offset:32768
s_add_u32 m0, s69, s59
v_mfma_f32_16x16x32_bf16 v[204:207], a[128:131], v[144:147], v[228:231]
buffer_load_dwordx4 v239, s[16:19], s65 offen lds
v_mfma_f32_16x16x32_bf16 v[204:207], a[132:135], v[148:151], v[204:207]
ds_read_b128 a[60:63], v233 offset:32768
v_xor_b32 v235, 32, v235
v_mfma_f32_16x16x32_bf16 v[204:207], a[136:139], v[152:155], v[204:207]
s_add_u32 m0, s69, s60
v_accvgpr_mov_b32 a17, a233
v_accvgpr_mov_b32 a18, a234
v_mfma_f32_16x16x32_bf16 v[204:207], a[140:143], v[156:159], v[204:207]
v_accvgpr_mov_b32 a19, a235
v_accvgpr_mov_b32 a20, a236
v_mfma_f32_16x16x32_bf16 v[204:207], a[144:147], v[160:163], v[204:207]
v_accvgpr_mov_b32 a21, a237
v_accvgpr_mov_b32 a22, a238
v_mfma_f32_16x16x32_bf16 v[204:207], a[148:151], v[164:167], v[204:207]
s_waitcnt lgkmcnt(2)
v_accvgpr_mov_b32 a23, a239
v_accvgpr_mov_b32 a24, a240
v_mfma_f32_16x16x32_bf16 v[204:207], a[172:175], v[188:191], v[204:207]
s_waitcnt lgkmcnt(0)
v_accvgpr_mov_b32 a25, a241
v_accvgpr_mov_b32 a26, a242
v_mfma_f32_16x16x32_bf16 v[204:207], a[168:171], v[184:187], v[204:207]
ds_read_b64_tr_b16 a[128:129], v235 offset:40960
v_accvgpr_mov_b32 a27, a243
v_mfma_f32_16x16x32_bf16 v[204:207], a[164:167], v[180:183], v[204:207]
ds_read_b64_tr_b16 a[130:131], v235 offset:43008
v_accvgpr_mov_b32 a28, a244
v_mfma_f32_16x16x32_bf16 v[204:207], a[160:163], v[176:179], v[204:207]
ds_read_b64_tr_b16 a[132:133], v235 offset:45056
v_accvgpr_mov_b32 a29, a245
v_mfma_f32_16x16x32_bf16 v[204:207], a[156:159], v[172:175], v[204:207]
buffer_load_dwordx4 v239, s[16:19], s66 offen lds
v_mfma_f32_16x16x32_bf16 v[204:207], a[152:155], v[168:171], v[204:207]
ds_read_b64_tr_b16 a[134:135], v235 offset:47104
s_add_u32 m0, s46, 28544
v_mfma_f32_16x16x32_bf16 v[200:203], a[152:155], v[120:123], v[200:203]
ds_read_b64_tr_b16 a[136:137], v235 offset:49152
v_accvgpr_mov_b32 a30, a246
v_mfma_f32_16x16x32_bf16 v[200:203], a[156:159], v[124:127], v[200:203]
ds_read_b64_tr_b16 a[138:139], v235 offset:51200
v_accvgpr_mov_b32 a31, a247
v_mfma_f32_16x16x32_bf16 v[200:203], a[160:163], v[128:131], v[200:203]
buffer_load_dwordx4 v239, s[20:23], s53 offen offset:128 nt lds
v_mfma_f32_16x16x32_bf16 v[200:203], a[164:167], v[132:135], v[200:203]
ds_read_b64_tr_b16 a[140:141], v235 offset:53248
v_fma_f32 v204, v204, v247, v255
v_mfma_f32_16x16x32_bf16 v[200:203], a[168:171], v[136:139], v[200:203]
ds_read_b64_tr_b16 a[142:143], v235 offset:55296
v_fma_f32 v205, v205, v247, v255
v_mfma_f32_16x16x32_bf16 v[200:203], a[172:175], v[140:143], v[200:203]
ds_read_b64_tr_b16 a[144:145], v235 offset:57344
v_cvt_pk_bf16_f32 v220, v204, v205
v_mfma_f32_16x16x32_bf16 v[196:199], a[172:175], v[92:95], v[196:199]
s_add_u32 m0, s69, s61
v_fma_f32 v206, v206, v247, v255
v_fma_f32 v207, v207, v247, v255
v_mfma_f32_16x16x32_bf16 v[196:199], a[168:171], v[88:91], v[196:199]
ds_read_b64_tr_b16 a[146:147], v235 offset:59392
v_cvt_pk_bf16_f32 v221, v206, v207
v_mfma_f32_16x16x32_bf16 v[196:199], a[164:167], v[84:87], v[196:199]
ds_read_b64_tr_b16 a[148:149], v235 offset:61440
v_accvgpr_mov_b32 a32, a248
v_mfma_f32_16x16x32_bf16 v[196:199], a[160:163], v[80:83], v[196:199]
ds_read_b64_tr_b16 a[150:151], v235 offset:63488
v_fma_f32 v200, v200, v246, v254
v_mfma_f32_16x16x32_bf16 v[196:199], a[156:159], v[76:79], v[196:199]
buffer_load_dwordx4 v239, s[16:19], s67 offen lds
v_mfma_f32_16x16x32_bf16 v[196:199], a[152:155], v[72:75], v[196:199]
s_add_u32 m0, s75, s56
v_fma_f32 v201, v201, v246, v254
v_cvt_pk_bf16_f32 v212, v200, v201
v_mfma_f32_16x16x32_bf16 v[192:195], a[152:155], v[24:27], v[192:195]
v_fma_f32 v202, v202, v246, v254
v_fma_f32 v203, v203, v246, v254
v_mfma_f32_16x16x32_bf16 v[192:195], a[156:159], v[28:31], v[192:195]
s_add_u32 s16, s16, 128
s_addc_u32 s17, s17, 0
v_cvt_pk_bf16_f32 v213, v202, v203
v_mfma_f32_16x16x32_bf16 v[192:195], a[160:163], v[32:35], v[192:195]
v_accvgpr_mov_b32 a33, a249
v_accvgpr_mov_b32 a34, a250
v_mfma_f32_16x16x32_bf16 v[192:195], a[164:167], v[36:39], v[192:195]
v_fma_f32 v196, v196, v245, v253
v_fma_f32 v197, v197, v245, v253
v_mfma_f32_16x16x32_bf16 v[192:195], a[168:171], v[40:43], v[192:195]
v_cvt_pk_bf16_f32 v196, v196, v197
v_fma_f32 v198, v198, v245, v253
v_mfma_f32_16x16x32_bf16 v[192:195], a[172:175], v[44:47], v[192:195]
s_waitcnt lgkmcnt(0)
v_fma_f32 v199, v199, v245, v253
v_cvt_pk_bf16_f32 v197, v198, v199
v_mfma_f32_16x16x32_bf16 v[204:207], a[148:151], v[164:167], v[228:231]
ds_write_b64 v242, v[196:197] offset:8192
v_mfma_f32_16x16x32_bf16 v[204:207], a[144:147], v[160:163], v[204:207]
ds_read_b64_tr_b16 a[152:153], v234 offset:0
v_accvgpr_mov_b32 a35, a251
v_mfma_f32_16x16x32_bf16 v[204:207], a[140:143], v[156:159], v[204:207]
ds_read_b64_tr_b16 a[154:155], v234 offset:2048
v_accvgpr_mov_b32 a36, a176
v_mfma_f32_16x16x32_bf16 v[204:207], a[136:139], v[152:155], v[204:207]
ds_read_b64_tr_b16 a[156:157], v234 offset:4096
v_fma_f32 v192, v192, v244, v252
v_mfma_f32_16x16x32_bf16 v[204:207], a[132:135], v[148:151], v[204:207]
v_fma_f32 v193, v193, v244, v252
v_cvt_pk_bf16_f32 v192, v192, v193
v_mfma_f32_16x16x32_bf16 v[204:207], a[128:131], v[144:147], v[204:207]
ds_read_b64_tr_b16 a[158:159], v234 offset:6144
v_fma_f32 v194, v194, v244, v252
v_mfma_f32_16x16x32_bf16 v[200:203], a[128:131], v[96:99], v[228:231]
ds_read_b64_tr_b16 a[160:161], v234 offset:8192
v_fma_f32 v195, v195, v244, v252
v_mfma_f32_16x16x32_bf16 v[200:203], a[132:135], v[100:103], v[200:203]
ds_read_b64_tr_b16 a[162:163], v234 offset:10240
v_cvt_pk_bf16_f32 v193, v194, v195
v_mfma_f32_16x16x32_bf16 v[200:203], a[136:139], v[104:107], v[200:203]
v_accvgpr_mov_b32 a37, a177
v_accvgpr_mov_b32 a38, a178
v_mfma_f32_16x16x32_bf16 v[200:203], a[140:143], v[108:111], v[200:203]
ds_read_b64_tr_b16 a[164:165], v234 offset:12288
v_accvgpr_mov_b32 a39, a179
v_mfma_f32_16x16x32_bf16 v[200:203], a[144:147], v[112:115], v[200:203]
ds_read_b64_tr_b16 a[166:167], v234 offset:14336
v_mfma_f32_16x16x32_bf16 v[200:203], a[148:151], v[116:119], v[200:203]
ds_read_b64_tr_b16 a[168:169], v234 offset:16384
v_mfma_f32_16x16x32_bf16 v[196:199], a[148:151], v[68:71], v[228:231]
v_mfma_f32_16x16x32_bf16 v[196:199], a[144:147], v[64:67], v[196:199]
ds_read_b64_tr_b16 a[170:171], v234 offset:18432
v_mfma_f32_16x16x32_bf16 v[196:199], a[140:143], v[60:63], v[196:199]
ds_read_b64_tr_b16 a[172:173], v234 offset:20480
v_mfma_f32_16x16x32_bf16 v[196:199], a[136:139], v[56:59], v[196:199]
ds_read_b64_tr_b16 a[174:175], v234 offset:22528
v_xor_b32 v234, 0x60, v234
v_mfma_f32_16x16x32_bf16 v[196:199], a[132:135], v[52:55], v[196:199]
ds_write_b64 v242, v[192:193] offset:0
v_mfma_f32_16x16x32_bf16 v[196:199], a[128:131], v[48:51], v[196:199]
v_xor_b32 v235, 0x60, v235
v_mfma_f32_16x16x32_bf16 v[192:195], a[128:131], v[0:3], v[228:231]
v_mfma_f32_16x16x32_bf16 v[192:195], a[132:135], v[4:7], v[192:195]
v_mfma_f32_16x16x32_bf16 v[192:195], a[136:139], v[8:11], v[192:195]
v_mfma_f32_16x16x32_bf16 v[192:195], a[140:143], v[12:15], v[192:195]
v_mfma_f32_16x16x32_bf16 v[192:195], a[144:147], v[16:19], v[192:195]
v_mfma_f32_16x16x32_bf16 v[192:195], a[148:151], v[20:23], v[192:195]
s_waitcnt vmcnt(8) lgkmcnt(1)
v_mfma_f32_16x16x32_bf16 v[192:195], a[172:175], v[44:47], v[192:195]
s_barrier
v_mfma_f32_16x16x32_bf16 v[192:195], a[168:171], v[40:43], v[192:195]
ds_read_b64_tr_b16 a[128:129], v234 offset:24576
v_mfma_f32_16x16x32_bf16 v[192:195], a[164:167], v[36:39], v[192:195]
ds_read_b64_tr_b16 a[130:131], v234 offset:26624
s_waitcnt vmcnt(9)
v_mfma_f32_16x16x32_bf16 v[192:195], a[160:163], v[32:35], v[192:195]
ds_read_b64_tr_b16 a[132:133], v234 offset:28672
v_mfma_f32_16x16x32_bf16 v[192:195], a[156:159], v[28:31], v[192:195]
buffer_load_dwordx4 v239, s[92:95], s62 offen lds
v_mfma_f32_16x16x32_bf16 v[192:195], a[152:155], v[24:27], v[192:195]
ds_read_b64_tr_b16 a[134:135], v234 offset:30720
s_add_u32 m0, s46, 32512
v_mfma_f32_16x16x32_bf16 v[196:199], a[152:155], v[72:75], v[196:199]
ds_read_b64_tr_b16 a[136:137], v234 offset:32768
v_mfma_f32_16x16x32_bf16 v[196:199], a[156:159], v[76:79], v[196:199]
ds_read_b64_tr_b16 a[138:139], v234 offset:34816
v_mfma_f32_16x16x32_bf16 v[196:199], a[160:163], v[80:83], v[196:199]
buffer_load_dwordx4 v239, s[20:23], s52 offen offset:256 nt lds
v_mfma_f32_16x16x32_bf16 v[196:199], a[164:167], v[84:87], v[196:199]
ds_read_b64_tr_b16 a[140:141], v234 offset:36864
v_fma_f32 v192, v192, v244, v252
v_mfma_f32_16x16x32_bf16 v[196:199], a[168:171], v[88:91], v[196:199]
ds_read_b64_tr_b16 a[142:143], v234 offset:38912
v_fma_f32 v193, v193, v244, v252
v_mfma_f32_16x16x32_bf16 v[196:199], a[172:175], v[92:95], v[196:199]
ds_read_b64_tr_b16 a[144:145], v234 offset:40960
v_cvt_pk_bf16_f32 v192, v192, v193
v_mfma_f32_16x16x32_bf16 v[200:203], a[172:175], v[140:143], v[200:203]
ds_read_b128 a[64:67], v232 offset:16384
v_fma_f32 v194, v194, v244, v252
v_mfma_f32_16x16x32_bf16 v[200:203], a[168:171], v[136:139], v[200:203]
ds_read_b64_tr_b16 a[146:147], v234 offset:43008
v_fma_f32 v195, v195, v244, v252
v_mfma_f32_16x16x32_bf16 v[200:203], a[164:167], v[132:135], v[200:203]
ds_read_b64_tr_b16 a[148:149], v234 offset:45056
v_cvt_pk_bf16_f32 v193, v194, v195
v_mfma_f32_16x16x32_bf16 v[200:203], a[160:163], v[128:131], v[200:203]
ds_read_b64_tr_b16 a[150:151], v234 offset:47104
s_add_u32 m0, s75, s57
v_mfma_f32_16x16x32_bf16 v[200:203], a[156:159], v[124:127], v[200:203]
ds_write_b64 v243, v[192:193] offset:0
v_mfma_f32_16x16x32_bf16 v[200:203], a[152:155], v[120:123], v[200:203]
buffer_load_dwordx4 v239, s[92:95], s63 offen lds
v_mfma_f32_16x16x32_bf16 v[204:207], a[152:155], v[168:171], v[204:207]
ds_read_b128 a[68:71], v233 offset:16384
v_fma_f32 v196, v196, v245, v253
v_mfma_f32_16x16x32_bf16 v[204:207], a[156:159], v[172:175], v[204:207]
ds_read_b128 a[180:183], v248 offset:0
v_fma_f32 v197, v197, v245, v253
v_mfma_f32_16x16x32_bf16 v[204:207], a[160:163], v[176:179], v[204:207]
ds_read_b128 a[184:187], v248 offset:4096
s_add_u32 m0, s46, 36608
v_mfma_f32_16x16x32_bf16 v[204:207], a[164:167], v[180:183], v[204:207]
buffer_load_dwordx4 v239, s[20:23], s53 offen offset:256 nt lds
v_mfma_f32_16x16x32_bf16 v[204:207], a[168:171], v[184:187], v[204:207]
ds_write_b64 v240, v[208:209] offset:0
v_mfma_f32_16x16x32_bf16 v[204:207], a[172:175], v[188:191], v[204:207]
s_waitcnt lgkmcnt(5)
v_cvt_pk_bf16_f32 v196, v196, v197
v_fma_f32 v198, v198, v245, v253
v_mfma_f32_16x16x32_bf16 v[192:195], a[148:151], v[20:23], v[228:231]
s_add_u32 m0, s75, s58
v_fma_f32 v199, v199, v245, v253
v_cvt_pk_bf16_f32 v197, v198, v199
v_mfma_f32_16x16x32_bf16 v[192:195], a[144:147], v[16:19], v[192:195]
ds_read_b64_tr_b16 a[152:153], v234 offset:49152
v_fma_f32 v200, v200, v246, v254
v_mfma_f32_16x16x32_bf16 v[192:195], a[140:143], v[12:15], v[192:195]
ds_read_b64_tr_b16 a[154:155], v234 offset:51200
v_fma_f32 v201, v201, v246, v254
v_mfma_f32_16x16x32_bf16 v[192:195], a[136:139], v[8:11], v[192:195]
ds_read_b64_tr_b16 a[156:157], v234 offset:53248
v_cvt_pk_bf16_f32 v214, v200, v201
v_mfma_f32_16x16x32_bf16 v[192:195], a[132:135], v[4:7], v[192:195]
ds_write_b64 v243, v[196:197] offset:8192
v_mfma_f32_16x16x32_bf16 v[192:195], a[128:131], v[0:3], v[192:195]
ds_read_b64_tr_b16 a[158:159], v234 offset:55296
v_fma_f32 v202, v202, v246, v254
v_mfma_f32_16x16x32_bf16 v[196:199], a[128:131], v[48:51], v[228:231]
ds_read_b64_tr_b16 a[160:161], v234 offset:57344
v_fma_f32 v203, v203, v246, v254
v_mfma_f32_16x16x32_bf16 v[196:199], a[132:135], v[52:55], v[196:199]
ds_read_b64_tr_b16 a[162:163], v234 offset:59392
v_cvt_pk_bf16_f32 v215, v202, v203
v_mfma_f32_16x16x32_bf16 v[196:199], a[136:139], v[56:59], v[196:199]
buffer_load_dwordx4 v239, s[92:95], s64 offen lds
v_mfma_f32_16x16x32_bf16 v[196:199], a[140:143], v[60:63], v[196:199]
ds_read_b64_tr_b16 a[164:165], v234 offset:61440
v_fma_f32 v204, v204, v247, v255
v_mfma_f32_16x16x32_bf16 v[196:199], a[144:147], v[64:67], v[196:199]
ds_read_b64_tr_b16 a[166:167], v234 offset:63488
v_fma_f32 v205, v205, v247, v255
v_mfma_f32_16x16x32_bf16 v[196:199], a[148:151], v[68:71], v[196:199]
ds_read_b64_tr_b16 a[168:169], v235 offset:8192
v_cvt_pk_bf16_f32 v222, v204, v205
v_mfma_f32_16x16x32_bf16 v[200:203], a[148:151], v[116:119], v[228:231]
ds_read_b128 a[188:191], v248 offset:8192
v_fma_f32 v206, v206, v247, v255
v_mfma_f32_16x16x32_bf16 v[200:203], a[144:147], v[112:115], v[200:203]
ds_read_b64_tr_b16 a[170:171], v235 offset:10240
v_fma_f32 v207, v207, v247, v255
v_mfma_f32_16x16x32_bf16 v[200:203], a[140:143], v[108:111], v[200:203]
ds_read_b64_tr_b16 a[172:173], v235 offset:12288
v_cvt_pk_bf16_f32 v223, v206, v207
v_mfma_f32_16x16x32_bf16 v[200:203], a[136:139], v[104:107], v[200:203]
ds_read_b64_tr_b16 a[174:175], v235 offset:14336
s_waitcnt lgkmcnt(15)
v_mfma_f32_16x16x32_bf16 v[200:203], a[132:135], v[100:103], v[200:203]
buffer_store_dwordx4 a[180:183], v239, s[24:27], s48 offen offset:0 sc1
v_mfma_f32_16x16x32_bf16 v[200:203], a[128:131], v[96:99], v[200:203]
ds_read_b128 a[192:195], v248 offset:12288
v_xor_b32 v234, 32, v234
v_mfma_f32_16x16x32_bf16 v[204:207], a[128:131], v[144:147], v[228:231]
ds_write_b64 v240, v[216:217] offset:8192
v_mfma_f32_16x16x32_bf16 v[204:207], a[132:135], v[148:151], v[204:207]
ds_write_b64 v241, v[210:211] offset:0
v_mfma_f32_16x16x32_bf16 v[204:207], a[136:139], v[152:155], v[204:207]
ds_write_b64 v242, v[212:213] offset:0
v_mfma_f32_16x16x32_bf16 v[204:207], a[140:143], v[156:159], v[204:207]
ds_write_b64 v243, v[214:215] offset:0
v_mfma_f32_16x16x32_bf16 v[204:207], a[144:147], v[160:163], v[204:207]
ds_write_b64 v241, v[218:219] offset:8192
v_mfma_f32_16x16x32_bf16 v[204:207], a[148:151], v[164:167], v[204:207]
s_waitcnt lgkmcnt(6)
s_add_u32 m0, s75, s59
v_xor_b32 v235, 32, v235
v_mfma_f32_16x16x32_bf16 v[204:207], a[172:175], v[188:191], v[204:207]
buffer_load_dwordx4 v239, s[92:95], s65 offen lds
v_mfma_f32_16x16x32_bf16 v[204:207], a[168:171], v[184:187], v[204:207]
ds_read_b64_tr_b16 a[128:129], v234 offset:24576
s_add_u32 m0, s75, s60
v_mfma_f32_16x16x32_bf16 v[204:207], a[164:167], v[180:183], v[204:207]
ds_read_b64_tr_b16 a[130:131], v234 offset:26624
s_waitcnt lgkmcnt(15)
v_mfma_f32_16x16x32_bf16 v[204:207], a[160:163], v[176:179], v[204:207]
ds_read_b64_tr_b16 a[132:133], v234 offset:28672
s_waitcnt lgkmcnt(8)
v_mfma_f32_16x16x32_bf16 v[204:207], a[156:159], v[172:175], v[204:207]
ds_read_b128 a[196:199], v248 offset:0
v_mfma_f32_16x16x32_bf16 v[204:207], a[152:155], v[168:171], v[204:207]
ds_read_b64_tr_b16 a[134:135], v234 offset:30720
v_mfma_f32_16x16x32_bf16 v[200:203], a[152:155], v[120:123], v[200:203]
ds_read_b64_tr_b16 a[136:137], v234 offset:32768
v_mfma_f32_16x16x32_bf16 v[200:203], a[156:159], v[124:127], v[200:203]
ds_read_b64_tr_b16 a[138:139], v234 offset:34816
v_mfma_f32_16x16x32_bf16 v[200:203], a[160:163], v[128:131], v[200:203]
ds_read_b128 a[200:203], v248 offset:4096
v_mfma_f32_16x16x32_bf16 v[200:203], a[164:167], v[132:135], v[200:203]
ds_read_b64_tr_b16 a[140:141], v234 offset:36864
v_fma_f32 v204, v204, v247, v255
v_mfma_f32_16x16x32_bf16 v[200:203], a[168:171], v[136:139], v[200:203]
ds_read_b64_tr_b16 a[142:143], v234 offset:38912
v_fma_f32 v205, v205, v247, v255
v_mfma_f32_16x16x32_bf16 v[200:203], a[172:175], v[140:143], v[200:203]
ds_read_b64_tr_b16 a[144:145], v234 offset:40960
v_cvt_pk_bf16_f32 v216, v204, v205
v_mfma_f32_16x16x32_bf16 v[196:199], a[172:175], v[92:95], v[196:199]
buffer_load_dwordx4 v239, s[92:95], s66 offen lds
v_mfma_f32_16x16x32_bf16 v[196:199], a[168:171], v[88:91], v[196:199]
ds_read_b64_tr_b16 a[146:147], v234 offset:43008
v_fma_f32 v206, v206, v247, v255
v_mfma_f32_16x16x32_bf16 v[196:199], a[164:167], v[84:87], v[196:199]
ds_read_b64_tr_b16 a[148:149], v234 offset:45056
v_fma_f32 v207, v207, v247, v255
v_mfma_f32_16x16x32_bf16 v[196:199], a[160:163], v[80:83], v[196:199]
ds_read_b64_tr_b16 a[150:151], v234 offset:47104
s_add_u32 m0, s46, 16000
v_mfma_f32_16x16x32_bf16 v[196:199], a[156:159], v[76:79], v[196:199]
ds_write_b64 v242, v[220:221] offset:8192
v_mfma_f32_16x16x32_bf16 v[196:199], a[152:155], v[72:75], v[196:199]
buffer_load_dwordx4 v239, s[20:23], s52 offen offset:384 nt lds
v_mfma_f32_16x16x32_bf16 v[192:195], a[152:155], v[24:27], v[192:195]
ds_write_b64 v243, v[222:223] offset:8192
v_mfma_f32_16x16x32_bf16 v[192:195], a[156:159], v[28:31], v[192:195]
s_add_u32 m0, s75, s61
v_cvt_pk_bf16_f32 v217, v206, v207
v_fma_f32 v200, v200, v246, v254
v_mfma_f32_16x16x32_bf16 v[192:195], a[160:163], v[32:35], v[192:195]
s_waitcnt vmcnt(10)
v_fma_f32 v201, v201, v246, v254
v_cvt_pk_bf16_f32 v208, v200, v201
v_mfma_f32_16x16x32_bf16 v[192:195], a[164:167], v[36:39], v[192:195]
ds_read_b128 a[204:207], v248 offset:8192
v_fma_f32 v202, v202, v246, v254
v_mfma_f32_16x16x32_bf16 v[192:195], a[168:171], v[40:43], v[192:195]
ds_read_b128 a[208:211], v248 offset:12288
v_fma_f32 v203, v203, v246, v254
v_mfma_f32_16x16x32_bf16 v[192:195], a[172:175], v[44:47], v[192:195]
s_waitcnt lgkmcnt(4)
v_cvt_pk_bf16_f32 v209, v202, v203
v_fma_f32 v196, v196, v245, v253
v_mfma_f32_16x16x32_bf16 v[204:207], a[148:151], v[164:167], v[228:231]
ds_read_b128 a[72:75], v232 offset:24576
v_fma_f32 v197, v197, v245, v253
v_mfma_f32_16x16x32_bf16 v[204:207], a[144:147], v[160:163], v[204:207]
ds_read_b64_tr_b16 a[152:153], v234 offset:49152
v_cvt_pk_bf16_f32 v226, v196, v197
v_mfma_f32_16x16x32_bf16 v[204:207], a[140:143], v[156:159], v[204:207]
ds_read_b64_tr_b16 a[154:155], v234 offset:51200
v_fma_f32 v198, v198, v245, v253
v_mfma_f32_16x16x32_bf16 v[204:207], a[136:139], v[152:155], v[204:207]
ds_read_b64_tr_b16 a[156:157], v234 offset:53248
v_fma_f32 v199, v199, v245, v253
v_mfma_f32_16x16x32_bf16 v[204:207], a[132:135], v[148:151], v[204:207]
buffer_load_dwordx4 v239, s[92:95], s67 offen lds
v_mfma_f32_16x16x32_bf16 v[204:207], a[128:131], v[144:147], v[204:207]
ds_read_b64_tr_b16 a[158:159], v234 offset:55296
v_cvt_pk_bf16_f32 v227, v198, v199
v_mfma_f32_16x16x32_bf16 v[200:203], a[128:131], v[96:99], v[228:231]
ds_read_b64_tr_b16 a[160:161], v234 offset:57344
v_fma_f32 v192, v192, v244, v252
v_mfma_f32_16x16x32_bf16 v[200:203], a[132:135], v[100:103], v[200:203]
ds_read_b64_tr_b16 a[162:163], v234 offset:59392
v_fma_f32 v193, v193, v244, v252
v_mfma_f32_16x16x32_bf16 v[200:203], a[136:139], v[104:107], v[200:203]
ds_read_b128 a[76:79], v233 offset:24576
s_add_u32 m0, s46, 20096
v_mfma_f32_16x16x32_bf16 v[200:203], a[140:143], v[108:111], v[200:203]
ds_read_b64_tr_b16 a[164:165], v234 offset:61440
v_cvt_pk_bf16_f32 v224, v192, v193
v_mfma_f32_16x16x32_bf16 v[200:203], a[144:147], v[112:115], v[200:203]
ds_read_b64_tr_b16 a[166:167], v234 offset:63488
v_fma_f32 v194, v194, v244, v252
v_mfma_f32_16x16x32_bf16 v[200:203], a[148:151], v[116:119], v[200:203]
ds_read_b64_tr_b16 a[168:169], v235 offset:8192
v_fma_f32 v195, v195, v244, v252
v_mfma_f32_16x16x32_bf16 v[196:199], a[148:151], v[68:71], v[228:231]
buffer_load_dwordx4 v239, s[20:23], s53 offen offset:384 nt lds
v_mfma_f32_16x16x32_bf16 v[196:199], a[144:147], v[64:67], v[196:199]
ds_read_b64_tr_b16 a[170:171], v235 offset:10240
v_cvt_pk_bf16_f32 v225, v194, v195
v_mfma_f32_16x16x32_bf16 v[196:199], a[140:143], v[60:63], v[196:199]
ds_read_b64_tr_b16 a[172:173], v235 offset:12288
s_add_u32 m0, s38, s56
v_mfma_f32_16x16x32_bf16 v[196:199], a[136:139], v[56:59], v[196:199]
ds_read_b64_tr_b16 a[174:175], v235 offset:14336
v_xor_b32 v234, 0x60, v234
v_mfma_f32_16x16x32_bf16 v[196:199], a[132:135], v[52:55], v[196:199]
buffer_load_dwordx4 v239, s[16:19], s62 offen lds
v_mfma_f32_16x16x32_bf16 v[196:199], a[128:131], v[48:51], v[196:199]
ds_write_b64 v240, v[226:227] offset:8192
v_mfma_f32_16x16x32_bf16 v[192:195], a[128:131], v[0:3], v[228:231]
ds_write_b64 v240, v[224:225] offset:0
v_mfma_f32_16x16x32_bf16 v[192:195], a[132:135], v[4:7], v[192:195]
s_add_u32 m0, s38, s57
s_waitcnt lgkmcnt(8)
v_xor_b32 v235, 0x60, v235
v_mfma_f32_16x16x32_bf16 v[192:195], a[136:139], v[8:11], v[192:195]
s_add_u32 s92, s92, 128
s_addc_u32 s93, s93, 0
s_waitcnt lgkmcnt(15)
v_mfma_f32_16x16x32_bf16 v[192:195], a[140:143], v[12:15], v[192:195]
s_waitcnt lgkmcnt(15)
v_mfma_f32_16x16x32_bf16 v[192:195], a[144:147], v[16:19], v[192:195]
v_mfma_f32_16x16x32_bf16 v[192:195], a[148:151], v[20:23], v[192:195]
s_waitcnt lgkmcnt(2)
v_mfma_f32_16x16x32_bf16 v[192:195], a[172:175], v[44:47], v[192:195]
v_mfma_f32_16x16x32_bf16 v[192:195], a[168:171], v[40:43], v[192:195]
ds_read_b64_tr_b16 a[128:129], v234 offset:24576
v_mfma_f32_16x16x32_bf16 v[192:195], a[164:167], v[36:39], v[192:195]
ds_read_b64_tr_b16 a[130:131], v234 offset:26624
v_mfma_f32_16x16x32_bf16 v[192:195], a[160:163], v[32:35], v[192:195]
ds_read_b64_tr_b16 a[132:133], v234 offset:28672
v_mfma_f32_16x16x32_bf16 v[192:195], a[156:159], v[28:31], v[192:195]
v_mfma_f32_16x16x32_bf16 v[192:195], a[152:155], v[24:27], v[192:195]
ds_read_b64_tr_b16 a[134:135], v234 offset:30720
v_mfma_f32_16x16x32_bf16 v[196:199], a[152:155], v[72:75], v[196:199]
ds_read_b64_tr_b16 a[136:137], v234 offset:32768
v_mfma_f32_16x16x32_bf16 v[196:199], a[156:159], v[76:79], v[196:199]
ds_read_b64_tr_b16 a[138:139], v234 offset:34816
v_mfma_f32_16x16x32_bf16 v[196:199], a[160:163], v[80:83], v[196:199]
buffer_load_dwordx4 v239, s[16:19], s63 offen lds
v_mfma_f32_16x16x32_bf16 v[196:199], a[164:167], v[84:87], v[196:199]
ds_read_b64_tr_b16 a[140:141], v234 offset:36864
v_fma_f32 v192, v192, v244, v252
v_mfma_f32_16x16x32_bf16 v[196:199], a[168:171], v[88:91], v[196:199]
ds_read_b64_tr_b16 a[142:143], v234 offset:38912
v_fma_f32 v193, v193, v244, v252
v_mfma_f32_16x16x32_bf16 v[196:199], a[172:175], v[92:95], v[196:199]
ds_read_b64_tr_b16 a[144:145], v234 offset:40960
v_cvt_pk_bf16_f32 v192, v192, v193
v_mfma_f32_16x16x32_bf16 v[200:203], a[172:175], v[140:143], v[200:203]
s_add_u32 m0, s38, s58
v_fma_f32 v194, v194, v244, v252
v_fma_f32 v195, v195, v244, v252
v_mfma_f32_16x16x32_bf16 v[200:203], a[168:171], v[136:139], v[200:203]
ds_read_b64_tr_b16 a[146:147], v234 offset:43008
v_cvt_pk_bf16_f32 v193, v194, v195
v_mfma_f32_16x16x32_bf16 v[200:203], a[164:167], v[132:135], v[200:203]
ds_read_b64_tr_b16 a[148:149], v234 offset:45056
v_mfma_f32_16x16x32_bf16 v[200:203], a[160:163], v[128:131], v[200:203]
ds_read_b64_tr_b16 a[150:151], v234 offset:47104
v_fma_f32 v196, v196, v245, v253
v_mfma_f32_16x16x32_bf16 v[200:203], a[156:159], v[124:127], v[200:203]
ds_write_b64 v241, v[192:193] offset:0
v_mfma_f32_16x16x32_bf16 v[200:203], a[152:155], v[120:123], v[200:203]
v_fma_f32 v197, v197, v245, v253
v_cvt_pk_bf16_f32 v196, v196, v197
v_mfma_f32_16x16x32_bf16 v[204:207], a[152:155], v[168:171], v[204:207]
v_fma_f32 v198, v198, v245, v253
v_fma_f32 v199, v199, v245, v253
v_mfma_f32_16x16x32_bf16 v[204:207], a[156:159], v[172:175], v[204:207]
v_cvt_pk_bf16_f32 v197, v198, v199
v_mfma_f32_16x16x32_bf16 v[204:207], a[160:163], v[176:179], v[204:207]
ds_write_b64 v241, v[196:197] offset:8192
v_mfma_f32_16x16x32_bf16 v[204:207], a[164:167], v[180:183], v[204:207]
buffer_load_dwordx4 v239, s[16:19], s64 offen lds
v_mfma_f32_16x16x32_bf16 v[204:207], a[168:171], v[184:187], v[204:207]
s_add_u32 m0, s46, 24576
v_fma_f32 v200, v200, v246, v254
v_fma_f32 v201, v201, v246, v254
v_mfma_f32_16x16x32_bf16 v[204:207], a[172:175], v[188:191], v[204:207]
s_waitcnt lgkmcnt(2)
v_cvt_pk_bf16_f32 v210, v200, v201
v_fma_f32 v202, v202, v246, v254
v_mfma_f32_16x16x32_bf16 v[192:195], a[148:151], v[20:23], v[228:231]
v_fma_f32 v203, v203, v246, v254
v_cvt_pk_bf16_f32 v211, v202, v203
v_mfma_f32_16x16x32_bf16 v[192:195], a[144:147], v[16:19], v[192:195]
ds_read_b64_tr_b16 a[152:153], v234 offset:49152
v_mfma_f32_16x16x32_bf16 v[192:195], a[140:143], v[12:15], v[192:195]
ds_read_b64_tr_b16 a[154:155], v234 offset:51200
v_mfma_f32_16x16x32_bf16 v[192:195], a[136:139], v[8:11], v[192:195]
ds_read_b64_tr_b16 a[156:157], v234 offset:53248
v_fma_f32 v204, v204, v247, v255
v_mfma_f32_16x16x32_bf16 v[192:195], a[132:135], v[4:7], v[192:195]
v_fma_f32 v205, v205, v247, v255
v_cvt_pk_bf16_f32 v218, v204, v205
v_mfma_f32_16x16x32_bf16 v[192:195], a[128:131], v[0:3], v[192:195]
ds_read_b64_tr_b16 a[158:159], v234 offset:55296
v_fma_f32 v206, v206, v247, v255
v_mfma_f32_16x16x32_bf16 v[196:199], a[128:131], v[48:51], v[228:231]
ds_read_b64_tr_b16 a[160:161], v234 offset:57344
v_fma_f32 v207, v207, v247, v255
v_mfma_f32_16x16x32_bf16 v[196:199], a[132:135], v[52:55], v[196:199]
ds_read_b64_tr_b16 a[162:163], v234 offset:59392
v_cvt_pk_bf16_f32 v219, v206, v207
v_mfma_f32_16x16x32_bf16 v[196:199], a[136:139], v[56:59], v[196:199]
buffer_load_dwordx4 v239, s[20:23], s54 offen offset:0 nt lds
v_mfma_f32_16x16x32_bf16 v[196:199], a[140:143], v[60:63], v[196:199]
ds_read_b64_tr_b16 a[164:165], v234 offset:61440
s_add_u32 m0, s38, s59
v_mfma_f32_16x16x32_bf16 v[196:199], a[144:147], v[64:67], v[196:199]
ds_read_b64_tr_b16 a[166:167], v234 offset:63488
s_waitcnt vmcnt(11)
v_mfma_f32_16x16x32_bf16 v[196:199], a[148:151], v[68:71], v[196:199]
ds_read_b64_tr_b16 a[168:169], v235 offset:8192
v_mfma_f32_16x16x32_bf16 v[200:203], a[148:151], v[116:119], v[228:231]
buffer_load_dwordx4 v239, s[16:19], s65 offen lds
v_mfma_f32_16x16x32_bf16 v[200:203], a[144:147], v[112:115], v[200:203]
ds_read_b64_tr_b16 a[170:171], v235 offset:10240
s_add_u32 m0, s46, 28672
v_mfma_f32_16x16x32_bf16 v[200:203], a[140:143], v[108:111], v[200:203]
ds_read_b64_tr_b16 a[172:173], v235 offset:12288
v_mfma_f32_16x16x32_bf16 v[200:203], a[136:139], v[104:107], v[200:203]
ds_read_b64_tr_b16 a[174:175], v235 offset:14336
v_xor_b32 v234, 32, v234
v_mfma_f32_16x16x32_bf16 v[200:203], a[132:135], v[100:103], v[200:203]
ds_read_b128 a[80:83], v232 offset:32768
v_xor_b32 v235, 32, v235
v_mfma_f32_16x16x32_bf16 v[200:203], a[128:131], v[96:99], v[200:203]
ds_read_b128 a[84:87], v233 offset:32768
v_mfma_f32_16x16x32_bf16 v[204:207], a[128:131], v[144:147], v[228:231]
v_mfma_f32_16x16x32_bf16 v[204:207], a[132:135], v[148:151], v[204:207]
v_mfma_f32_16x16x32_bf16 v[204:207], a[136:139], v[152:155], v[204:207]
v_mfma_f32_16x16x32_bf16 v[204:207], a[140:143], v[156:159], v[204:207]
v_mfma_f32_16x16x32_bf16 v[204:207], a[144:147], v[160:163], v[204:207]
s_waitcnt lgkmcnt(0)
v_mfma_f32_16x16x32_bf16 v[204:207], a[148:151], v[164:167], v[204:207]
s_waitcnt lgkmcnt(2)
v_mfma_f32_16x16x32_bf16 v[204:207], a[172:175], v[188:191], v[204:207]
buffer_load_dwordx4 v239, s[20:23], s55 offen offset:0 nt lds
v_mfma_f32_16x16x32_bf16 v[204:207], a[168:171], v[184:187], v[204:207]
ds_read_b64_tr_b16 a[128:129], v234 offset:24576
s_add_u32 m0, s38, s60
v_mfma_f32_16x16x32_bf16 v[204:207], a[164:167], v[180:183], v[204:207]
ds_read_b64_tr_b16 a[130:131], v234 offset:26624
v_mfma_f32_16x16x32_bf16 v[204:207], a[160:163], v[176:179], v[204:207]
ds_read_b64_tr_b16 a[132:133], v234 offset:28672
v_mfma_f32_16x16x32_bf16 v[204:207], a[156:159], v[172:175], v[204:207]
buffer_load_dwordx4 v239, s[16:19], s66 offen lds
v_mfma_f32_16x16x32_bf16 v[204:207], a[152:155], v[168:171], v[204:207]
ds_read_b64_tr_b16 a[134:135], v234 offset:30720
s_add_u32 m0, s38, s61
v_mfma_f32_16x16x32_bf16 v[200:203], a[152:155], v[120:123], v[200:203]
ds_read_b64_tr_b16 a[136:137], v234 offset:32768
v_mfma_f32_16x16x32_bf16 v[200:203], a[156:159], v[124:127], v[200:203]
ds_read_b64_tr_b16 a[138:139], v234 offset:34816
v_mfma_f32_16x16x32_bf16 v[200:203], a[160:163], v[128:131], v[200:203]
v_mfma_f32_16x16x32_bf16 v[200:203], a[164:167], v[132:135], v[200:203]
ds_read_b64_tr_b16 a[140:141], v234 offset:36864
v_fma_f32 v204, v204, v247, v255
v_mfma_f32_16x16x32_bf16 v[200:203], a[168:171], v[136:139], v[200:203]
ds_read_b64_tr_b16 a[142:143], v234 offset:38912
v_fma_f32 v205, v205, v247, v255
v_mfma_f32_16x16x32_bf16 v[200:203], a[172:175], v[140:143], v[200:203]
ds_read_b64_tr_b16 a[144:145], v234 offset:40960
v_cvt_pk_bf16_f32 v220, v204, v205
v_mfma_f32_16x16x32_bf16 v[196:199], a[172:175], v[92:95], v[196:199]
v_fma_f32 v206, v206, v247, v255
v_fma_f32 v207, v207, v247, v255
v_mfma_f32_16x16x32_bf16 v[196:199], a[168:171], v[88:91], v[196:199]
ds_read_b64_tr_b16 a[146:147], v234 offset:43008
v_cvt_pk_bf16_f32 v221, v206, v207
v_mfma_f32_16x16x32_bf16 v[196:199], a[164:167], v[84:87], v[196:199]
ds_read_b64_tr_b16 a[148:149], v234 offset:45056
v_mfma_f32_16x16x32_bf16 v[196:199], a[160:163], v[80:83], v[196:199]
ds_read_b64_tr_b16 a[150:151], v234 offset:47104
v_fma_f32 v200, v200, v246, v254
v_mfma_f32_16x16x32_bf16 v[196:199], a[156:159], v[76:79], v[196:199]
buffer_load_dwordx4 v239, s[16:19], s67 offen lds
v_mfma_f32_16x16x32_bf16 v[196:199], a[152:155], v[72:75], v[196:199]
s_add_u32 m0, s39, s56
v_fma_f32 v201, v201, v246, v254
v_cvt_pk_bf16_f32 v212, v200, v201
v_mfma_f32_16x16x32_bf16 v[192:195], a[152:155], v[24:27], v[192:195]
s_mov_b32 s18, 24576
v_fma_f32 v202, v202, v246, v254
v_fma_f32 v203, v203, v246, v254
v_mfma_f32_16x16x32_bf16 v[192:195], a[156:159], v[28:31], v[192:195]
s_add_u32 s16, s70, s37
s_addc_u32 s17, s71, 0
v_cvt_pk_bf16_f32 v213, v202, v203
v_mfma_f32_16x16x32_bf16 v[192:195], a[160:163], v[32:35], v[192:195]
v_mfma_f32_16x16x32_bf16 v[192:195], a[164:167], v[36:39], v[192:195]
v_fma_f32 v196, v196, v245, v253
v_fma_f32 v197, v197, v245, v253
v_mfma_f32_16x16x32_bf16 v[192:195], a[168:171], v[40:43], v[192:195]
v_cvt_pk_bf16_f32 v196, v196, v197
v_fma_f32 v198, v198, v245, v253
v_mfma_f32_16x16x32_bf16 v[192:195], a[172:175], v[44:47], v[192:195]
s_waitcnt lgkmcnt(0)
v_fma_f32 v199, v199, v245, v253
v_cvt_pk_bf16_f32 v197, v198, v199
v_mfma_f32_16x16x32_bf16 v[204:207], a[148:151], v[164:167], v[228:231]
ds_write_b64 v242, v[196:197] offset:8192
v_mfma_f32_16x16x32_bf16 v[204:207], a[144:147], v[160:163], v[204:207]
ds_read_b64_tr_b16 a[152:153], v234 offset:49152
v_mfma_f32_16x16x32_bf16 v[204:207], a[140:143], v[156:159], v[204:207]
ds_read_b64_tr_b16 a[154:155], v234 offset:51200
v_mfma_f32_16x16x32_bf16 v[204:207], a[136:139], v[152:155], v[204:207]
ds_read_b64_tr_b16 a[156:157], v234 offset:53248
v_fma_f32 v192, v192, v244, v252
v_mfma_f32_16x16x32_bf16 v[204:207], a[132:135], v[148:151], v[204:207]
v_fma_f32 v193, v193, v244, v252
v_cvt_pk_bf16_f32 v192, v192, v193
v_mfma_f32_16x16x32_bf16 v[204:207], a[128:131], v[144:147], v[204:207]
ds_read_b64_tr_b16 a[158:159], v234 offset:55296
v_fma_f32 v194, v194, v244, v252
v_mfma_f32_16x16x32_bf16 v[200:203], a[128:131], v[96:99], v[228:231]
ds_read_b64_tr_b16 a[160:161], v234 offset:57344
v_fma_f32 v195, v195, v244, v252
v_mfma_f32_16x16x32_bf16 v[200:203], a[132:135], v[100:103], v[200:203]
ds_read_b64_tr_b16 a[162:163], v234 offset:59392
v_cvt_pk_bf16_f32 v193, v194, v195
v_mfma_f32_16x16x32_bf16 v[200:203], a[136:139], v[104:107], v[200:203]
v_mfma_f32_16x16x32_bf16 v[200:203], a[140:143], v[108:111], v[200:203]
ds_read_b64_tr_b16 a[164:165], v234 offset:61440
v_mfma_f32_16x16x32_bf16 v[200:203], a[144:147], v[112:115], v[200:203]
ds_read_b64_tr_b16 a[166:167], v234 offset:63488
v_mfma_f32_16x16x32_bf16 v[200:203], a[148:151], v[116:119], v[200:203]
ds_read_b64_tr_b16 a[168:169], v235 offset:8192
v_mfma_f32_16x16x32_bf16 v[196:199], a[148:151], v[68:71], v[228:231]
v_mfma_f32_16x16x32_bf16 v[196:199], a[144:147], v[64:67], v[196:199]
ds_read_b64_tr_b16 a[170:171], v235 offset:10240
v_mfma_f32_16x16x32_bf16 v[196:199], a[140:143], v[60:63], v[196:199]
ds_read_b64_tr_b16 a[172:173], v235 offset:12288
v_mfma_f32_16x16x32_bf16 v[196:199], a[136:139], v[56:59], v[196:199]
ds_read_b64_tr_b16 a[174:175], v235 offset:14336
v_xor_b32 v234, 0x60, v234
v_mfma_f32_16x16x32_bf16 v[196:199], a[132:135], v[52:55], v[196:199]
ds_write_b64 v242, v[192:193] offset:0
v_mfma_f32_16x16x32_bf16 v[196:199], a[128:131], v[48:51], v[196:199]
v_xor_b32 v235, 0x60, v235
v_mfma_f32_16x16x32_bf16 v[192:195], a[128:131], v[0:3], v[228:231]
v_mfma_f32_16x16x32_bf16 v[192:195], a[132:135], v[4:7], v[192:195]
s_waitcnt vmcnt(8)
v_mfma_f32_16x16x32_bf16 v[192:195], a[136:139], v[8:11], v[192:195]
ds_read_b128 a[88:91], v232 offset:16384
v_mfma_f32_16x16x32_bf16 v[192:195], a[140:143], v[12:15], v[192:195]
ds_read_b128 a[92:95], v233 offset:16384
v_mfma_f32_16x16x32_bf16 v[192:195], a[144:147], v[16:19], v[192:195]
v_mfma_f32_16x16x32_bf16 v[192:195], a[148:151], v[20:23], v[192:195]
s_waitcnt vmcnt(9) lgkmcnt(3)
v_mfma_f32_16x16x32_bf16 v[192:195], a[172:175], v[44:47], v[192:195]
s_barrier
v_mfma_f32_16x16x32_bf16 v[192:195], a[168:171], v[40:43], v[192:195]
ds_read_b64_tr_b16 a[128:129], v235 offset:16384
v_mfma_f32_16x16x32_bf16 v[192:195], a[164:167], v[36:39], v[192:195]
ds_read_b64_tr_b16 a[130:131], v235 offset:18432
s_waitcnt lgkmcnt(2)
v_mfma_f32_16x16x32_bf16 v[192:195], a[160:163], v[32:35], v[192:195]
ds_read_b64_tr_b16 a[132:133], v235 offset:20480
v_mfma_f32_16x16x32_bf16 v[192:195], a[156:159], v[28:31], v[192:195]
buffer_load_dwordx4 v239, s[92:95], s62 offen lds
v_mfma_f32_16x16x32_bf16 v[192:195], a[152:155], v[24:27], v[192:195]
ds_read_b64_tr_b16 a[134:135], v235 offset:22528
s_add_u32 m0, s46, 32640
v_mfma_f32_16x16x32_bf16 v[196:199], a[152:155], v[72:75], v[196:199]
ds_read_b64_tr_b16 a[136:137], v235 offset:24576
v_mfma_f32_16x16x32_bf16 v[196:199], a[156:159], v[76:79], v[196:199]
ds_read_b64_tr_b16 a[138:139], v235 offset:26624
v_mfma_f32_16x16x32_bf16 v[196:199], a[160:163], v[80:83], v[196:199]
v_mfma_f32_16x16x32_bf16 v[196:199], a[164:167], v[84:87], v[196:199]
ds_read_b64_tr_b16 a[140:141], v235 offset:28672
v_fma_f32 v192, v192, v244, v252
v_mfma_f32_16x16x32_bf16 v[196:199], a[168:171], v[88:91], v[196:199]
ds_read_b64_tr_b16 a[142:143], v235 offset:30720
v_fma_f32 v193, v193, v244, v252
v_mfma_f32_16x16x32_bf16 v[196:199], a[172:175], v[92:95], v[196:199]
ds_read_b64_tr_b16 a[144:145], v235 offset:32768
v_cvt_pk_bf16_f32 v192, v192, v193
v_mfma_f32_16x16x32_bf16 v[200:203], a[172:175], v[140:143], v[200:203]
buffer_load_dwordx4 v239, s[20:23], s54 offen offset:128 nt lds
v_mfma_f32_16x16x32_bf16 v[200:203], a[168:171], v[136:139], v[200:203]
ds_read_b64_tr_b16 a[146:147], v235 offset:34816
v_fma_f32 v194, v194, v244, v252
v_mfma_f32_16x16x32_bf16 v[200:203], a[164:167], v[132:135], v[200:203]
ds_read_b64_tr_b16 a[148:149], v235 offset:36864
v_fma_f32 v195, v195, v244, v252
v_mfma_f32_16x16x32_bf16 v[200:203], a[160:163], v[128:131], v[200:203]
ds_read_b64_tr_b16 a[150:151], v235 offset:38912
v_cvt_pk_bf16_f32 v193, v194, v195
v_mfma_f32_16x16x32_bf16 v[200:203], a[156:159], v[124:127], v[200:203]
ds_write_b64 v243, v[192:193] offset:0
v_mfma_f32_16x16x32_bf16 v[200:203], a[152:155], v[120:123], v[200:203]
s_add_u32 m0, s39, s57
v_fma_f32 v196, v196, v245, v253
v_fma_f32 v197, v197, v245, v253
v_mfma_f32_16x16x32_bf16 v[204:207], a[152:155], v[168:171], v[204:207]
buffer_load_dwordx4 v239, s[92:95], s63 offen lds
v_mfma_f32_16x16x32_bf16 v[204:207], a[156:159], v[172:175], v[204:207]
ds_read_b128 a[212:215], v248 offset:0
v_cvt_pk_bf16_f32 v196, v196, v197
v_mfma_f32_16x16x32_bf16 v[204:207], a[160:163], v[176:179], v[204:207]
ds_read_b128 a[216:219], v248 offset:4096
v_fma_f32 v198, v198, v245, v253
v_mfma_f32_16x16x32_bf16 v[204:207], a[164:167], v[180:183], v[204:207]
buffer_store_dwordx4 a[184:187], v239, s[24:27], s49 offen offset:0 sc1
v_mfma_f32_16x16x32_bf16 v[204:207], a[168:171], v[184:187], v[204:207]
ds_write_b64 v240, v[208:209] offset:0
v_mfma_f32_16x16x32_bf16 v[204:207], a[172:175], v[188:191], v[204:207]
s_waitcnt lgkmcnt(4)
v_fma_f32 v199, v199, v245, v253
v_cvt_pk_bf16_f32 v197, v198, v199
v_mfma_f32_16x16x32_bf16 v[192:195], a[148:151], v[20:23], v[228:231]
ds_write_b64 v243, v[196:197] offset:8192
v_mfma_f32_16x16x32_bf16 v[192:195], a[144:147], v[16:19], v[192:195]
ds_read_b64_tr_b16 a[152:153], v235 offset:40960
v_fma_f32 v200, v200, v246, v254
v_mfma_f32_16x16x32_bf16 v[192:195], a[140:143], v[12:15], v[192:195]
ds_read_b64_tr_b16 a[154:155], v235 offset:43008
v_fma_f32 v201, v201, v246, v254
v_mfma_f32_16x16x32_bf16 v[192:195], a[136:139], v[8:11], v[192:195]
ds_read_b64_tr_b16 a[156:157], v235 offset:45056
s_add_u32 m0, s46, 36736
v_mfma_f32_16x16x32_bf16 v[192:195], a[132:135], v[4:7], v[192:195]
buffer_load_dwordx4 v239, s[20:23], s55 offen offset:128 nt lds
v_mfma_f32_16x16x32_bf16 v[192:195], a[128:131], v[0:3], v[192:195]
ds_read_b64_tr_b16 a[158:159], v235 offset:47104
v_cvt_pk_bf16_f32 v214, v200, v201
v_mfma_f32_16x16x32_bf16 v[196:199], a[128:131], v[48:51], v[228:231]
ds_read_b64_tr_b16 a[160:161], v235 offset:49152
v_fma_f32 v202, v202, v246, v254
v_mfma_f32_16x16x32_bf16 v[196:199], a[132:135], v[52:55], v[196:199]
ds_read_b64_tr_b16 a[162:163], v235 offset:51200
v_fma_f32 v203, v203, v246, v254
v_mfma_f32_16x16x32_bf16 v[196:199], a[136:139], v[56:59], v[196:199]
ds_read_b128 a[220:223], v248 offset:8192
v_cvt_pk_bf16_f32 v215, v202, v203
v_mfma_f32_16x16x32_bf16 v[196:199], a[140:143], v[60:63], v[196:199]
ds_read_b64_tr_b16 a[164:165], v235 offset:53248
v_fma_f32 v204, v204, v247, v255
v_mfma_f32_16x16x32_bf16 v[196:199], a[144:147], v[64:67], v[196:199]
ds_read_b64_tr_b16 a[166:167], v235 offset:55296
v_fma_f32 v205, v205, v247, v255
v_mfma_f32_16x16x32_bf16 v[196:199], a[148:151], v[68:71], v[196:199]
ds_read_b64_tr_b16 a[168:169], v235 offset:57344
v_cvt_pk_bf16_f32 v222, v204, v205
v_mfma_f32_16x16x32_bf16 v[200:203], a[148:151], v[116:119], v[228:231]
ds_read_b128 a[224:227], v248 offset:12288
v_fma_f32 v206, v206, v247, v255
v_mfma_f32_16x16x32_bf16 v[200:203], a[144:147], v[112:115], v[200:203]
ds_read_b64_tr_b16 a[170:171], v235 offset:59392
v_fma_f32 v207, v207, v247, v255
v_mfma_f32_16x16x32_bf16 v[200:203], a[140:143], v[108:111], v[200:203]
ds_read_b64_tr_b16 a[172:173], v235 offset:61440
s_add_u32 m0, s39, s58
v_mfma_f32_16x16x32_bf16 v[200:203], a[136:139], v[104:107], v[200:203]
ds_read_b64_tr_b16 a[174:175], v235 offset:63488
v_cvt_pk_bf16_f32 v223, v206, v207
v_mfma_f32_16x16x32_bf16 v[200:203], a[132:135], v[100:103], v[200:203]
buffer_load_dwordx4 v239, s[92:95], s64 offen lds
v_mfma_f32_16x16x32_bf16 v[200:203], a[128:131], v[96:99], v[200:203]
ds_write_b64 v240, v[216:217] offset:8192
v_mfma_f32_16x16x32_bf16 v[204:207], a[128:131], v[144:147], v[228:231]
ds_write_b64 v241, v[210:211] offset:0
v_mfma_f32_16x16x32_bf16 v[204:207], a[132:135], v[148:151], v[204:207]
ds_write_b64 v242, v[212:213] offset:0
v_mfma_f32_16x16x32_bf16 v[204:207], a[136:139], v[152:155], v[204:207]
ds_write_b64 v243, v[214:215] offset:0
v_mfma_f32_16x16x32_bf16 v[204:207], a[140:143], v[156:159], v[204:207]
ds_write_b64 v241, v[218:219] offset:8192
v_mfma_f32_16x16x32_bf16 v[204:207], a[144:147], v[160:163], v[204:207]
ds_write_b64 v242, v[220:221] offset:8192
v_mfma_f32_16x16x32_bf16 v[204:207], a[148:151], v[164:167], v[204:207]
s_waitcnt lgkmcnt(6)
s_add_u32 s74, s101, L_t3-L_pc3
v_xor_b32 v235, 32, v235
v_mfma_f32_16x16x32_bf16 v[204:207], a[172:175], v[188:191], v[204:207]
ds_read_b128 a[228:231], v248 offset:0
s_add_u32 m0, s39, s59
v_mfma_f32_16x16x32_bf16 v[204:207], a[168:171], v[184:187], v[204:207]
ds_read_b64_tr_b16 a[128:129], v235 offset:16384
s_waitcnt lgkmcnt(15)
v_mfma_f32_16x16x32_bf16 v[204:207], a[164:167], v[180:183], v[204:207]
ds_read_b64_tr_b16 a[130:131], v235 offset:18432
s_waitcnt lgkmcnt(12)
v_mfma_f32_16x16x32_bf16 v[204:207], a[160:163], v[176:179], v[204:207]
ds_read_b64_tr_b16 a[132:133], v235 offset:20480
v_mfma_f32_16x16x32_bf16 v[204:207], a[156:159], v[172:175], v[204:207]
buffer_load_dwordx4 v239, s[92:95], s65 offen lds
v_mfma_f32_16x16x32_bf16 v[204:207], a[152:155], v[168:171], v[204:207]
ds_read_b64_tr_b16 a[134:135], v235 offset:22528
s_getpc_b64 s[28:29]
L_pc3:
s_add_u32 s28, s28, s74
s_addc_u32 s29, s29, 0
v_mfma_f32_16x16x32_bf16 v[200:203], a[152:155], v[120:123], v[200:203]
ds_read_b64_tr_b16 a[136:137], v235 offset:24576
s_add_u32 m0, s39, s60
v_mfma_f32_16x16x32_bf16 v[200:203], a[156:159], v[124:127], v[200:203]
ds_read_b64_tr_b16 a[138:139], v235 offset:26624
v_mfma_f32_16x16x32_bf16 v[200:203], a[160:163], v[128:131], v[200:203]
global_load_dword v251, v239, s[28:29]
v_mfma_f32_16x16x32_bf16 v[200:203], a[164:167], v[132:135], v[200:203]
ds_read_b64_tr_b16 a[140:141], v235 offset:28672
v_fma_f32 v204, v204, v247, v255
v_mfma_f32_16x16x32_bf16 v[200:203], a[168:171], v[136:139], v[200:203]
ds_read_b64_tr_b16 a[142:143], v235 offset:30720
v_fma_f32 v205, v205, v247, v255
v_mfma_f32_16x16x32_bf16 v[200:203], a[172:175], v[140:143], v[200:203]
ds_read_b64_tr_b16 a[144:145], v235 offset:32768
v_cvt_pk_bf16_f32 v216, v204, v205
v_mfma_f32_16x16x32_bf16 v[196:199], a[172:175], v[92:95], v[196:199]
buffer_load_dwordx4 v239, s[92:95], s66 offen lds
v_mfma_f32_16x16x32_bf16 v[196:199], a[168:171], v[88:91], v[196:199]
ds_read_b64_tr_b16 a[146:147], v235 offset:34816
v_fma_f32 v206, v206, v247, v255
v_mfma_f32_16x16x32_bf16 v[196:199], a[164:167], v[84:87], v[196:199]
ds_read_b64_tr_b16 a[148:149], v235 offset:36864
v_fma_f32 v207, v207, v247, v255
v_mfma_f32_16x16x32_bf16 v[196:199], a[160:163], v[80:83], v[196:199]
ds_read_b64_tr_b16 a[150:151], v235 offset:38912
v_cvt_pk_bf16_f32 v217, v206, v207
v_mfma_f32_16x16x32_bf16 v[196:199], a[156:159], v[76:79], v[196:199]
ds_read_b128 a[232:235], v248 offset:4096
v_fma_f32 v200, v200, v246, v254
v_mfma_f32_16x16x32_bf16 v[196:199], a[152:155], v[72:75], v[196:199]
ds_write_b64 v243, v[222:223] offset:8192
v_mfma_f32_16x16x32_bf16 v[192:195], a[152:155], v[24:27], v[192:195]
s_add_u32 m0, s39, s61
v_fma_f32 v201, v201, v246, v254
v_cvt_pk_bf16_f32 v208, v200, v201
v_mfma_f32_16x16x32_bf16 v[192:195], a[156:159], v[28:31], v[192:195]
s_waitcnt vmcnt(11)
v_fma_f32 v202, v202, v246, v254
v_fma_f32 v203, v203, v246, v254
v_mfma_f32_16x16x32_bf16 v[192:195], a[160:163], v[32:35], v[192:195]
ds_read_b128 a[236:239], v248 offset:8192
v_cvt_pk_bf16_f32 v209, v202, v203
v_mfma_f32_16x16x32_bf16 v[192:195], a[164:167], v[36:39], v[192:195]
ds_read_b128 a[240:243], v248 offset:12288
v_fma_f32 v196, v196, v245, v253
v_mfma_f32_16x16x32_bf16 v[192:195], a[168:171], v[40:43], v[192:195]
ds_read_b128 a[96:99], v232 offset:24576
v_fma_f32 v197, v197, v245, v253
v_mfma_f32_16x16x32_bf16 v[192:195], a[172:175], v[44:47], v[192:195]
s_waitcnt lgkmcnt(5)
v_cvt_pk_bf16_f32 v226, v196, v197
v_fma_f32 v198, v198, v245, v253
v_mfma_f32_16x16x32_bf16 v[204:207], a[148:151], v[164:167], v[228:231]
ds_read_b128 a[100:103], v233 offset:24576
v_fma_f32 v199, v199, v245, v253
v_mfma_f32_16x16x32_bf16 v[204:207], a[144:147], v[160:163], v[204:207]
ds_read_b64_tr_b16 a[152:153], v235 offset:40960
v_cvt_pk_bf16_f32 v227, v198, v199
v_mfma_f32_16x16x32_bf16 v[204:207], a[140:143], v[156:159], v[204:207]
ds_read_b64_tr_b16 a[154:155], v235 offset:43008
s_waitcnt lgkmcnt(7)
v_mfma_f32_16x16x32_bf16 v[204:207], a[136:139], v[152:155], v[204:207]
ds_read_b64_tr_b16 a[156:157], v235 offset:45056
v_fma_f32 v192, v192, v244, v252
v_mfma_f32_16x16x32_bf16 v[204:207], a[132:135], v[148:151], v[204:207]
buffer_load_dwordx4 v239, s[92:95], s67 offen lds
v_mfma_f32_16x16x32_bf16 v[204:207], a[128:131], v[144:147], v[204:207]
ds_read_b64_tr_b16 a[158:159], v235 offset:47104
v_fma_f32 v193, v193, v244, v252
v_mfma_f32_16x16x32_bf16 v[200:203], a[128:131], v[96:99], v[228:231]
ds_read_b64_tr_b16 a[160:161], v235 offset:49152
v_cvt_pk_bf16_f32 v224, v192, v193
v_mfma_f32_16x16x32_bf16 v[200:203], a[132:135], v[100:103], v[200:203]
ds_read_b64_tr_b16 a[162:163], v235 offset:51200
v_fma_f32 v194, v194, v244, v252
v_mfma_f32_16x16x32_bf16 v[200:203], a[136:139], v[104:107], v[200:203]
s_add_u32 m0, s40, s56
v_fma_f32 v195, v195, v244, v252
v_cvt_pk_bf16_f32 v225, v194, v195
v_mfma_f32_16x16x32_bf16 v[200:203], a[140:143], v[108:111], v[200:203]
ds_read_b64_tr_b16 a[164:165], v235 offset:53248
s_waitcnt lgkmcnt(7)
v_mfma_f32_16x16x32_bf16 v[200:203], a[144:147], v[112:115], v[200:203]
ds_read_b64_tr_b16 a[166:167], v235 offset:55296
s_mov_b32 s94, 24576
v_mfma_f32_16x16x32_bf16 v[200:203], a[148:151], v[116:119], v[200:203]
ds_read_b64_tr_b16 a[168:169], v235 offset:57344
s_add_u32 s68, s37, 24576
v_mfma_f32_16x16x32_bf16 v[196:199], a[148:151], v[68:71], v[228:231]
s_add_u32 s92, s70, s68
s_addc_u32 s93, s71, 0
s_waitcnt lgkmcnt(11)
v_mfma_f32_16x16x32_bf16 v[196:199], a[144:147], v[64:67], v[196:199]
ds_read_b64_tr_b16 a[170:171], v235 offset:59392
v_mfma_f32_16x16x32_bf16 v[196:199], a[140:143], v[60:63], v[196:199]
ds_read_b64_tr_b16 a[172:173], v235 offset:61440
v_mfma_f32_16x16x32_bf16 v[196:199], a[136:139], v[56:59], v[196:199]
ds_read_b64_tr_b16 a[174:175], v235 offset:63488
v_xor_b32 v235, 0x60, v235
v_mfma_f32_16x16x32_bf16 v[196:199], a[132:135], v[52:55], v[196:199]
buffer_load_dwordx4 v239, s[16:19], s56 offen lds
v_mfma_f32_16x16x32_bf16 v[196:199], a[128:131], v[48:51], v[196:199]
ds_write_b64 v240, v[226:227] offset:8192
v_mfma_f32_16x16x32_bf16 v[192:195], a[128:131], v[0:3], v[228:231]
ds_write_b64 v240, v[224:225] offset:0
v_mfma_f32_16x16x32_bf16 v[192:195], a[132:135], v[4:7], v[192:195]
s_add_u32 m0, s46, 16128
v_mfma_f32_16x16x32_bf16 v[192:195], a[136:139], v[8:11], v[192:195]
v_mfma_f32_16x16x32_bf16 v[192:195], a[140:143], v[12:15], v[192:195]
v_mfma_f32_16x16x32_bf16 v[192:195], a[144:147], v[16:19], v[192:195]
v_mfma_f32_16x16x32_bf16 v[192:195], a[148:151], v[20:23], v[192:195]
s_waitcnt lgkmcnt(2)
v_mfma_f32_16x16x32_bf16 v[192:195], a[172:175], v[44:47], v[192:195]
v_mfma_f32_16x16x32_bf16 v[192:195], a[168:171], v[40:43], v[192:195]
ds_read_b64_tr_b16 a[128:129], v235 offset:16384
v_mfma_f32_16x16x32_bf16 v[192:195], a[164:167], v[36:39], v[192:195]
ds_read_b64_tr_b16 a[130:131], v235 offset:18432
v_mfma_f32_16x16x32_bf16 v[192:195], a[160:163], v[32:35], v[192:195]
ds_read_b64_tr_b16 a[132:133], v235 offset:20480
v_mfma_f32_16x16x32_bf16 v[192:195], a[156:159], v[28:31], v[192:195]
buffer_load_dwordx4 v239, s[20:23], s54 offen offset:256 nt lds
v_mfma_f32_16x16x32_bf16 v[192:195], a[152:155], v[24:27], v[192:195]
ds_read_b64_tr_b16 a[134:135], v235 offset:22528
s_add_u32 m0, s40, s57
v_mfma_f32_16x16x32_bf16 v[196:199], a[152:155], v[72:75], v[196:199]
ds_read_b64_tr_b16 a[136:137], v235 offset:24576
v_mfma_f32_16x16x32_bf16 v[196:199], a[156:159], v[76:79], v[196:199]
ds_read_b64_tr_b16 a[138:139], v235 offset:26624
v_mfma_f32_16x16x32_bf16 v[196:199], a[160:163], v[80:83], v[196:199]
buffer_load_dwordx4 v239, s[16:19], s57 offen lds
v_mfma_f32_16x16x32_bf16 v[196:199], a[164:167], v[84:87], v[196:199]
ds_read_b64_tr_b16 a[140:141], v235 offset:28672
v_fma_f32 v192, v192, v244, v252
v_mfma_f32_16x16x32_bf16 v[196:199], a[168:171], v[88:91], v[196:199]
ds_read_b64_tr_b16 a[142:143], v235 offset:30720
v_fma_f32 v193, v193, v244, v252
v_mfma_f32_16x16x32_bf16 v[196:199], a[172:175], v[92:95], v[196:199]
ds_read_b64_tr_b16 a[144:145], v235 offset:32768
v_cvt_pk_bf16_f32 v192, v192, v193
v_mfma_f32_16x16x32_bf16 v[200:203], a[172:175], v[140:143], v[200:203]
s_add_u32 m0, s46, 20224
v_fma_f32 v194, v194, v244, v252
v_fma_f32 v195, v195, v244, v252
v_mfma_f32_16x16x32_bf16 v[200:203], a[168:171], v[136:139], v[200:203]
ds_read_b64_tr_b16 a[146:147], v235 offset:34816
v_cvt_pk_bf16_f32 v193, v194, v195
v_mfma_f32_16x16x32_bf16 v[200:203], a[164:167], v[132:135], v[200:203]
ds_read_b64_tr_b16 a[148:149], v235 offset:36864
v_mfma_f32_16x16x32_bf16 v[200:203], a[160:163], v[128:131], v[200:203]
ds_read_b64_tr_b16 a[150:151], v235 offset:38912
v_fma_f32 v196, v196, v245, v253
v_mfma_f32_16x16x32_bf16 v[200:203], a[156:159], v[124:127], v[200:203]
ds_write_b64 v241, v[192:193] offset:0
v_mfma_f32_16x16x32_bf16 v[200:203], a[152:155], v[120:123], v[200:203]
v_fma_f32 v197, v197, v245, v253
v_cvt_pk_bf16_f32 v196, v196, v197
v_mfma_f32_16x16x32_bf16 v[204:207], a[152:155], v[168:171], v[204:207]
v_fma_f32 v198, v198, v245, v253
v_fma_f32 v199, v199, v245, v253
v_mfma_f32_16x16x32_bf16 v[204:207], a[156:159], v[172:175], v[204:207]
buffer_store_dwordx4 a[188:191], v239, s[24:27], s50 offen offset:0 sc1
v_mfma_f32_16x16x32_bf16 v[204:207], a[160:163], v[176:179], v[204:207]
buffer_load_dwordx4 v239, s[20:23], s55 offen offset:256 nt lds
v_mfma_f32_16x16x32_bf16 v[204:207], a[164:167], v[180:183], v[204:207]
s_add_u32 m0, s40, s58
v_cvt_pk_bf16_f32 v197, v198, v199
v_fma_f32 v200, v200, v246, v254
v_mfma_f32_16x16x32_bf16 v[204:207], a[168:171], v[184:187], v[204:207]
ds_write_b64 v241, v[196:197] offset:8192
v_mfma_f32_16x16x32_bf16 v[204:207], a[172:175], v[188:191], v[204:207]
s_waitcnt lgkmcnt(2)
v_fma_f32 v201, v201, v246, v254
v_cvt_pk_bf16_f32 v210, v200, v201
v_mfma_f32_16x16x32_bf16 v[192:195], a[148:151], v[20:23], v[228:231]
buffer_load_dwordx4 v239, s[16:19], s58 offen lds
v_mfma_f32_16x16x32_bf16 v[192:195], a[144:147], v[16:19], v[192:195]
ds_read_b64_tr_b16 a[152:153], v235 offset:40960
v_fma_f32 v202, v202, v246, v254
v_mfma_f32_16x16x32_bf16 v[192:195], a[140:143], v[12:15], v[192:195]
ds_read_b64_tr_b16 a[154:155], v235 offset:43008
v_fma_f32 v203, v203, v246, v254
v_mfma_f32_16x16x32_bf16 v[192:195], a[136:139], v[8:11], v[192:195]
ds_read_b64_tr_b16 a[156:157], v235 offset:45056
v_cvt_pk_bf16_f32 v211, v202, v203
v_mfma_f32_16x16x32_bf16 v[192:195], a[132:135], v[4:7], v[192:195]
s_add_u32 m0, s40, s59
v_fma_f32 v204, v204, v247, v255
v_fma_f32 v205, v205, v247, v255
v_mfma_f32_16x16x32_bf16 v[192:195], a[128:131], v[0:3], v[192:195]
ds_read_b64_tr_b16 a[158:159], v235 offset:47104
v_cvt_pk_bf16_f32 v218, v204, v205
v_mfma_f32_16x16x32_bf16 v[196:199], a[128:131], v[48:51], v[228:231]
ds_read_b64_tr_b16 a[160:161], v235 offset:49152
v_fma_f32 v206, v206, v247, v255
v_mfma_f32_16x16x32_bf16 v[196:199], a[132:135], v[52:55], v[196:199]
ds_read_b64_tr_b16 a[162:163], v235 offset:51200
v_fma_f32 v207, v207, v247, v255
v_mfma_f32_16x16x32_bf16 v[196:199], a[136:139], v[56:59], v[196:199]
v_cvt_pk_bf16_f32 v219, v206, v207
v_mfma_f32_16x16x32_bf16 v[196:199], a[140:143], v[60:63], v[196:199]
ds_read_b64_tr_b16 a[164:165], v235 offset:53248
v_mfma_f32_16x16x32_bf16 v[196:199], a[144:147], v[64:67], v[196:199]
ds_read_b64_tr_b16 a[166:167], v235 offset:55296
v_mfma_f32_16x16x32_bf16 v[196:199], a[148:151], v[68:71], v[196:199]
ds_read_b64_tr_b16 a[168:169], v235 offset:57344
v_mfma_f32_16x16x32_bf16 v[200:203], a[148:151], v[116:119], v[228:231]
buffer_load_dwordx4 v239, s[16:19], s59 offen lds
v_mfma_f32_16x16x32_bf16 v[200:203], a[144:147], v[112:115], v[200:203]
ds_read_b64_tr_b16 a[170:171], v235 offset:59392
s_add_u32 m0, s40, s60
v_mfma_f32_16x16x32_bf16 v[200:203], a[140:143], v[108:111], v[200:203]
ds_read_b64_tr_b16 a[172:173], v235 offset:61440
s_waitcnt vmcnt(12)
v_mfma_f32_16x16x32_bf16 v[200:203], a[136:139], v[104:107], v[200:203]
ds_read_b64_tr_b16 a[174:175], v235 offset:63488
v_xor_b32 v235, 32, v235
v_mfma_f32_16x16x32_bf16 v[200:203], a[132:135], v[100:103], v[200:203]
ds_read_b128 a[104:107], v232 offset:32768
v_mfma_f32_16x16x32_bf16 v[200:203], a[128:131], v[96:99], v[200:203]
ds_read_b128 a[108:111], v233 offset:32768
v_mfma_f32_16x16x32_bf16 v[204:207], a[128:131], v[144:147], v[228:231]
v_mfma_f32_16x16x32_bf16 v[204:207], a[132:135], v[148:151], v[204:207]
v_mfma_f32_16x16x32_bf16 v[204:207], a[136:139], v[152:155], v[204:207]
v_mfma_f32_16x16x32_bf16 v[204:207], a[140:143], v[156:159], v[204:207]
v_mfma_f32_16x16x32_bf16 v[204:207], a[144:147], v[160:163], v[204:207]
s_waitcnt lgkmcnt(0)
v_mfma_f32_16x16x32_bf16 v[204:207], a[148:151], v[164:167], v[204:207]
s_waitcnt lgkmcnt(2)
v_mfma_f32_16x16x32_bf16 v[204:207], a[172:175], v[188:191], v[204:207]
buffer_load_dwordx4 v239, s[16:19], s60 offen lds
v_mfma_f32_16x16x32_bf16 v[204:207], a[168:171], v[184:187], v[204:207]
ds_read_b64_tr_b16 a[128:129], v235 offset:16384
s_add_u32 m0, s40, s61
v_mfma_f32_16x16x32_bf16 v[204:207], a[164:167], v[180:183], v[204:207]
ds_read_b64_tr_b16 a[130:131], v235 offset:18432
v_mfma_f32_16x16x32_bf16 v[204:207], a[160:163], v[176:179], v[204:207]
ds_read_b64_tr_b16 a[132:133], v235 offset:20480
v_mfma_f32_16x16x32_bf16 v[204:207], a[156:159], v[172:175], v[204:207]
v_mfma_f32_16x16x32_bf16 v[204:207], a[152:155], v[168:171], v[204:207]
ds_read_b64_tr_b16 a[134:135], v235 offset:22528
v_mfma_f32_16x16x32_bf16 v[200:203], a[152:155], v[120:123], v[200:203]
ds_read_b64_tr_b16 a[136:137], v235 offset:24576
v_mfma_f32_16x16x32_bf16 v[200:203], a[156:159], v[124:127], v[200:203]
ds_read_b64_tr_b16 a[138:139], v235 offset:26624
v_mfma_f32_16x16x32_bf16 v[200:203], a[160:163], v[128:131], v[200:203]
v_mfma_f32_16x16x32_bf16 v[200:203], a[164:167], v[132:135], v[200:203]
ds_read_b64_tr_b16 a[140:141], v235 offset:28672
v_fma_f32 v204, v204, v247, v255
v_mfma_f32_16x16x32_bf16 v[200:203], a[168:171], v[136:139], v[200:203]
ds_read_b64_tr_b16 a[142:143], v235 offset:30720
v_fma_f32 v205, v205, v247, v255
v_mfma_f32_16x16x32_bf16 v[200:203], a[172:175], v[140:143], v[200:203]
ds_read_b64_tr_b16 a[144:145], v235 offset:32768
v_cvt_pk_bf16_f32 v220, v204, v205
v_mfma_f32_16x16x32_bf16 v[196:199], a[172:175], v[92:95], v[196:199]
v_fma_f32 v206, v206, v247, v255
v_fma_f32 v207, v207, v247, v255
v_mfma_f32_16x16x32_bf16 v[196:199], a[168:171], v[88:91], v[196:199]
ds_read_b64_tr_b16 a[146:147], v235 offset:34816
v_cvt_pk_bf16_f32 v221, v206, v207
v_mfma_f32_16x16x32_bf16 v[196:199], a[164:167], v[84:87], v[196:199]
ds_read_b64_tr_b16 a[148:149], v235 offset:36864
v_mfma_f32_16x16x32_bf16 v[196:199], a[160:163], v[80:83], v[196:199]
ds_read_b64_tr_b16 a[150:151], v235 offset:38912
v_fma_f32 v200, v200, v246, v254
v_mfma_f32_16x16x32_bf16 v[196:199], a[156:159], v[76:79], v[196:199]
buffer_load_dwordx4 v239, s[16:19], s61 offen lds
v_mfma_f32_16x16x32_bf16 v[196:199], a[152:155], v[72:75], v[196:199]
s_add_u32 m0, s46, 24192
v_fma_f32 v201, v201, v246, v254
v_cvt_pk_bf16_f32 v212, v200, v201
v_mfma_f32_16x16x32_bf16 v[192:195], a[152:155], v[24:27], v[192:195]
v_fma_f32 v202, v202, v246, v254
v_fma_f32 v203, v203, v246, v254
v_mfma_f32_16x16x32_bf16 v[192:195], a[156:159], v[28:31], v[192:195]
s_add_u32 s16, s16, 49152
s_addc_u32 s17, s17, 0
v_cvt_pk_bf16_f32 v213, v202, v203
v_mfma_f32_16x16x32_bf16 v[192:195], a[160:163], v[32:35], v[192:195]
v_mfma_f32_16x16x32_bf16 v[192:195], a[164:167], v[36:39], v[192:195]
v_fma_f32 v196, v196, v245, v253
v_fma_f32 v197, v197, v245, v253
v_mfma_f32_16x16x32_bf16 v[192:195], a[168:171], v[40:43], v[192:195]
v_cvt_pk_bf16_f32 v196, v196, v197
v_fma_f32 v198, v198, v245, v253
v_mfma_f32_16x16x32_bf16 v[192:195], a[172:175], v[44:47], v[192:195]
s_waitcnt lgkmcnt(0)
v_fma_f32 v199, v199, v245, v253
v_cvt_pk_bf16_f32 v197, v198, v199
v_mfma_f32_16x16x32_bf16 v[204:207], a[148:151], v[164:167], v[228:231]
ds_write_b64 v242, v[196:197] offset:8192
v_mfma_f32_16x16x32_bf16 v[204:207], a[144:147], v[160:163], v[204:207]
ds_read_b64_tr_b16 a[152:153], v235 offset:40960
v_mfma_f32_16x16x32_bf16 v[204:207], a[140:143], v[156:159], v[204:207]
ds_read_b64_tr_b16 a[154:155], v235 offset:43008
v_mfma_f32_16x16x32_bf16 v[204:207], a[136:139], v[152:155], v[204:207]
ds_read_b64_tr_b16 a[156:157], v235 offset:45056
v_fma_f32 v192, v192, v244, v252
v_mfma_f32_16x16x32_bf16 v[204:207], a[132:135], v[148:151], v[204:207]
v_fma_f32 v193, v193, v244, v252
v_cvt_pk_bf16_f32 v192, v192, v193
v_mfma_f32_16x16x32_bf16 v[204:207], a[128:131], v[144:147], v[204:207]
ds_read_b64_tr_b16 a[158:159], v235 offset:47104
v_fma_f32 v194, v194, v244, v252
v_mfma_f32_16x16x32_bf16 v[200:203], a[128:131], v[96:99], v[228:231]
ds_read_b64_tr_b16 a[160:161], v235 offset:49152
v_fma_f32 v195, v195, v244, v252
v_mfma_f32_16x16x32_bf16 v[200:203], a[132:135], v[100:103], v[200:203]
ds_read_b64_tr_b16 a[162:163], v235 offset:51200
v_cvt_pk_bf16_f32 v193, v194, v195
v_mfma_f32_16x16x32_bf16 v[200:203], a[136:139], v[104:107], v[200:203]
v_mfma_f32_16x16x32_bf16 v[200:203], a[140:143], v[108:111], v[200:203]
ds_read_b64_tr_b16 a[164:165], v235 offset:53248
v_mfma_f32_16x16x32_bf16 v[200:203], a[144:147], v[112:115], v[200:203]
ds_read_b64_tr_b16 a[166:167], v235 offset:55296
v_mfma_f32_16x16x32_bf16 v[200:203], a[148:151], v[116:119], v[200:203]
ds_read_b64_tr_b16 a[168:169], v235 offset:57344
v_mfma_f32_16x16x32_bf16 v[196:199], a[148:151], v[68:71], v[228:231]
v_mfma_f32_16x16x32_bf16 v[196:199], a[144:147], v[64:67], v[196:199]
ds_read_b64_tr_b16 a[170:171], v235 offset:59392
v_mfma_f32_16x16x32_bf16 v[196:199], a[140:143], v[60:63], v[196:199]
ds_read_b64_tr_b16 a[172:173], v235 offset:61440
v_mfma_f32_16x16x32_bf16 v[196:199], a[136:139], v[56:59], v[196:199]
ds_read_b64_tr_b16 a[174:175], v235 offset:63488
v_xor_b32 v235, 0x60, v235
v_mfma_f32_16x16x32_bf16 v[196:199], a[132:135], v[52:55], v[196:199]
ds_write_b64 v242, v[192:193] offset:0
v_mfma_f32_16x16x32_bf16 v[196:199], a[128:131], v[48:51], v[196:199]
v_mfma_f32_16x16x32_bf16 v[192:195], a[128:131], v[0:3], v[228:231]
v_mfma_f32_16x16x32_bf16 v[192:195], a[132:135], v[4:7], v[192:195]
v_mfma_f32_16x16x32_bf16 v[192:195], a[136:139], v[8:11], v[192:195]
v_mfma_f32_16x16x32_bf16 v[192:195], a[140:143], v[12:15], v[192:195]
v_mfma_f32_16x16x32_bf16 v[192:195], a[144:147], v[16:19], v[192:195]
v_mfma_f32_16x16x32_bf16 v[192:195], a[148:151], v[20:23], v[192:195]
s_waitcnt vmcnt(9) lgkmcnt(1)
v_mfma_f32_16x16x32_bf16 v[192:195], a[172:175], v[44:47], v[192:195]
s_barrier
v_mfma_f32_16x16x32_bf16 v[192:195], a[168:171], v[40:43], v[192:195]
ds_read_b64_tr_b16 a[128:129], v234 offset:0
v_mfma_f32_16x16x32_bf16 v[192:195], a[164:167], v[36:39], v[192:195]
ds_read_b64_tr_b16 a[130:131], v234 offset:2048
v_mfma_f32_16x16x32_bf16 v[192:195], a[160:163], v[32:35], v[192:195]
ds_read_b64_tr_b16 a[132:133], v234 offset:4096
v_mfma_f32_16x16x32_bf16 v[192:195], a[156:159], v[28:31], v[192:195]
buffer_load_dwordx4 v239, s[20:23], s54 offen offset:384 nt lds
v_mfma_f32_16x16x32_bf16 v[192:195], a[152:155], v[24:27], v[192:195]
ds_read_b64_tr_b16 a[134:135], v234 offset:6144
s_add_u32 m0, s69, s56
v_mfma_f32_16x16x32_bf16 v[196:199], a[152:155], v[72:75], v[196:199]
ds_read_b64_tr_b16 a[136:137], v234 offset:8192
v_mfma_f32_16x16x32_bf16 v[196:199], a[156:159], v[76:79], v[196:199]
ds_read_b64_tr_b16 a[138:139], v234 offset:10240
v_mfma_f32_16x16x32_bf16 v[196:199], a[160:163], v[80:83], v[196:199]
buffer_load_dwordx4 v239, s[92:95], s56 offen lds
v_mfma_f32_16x16x32_bf16 v[196:199], a[164:167], v[84:87], v[196:199]
ds_read_b64_tr_b16 a[140:141], v234 offset:12288
v_fma_f32 v192, v192, v244, v252
v_mfma_f32_16x16x32_bf16 v[196:199], a[168:171], v[88:91], v[196:199]
ds_read_b64_tr_b16 a[142:143], v234 offset:14336
v_fma_f32 v193, v193, v244, v252
v_mfma_f32_16x16x32_bf16 v[196:199], a[172:175], v[92:95], v[196:199]
ds_read_b64_tr_b16 a[144:145], v234 offset:16384
v_cvt_pk_bf16_f32 v192, v192, v193
v_mfma_f32_16x16x32_bf16 v[200:203], a[172:175], v[140:143], v[200:203]
buffer_store_dwordx4 a[192:195], v239, s[24:27], s51 offen offset:0 sc1
v_mfma_f32_16x16x32_bf16 v[200:203], a[168:171], v[136:139], v[200:203]
ds_read_b64_tr_b16 a[146:147], v234 offset:18432
v_fma_f32 v194, v194, v244, v252
v_mfma_f32_16x16x32_bf16 v[200:203], a[164:167], v[132:135], v[200:203]
ds_read_b64_tr_b16 a[148:149], v234 offset:20480
s_add_u32 m0, s46, 28288
v_mfma_f32_16x16x32_bf16 v[200:203], a[160:163], v[128:131], v[200:203]
ds_read_b64_tr_b16 a[150:151], v234 offset:22528
v_fma_f32 v195, v195, v244, v252
v_mfma_f32_16x16x32_bf16 v[200:203], a[156:159], v[124:127], v[200:203]
v_cvt_pk_bf16_f32 v193, v194, v195
v_fma_f32 v196, v196, v245, v253
v_mfma_f32_16x16x32_bf16 v[200:203], a[152:155], v[120:123], v[200:203]
ds_write_b64 v243, v[192:193] offset:0
v_mfma_f32_16x16x32_bf16 v[204:207], a[152:155], v[168:171], v[204:207]
buffer_load_dwordx4 v239, s[20:23], s55 offen offset:384 nt lds
v_mfma_f32_16x16x32_bf16 v[204:207], a[156:159], v[172:175], v[204:207]
s_add_u32 m0, s69, s57
v_fma_f32 v197, v197, v245, v253
v_cvt_pk_bf16_f32 v196, v196, v197
v_mfma_f32_16x16x32_bf16 v[204:207], a[160:163], v[176:179], v[204:207]
buffer_load_dwordx4 v239, s[92:95], s57 offen lds
v_mfma_f32_16x16x32_bf16 v[204:207], a[164:167], v[180:183], v[204:207]
ds_read_b128 a[244:247], v248 offset:0
v_fma_f32 v198, v198, v245, v253
v_mfma_f32_16x16x32_bf16 v[204:207], a[168:171], v[184:187], v[204:207]
ds_read_b128 a[248:251], v248 offset:4096
v_fma_f32 v199, v199, v245, v253
v_mfma_f32_16x16x32_bf16 v[204:207], a[172:175], v[188:191], v[204:207]
s_waitcnt lgkmcnt(3)
v_cvt_pk_bf16_f32 v197, v198, v199
v_fma_f32 v200, v200, v246, v254
v_mfma_f32_16x16x32_bf16 v[192:195], a[148:151], v[20:23], v[228:231]
ds_write_b64 v243, v[196:197] offset:8192
v_mfma_f32_16x16x32_bf16 v[192:195], a[144:147], v[16:19], v[192:195]
ds_read_b64_tr_b16 a[152:153], v234 offset:24576
v_fma_f32 v201, v201, v246, v254
v_mfma_f32_16x16x32_bf16 v[192:195], a[140:143], v[12:15], v[192:195]
ds_read_b64_tr_b16 a[154:155], v234 offset:26624
v_cvt_pk_bf16_f32 v214, v200, v201
v_mfma_f32_16x16x32_bf16 v[192:195], a[136:139], v[8:11], v[192:195]
ds_read_b64_tr_b16 a[156:157], v234 offset:28672
v_fma_f32 v202, v202, v246, v254
v_mfma_f32_16x16x32_bf16 v[192:195], a[132:135], v[4:7], v[192:195]
ds_read_b128 a[176:179], v248 offset:8192
v_fma_f32 v203, v203, v246, v254
v_mfma_f32_16x16x32_bf16 v[192:195], a[128:131], v[0:3], v[192:195]
ds_read_b64_tr_b16 a[158:159], v234 offset:30720
v_cvt_pk_bf16_f32 v215, v202, v203
v_mfma_f32_16x16x32_bf16 v[196:199], a[128:131], v[48:51], v[228:231]
ds_read_b64_tr_b16 a[160:161], v234 offset:32768
v_fma_f32 v204, v204, v247, v255
v_mfma_f32_16x16x32_bf16 v[196:199], a[132:135], v[52:55], v[196:199]
ds_read_b64_tr_b16 a[162:163], v234 offset:34816
v_fma_f32 v205, v205, v247, v255
v_mfma_f32_16x16x32_bf16 v[196:199], a[136:139], v[56:59], v[196:199]
ds_read_b128 a[180:183], v248 offset:12288
v_cvt_pk_bf16_f32 v222, v204, v205
v_mfma_f32_16x16x32_bf16 v[196:199], a[140:143], v[60:63], v[196:199]
ds_read_b64_tr_b16 a[164:165], v234 offset:36864
v_fma_f32 v206, v206, v247, v255
v_mfma_f32_16x16x32_bf16 v[196:199], a[144:147], v[64:67], v[196:199]
ds_read_b64_tr_b16 a[166:167], v234 offset:38912
s_add_u32 m0, s69, s58
v_mfma_f32_16x16x32_bf16 v[196:199], a[148:151], v[68:71], v[196:199]
ds_read_b64_tr_b16 a[168:169], v234 offset:40960
v_fma_f32 v207, v207, v247, v255
v_mfma_f32_16x16x32_bf16 v[200:203], a[148:151], v[116:119], v[228:231]
buffer_load_dwordx4 v239, s[92:95], s58 offen lds
v_mfma_f32_16x16x32_bf16 v[200:203], a[144:147], v[112:115], v[200:203]
ds_read_b64_tr_b16 a[170:171], v234 offset:43008
v_cvt_pk_bf16_f32 v223, v206, v207
v_mfma_f32_16x16x32_bf16 v[200:203], a[140:143], v[108:111], v[200:203]
ds_read_b64_tr_b16 a[172:173], v234 offset:45056
s_add_u32 m0, s69, s59
v_mfma_f32_16x16x32_bf16 v[200:203], a[136:139], v[104:107], v[200:203]
ds_read_b64_tr_b16 a[174:175], v234 offset:47104
v_xor_b32 v234, 32, v234
v_mfma_f32_16x16x32_bf16 v[200:203], a[132:135], v[100:103], v[200:203]
ds_write_b64 v240, v[216:217] offset:8192
v_mfma_f32_16x16x32_bf16 v[200:203], a[128:131], v[96:99], v[200:203]
ds_write_b64 v240, v[208:209] offset:0
v_mfma_f32_16x16x32_bf16 v[204:207], a[128:131], v[144:147], v[228:231]
ds_write_b64 v241, v[210:211] offset:0
v_mfma_f32_16x16x32_bf16 v[204:207], a[132:135], v[148:151], v[204:207]
ds_write_b64 v242, v[212:213] offset:0
v_mfma_f32_16x16x32_bf16 v[204:207], a[136:139], v[152:155], v[204:207]
ds_write_b64 v243, v[214:215] offset:0
v_mfma_f32_16x16x32_bf16 v[204:207], a[140:143], v[156:159], v[204:207]
buffer_load_dwordx4 v239, s[92:95], s59 offen lds
v_mfma_f32_16x16x32_bf16 v[204:207], a[144:147], v[160:163], v[204:207]
ds_write_b64 v241, v[218:219] offset:8192
v_mfma_f32_16x16x32_bf16 v[204:207], a[148:151], v[164:167], v[204:207]
s_waitcnt lgkmcnt(6)
s_add_u32 m0, s69, s60
s_waitcnt vmcnt(11)
v_mfma_f32_16x16x32_bf16 v[204:207], a[172:175], v[188:191], v[204:207]
ds_read_b128 a[184:187], v248 offset:0
s_waitcnt lgkmcnt(15)
v_mfma_f32_16x16x32_bf16 v[204:207], a[168:171], v[184:187], v[204:207]
ds_read_b64_tr_b16 a[128:129], v234 offset:0
s_waitcnt lgkmcnt(14)
v_mfma_f32_16x16x32_bf16 v[204:207], a[164:167], v[180:183], v[204:207]
ds_read_b64_tr_b16 a[130:131], v234 offset:2048
v_mfma_f32_16x16x32_bf16 v[204:207], a[160:163], v[176:179], v[204:207]
ds_read_b64_tr_b16 a[132:133], v234 offset:4096
v_mfma_f32_16x16x32_bf16 v[204:207], a[156:159], v[172:175], v[204:207]
buffer_store_dwordx4 a[196:199], v239, s[24:27], s52 offen offset:0 sc1
v_mfma_f32_16x16x32_bf16 v[204:207], a[152:155], v[168:171], v[204:207]
ds_read_b64_tr_b16 a[134:135], v234 offset:6144
v_mfma_f32_16x16x32_bf16 v[200:203], a[152:155], v[120:123], v[200:203]
ds_read_b64_tr_b16 a[136:137], v234 offset:8192
v_mfma_f32_16x16x32_bf16 v[200:203], a[156:159], v[124:127], v[200:203]
ds_read_b64_tr_b16 a[138:139], v234 offset:10240
v_mfma_f32_16x16x32_bf16 v[200:203], a[160:163], v[128:131], v[200:203]
ds_read_b128 a[188:191], v248 offset:4096
v_mfma_f32_16x16x32_bf16 v[200:203], a[164:167], v[132:135], v[200:203]
ds_read_b64_tr_b16 a[140:141], v234 offset:12288
v_fma_f32 v204, v204, v247, v255
v_mfma_f32_16x16x32_bf16 v[200:203], a[168:171], v[136:139], v[200:203]
ds_read_b64_tr_b16 a[142:143], v234 offset:14336
v_fma_f32 v205, v205, v247, v255
v_mfma_f32_16x16x32_bf16 v[200:203], a[172:175], v[140:143], v[200:203]
ds_read_b64_tr_b16 a[144:145], v234 offset:16384
v_cvt_pk_bf16_f32 v216, v204, v205
v_mfma_f32_16x16x32_bf16 v[196:199], a[172:175], v[92:95], v[196:199]
buffer_load_dwordx4 v239, s[92:95], s60 offen lds
v_mfma_f32_16x16x32_bf16 v[196:199], a[168:171], v[88:91], v[196:199]
ds_read_b64_tr_b16 a[146:147], v234 offset:18432
v_fma_f32 v206, v206, v247, v255
v_mfma_f32_16x16x32_bf16 v[196:199], a[164:167], v[84:87], v[196:199]
ds_read_b64_tr_b16 a[148:149], v234 offset:20480
v_fma_f32 v207, v207, v247, v255
v_mfma_f32_16x16x32_bf16 v[196:199], a[160:163], v[80:83], v[196:199]
ds_read_b64_tr_b16 a[150:151], v234 offset:22528
v_cvt_pk_bf16_f32 v217, v206, v207
v_mfma_f32_16x16x32_bf16 v[196:199], a[156:159], v[76:79], v[196:199]
ds_write_b64 v242, v[220:221] offset:8192
v_mfma_f32_16x16x32_bf16 v[196:199], a[152:155], v[72:75], v[196:199]
ds_write_b64 v243, v[222:223] offset:8192
v_mfma_f32_16x16x32_bf16 v[192:195], a[152:155], v[24:27], v[192:195]
ds_read_b128 a[112:115], v232 offset:16384
v_fma_f32 v200, v200, v246, v254
v_mfma_f32_16x16x32_bf16 v[192:195], a[156:159], v[28:31], v[192:195]
ds_read_b128 a[116:119], v233 offset:16384
v_fma_f32 v201, v201, v246, v254
v_mfma_f32_16x16x32_bf16 v[192:195], a[160:163], v[32:35], v[192:195]
ds_read_b128 a[192:195], v248 offset:8192
v_cvt_pk_bf16_f32 v208, v200, v201
v_mfma_f32_16x16x32_bf16 v[192:195], a[164:167], v[36:39], v[192:195]
ds_read_b128 a[196:199], v248 offset:12288
v_fma_f32 v202, v202, v246, v254
v_mfma_f32_16x16x32_bf16 v[192:195], a[168:171], v[40:43], v[192:195]
s_add_u32 m0, s69, s61
v_fma_f32 v203, v203, v246, v254
v_cvt_pk_bf16_f32 v209, v202, v203
v_mfma_f32_16x16x32_bf16 v[192:195], a[172:175], v[44:47], v[192:195]
s_waitcnt lgkmcnt(6)
v_fma_f32 v196, v196, v245, v253
v_fma_f32 v197, v197, v245, v253
v_mfma_f32_16x16x32_bf16 v[204:207], a[148:151], v[164:167], v[228:231]
s_waitcnt lgkmcnt(2)
v_cvt_pk_bf16_f32 v226, v196, v197
v_fma_f32 v198, v198, v245, v253
v_mfma_f32_16x16x32_bf16 v[204:207], a[144:147], v[160:163], v[204:207]
ds_read_b64_tr_b16 a[152:153], v234 offset:24576
v_fma_f32 v199, v199, v245, v253
v_mfma_f32_16x16x32_bf16 v[204:207], a[140:143], v[156:159], v[204:207]
ds_read_b64_tr_b16 a[154:155], v234 offset:26624
v_cvt_pk_bf16_f32 v227, v198, v199
v_mfma_f32_16x16x32_bf16 v[204:207], a[136:139], v[152:155], v[204:207]
ds_read_b64_tr_b16 a[156:157], v234 offset:28672
v_fma_f32 v192, v192, v244, v252
v_mfma_f32_16x16x32_bf16 v[204:207], a[132:135], v[148:151], v[204:207]
buffer_load_dwordx4 v239, s[92:95], s61 offen lds
v_mfma_f32_16x16x32_bf16 v[204:207], a[128:131], v[144:147], v[204:207]
ds_read_b64_tr_b16 a[158:159], v234 offset:30720
v_fma_f32 v193, v193, v244, v252
v_mfma_f32_16x16x32_bf16 v[200:203], a[128:131], v[96:99], v[228:231]
ds_read_b64_tr_b16 a[160:161], v234 offset:32768
v_cvt_pk_bf16_f32 v224, v192, v193
v_mfma_f32_16x16x32_bf16 v[200:203], a[132:135], v[100:103], v[200:203]
ds_read_b64_tr_b16 a[162:163], v234 offset:34816
v_fma_f32 v194, v194, v244, v252
v_mfma_f32_16x16x32_bf16 v[200:203], a[136:139], v[104:107], v[200:203]
s_add_u32 m0, s75, s56
v_fma_f32 v195, v195, v244, v252
v_cvt_pk_bf16_f32 v225, v194, v195
v_mfma_f32_16x16x32_bf16 v[200:203], a[140:143], v[108:111], v[200:203]
ds_read_b64_tr_b16 a[164:165], v234 offset:36864
s_waitcnt lgkmcnt(15)
v_mfma_f32_16x16x32_bf16 v[200:203], a[144:147], v[112:115], v[200:203]
ds_read_b64_tr_b16 a[166:167], v234 offset:38912
s_waitcnt lgkmcnt(8)
v_mfma_f32_16x16x32_bf16 v[200:203], a[148:151], v[116:119], v[200:203]
ds_read_b64_tr_b16 a[168:169], v234 offset:40960
v_mfma_f32_16x16x32_bf16 v[196:199], a[148:151], v[68:71], v[228:231]
s_add_u32 s92, s92, 49152
s_addc_u32 s93, s93, 0
v_mfma_f32_16x16x32_bf16 v[196:199], a[144:147], v[64:67], v[196:199]
ds_read_b64_tr_b16 a[170:171], v234 offset:43008
v_mfma_f32_16x16x32_bf16 v[196:199], a[140:143], v[60:63], v[196:199]
ds_read_b64_tr_b16 a[172:173], v234 offset:45056
v_mfma_f32_16x16x32_bf16 v[196:199], a[136:139], v[56:59], v[196:199]
ds_read_b64_tr_b16 a[174:175], v234 offset:47104
v_xor_b32 v234, 0x60, v234
v_mfma_f32_16x16x32_bf16 v[196:199], a[132:135], v[52:55], v[196:199]
buffer_load_dwordx4 v239, s[16:19], s56 offen lds
v_mfma_f32_16x16x32_bf16 v[196:199], a[128:131], v[48:51], v[196:199]
ds_write_b64 v240, v[208:209] offset:16384
v_mfma_f32_16x16x32_bf16 v[192:195], a[128:131], v[0:3], v[228:231]
ds_write_b64 v240, v[226:227] offset:8192
v_mfma_f32_16x16x32_bf16 v[192:195], a[132:135], v[4:7], v[192:195]
ds_write_b64 v240, v[224:225] offset:0
v_mfma_f32_16x16x32_bf16 v[192:195], a[136:139], v[8:11], v[192:195]
s_add_u32 m0, s75, s57
v_mfma_f32_16x16x32_bf16 v[192:195], a[140:143], v[12:15], v[192:195]
v_mfma_f32_16x16x32_bf16 v[192:195], a[144:147], v[16:19], v[192:195]
v_mfma_f32_16x16x32_bf16 v[192:195], a[148:151], v[20:23], v[192:195]
s_waitcnt lgkmcnt(3)
v_mfma_f32_16x16x32_bf16 v[192:195], a[172:175], v[44:47], v[192:195]
v_mfma_f32_16x16x32_bf16 v[192:195], a[168:171], v[40:43], v[192:195]
ds_read_b64_tr_b16 a[128:129], v234 offset:0
v_mfma_f32_16x16x32_bf16 v[192:195], a[164:167], v[36:39], v[192:195]
ds_read_b64_tr_b16 a[130:131], v234 offset:2048
v_mfma_f32_16x16x32_bf16 v[192:195], a[160:163], v[32:35], v[192:195]
ds_read_b64_tr_b16 a[132:133], v234 offset:4096
v_mfma_f32_16x16x32_bf16 v[192:195], a[156:159], v[28:31], v[192:195]
buffer_store_dwordx4 a[200:203], v239, s[24:27], s53 offen offset:0 sc1
v_mfma_f32_16x16x32_bf16 v[192:195], a[152:155], v[24:27], v[192:195]
ds_read_b64_tr_b16 a[134:135], v234 offset:6144
v_mfma_f32_16x16x32_bf16 v[196:199], a[152:155], v[72:75], v[196:199]
ds_read_b64_tr_b16 a[136:137], v234 offset:8192
v_mfma_f32_16x16x32_bf16 v[196:199], a[156:159], v[76:79], v[196:199]
ds_read_b64_tr_b16 a[138:139], v234 offset:10240
v_mfma_f32_16x16x32_bf16 v[196:199], a[160:163], v[80:83], v[196:199]
buffer_load_dwordx4 v239, s[16:19], s57 offen lds
v_mfma_f32_16x16x32_bf16 v[196:199], a[164:167], v[84:87], v[196:199]
ds_read_b64_tr_b16 a[140:141], v234 offset:12288
v_fma_f32 v192, v192, v244, v252
v_mfma_f32_16x16x32_bf16 v[196:199], a[168:171], v[88:91], v[196:199]
ds_read_b64_tr_b16 a[142:143], v234 offset:14336
v_fma_f32 v193, v193, v244, v252
v_mfma_f32_16x16x32_bf16 v[196:199], a[172:175], v[92:95], v[196:199]
ds_read_b64_tr_b16 a[144:145], v234 offset:16384
v_cvt_pk_bf16_f32 v192, v192, v193
v_mfma_f32_16x16x32_bf16 v[200:203], a[172:175], v[140:143], v[200:203]
s_add_u32 m0, s75, s58
v_fma_f32 v194, v194, v244, v252
v_fma_f32 v195, v195, v244, v252
v_mfma_f32_16x16x32_bf16 v[200:203], a[168:171], v[136:139], v[200:203]
ds_read_b64_tr_b16 a[146:147], v234 offset:18432
v_cvt_pk_bf16_f32 v193, v194, v195
v_mfma_f32_16x16x32_bf16 v[200:203], a[164:167], v[132:135], v[200:203]
ds_read_b64_tr_b16 a[148:149], v234 offset:20480
v_mfma_f32_16x16x32_bf16 v[200:203], a[160:163], v[128:131], v[200:203]
ds_read_b64_tr_b16 a[150:151], v234 offset:22528
v_fma_f32 v196, v196, v245, v253
v_mfma_f32_16x16x32_bf16 v[200:203], a[156:159], v[124:127], v[200:203]
ds_write_b64 v241, v[192:193] offset:0
v_mfma_f32_16x16x32_bf16 v[200:203], a[152:155], v[120:123], v[200:203]
v_fma_f32 v197, v197, v245, v253
v_cvt_pk_bf16_f32 v196, v196, v197
v_mfma_f32_16x16x32_bf16 v[204:207], a[152:155], v[168:171], v[204:207]
v_fma_f32 v198, v198, v245, v253
v_fma_f32 v199, v199, v245, v253
v_mfma_f32_16x16x32_bf16 v[204:207], a[156:159], v[172:175], v[204:207]
v_cvt_pk_bf16_f32 v197, v198, v199
v_mfma_f32_16x16x32_bf16 v[204:207], a[160:163], v[176:179], v[204:207]
ds_write_b64 v241, v[196:197] offset:8192
v_mfma_f32_16x16x32_bf16 v[204:207], a[164:167], v[180:183], v[204:207]
buffer_load_dwordx4 v239, s[16:19], s58 offen lds
v_mfma_f32_16x16x32_bf16 v[204:207], a[168:171], v[184:187], v[204:207]
s_add_u32 m0, s75, s59
v_fma_f32 v200, v200, v246, v254
v_fma_f32 v201, v201, v246, v254
v_mfma_f32_16x16x32_bf16 v[204:207], a[172:175], v[188:191], v[204:207]
s_waitcnt lgkmcnt(2)
v_cvt_pk_bf16_f32 v210, v200, v201
v_fma_f32 v202, v202, v246, v254
v_mfma_f32_16x16x32_bf16 v[192:195], a[148:151], v[20:23], v[228:231]
v_fma_f32 v203, v203, v246, v254
v_cvt_pk_bf16_f32 v211, v202, v203
v_mfma_f32_16x16x32_bf16 v[192:195], a[144:147], v[16:19], v[192:195]
ds_read_b64_tr_b16 a[152:153], v234 offset:24576
v_mfma_f32_16x16x32_bf16 v[192:195], a[140:143], v[12:15], v[192:195]
ds_read_b64_tr_b16 a[154:155], v234 offset:26624
v_mfma_f32_16x16x32_bf16 v[192:195], a[136:139], v[8:11], v[192:195]
ds_read_b64_tr_b16 a[156:157], v234 offset:28672
v_fma_f32 v204, v204, v247, v255
v_mfma_f32_16x16x32_bf16 v[192:195], a[132:135], v[4:7], v[192:195]
s_waitcnt vmcnt(10)
v_fma_f32 v205, v205, v247, v255
v_cvt_pk_bf16_f32 v218, v204, v205
v_mfma_f32_16x16x32_bf16 v[192:195], a[128:131], v[0:3], v[192:195]
ds_read_b64_tr_b16 a[158:159], v234 offset:30720
v_fma_f32 v206, v206, v247, v255
v_mfma_f32_16x16x32_bf16 v[196:199], a[128:131], v[48:51], v[228:231]
ds_read_b64_tr_b16 a[160:161], v234 offset:32768
v_fma_f32 v207, v207, v247, v255
v_mfma_f32_16x16x32_bf16 v[196:199], a[132:135], v[52:55], v[196:199]
ds_read_b64_tr_b16 a[162:163], v234 offset:34816
v_cvt_pk_bf16_f32 v219, v206, v207
v_mfma_f32_16x16x32_bf16 v[196:199], a[136:139], v[56:59], v[196:199]
ds_read_b128 a[120:123], v232 offset:24576
v_mfma_f32_16x16x32_bf16 v[196:199], a[140:143], v[60:63], v[196:199]
ds_read_b64_tr_b16 a[164:165], v234 offset:36864
v_mfma_f32_16x16x32_bf16 v[196:199], a[144:147], v[64:67], v[196:199]
ds_read_b64_tr_b16 a[166:167], v234 offset:38912
v_mfma_f32_16x16x32_bf16 v[196:199], a[148:151], v[68:71], v[196:199]
ds_read_b64_tr_b16 a[168:169], v234 offset:40960
v_mfma_f32_16x16x32_bf16 v[200:203], a[148:151], v[116:119], v[228:231]
buffer_load_dwordx4 v239, s[16:19], s59 offen lds
v_mfma_f32_16x16x32_bf16 v[200:203], a[144:147], v[112:115], v[200:203]
ds_read_b64_tr_b16 a[170:171], v234 offset:43008
s_add_u32 m0, s75, s60
v_mfma_f32_16x16x32_bf16 v[200:203], a[140:143], v[108:111], v[200:203]
ds_read_b64_tr_b16 a[172:173], v234 offset:45056
v_mfma_f32_16x16x32_bf16 v[200:203], a[136:139], v[104:107], v[200:203]
ds_read_b64_tr_b16 a[174:175], v234 offset:47104
v_xor_b32 v234, 32, v234
v_mfma_f32_16x16x32_bf16 v[200:203], a[132:135], v[100:103], v[200:203]
ds_read_b128 a[124:127], v233 offset:24576
v_mfma_f32_16x16x32_bf16 v[200:203], a[128:131], v[96:99], v[200:203]
ds_write_b64 v241, v[210:211] offset:16384
v_mfma_f32_16x16x32_bf16 v[204:207], a[128:131], v[144:147], v[228:231]
ds_write_b64 v240, v[216:217] offset:24576
v_mfma_f32_16x16x32_bf16 v[204:207], a[132:135], v[148:151], v[204:207]
ds_write_b64 v241, v[218:219] offset:24576
v_mfma_f32_16x16x32_bf16 v[204:207], a[136:139], v[152:155], v[204:207]
v_mfma_f32_16x16x32_bf16 v[204:207], a[140:143], v[156:159], v[204:207]
s_waitcnt lgkmcnt(3)
v_mfma_f32_16x16x32_bf16 v[204:207], a[144:147], v[160:163], v[204:207]
v_mfma_f32_16x16x32_bf16 v[204:207], a[148:151], v[164:167], v[204:207]
s_waitcnt lgkmcnt(4)
v_mfma_f32_16x16x32_bf16 v[204:207], a[172:175], v[188:191], v[204:207]
buffer_load_dwordx4 v239, s[16:19], s60 offen lds
v_mfma_f32_16x16x32_bf16 v[204:207], a[168:171], v[184:187], v[204:207]
ds_read_b64_tr_b16 a[128:129], v234 offset:0
s_add_u32 m0, s75, s61
v_mfma_f32_16x16x32_bf16 v[204:207], a[164:167], v[180:183], v[204:207]
ds_read_b64_tr_b16 a[130:131], v234 offset:2048
v_mfma_f32_16x16x32_bf16 v[204:207], a[160:163], v[176:179], v[204:207]
ds_read_b64_tr_b16 a[132:133], v234 offset:4096
v_mfma_f32_16x16x32_bf16 v[204:207], a[156:159], v[172:175], v[204:207]
v_mfma_f32_16x16x32_bf16 v[204:207], a[152:155], v[168:171], v[204:207]
ds_read_b64_tr_b16 a[134:135], v234 offset:6144
v_mfma_f32_16x16x32_bf16 v[200:203], a[152:155], v[120:123], v[200:203]
ds_read_b64_tr_b16 a[136:137], v234 offset:8192
v_mfma_f32_16x16x32_bf16 v[200:203], a[156:159], v[124:127], v[200:203]
ds_read_b64_tr_b16 a[138:139], v234 offset:10240
v_mfma_f32_16x16x32_bf16 v[200:203], a[160:163], v[128:131], v[200:203]
v_mfma_f32_16x16x32_bf16 v[200:203], a[164:167], v[132:135], v[200:203]
ds_read_b64_tr_b16 a[140:141], v234 offset:12288
v_fma_f32 v204, v204, v247, v255
v_mfma_f32_16x16x32_bf16 v[200:203], a[168:171], v[136:139], v[200:203]
ds_read_b64_tr_b16 a[142:143], v234 offset:14336
v_fma_f32 v205, v205, v247, v255
v_mfma_f32_16x16x32_bf16 v[200:203], a[172:175], v[140:143], v[200:203]
ds_read_b64_tr_b16 a[144:145], v234 offset:16384
v_cvt_pk_bf16_f32 v220, v204, v205
v_mfma_f32_16x16x32_bf16 v[196:199], a[172:175], v[92:95], v[196:199]
v_fma_f32 v206, v206, v247, v255
v_fma_f32 v207, v207, v247, v255
v_mfma_f32_16x16x32_bf16 v[196:199], a[168:171], v[88:91], v[196:199]
ds_read_b64_tr_b16 a[146:147], v234 offset:18432
v_cvt_pk_bf16_f32 v221, v206, v207
v_mfma_f32_16x16x32_bf16 v[196:199], a[164:167], v[84:87], v[196:199]
ds_read_b64_tr_b16 a[148:149], v234 offset:20480
v_mfma_f32_16x16x32_bf16 v[196:199], a[160:163], v[80:83], v[196:199]
ds_read_b64_tr_b16 a[150:151], v234 offset:22528
v_fma_f32 v200, v200, v246, v254
v_mfma_f32_16x16x32_bf16 v[196:199], a[156:159], v[76:79], v[196:199]
buffer_load_dwordx4 v239, s[16:19], s61 offen lds
v_mfma_f32_16x16x32_bf16 v[196:199], a[152:155], v[72:75], v[196:199]
ds_write_b64 v242, v[220:221] offset:24576
v_mfma_f32_16x16x32_bf16 v[192:195], a[152:155], v[24:27], v[192:195]
s_add_u32 m0, s38, s56
v_fma_f32 v201, v201, v246, v254
v_cvt_pk_bf16_f32 v212, v200, v201
v_mfma_f32_16x16x32_bf16 v[192:195], a[156:159], v[28:31], v[192:195]
v_fma_f32 v202, v202, v246, v254
v_fma_f32 v203, v203, v246, v254
v_mfma_f32_16x16x32_bf16 v[192:195], a[160:163], v[32:35], v[192:195]
s_add_u32 s16, s16, 49152
s_addc_u32 s17, s17, 0
v_cvt_pk_bf16_f32 v213, v202, v203
v_mfma_f32_16x16x32_bf16 v[192:195], a[164:167], v[36:39], v[192:195]
ds_write_b64 v242, v[212:213] offset:16384
v_mfma_f32_16x16x32_bf16 v[192:195], a[168:171], v[40:43], v[192:195]
v_fma_f32 v196, v196, v245, v253
v_fma_f32 v197, v197, v245, v253
v_mfma_f32_16x16x32_bf16 v[192:195], a[172:175], v[44:47], v[192:195]
s_waitcnt lgkmcnt(2)
v_cvt_pk_bf16_f32 v196, v196, v197
v_fma_f32 v198, v198, v245, v253
v_mfma_f32_16x16x32_bf16 v[204:207], a[148:151], v[164:167], v[228:231]
v_fma_f32 v199, v199, v245, v253
v_cvt_pk_bf16_f32 v197, v198, v199
v_mfma_f32_16x16x32_bf16 v[204:207], a[144:147], v[160:163], v[204:207]
ds_read_b64_tr_b16 a[152:153], v234 offset:24576
v_mfma_f32_16x16x32_bf16 v[204:207], a[140:143], v[156:159], v[204:207]
ds_read_b64_tr_b16 a[154:155], v234 offset:26624
v_mfma_f32_16x16x32_bf16 v[204:207], a[136:139], v[152:155], v[204:207]
ds_read_b64_tr_b16 a[156:157], v234 offset:28672
v_fma_f32 v192, v192, v244, v252
v_mfma_f32_16x16x32_bf16 v[204:207], a[132:135], v[148:151], v[204:207]
ds_write_b64 v242, v[196:197] offset:8192
v_mfma_f32_16x16x32_bf16 v[204:207], a[128:131], v[144:147], v[204:207]
ds_read_b64_tr_b16 a[158:159], v234 offset:30720
v_fma_f32 v193, v193, v244, v252
v_mfma_f32_16x16x32_bf16 v[200:203], a[128:131], v[96:99], v[228:231]
ds_read_b64_tr_b16 a[160:161], v234 offset:32768
v_cvt_pk_bf16_f32 v192, v192, v193
v_mfma_f32_16x16x32_bf16 v[200:203], a[132:135], v[100:103], v[200:203]
ds_read_b64_tr_b16 a[162:163], v234 offset:34816
v_fma_f32 v194, v194, v244, v252
v_mfma_f32_16x16x32_bf16 v[200:203], a[136:139], v[104:107], v[200:203]
v_fma_f32 v195, v195, v244, v252
v_cvt_pk_bf16_f32 v193, v194, v195
v_mfma_f32_16x16x32_bf16 v[200:203], a[140:143], v[108:111], v[200:203]
ds_read_b64_tr_b16 a[164:165], v234 offset:36864
v_mfma_f32_16x16x32_bf16 v[200:203], a[144:147], v[112:115], v[200:203]
ds_read_b64_tr_b16 a[166:167], v234 offset:38912
v_mfma_f32_16x16x32_bf16 v[200:203], a[148:151], v[116:119], v[200:203]
ds_read_b64_tr_b16 a[168:169], v234 offset:40960
v_mfma_f32_16x16x32_bf16 v[196:199], a[148:151], v[68:71], v[228:231]
v_mfma_f32_16x16x32_bf16 v[196:199], a[144:147], v[64:67], v[196:199]
ds_read_b64_tr_b16 a[170:171], v234 offset:43008
v_mfma_f32_16x16x32_bf16 v[196:199], a[140:143], v[60:63], v[196:199]
ds_read_b64_tr_b16 a[172:173], v234 offset:45056
v_mfma_f32_16x16x32_bf16 v[196:199], a[136:139], v[56:59], v[196:199]
ds_read_b64_tr_b16 a[174:175], v234 offset:47104
v_xor_b32 v234, 0x60, v234
v_mfma_f32_16x16x32_bf16 v[196:199], a[132:135], v[52:55], v[196:199]
ds_write_b64 v242, v[192:193] offset:0
v_mfma_f32_16x16x32_bf16 v[196:199], a[128:131], v[48:51], v[196:199]
v_mfma_f32_16x16x32_bf16 v[192:195], a[128:131], v[0:3], v[228:231]
v_mfma_f32_16x16x32_bf16 v[192:195], a[132:135], v[4:7], v[192:195]
v_mfma_f32_16x16x32_bf16 v[192:195], a[136:139], v[8:11], v[192:195]
v_mfma_f32_16x16x32_bf16 v[192:195], a[140:143], v[12:15], v[192:195]
v_mfma_f32_16x16x32_bf16 v[192:195], a[144:147], v[16:19], v[192:195]
v_mfma_f32_16x16x32_bf16 v[192:195], a[148:151], v[20:23], v[192:195]
s_waitcnt vmcnt(7) lgkmcnt(1)
v_mfma_f32_16x16x32_bf16 v[192:195], a[172:175], v[44:47], v[192:195]
s_barrier
v_mfma_f32_16x16x32_bf16 v[192:195], a[168:171], v[40:43], v[192:195]
ds_read_b128 a[128:131], v236 offset:49152
v_mfma_f32_16x16x32_bf16 v[192:195], a[164:167], v[36:39], v[192:195]
ds_read_b128 a[132:135], v237 offset:49152
v_mfma_f32_16x16x32_bf16 v[192:195], a[160:163], v[32:35], v[192:195]
ds_read_b128 a[136:139], v236 offset:50176
v_mfma_f32_16x16x32_bf16 v[192:195], a[156:159], v[28:31], v[192:195]
buffer_load_dwordx4 v239, s[92:95], s56 offen lds
v_mfma_f32_16x16x32_bf16 v[192:195], a[152:155], v[24:27], v[192:195]
ds_read_b128 a[140:143], v237 offset:50176
s_add_u32 m0, s38, s57
v_mfma_f32_16x16x32_bf16 v[196:199], a[152:155], v[72:75], v[196:199]
ds_read_b128 a[144:147], v236 offset:51200
v_mfma_f32_16x16x32_bf16 v[196:199], a[156:159], v[76:79], v[196:199]
ds_read_b128 a[148:151], v237 offset:51200
v_mfma_f32_16x16x32_bf16 v[196:199], a[160:163], v[80:83], v[196:199]
v_mfma_f32_16x16x32_bf16 v[196:199], a[164:167], v[84:87], v[196:199]
v_fma_f32 v192, v192, v244, v252
v_fma_f32 v193, v193, v244, v252
v_mfma_f32_16x16x32_bf16 v[196:199], a[168:171], v[88:91], v[196:199]
v_cvt_pk_bf16_f32 v192, v192, v193
v_fma_f32 v194, v194, v244, v252
v_mfma_f32_16x16x32_bf16 v[196:199], a[172:175], v[92:95], v[196:199]
v_fma_f32 v195, v195, v244, v252
v_cvt_pk_bf16_f32 v193, v194, v195
v_mfma_f32_16x16x32_bf16 v[200:203], a[172:175], v[140:143], v[200:203]
v_mfma_f32_16x16x32_bf16 v[200:203], a[168:171], v[136:139], v[200:203]
v_mfma_f32_16x16x32_bf16 v[200:203], a[164:167], v[132:135], v[200:203]
v_mfma_f32_16x16x32_bf16 v[200:203], a[160:163], v[128:131], v[200:203]
s_nop 1
v_fma_f32 v196, v196, v245, v253
v_fma_f32 v197, v197, v245, v253
v_mfma_f32_16x16x32_bf16 v[200:203], a[156:159], v[124:127], v[200:203]
ds_write_b64 v243, v[192:193] offset:0
v_mfma_f32_16x16x32_bf16 v[200:203], a[152:155], v[120:123], v[200:203]
v_cvt_pk_bf16_f32 v196, v196, v197
v_fma_f32 v198, v198, v245, v253
v_mfma_f32_16x16x32_bf16 v[204:207], a[152:155], v[168:171], v[204:207]
ds_read_b128 a[152:155], v236 offset:52224
v_fma_f32 v199, v199, v245, v253
v_mfma_f32_16x16x32_bf16 v[204:207], a[156:159], v[172:175], v[204:207]
ds_read_b128 a[156:159], v237 offset:52224
v_cvt_pk_bf16_f32 v197, v198, v199
v_mfma_f32_16x16x32_bf16 v[204:207], a[160:163], v[176:179], v[204:207]
ds_write_b64 v243, v[196:197] offset:8192
v_mfma_f32_16x16x32_bf16 v[204:207], a[164:167], v[180:183], v[204:207]
buffer_load_dwordx4 v239, s[92:95], s57 offen lds
v_mfma_f32_16x16x32_bf16 v[204:207], a[168:171], v[184:187], v[204:207]
buffer_store_dwordx4 a[204:207], v239, s[24:27], s54 offen offset:0 sc1
v_mfma_f32_16x16x32_bf16 v[204:207], a[172:175], v[188:191], v[204:207]
s_waitcnt lgkmcnt(4)
v_fma_f32 v200, v200, v246, v254
v_fma_f32 v201, v201, v246, v254
L_p1_2:
v_mfma_f32_16x16x32_bf16 v[40:43], a[128:131], a[0:3], 0
s_add_u32 m0, s38, s58
v_cvt_pk_bf16_f32 v214, v200, v201
v_fma_f32 v202, v202, v246, v254
v_mfma_f32_16x16x32_bf16 v[40:43], a[132:135], a[4:7], v[40:43]
ds_read_b128 a[160:163], v236 offset:57344
v_fma_f32 v203, v203, v246, v254
v_mfma_f32_16x16x32_bf16 v[40:43], a[136:139], a[8:11], v[40:43]
ds_read_b128 a[164:167], v237 offset:57344
v_cvt_pk_bf16_f32 v215, v202, v203
v_mfma_f32_16x16x32_bf16 v[40:43], a[140:143], a[12:15], v[40:43]
ds_write_b64 v243, v[214:215] offset:16384
v_mfma_f32_16x16x32_bf16 v[40:43], a[144:147], a[16:19], v[40:43]
v_fma_f32 v204, v204, v247, v255
v_fma_f32 v205, v205, v247, v255
v_mfma_f32_16x16x32_bf16 v[40:43], a[148:151], a[20:23], v[40:43]
s_waitcnt lgkmcnt(4)
v_cvt_pk_bf16_f32 v222, v204, v205
v_fma_f32 v206, v206, v247, v255
v_mfma_f32_16x16x32_bf16 v[40:43], a[152:155], a[24:27], v[40:43]
v_fma_f32 v207, v207, v247, v255
v_cvt_pk_bf16_f32 v223, v206, v207
v_mfma_f32_16x16x32_bf16 v[40:43], a[156:159], a[28:31], v[40:43]
ds_write_b64 v243, v[222:223] offset:24576
L_t3:
v_mfma_f32_16x16x32_bf16 v[88:91], a[156:159], a[60:63], 0
v_mfma_f32_16x16x32_bf16 v[88:91], a[152:155], a[56:59], v[88:91]
ds_read_b128 a[168:171], v236 offset:58368
v_mfma_f32_16x16x32_bf16 v[88:91], a[148:151], a[52:55], v[88:91]
ds_read_b128 a[172:175], v237 offset:58368
s_nop 1
v_max3_f32 v184, v40, v41, v42
v_max_f32 v184, v184, v43
v_mov_b32 v185, v184
v_mfma_f32_16x16x32_bf16 v[88:91], a[144:147], a[48:51], v[88:91]
s_nop 0
v_permlane32_swap_b32 v184, v185
v_max_f32 v184, v184, v185
v_mov_b32 v185, v184
s_nop 1
v_permlane16_swap_b32 v184, v185
v_max_f32 v184, v184, v185
v_sub_f32 v228, s78, v184
v_mul_f32 v185, s41, v228
v_fma_f32 v40, v40, s41, v185
v_fma_f32 v41, v41, s41, v185
v_mfma_f32_16x16x32_bf16 v[88:91], a[140:143], a[44:47], v[88:91]
v_exp_f32 v40, v40
v_mov_b32 v229, v228
v_mov_b32 v230, v228
v_mov_b32 v231, v228
v_mfma_f32_16x16x32_bf16 v[88:91], a[136:139], a[40:43], v[88:91]
v_fma_f32 v42, v42, s41, v185
v_fma_f32 v43, v43, s41, v185
v_mfma_f32_16x16x32_bf16 v[88:91], a[132:135], a[36:39], v[88:91]
v_exp_f32 v41, v41
v_mfma_f32_16x16x32_bf16 v[88:91], a[128:131], a[32:35], v[88:91]
v_exp_f32 v42, v42
v_mfma_f32_16x16x32_bf16 v[136:139], a[128:131], a[64:67], 0
buffer_load_dwordx4 v239, s[92:95], s58 offen lds
v_exp_f32 v43, v43
v_mfma_f32_16x16x32_bf16 v[136:139], a[132:135], a[68:71], v[136:139]
ds_read_b128 v[192:195], v236 offset:59392
v_cvt_pk_bf16_f32 v0, v40, v41
s_nop 0
v_max3_f32 v184, v88, v89, v90
v_max_f32 v184, v184, v91
v_mov_b32 v185, v184
v_mfma_f32_16x16x32_bf16 v[136:139], a[136:139], a[72:75], v[136:139]
ds_read_b128 v[196:199], v237 offset:59392
v_cvt_pk_bf16_f32 v1, v42, v43
v_permlane32_swap_b32 v184, v185
v_max_f32 v184, v184, v185
v_mov_b32 v185, v184
v_mfma_f32_16x16x32_bf16 v[136:139], a[140:143], a[76:79], v[136:139]
s_add_u32 m0, s38, s59
v_permlane16_swap_b32 v184, v185
v_max_f32 v184, v184, v185
v_sub_f32 v252, s78, v184
v_mul_f32 v185, s41, v252
v_fma_f32 v88, v88, s41, v185
v_fma_f32 v89, v89, s41, v185
v_mfma_f32_16x16x32_bf16 v[136:139], a[144:147], a[80:83], v[136:139]
buffer_store_dwordx4 a[208:211], v239, s[24:27], s55 offen offset:0 sc1
v_exp_f32 v88, v88
v_mov_b32 v253, v252
v_mov_b32 v254, v252
v_mov_b32 v255, v252
v_mfma_f32_16x16x32_bf16 v[136:139], a[148:151], a[84:87], v[136:139]
v_fma_f32 v90, v90, s41, v185
v_fma_f32 v91, v91, s41, v185
v_mfma_f32_16x16x32_bf16 v[136:139], a[152:155], a[88:91], v[136:139]
v_exp_f32 v89, v89
v_mfma_f32_16x16x32_bf16 v[136:139], a[156:159], a[92:95], v[136:139]
v_exp_f32 v90, v90
v_mfma_f32_16x16x32_bf16 v[40:43], a[156:159], a[124:127], 0
v_exp_f32 v91, v91
v_mfma_f32_16x16x32_bf16 v[40:43], a[152:155], a[120:123], v[40:43]
ds_read_b128 a[156:159], v237 offset:60416
v_cvt_pk_bf16_f32 v48, v88, v89
s_nop 1
v_max3_f32 v184, v136, v137, v138
v_max_f32 v184, v184, v139
v_mov_b32 v185, v184
v_mfma_f32_16x16x32_bf16 v[40:43], a[148:151], a[116:119], v[40:43]
ds_read_b128 a[152:155], v236 offset:60416
v_cvt_pk_bf16_f32 v49, v90, v91
v_permlane32_swap_b32 v184, v185
v_max_f32 v184, v184, v185
v_mov_b32 v185, v184
v_mfma_f32_16x16x32_bf16 v[40:43], a[144:147], a[112:115], v[40:43]
s_nop 0
v_permlane16_swap_b32 v184, v185
v_max_f32 v184, v184, v185
v_sub_f32 v244, s78, v184
v_mul_f32 v185, s41, v244
v_fma_f32 v136, v136, s41, v185
v_fma_f32 v137, v137, s41, v185
v_mfma_f32_16x16x32_bf16 v[40:43], a[140:143], a[108:111], v[40:43]
v_exp_f32 v136, v136
v_mov_b32 v245, v244
v_mov_b32 v246, v244
v_mov_b32 v247, v244
v_mfma_f32_16x16x32_bf16 v[40:43], a[136:139], a[104:107], v[40:43]
v_fma_f32 v138, v138, s41, v185
v_fma_f32 v139, v139, s41, v185
v_mfma_f32_16x16x32_bf16 v[40:43], a[132:135], a[100:103], v[40:43]
v_exp_f32 v137, v137
v_mfma_f32_16x16x32_bf16 v[40:43], a[128:131], a[96:99], v[40:43]
s_waitcnt lgkmcnt(2)
v_exp_f32 v138, v138
v_mfma_f32_16x16x32_bf16 v[88:91], a[160:163], a[0:3], v[228:231]
v_exp_f32 v139, v139
v_mfma_f32_16x16x32_bf16 v[88:91], a[164:167], a[4:7], v[88:91]
ds_read_b128 a[128:131], v249 offset:8192
v_cvt_pk_bf16_f32 v96, v136, v137
s_nop 0
v_max3_f32 v184, v40, v41, v42
v_max_f32 v184, v184, v43
v_mov_b32 v185, v184
v_mfma_f32_16x16x32_bf16 v[88:91], a[168:171], a[8:11], v[88:91]
ds_read_b128 a[132:135], v250 offset:8192
v_cvt_pk_bf16_f32 v97, v138, v139
v_permlane32_swap_b32 v184, v185
v_max_f32 v184, v184, v185
v_mov_b32 v185, v184
v_mfma_f32_16x16x32_bf16 v[88:91], a[172:175], a[12:15], v[88:91]
buffer_load_dwordx4 v239, s[92:95], s59 offen lds
v_permlane16_swap_b32 v184, v185
v_max_f32 v184, v184, v185
v_sub_f32 v220, s78, v184
v_mul_f32 v185, s41, v220
v_fma_f32 v40, v40, s41, v185
v_fma_f32 v41, v41, s41, v185
v_mfma_f32_16x16x32_bf16 v[88:91], v[192:195], a[16:19], v[88:91]
s_add_u32 m0, s38, s60
v_exp_f32 v40, v40
v_mov_b32 v221, v220
v_mov_b32 v222, v220
v_mov_b32 v223, v220
v_mfma_f32_16x16x32_bf16 v[88:91], v[196:199], a[20:23], v[88:91]
s_waitcnt lgkmcnt(2)
v_fma_f32 v42, v42, s41, v185
v_fma_f32 v43, v43, s41, v185
v_mfma_f32_16x16x32_bf16 v[88:91], a[152:155], a[24:27], v[88:91]
v_exp_f32 v41, v41
v_mfma_f32_16x16x32_bf16 v[88:91], a[156:159], a[28:31], v[88:91]
v_exp_f32 v42, v42
v_mfma_f32_16x16x32_bf16 v[136:139], a[156:159], a[60:63], v[252:255]
v_exp_f32 v43, v43
v_mfma_f32_16x16x32_bf16 v[136:139], a[152:155], a[56:59], v[136:139]
ds_read_b128 a[136:139], v249 offset:9216
v_cvt_pk_bf16_f32 v144, v40, v41
v_mfma_f32_16x16x32_bf16 v[136:139], v[196:199], a[52:55], v[136:139]
ds_read_b128 a[140:143], v250 offset:9216
v_cvt_pk_bf16_f32 v145, v42, v43
v_mfma_f32_16x16x32_bf16 v[136:139], v[192:195], a[48:51], v[136:139]
buffer_store_dwordx4 a[212:215], v239, s[24:27], s48 offen offset:128 sc1
v_mul_f32 v88, s41, v88
v_mul_f32 v89, s41, v89
v_mfma_f32_16x16x32_bf16 v[136:139], a[172:175], a[44:47], v[136:139]
v_exp_f32 v88, v88
v_mfma_f32_16x16x32_bf16 v[136:139], a[168:171], a[40:43], v[136:139]
v_mul_f32 v90, s41, v90
v_mul_f32 v91, s41, v91
v_mfma_f32_16x16x32_bf16 v[136:139], a[164:167], a[36:39], v[136:139]
v_exp_f32 v89, v89
v_mfma_f32_16x16x32_bf16 v[136:139], a[160:163], a[32:35], v[136:139]
v_exp_f32 v90, v90
v_mfma_f32_16x16x32_bf16 v[40:43], a[160:163], a[64:67], v[244:247]
v_exp_f32 v91, v91
v_mfma_f32_16x16x32_bf16 v[40:43], a[164:167], a[68:71], v[40:43]
ds_read_b128 a[144:147], v249 offset:10240
v_cvt_pk_bf16_f32 v2, v88, v89
v_mfma_f32_16x16x32_bf16 v[40:43], a[168:171], a[72:75], v[40:43]
ds_read_b128 a[148:151], v250 offset:10240
v_cvt_pk_bf16_f32 v3, v90, v91
v_mfma_f32_16x16x32_bf16 v[40:43], a[172:175], a[76:79], v[40:43]
v_mul_f32 v136, s41, v136
v_mul_f32 v137, s41, v137
v_mfma_f32_16x16x32_bf16 v[40:43], v[192:195], a[80:83], v[40:43]
v_exp_f32 v136, v136
v_mfma_f32_16x16x32_bf16 v[40:43], v[196:199], a[84:87], v[40:43]
buffer_load_dwordx4 v239, s[92:95], s60 offen lds
v_mul_f32 v138, s41, v138
v_mul_f32 v139, s41, v139
v_mfma_f32_16x16x32_bf16 v[40:43], a[152:155], a[88:91], v[40:43]
s_add_u32 m0, s38, s61
v_exp_f32 v137, v137
v_mfma_f32_16x16x32_bf16 v[40:43], a[156:159], a[92:95], v[40:43]
v_exp_f32 v138, v138
v_mfma_f32_16x16x32_bf16 v[88:91], a[156:159], a[124:127], v[220:223]
v_exp_f32 v139, v139
v_mfma_f32_16x16x32_bf16 v[88:91], a[152:155], a[120:123], v[88:91]
ds_read_b128 a[156:159], v250 offset:11264
v_cvt_pk_bf16_f32 v50, v136, v137
v_mfma_f32_16x16x32_bf16 v[88:91], v[196:199], a[116:119], v[88:91]
ds_read_b128 a[152:155], v249 offset:11264
v_cvt_pk_bf16_f32 v51, v138, v139
v_mfma_f32_16x16x32_bf16 v[88:91], v[192:195], a[112:115], v[88:91]
v_mul_f32 v40, s41, v40
v_mul_f32 v41, s41, v41
v_mfma_f32_16x16x32_bf16 v[88:91], a[172:175], a[108:111], v[88:91]
v_exp_f32 v40, v40
v_mfma_f32_16x16x32_bf16 v[88:91], a[168:171], a[104:107], v[88:91]
v_mul_f32 v42, s41, v42
v_mul_f32 v43, s41, v43
v_mfma_f32_16x16x32_bf16 v[88:91], a[164:167], a[100:103], v[88:91]
v_exp_f32 v41, v41
v_mfma_f32_16x16x32_bf16 v[88:91], a[160:163], a[96:99], v[88:91]
s_waitcnt lgkmcnt(2)
v_exp_f32 v42, v42
v_mfma_f32_16x16x32_bf16 v[200:203], a[128:131], a[0:3], v[228:231]
v_exp_f32 v43, v43
v_mfma_f32_16x16x32_bf16 v[200:203], a[132:135], a[4:7], v[200:203]
ds_read_b128 a[160:163], v249 offset:16384
v_cvt_pk_bf16_f32 v98, v40, v41
v_mfma_f32_16x16x32_bf16 v[200:203], a[136:139], a[8:11], v[200:203]
ds_read_b128 a[164:167], v250 offset:16384
v_cvt_pk_bf16_f32 v99, v42, v43
v_mfma_f32_16x16x32_bf16 v[200:203], a[140:143], a[12:15], v[200:203]
buffer_store_dwordx4 a[216:219], v239, s[24:27], s49 offen offset:128 sc1
v_mul_f32 v88, s41, v88
v_mul_f32 v89, s41, v89
v_mfma_f32_16x16x32_bf16 v[200:203], a[144:147], a[16:19], v[200:203]
v_exp_f32 v88, v88
v_mfma_f32_16x16x32_bf16 v[200:203], a[148:151], a[20:23], v[200:203]
s_waitcnt lgkmcnt(2)
v_mul_f32 v90, s41, v90
v_mul_f32 v91, s41, v91
v_mfma_f32_16x16x32_bf16 v[200:203], a[152:155], a[24:27], v[200:203]
v_exp_f32 v89, v89
v_mfma_f32_16x16x32_bf16 v[200:203], a[156:159], a[28:31], v[200:203]
v_exp_f32 v90, v90
v_mfma_f32_16x16x32_bf16 v[208:211], a[252:255], v[0:3], 0
buffer_load_dwordx4 v239, s[92:95], s61 offen lds
v_mfma_f32_16x16x32_bf16 v[204:207], a[156:159], a[60:63], v[252:255]
s_add_u32 m0, s39, s56
v_exp_f32 v91, v91
v_mfma_f32_16x16x32_bf16 v[204:207], a[152:155], a[56:59], v[204:207]
ds_read_b128 a[168:171], v249 offset:17408
v_cvt_pk_bf16_f32 v146, v88, v89
v_mfma_f32_16x16x32_bf16 v[204:207], a[148:151], a[52:55], v[204:207]
ds_read_b128 a[172:175], v250 offset:17408
v_cvt_pk_bf16_f32 v147, v90, v91
v_mfma_f32_16x16x32_bf16 v[204:207], a[144:147], a[48:51], v[204:207]
s_add_u32 s92, s92, 49152
s_addc_u32 s93, s93, 0
v_mul_f32 v200, s41, v200
v_mul_f32 v201, s41, v201
v_mfma_f32_16x16x32_bf16 v[204:207], a[140:143], a[44:47], v[204:207]
v_exp_f32 v200, v200
v_mfma_f32_16x16x32_bf16 v[204:207], a[136:139], a[40:43], v[204:207]
v_mul_f32 v202, s41, v202
v_mul_f32 v203, s41, v203
v_mfma_f32_16x16x32_bf16 v[204:207], a[132:135], a[36:39], v[204:207]
v_exp_f32 v201, v201
v_mfma_f32_16x16x32_bf16 v[204:207], a[128:131], a[32:35], v[204:207]
v_exp_f32 v202, v202
v_mfma_f32_16x16x32_bf16 v[210:213], a[252:255], v[48:51], 0
buffer_load_dwordx4 v239, s[16:19], s56 offen lds
v_mfma_f32_16x16x32_bf16 v[224:227], a[128:131], a[64:67], v[244:247]
s_add_u32 m0, s39, s57
v_exp_f32 v203, v203
v_mfma_f32_16x16x32_bf16 v[224:227], a[132:135], a[68:71], v[224:227]
ds_read_b128 v[192:195], v249 offset:18432
v_cvt_pk_bf16_f32 v4, v200, v201
v_mfma_f32_16x16x32_bf16 v[224:227], a[136:139], a[72:75], v[224:227]
ds_read_b128 v[196:199], v250 offset:18432
v_cvt_pk_bf16_f32 v5, v202, v203
v_mfma_f32_16x16x32_bf16 v[224:227], a[140:143], a[76:79], v[224:227]
v_mul_f32 v204, s41, v204
v_mul_f32 v205, s41, v205
v_mfma_f32_16x16x32_bf16 v[224:227], a[144:147], a[80:83], v[224:227]
v_exp_f32 v204, v204
v_mfma_f32_16x16x32_bf16 v[224:227], a[148:151], a[84:87], v[224:227]
v_mul_f32 v206, s41, v206
v_mul_f32 v207, s41, v207
v_mfma_f32_16x16x32_bf16 v[224:227], a[152:155], a[88:91], v[224:227]
v_exp_f32 v205, v205
v_mfma_f32_16x16x32_bf16 v[224:227], a[156:159], a[92:95], v[224:227]
v_exp_f32 v206, v206
v_mfma_f32_16x16x32_bf16 v[212:215], a[252:255], v[96:99], 0
buffer_load_dwordx4 v239, s[16:19], s57 offen lds
v_mfma_f32_16x16x32_bf16 v[200:203], a[156:159], a[124:127], v[220:223]
buffer_store_dwordx4 a[220:223], v239, s[24:27], s50 offen offset:128 sc1
v_exp_f32 v207, v207
v_mfma_f32_16x16x32_bf16 v[200:203], a[152:155], a[120:123], v[200:203]
ds_read_b128 a[156:159], v250 offset:19456
v_cvt_pk_bf16_f32 v52, v204, v205
v_mfma_f32_16x16x32_bf16 v[200:203], a[148:151], a[116:119], v[200:203]
ds_read_b128 a[152:155], v249 offset:19456
v_cvt_pk_bf16_f32 v53, v206, v207
v_mfma_f32_16x16x32_bf16 v[200:203], a[144:147], a[112:115], v[200:203]
s_add_u32 m0, s39, s58
v_mul_f32 v224, s41, v224
v_mul_f32 v225, s41, v225
v_mfma_f32_16x16x32_bf16 v[200:203], a[140:143], a[108:111], v[200:203]
v_exp_f32 v224, v224
v_mfma_f32_16x16x32_bf16 v[200:203], a[136:139], a[104:107], v[200:203]
v_mul_f32 v226, s41, v226
v_mul_f32 v227, s41, v227
v_mfma_f32_16x16x32_bf16 v[200:203], a[132:135], a[100:103], v[200:203]
v_exp_f32 v225, v225
v_mfma_f32_16x16x32_bf16 v[200:203], a[128:131], a[96:99], v[200:203]
s_waitcnt lgkmcnt(2)
v_exp_f32 v226, v226
v_mfma_f32_16x16x32_bf16 v[204:207], a[160:163], a[0:3], v[228:231]
v_exp_f32 v227, v227
v_mfma_f32_16x16x32_bf16 v[204:207], a[164:167], a[4:7], v[204:207]
ds_read_b128 a[128:131], v249 offset:24576
v_cvt_pk_bf16_f32 v100, v224, v225
v_mfma_f32_16x16x32_bf16 v[204:207], a[168:171], a[8:11], v[204:207]
ds_read_b128 a[132:135], v250 offset:24576
v_cvt_pk_bf16_f32 v101, v226, v227
v_mfma_f32_16x16x32_bf16 v[204:207], a[172:175], a[12:15], v[204:207]
v_mul_f32 v200, s41, v200
v_mul_f32 v201, s41, v201
v_mfma_f32_16x16x32_bf16 v[204:207], v[192:195], a[16:19], v[204:207]
v_exp_f32 v200, v200
v_mfma_f32_16x16x32_bf16 v[204:207], v[196:199], a[20:23], v[204:207]
s_waitcnt lgkmcnt(2)
v_mul_f32 v202, s41, v202
v_mul_f32 v203, s41, v203
v_mfma_f32_16x16x32_bf16 v[204:207], a[152:155], a[24:27], v[204:207]
v_exp_f32 v201, v201
v_mfma_f32_16x16x32_bf16 v[204:207], a[156:159], a[28:31], v[204:207]
v_exp_f32 v202, v202
v_mfma_f32_16x16x32_bf16 v[214:217], a[252:255], v[144:147], 0
buffer_load_dwordx4 v239, s[16:19], s58 offen lds
v_mfma_f32_16x16x32_bf16 v[224:227], a[156:159], a[60:63], v[252:255]
s_add_u32 m0, s39, s59
v_exp_f32 v203, v203
v_mfma_f32_16x16x32_bf16 v[224:227], a[152:155], a[56:59], v[224:227]
ds_read_b128 a[136:139], v249 offset:25600
v_cvt_pk_bf16_f32 v148, v200, v201
v_mfma_f32_16x16x32_bf16 v[224:227], v[196:199], a[52:55], v[224:227]
ds_read_b128 a[140:143], v250 offset:25600
v_cvt_pk_bf16_f32 v149, v202, v203
v_mfma_f32_16x16x32_bf16 v[224:227], v[192:195], a[48:51], v[224:227]
v_mul_f32 v204, s41, v204
v_mul_f32 v205, s41, v205
v_mfma_f32_16x16x32_bf16 v[224:227], a[172:175], a[44:47], v[224:227]
v_exp_f32 v204, v204
v_mfma_f32_16x16x32_bf16 v[224:227], a[168:171], a[40:43], v[224:227]
buffer_store_dwordx4 a[224:227], v239, s[24:27], s51 offen offset:128 sc1
v_mul_f32 v206, s41, v206
v_mul_f32 v207, s41, v207
v_mfma_f32_16x16x32_bf16 v[224:227], a[164:167], a[36:39], v[224:227]
v_exp_f32 v205, v205
v_mfma_f32_16x16x32_bf16 v[224:227], a[160:163], a[32:35], v[224:227]
v_exp_f32 v206, v206
v_mfma_f32_16x16x32_bf16 v[200:203], a[160:163], a[64:67], v[244:247]
v_exp_f32 v207, v207
v_mfma_f32_16x16x32_bf16 v[200:203], a[164:167], a[68:71], v[200:203]
ds_read_b128 a[144:147], v249 offset:26624
v_cvt_pk_bf16_f32 v6, v204, v205
v_mfma_f32_16x16x32_bf16 v[200:203], a[168:171], a[72:75], v[200:203]
ds_read_b128 a[148:151], v250 offset:26624
v_cvt_pk_bf16_f32 v7, v206, v207
v_mfma_f32_16x16x32_bf16 v[200:203], a[172:175], a[76:79], v[200:203]
v_mul_f32 v224, s41, v224
v_mul_f32 v225, s41, v225
v_mfma_f32_16x16x32_bf16 v[200:203], v[192:195], a[80:83], v[200:203]
v_exp_f32 v224, v224
v_mfma_f32_16x16x32_bf16 v[200:203], v[196:199], a[84:87], v[200:203]
v_mul_f32 v226, s41, v226
v_mul_f32 v227, s41, v227
v_mfma_f32_16x16x32_bf16 v[200:203], a[152:155], a[88:91], v[200:203]
v_exp_f32 v225, v225
v_mfma_f32_16x16x32_bf16 v[200:203], a[156:159], a[92:95], v[200:203]
v_exp_f32 v226, v226
v_mfma_f32_16x16x32_bf16 v[208:211], a[252:255], v[4:7], v[208:211]
buffer_load_dwordx4 v239, s[16:19], s59 offen lds
v_mfma_f32_16x16x32_bf16 v[204:207], a[156:159], a[124:127], v[220:223]
s_add_u32 m0, s39, s60
v_exp_f32 v227, v227
v_mfma_f32_16x16x32_bf16 v[204:207], a[152:155], a[120:123], v[204:207]
ds_read_b128 a[156:159], v250 offset:27648
v_cvt_pk_bf16_f32 v54, v224, v225
v_mfma_f32_16x16x32_bf16 v[204:207], v[196:199], a[116:119], v[204:207]
ds_read_b128 a[152:155], v249 offset:27648
v_cvt_pk_bf16_f32 v55, v226, v227
v_mfma_f32_16x16x32_bf16 v[204:207], v[192:195], a[112:115], v[204:207]
v_mul_f32 v200, s41, v200
v_mul_f32 v201, s41, v201
v_mfma_f32_16x16x32_bf16 v[204:207], a[172:175], a[108:111], v[204:207]
v_exp_f32 v200, v200
v_mfma_f32_16x16x32_bf16 v[204:207], a[168:171], a[104:107], v[204:207]
v_mul_f32 v202, s41, v202
v_mul_f32 v203, s41, v203
v_mfma_f32_16x16x32_bf16 v[204:207], a[164:167], a[100:103], v[204:207]
v_exp_f32 v201, v201
v_mfma_f32_16x16x32_bf16 v[204:207], a[160:163], a[96:99], v[204:207]
s_waitcnt lgkmcnt(2)
v_exp_f32 v202, v202
v_mfma_f32_16x16x32_bf16 v[224:227], a[128:131], a[0:3], v[228:231]
v_exp_f32 v203, v203
v_mfma_f32_16x16x32_bf16 v[224:227], a[132:135], a[4:7], v[224:227]
ds_read_b128 a[160:163], v249 offset:32768
v_cvt_pk_bf16_f32 v102, v200, v201
v_mfma_f32_16x16x32_bf16 v[224:227], a[136:139], a[8:11], v[224:227]
ds_read_b128 a[164:167], v250 offset:32768
v_cvt_pk_bf16_f32 v103, v202, v203
v_mfma_f32_16x16x32_bf16 v[224:227], a[140:143], a[12:15], v[224:227]
v_mul_f32 v204, s41, v204
v_mul_f32 v205, s41, v205
v_mfma_f32_16x16x32_bf16 v[224:227], a[144:147], a[16:19], v[224:227]
buffer_store_dwordx4 a[228:231], v239, s[24:27], s52 offen offset:128 sc1
v_exp_f32 v204, v204
v_mfma_f32_16x16x32_bf16 v[224:227], a[148:151], a[20:23], v[224:227]
s_waitcnt lgkmcnt(2)
v_mul_f32 v206, s41, v206
v_mul_f32 v207, s41, v207
v_mfma_f32_16x16x32_bf16 v[224:227], a[152:155], a[24:27], v[224:227]
v_exp_f32 v205, v205
v_mfma_f32_16x16x32_bf16 v[224:227], a[156:159], a[28:31], v[224:227]
v_exp_f32 v206, v206
v_mfma_f32_16x16x32_bf16 v[210:213], a[252:255], v[52:55], v[210:213]
buffer_load_dwordx4 v239, s[16:19], s60 offen lds
v_mfma_f32_16x16x32_bf16 v[200:203], a[156:159], a[60:63], v[252:255]
s_add_u32 m0, s39, s61
v_exp_f32 v207, v207
v_mfma_f32_16x16x32_bf16 v[200:203], a[152:155], a[56:59], v[200:203]
ds_read_b128 a[168:171], v249 offset:33792
v_cvt_pk_bf16_f32 v150, v204, v205
v_mfma_f32_16x16x32_bf16 v[200:203], a[148:151], a[52:55], v[200:203]
ds_read_b128 a[172:175], v250 offset:33792
v_cvt_pk_bf16_f32 v151, v206, v207
v_mfma_f32_16x16x32_bf16 v[200:203], a[144:147], a[48:51], v[200:203]
v_mul_f32 v224, s41, v224
v_mul_f32 v225, s41, v225
v_mfma_f32_16x16x32_bf16 v[200:203], a[140:143], a[44:47], v[200:203]
v_exp_f32 v224, v224
v_mfma_f32_16x16x32_bf16 v[200:203], a[136:139], a[40:43], v[200:203]
v_mul_f32 v226, s41, v226
v_mul_f32 v227, s41, v227
v_mfma_f32_16x16x32_bf16 v[200:203], a[132:135], a[36:39], v[200:203]
v_exp_f32 v225, v225
v_mfma_f32_16x16x32_bf16 v[200:203], a[128:131], a[32:35], v[200:203]
v_exp_f32 v226, v226
v_mfma_f32_16x16x32_bf16 v[204:207], a[128:131], a[64:67], v[244:247]
v_exp_f32 v227, v227
v_mfma_f32_16x16x32_bf16 v[204:207], a[132:135], a[68:71], v[204:207]
ds_read_b128 v[192:195], v249 offset:34816
v_cvt_pk_bf16_f32 v8, v224, v225
v_mfma_f32_16x16x32_bf16 v[204:207], a[136:139], a[72:75], v[204:207]
ds_read_b128 v[196:199], v250 offset:34816
v_cvt_pk_bf16_f32 v9, v226, v227
v_mfma_f32_16x16x32_bf16 v[204:207], a[140:143], a[76:79], v[204:207]
v_mul_f32 v200, s41, v200
v_mul_f32 v201, s41, v201
v_mfma_f32_16x16x32_bf16 v[204:207], a[144:147], a[80:83], v[204:207]
v_exp_f32 v200, v200
v_mfma_f32_16x16x32_bf16 v[204:207], a[148:151], a[84:87], v[204:207]
v_mul_f32 v202, s41, v202
v_mul_f32 v203, s41, v203
v_mfma_f32_16x16x32_bf16 v[204:207], a[152:155], a[88:91], v[204:207]
v_exp_f32 v201, v201
v_mfma_f32_16x16x32_bf16 v[204:207], a[156:159], a[92:95], v[204:207]
v_exp_f32 v202, v202
v_mfma_f32_16x16x32_bf16 v[212:215], a[252:255], v[100:103], v[212:215]
buffer_load_dwordx4 v239, s[16:19], s61 offen lds
v_mfma_f32_16x16x32_bf16 v[224:227], a[156:159], a[124:127], v[220:223]
s_add_u32 m0, s40, s56
v_exp_f32 v203, v203
v_mfma_f32_16x16x32_bf16 v[224:227], a[152:155], a[120:123], v[224:227]
ds_read_b128 a[156:159], v250 offset:35840
v_cvt_pk_bf16_f32 v56, v200, v201
v_mfma_f32_16x16x32_bf16 v[224:227], a[148:151], a[116:119], v[224:227]
ds_read_b128 a[152:155], v249 offset:35840
v_cvt_pk_bf16_f32 v57, v202, v203
v_mfma_f32_16x16x32_bf16 v[224:227], a[144:147], a[112:115], v[224:227]
buffer_store_dwordx4 a[232:235], v239, s[24:27], s53 offen offset:128 sc1
v_mul_f32 v204, s41, v204
v_mul_f32 v205, s41, v205
v_mfma_f32_16x16x32_bf16 v[224:227], a[140:143], a[108:111], v[224:227]
s_add_u32 s16, s16, 49152
s_addc_u32 s17, s17, 0
v_exp_f32 v204, v204
v_mfma_f32_16x16x32_bf16 v[224:227], a[136:139], a[104:107], v[224:227]
v_mul_f32 v206, s41, v206
v_mul_f32 v207, s41, v207
v_mfma_f32_16x16x32_bf16 v[224:227], a[132:135], a[100:103], v[224:227]
v_exp_f32 v205, v205
v_mfma_f32_16x16x32_bf16 v[224:227], a[128:131], a[96:99], v[224:227]
s_waitcnt vmcnt(10) lgkmcnt(0)
v_exp_f32 v206, v206
v_mfma_f32_16x16x32_bf16 v[200:203], a[160:163], a[0:3], v[228:231]
s_barrier
v_exp_f32 v207, v207
v_mfma_f32_16x16x32_bf16 v[200:203], a[164:167], a[4:7], v[200:203]
ds_read_b128 a[128:131], v249 offset:40960
v_cvt_pk_bf16_f32 v104, v204, v205
v_mfma_f32_16x16x32_bf16 v[200:203], a[168:171], a[8:11], v[200:203]
ds_read_b128 a[132:135], v250 offset:40960
v_cvt_pk_bf16_f32 v105, v206, v207
v_mfma_f32_16x16x32_bf16 v[200:203], a[172:175], a[12:15], v[200:203]
v_mul_f32 v224, s41, v224
v_mul_f32 v225, s41, v225
v_mfma_f32_16x16x32_bf16 v[200:203], v[192:195], a[16:19], v[200:203]
v_exp_f32 v224, v224
v_mfma_f32_16x16x32_bf16 v[200:203], v[196:199], a[20:23], v[200:203]
v_mul_f32 v226, s41, v226
v_mul_f32 v227, s41, v227
v_mfma_f32_16x16x32_bf16 v[200:203], a[152:155], a[24:27], v[200:203]
v_exp_f32 v225, v225
v_mfma_f32_16x16x32_bf16 v[200:203], a[156:159], a[28:31], v[200:203]
v_exp_f32 v226, v226
v_mfma_f32_16x16x32_bf16 v[214:217], a[252:255], v[148:151], v[214:217]
buffer_load_dwordx4 v239, s[92:95], s56 offen lds
v_mfma_f32_16x16x32_bf16 v[204:207], a[156:159], a[60:63], v[252:255]
s_add_u32 m0, s40, s57
v_exp_f32 v227, v227
v_mfma_f32_16x16x32_bf16 v[204:207], a[152:155], a[56:59], v[204:207]
ds_read_b128 a[136:139], v249 offset:41984
v_cvt_pk_bf16_f32 v152, v224, v225
v_mfma_f32_16x16x32_bf16 v[204:207], v[196:199], a[52:55], v[204:207]
ds_read_b128 a[140:143], v250 offset:41984
v_cvt_pk_bf16_f32 v153, v226, v227
v_mfma_f32_16x16x32_bf16 v[204:207], v[192:195], a[48:51], v[204:207]
v_mul_f32 v200, s41, v200
v_mul_f32 v201, s41, v201
v_mfma_f32_16x16x32_bf16 v[204:207], a[172:175], a[44:47], v[204:207]
v_exp_f32 v200, v200
v_mfma_f32_16x16x32_bf16 v[204:207], a[168:171], a[40:43], v[204:207]
v_mul_f32 v202, s41, v202
v_mul_f32 v203, s41, v203
v_mfma_f32_16x16x32_bf16 v[204:207], a[164:167], a[36:39], v[204:207]
v_exp_f32 v201, v201
v_mfma_f32_16x16x32_bf16 v[204:207], a[160:163], a[32:35], v[204:207]
v_exp_f32 v202, v202
v_mfma_f32_16x16x32_bf16 v[224:227], a[160:163], a[64:67], v[244:247]
v_exp_f32 v203, v203
v_mfma_f32_16x16x32_bf16 v[224:227], a[164:167], a[68:71], v[224:227]
ds_read_b128 a[144:147], v249 offset:43008
v_cvt_pk_bf16_f32 v10, v200, v201
v_mfma_f32_16x16x32_bf16 v[224:227], a[168:171], a[72:75], v[224:227]
ds_read_b128 a[148:151], v250 offset:43008
v_cvt_pk_bf16_f32 v11, v202, v203
v_mfma_f32_16x16x32_bf16 v[224:227], a[172:175], a[76:79], v[224:227]
v_mul_f32 v204, s41, v204
v_mul_f32 v205, s41, v205
v_mfma_f32_16x16x32_bf16 v[224:227], v[192:195], a[80:83], v[224:227]
buffer_store_dwordx4 a[236:239], v239, s[24:27], s54 offen offset:128 sc1
v_exp_f32 v204, v204
v_mfma_f32_16x16x32_bf16 v[224:227], v[196:199], a[84:87], v[224:227]
v_mul_f32 v206, s41, v206
v_mul_f32 v207, s41, v207
v_mfma_f32_16x16x32_bf16 v[224:227], a[152:155], a[88:91], v[224:227]
v_exp_f32 v205, v205
v_mfma_f32_16x16x32_bf16 v[224:227], a[156:159], a[92:95], v[224:227]
v_exp_f32 v206, v206
v_mfma_f32_16x16x32_bf16 v[208:211], a[252:255], v[8:11], v[208:211]
buffer_load_dwordx4 v239, s[92:95], s57 offen lds
v_mfma_f32_16x16x32_bf16 v[200:203], a[156:159], a[124:127], v[220:223]
s_add_u32 m0, s40, s58
v_exp_f32 v207, v207
v_mfma_f32_16x16x32_bf16 v[200:203], a[152:155], a[120:123], v[200:203]
ds_read_b128 a[156:159], v250 offset:44032
v_cvt_pk_bf16_f32 v58, v204, v205
v_mfma_f32_16x16x32_bf16 v[200:203], v[196:199], a[116:119], v[200:203]
ds_read_b128 a[152:155], v249 offset:44032
v_cvt_pk_bf16_f32 v59, v206, v207
v_mfma_f32_16x16x32_bf16 v[200:203], v[192:195], a[112:115], v[200:203]
v_mul_f32 v224, s41, v224
v_mul_f32 v225, s41, v225
v_mfma_f32_16x16x32_bf16 v[200:203], a[172:175], a[108:111], v[200:203]
v_exp_f32 v224, v224
v_mfma_f32_16x16x32_bf16 v[200:203], a[168:171], a[104:107], v[200:203]
v_mul_f32 v226, s41, v226
v_mul_f32 v227, s41, v227
v_mfma_f32_16x16x32_bf16 v[200:203], a[164:167], a[100:103], v[200:203]
v_exp_f32 v225, v225
v_mfma_f32_16x16x32_bf16 v[200:203], a[160:163], a[96:99], v[200:203]
s_waitcnt lgkmcnt(2)
v_exp_f32 v226, v226
v_mfma_f32_16x16x32_bf16 v[204:207], a[128:131], a[0:3], v[228:231]
v_exp_f32 v227, v227
v_mfma_f32_16x16x32_bf16 v[204:207], a[132:135], a[4:7], v[204:207]
ds_read_b128 a[160:163], v249 offset:49152
v_cvt_pk_bf16_f32 v106, v224, v225
v_mfma_f32_16x16x32_bf16 v[204:207], a[136:139], a[8:11], v[204:207]
ds_read_b128 a[164:167], v250 offset:49152
v_cvt_pk_bf16_f32 v107, v226, v227
v_mfma_f32_16x16x32_bf16 v[204:207], a[140:143], a[12:15], v[204:207]
v_mul_f32 v200, s41, v200
v_mul_f32 v201, s41, v201
v_mfma_f32_16x16x32_bf16 v[204:207], a[144:147], a[16:19], v[204:207]
v_exp_f32 v200, v200
v_mfma_f32_16x16x32_bf16 v[204:207], a[148:151], a[20:23], v[204:207]
s_waitcnt lgkmcnt(2)
v_mul_f32 v202, s41, v202
v_mul_f32 v203, s41, v203
v_mfma_f32_16x16x32_bf16 v[204:207], a[152:155], a[24:27], v[204:207]
v_exp_f32 v201, v201
v_mfma_f32_16x16x32_bf16 v[204:207], a[156:159], a[28:31], v[204:207]
v_exp_f32 v202, v202
v_mfma_f32_16x16x32_bf16 v[210:213], a[252:255], v[56:59], v[210:213]
buffer_load_dwordx4 v239, s[92:95], s58 offen lds
v_mfma_f32_16x16x32_bf16 v[224:227], a[156:159], a[60:63], v[252:255]
s_add_u32 m0, s40, s59
v_exp_f32 v203, v203
v_mfma_f32_16x16x32_bf16 v[224:227], a[152:155], a[56:59], v[224:227]
ds_read_b128 a[168:171], v249 offset:50176
v_cvt_pk_bf16_f32 v154, v200, v201
v_mfma_f32_16x16x32_bf16 v[224:227], a[148:151], a[52:55], v[224:227]
ds_read_b128 a[172:175], v250 offset:50176
v_cvt_pk_bf16_f32 v155, v202, v203
v_mfma_f32_16x16x32_bf16 v[224:227], a[144:147], a[48:51], v[224:227]
v_mul_f32 v204, s41, v204
v_mul_f32 v205, s41, v205
v_mfma_f32_16x16x32_bf16 v[224:227], a[140:143], a[44:47], v[224:227]
v_exp_f32 v204, v204
v_mfma_f32_16x16x32_bf16 v[224:227], a[136:139], a[40:43], v[224:227]
v_mul_f32 v206, s41, v206
v_mul_f32 v207, s41, v207
v_mfma_f32_16x16x32_bf16 v[224:227], a[132:135], a[36:39], v[224:227]
buffer_store_dwordx4 a[240:243], v239, s[24:27], s55 offen offset:128 sc1
v_exp_f32 v205, v205
v_mfma_f32_16x16x32_bf16 v[224:227], a[128:131], a[32:35], v[224:227]
v_exp_f32 v206, v206
v_mfma_f32_16x16x32_bf16 v[200:203], a[128:131], a[64:67], v[244:247]
v_exp_f32 v207, v207
v_mfma_f32_16x16x32_bf16 v[200:203], a[132:135], a[68:71], v[200:203]
ds_read_b128 v[192:195], v249 offset:51200
v_cvt_pk_bf16_f32 v12, v204, v205
v_mfma_f32_16x16x32_bf16 v[200:203], a[136:139], a[72:75], v[200:203]
ds_read_b128 v[196:199], v250 offset:51200
v_cvt_pk_bf16_f32 v13, v206, v207
v_mfma_f32_16x16x32_bf16 v[200:203], a[140:143], a[76:79], v[200:203]
v_mul_f32 v224, s41, v224
v_mul_f32 v225, s41, v225
v_mfma_f32_16x16x32_bf16 v[200:203], a[144:147], a[80:83], v[200:203]
v_exp_f32 v224, v224
v_mfma_f32_16x16x32_bf16 v[200:203], a[148:151], a[84:87], v[200:203]
v_mul_f32 v226, s41, v226
v_mul_f32 v227, s41, v227
v_mfma_f32_16x16x32_bf16 v[200:203], a[152:155], a[88:91], v[200:203]
v_exp_f32 v225, v225
v_mfma_f32_16x16x32_bf16 v[200:203], a[156:159], a[92:95], v[200:203]
v_exp_f32 v226, v226
v_mfma_f32_16x16x32_bf16 v[212:215], a[252:255], v[104:107], v[212:215]
buffer_load_dwordx4 v239, s[92:95], s59 offen lds
v_mfma_f32_16x16x32_bf16 v[204:207], a[156:159], a[124:127], v[220:223]
s_add_u32 m0, s40, s60
v_exp_f32 v227, v227
v_mfma_f32_16x16x32_bf16 v[204:207], a[152:155], a[120:123], v[204:207]
ds_read_b128 a[156:159], v250 offset:52224
v_cvt_pk_bf16_f32 v60, v224, v225
v_mfma_f32_16x16x32_bf16 v[204:207], a[148:151], a[116:119], v[204:207]
ds_read_b128 a[152:155], v249 offset:52224
v_cvt_pk_bf16_f32 v61, v226, v227
v_mfma_f32_16x16x32_bf16 v[204:207], a[144:147], a[112:115], v[204:207]
v_mul_f32 v200, s41, v200
v_mul_f32 v201, s41, v201
v_mfma_f32_16x16x32_bf16 v[204:207], a[140:143], a[108:111], v[204:207]
v_exp_f32 v200, v200
v_mfma_f32_16x16x32_bf16 v[204:207], a[136:139], a[104:107], v[204:207]
v_mul_f32 v202, s41, v202
v_mul_f32 v203, s41, v203
v_mfma_f32_16x16x32_bf16 v[204:207], a[132:135], a[100:103], v[204:207]
v_exp_f32 v201, v201
v_mfma_f32_16x16x32_bf16 v[204:207], a[128:131], a[96:99], v[204:207]
s_waitcnt lgkmcnt(2)
v_exp_f32 v202, v202
v_mfma_f32_16x16x32_bf16 v[224:227], a[160:163], a[0:3], v[228:231]
v_exp_f32 v203, v203
v_mfma_f32_16x16x32_bf16 v[224:227], a[164:167], a[4:7], v[224:227]
ds_read_b128 a[128:131], v249 offset:57344
v_cvt_pk_bf16_f32 v108, v200, v201
v_mfma_f32_16x16x32_bf16 v[224:227], a[168:171], a[8:11], v[224:227]
ds_read_b128 a[132:135], v250 offset:57344
v_cvt_pk_bf16_f32 v109, v202, v203
v_mfma_f32_16x16x32_bf16 v[224:227], a[172:175], a[12:15], v[224:227]
v_mul_f32 v204, s41, v204
v_mul_f32 v205, s41, v205
v_mfma_f32_16x16x32_bf16 v[224:227], v[192:195], a[16:19], v[224:227]
v_exp_f32 v204, v204
v_mfma_f32_16x16x32_bf16 v[224:227], v[196:199], a[20:23], v[224:227]
s_waitcnt lgkmcnt(2)
v_mul_f32 v206, s41, v206
v_mul_f32 v207, s41, v207
v_mfma_f32_16x16x32_bf16 v[224:227], a[152:155], a[24:27], v[224:227]
v_exp_f32 v205, v205
v_mfma_f32_16x16x32_bf16 v[224:227], a[156:159], a[28:31], v[224:227]
v_exp_f32 v206, v206
v_mfma_f32_16x16x32_bf16 v[214:217], a[252:255], v[152:155], v[214:217]
buffer_load_dwordx4 v239, s[92:95], s60 offen lds
v_mfma_f32_16x16x32_bf16 v[200:203], a[156:159], a[60:63], v[252:255]
s_add_u32 m0, s40, s61
v_exp_f32 v207, v207
v_mfma_f32_16x16x32_bf16 v[200:203], a[152:155], a[56:59], v[200:203]
ds_read_b128 a[136:139], v249 offset:58368
v_cvt_pk_bf16_f32 v156, v204, v205
v_mfma_f32_16x16x32_bf16 v[200:203], v[196:199], a[52:55], v[200:203]
ds_read_b128 a[140:143], v250 offset:58368
v_cvt_pk_bf16_f32 v157, v206, v207
v_mfma_f32_16x16x32_bf16 v[200:203], v[192:195], a[48:51], v[200:203]
buffer_store_dwordx4 a[244:247], v239, s[24:27], s48 offen offset:256 sc1
v_mul_f32 v224, s41, v224
v_mul_f32 v225, s41, v225
v_mfma_f32_16x16x32_bf16 v[200:203], a[172:175], a[44:47], v[200:203]
v_exp_f32 v224, v224
v_mfma_f32_16x16x32_bf16 v[200:203], a[168:171], a[40:43], v[200:203]
v_mul_f32 v226, s41, v226
v_mul_f32 v227, s41, v227
v_mfma_f32_16x16x32_bf16 v[200:203], a[164:167], a[36:39], v[200:203]
v_exp_f32 v225, v225
v_mfma_f32_16x16x32_bf16 v[200:203], a[160:163], a[32:35], v[200:203]
v_exp_f32 v226, v226
v_mfma_f32_16x16x32_bf16 v[204:207], a[160:163], a[64:67], v[244:247]
v_exp_f32 v227, v227
v_mfma_f32_16x16x32_bf16 v[204:207], a[164:167], a[68:71], v[204:207]
ds_read_b128 a[144:147], v249 offset:59392
v_cvt_pk_bf16_f32 v14, v224, v225
v_mfma_f32_16x16x32_bf16 v[204:207], a[168:171], a[72:75], v[204:207]
ds_read_b128 a[148:151], v250 offset:59392
v_cvt_pk_bf16_f32 v15, v226, v227
v_mfma_f32_16x16x32_bf16 v[204:207], a[172:175], a[76:79], v[204:207]
v_mul_f32 v200, s41, v200
v_mul_f32 v201, s41, v201
v_mfma_f32_16x16x32_bf16 v[204:207], v[192:195], a[80:83], v[204:207]
v_exp_f32 v200, v200
v_mfma_f32_16x16x32_bf16 v[204:207], v[196:199], a[84:87], v[204:207]
v_mul_f32 v202, s41, v202
v_mul_f32 v203, s41, v203
v_mfma_f32_16x16x32_bf16 v[204:207], a[152:155], a[88:91], v[204:207]
v_exp_f32 v201, v201
v_mfma_f32_16x16x32_bf16 v[204:207], a[156:159], a[92:95], v[204:207]
v_exp_f32 v202, v202
v_mfma_f32_16x16x32_bf16 v[208:211], a[252:255], v[12:15], v[208:211]
buffer_load_dwordx4 v239, s[92:95], s61 offen lds
v_mfma_f32_16x16x32_bf16 v[224:227], a[156:159], a[124:127], v[220:223]
s_add_u32 m0, s69, s56
v_exp_f32 v203, v203
v_mfma_f32_16x16x32_bf16 v[224:227], a[152:155], a[120:123], v[224:227]
ds_read_b128 a[156:159], v250 offset:60416
v_cvt_pk_bf16_f32 v62, v200, v201
v_mfma_f32_16x16x32_bf16 v[224:227], v[196:199], a[116:119], v[224:227]
ds_read_b128 a[152:155], v249 offset:60416
v_cvt_pk_bf16_f32 v63, v202, v203
v_mfma_f32_16x16x32_bf16 v[224:227], v[192:195], a[112:115], v[224:227]
s_add_u32 s92, s92, 49152
s_addc_u32 s93, s93, 0
v_mul_f32 v204, s41, v204
v_mul_f32 v205, s41, v205
v_mfma_f32_16x16x32_bf16 v[224:227], a[172:175], a[108:111], v[224:227]
v_exp_f32 v204, v204
v_mfma_f32_16x16x32_bf16 v[224:227], a[168:171], a[104:107], v[224:227]
v_mul_f32 v206, s41, v206
v_mul_f32 v207, s41, v207
v_mfma_f32_16x16x32_bf16 v[224:227], a[164:167], a[100:103], v[224:227]
v_exp_f32 v205, v205
v_mfma_f32_16x16x32_bf16 v[224:227], a[160:163], a[96:99], v[224:227]
s_waitcnt lgkmcnt(2)
v_exp_f32 v206, v206
v_mfma_f32_16x16x32_bf16 v[200:203], a[128:131], a[0:3], v[228:231]
v_exp_f32 v207, v207
v_mfma_f32_16x16x32_bf16 v[200:203], a[132:135], a[4:7], v[200:203]
ds_read_b128 a[160:163], v236 offset:0
v_cvt_pk_bf16_f32 v110, v204, v205
v_mfma_f32_16x16x32_bf16 v[200:203], a[136:139], a[8:11], v[200:203]
ds_read_b128 a[164:167], v237 offset:0
v_cvt_pk_bf16_f32 v111, v206, v207
v_mfma_f32_16x16x32_bf16 v[200:203], a[140:143], a[12:15], v[200:203]
v_mul_f32 v224, s41, v224
v_mul_f32 v225, s41, v225
v_mfma_f32_16x16x32_bf16 v[200:203], a[144:147], a[16:19], v[200:203]
buffer_store_dwordx4 a[248:251], v239, s[24:27], s49 offen offset:256 sc1
v_exp_f32 v224, v224
v_mfma_f32_16x16x32_bf16 v[200:203], a[148:151], a[20:23], v[200:203]
s_waitcnt lgkmcnt(2)
v_mul_f32 v226, s41, v226
v_mul_f32 v227, s41, v227
v_mfma_f32_16x16x32_bf16 v[200:203], a[152:155], a[24:27], v[200:203]
v_exp_f32 v225, v225
v_mfma_f32_16x16x32_bf16 v[200:203], a[156:159], a[28:31], v[200:203]
v_exp_f32 v226, v226
v_mfma_f32_16x16x32_bf16 v[210:213], a[252:255], v[60:63], v[210:213]
buffer_load_dwordx4 v239, s[16:19], s56 offen lds
v_mfma_f32_16x16x32_bf16 v[204:207], a[156:159], a[60:63], v[252:255]
s_add_u32 m0, s69, s57
v_exp_f32 v227, v227
v_mfma_f32_16x16x32_bf16 v[204:207], a[152:155], a[56:59], v[204:207]
ds_read_b128 a[168:171], v236 offset:1024
v_cvt_pk_bf16_f32 v158, v224, v225
v_mfma_f32_16x16x32_bf16 v[204:207], a[148:151], a[52:55], v[204:207]
ds_read_b128 a[172:175], v237 offset:1024
v_cvt_pk_bf16_f32 v159, v226, v227
v_mfma_f32_16x16x32_bf16 v[204:207], a[144:147], a[48:51], v[204:207]
v_mul_f32 v200, s41, v200
v_mul_f32 v201, s41, v201
v_mfma_f32_16x16x32_bf16 v[204:207], a[140:143], a[44:47], v[204:207]
v_exp_f32 v200, v200
v_mfma_f32_16x16x32_bf16 v[204:207], a[136:139], a[40:43], v[204:207]
v_mul_f32 v202, s41, v202
v_mul_f32 v203, s41, v203
v_mfma_f32_16x16x32_bf16 v[204:207], a[132:135], a[36:39], v[204:207]
v_exp_f32 v201, v201
v_mfma_f32_16x16x32_bf16 v[204:207], a[128:131], a[32:35], v[204:207]
v_exp_f32 v202, v202
v_mfma_f32_16x16x32_bf16 v[224:227], a[128:131], a[64:67], v[244:247]
v_exp_f32 v203, v203
v_mfma_f32_16x16x32_bf16 v[224:227], a[132:135], a[68:71], v[224:227]
ds_read_b128 v[192:195], v236 offset:2048
v_cvt_pk_bf16_f32 v16, v200, v201
v_mfma_f32_16x16x32_bf16 v[224:227], a[136:139], a[72:75], v[224:227]
ds_read_b128 v[196:199], v237 offset:2048
v_cvt_pk_bf16_f32 v17, v202, v203
v_mfma_f32_16x16x32_bf16 v[224:227], a[140:143], a[76:79], v[224:227]
v_mul_f32 v204, s41, v204
v_mul_f32 v205, s41, v205
v_mfma_f32_16x16x32_bf16 v[224:227], a[144:147], a[80:83], v[224:227]
v_exp_f32 v204, v204
v_mfma_f32_16x16x32_bf16 v[224:227], a[148:151], a[84:87], v[224:227]
v_mul_f32 v206, s41, v206
v_mul_f32 v207, s41, v207
v_mfma_f32_16x16x32_bf16 v[224:227], a[152:155], a[88:91], v[224:227]
v_exp_f32 v205, v205
v_mfma_f32_16x16x32_bf16 v[224:227], a[156:159], a[92:95], v[224:227]
v_exp_f32 v206, v206
v_mfma_f32_16x16x32_bf16 v[212:215], a[252:255], v[108:111], v[212:215]
buffer_load_dwordx4 v239, s[16:19], s57 offen lds
v_mfma_f32_16x16x32_bf16 v[200:203], a[156:159], a[124:127], v[220:223]
s_add_u32 m0, s69, s58
v_exp_f32 v207, v207
v_mfma_f32_16x16x32_bf16 v[200:203], a[152:155], a[120:123], v[200:203]
ds_read_b128 a[156:159], v237 offset:3072
v_cvt_pk_bf16_f32 v64, v204, v205
v_mfma_f32_16x16x32_bf16 v[200:203], a[148:151], a[116:119], v[200:203]
ds_read_b128 a[152:155], v236 offset:3072
v_cvt_pk_bf16_f32 v65, v206, v207
v_mfma_f32_16x16x32_bf16 v[200:203], a[144:147], a[112:115], v[200:203]
v_mul_f32 v224, s41, v224
v_mul_f32 v225, s41, v225
v_mfma_f32_16x16x32_bf16 v[200:203], a[140:143], a[108:111], v[200:203]
v_exp_f32 v224, v224
v_mfma_f32_16x16x32_bf16 v[200:203], a[136:139], a[104:107], v[200:203]
v_mul_f32 v226, s41, v226
v_mul_f32 v227, s41, v227
v_mfma_f32_16x16x32_bf16 v[200:203], a[132:135], a[100:103], v[200:203]
v_exp_f32 v225, v225
v_mfma_f32_16x16x32_bf16 v[200:203], a[128:131], a[96:99], v[200:203]
s_waitcnt lgkmcnt(2)
v_exp_f32 v226, v226
v_mfma_f32_16x16x32_bf16 v[204:207], a[160:163], a[0:3], v[228:231]
buffer_store_dwordx4 a[176:179], v239, s[24:27], s50 offen offset:256 sc1
v_exp_f32 v227, v227
v_mfma_f32_16x16x32_bf16 v[204:207], a[164:167], a[4:7], v[204:207]
ds_read_b128 a[128:131], v236 offset:8192
v_cvt_pk_bf16_f32 v112, v224, v225
v_mfma_f32_16x16x32_bf16 v[204:207], a[168:171], a[8:11], v[204:207]
ds_read_b128 a[132:135], v237 offset:8192
v_cvt_pk_bf16_f32 v113, v226, v227
v_mfma_f32_16x16x32_bf16 v[204:207], a[172:175], a[12:15], v[204:207]
v_mul_f32 v200, s41, v200
v_mul_f32 v201, s41, v201
v_mfma_f32_16x16x32_bf16 v[204:207], v[192:195], a[16:19], v[204:207]
v_exp_f32 v200, v200
v_mfma_f32_16x16x32_bf16 v[204:207], v[196:199], a[20:23], v[204:207]
s_waitcnt lgkmcnt(2)
v_mul_f32 v202, s41, v202
v_mul_f32 v203, s41, v203
v_mfma_f32_16x16x32_bf16 v[204:207], a[152:155], a[24:27], v[204:207]
v_exp_f32 v201, v201
v_mfma_f32_16x16x32_bf16 v[204:207], a[156:159], a[28:31], v[204:207]
v_exp_f32 v202, v202
v_mfma_f32_16x16x32_bf16 v[214:217], a[252:255], v[156:159], v[214:217]
buffer_load_dwordx4 v239, s[16:19], s58 offen lds
v_mfma_f32_16x16x32_bf16 v[224:227], a[156:159], a[60:63], v[252:255]
s_add_u32 m0, s69, s59
v_exp_f32 v203, v203
v_mfma_f32_16x16x32_bf16 v[224:227], a[152:155], a[56:59], v[224:227]
ds_read_b128 a[136:139], v236 offset:9216
v_cvt_pk_bf16_f32 v160, v200, v201
v_mfma_f32_16x16x32_bf16 v[224:227], v[196:199], a[52:55], v[224:227]
ds_read_b128 a[140:143], v237 offset:9216
v_cvt_pk_bf16_f32 v161, v202, v203
v_mfma_f32_16x16x32_bf16 v[224:227], v[192:195], a[48:51], v[224:227]
v_mul_f32 v204, s41, v204
v_mul_f32 v205, s41, v205
v_mfma_f32_16x16x32_bf16 v[224:227], a[172:175], a[44:47], v[224:227]
v_exp_f32 v204, v204
v_mfma_f32_16x16x32_bf16 v[224:227], a[168:171], a[40:43], v[224:227]
v_mul_f32 v206, s41, v206
v_mul_f32 v207, s41, v207
v_mfma_f32_16x16x32_bf16 v[224:227], a[164:167], a[36:39], v[224:227]
v_exp_f32 v205, v205
v_mfma_f32_16x16x32_bf16 v[224:227], a[160:163], a[32:35], v[224:227]
v_exp_f32 v206, v206
v_mfma_f32_16x16x32_bf16 v[200:203], a[160:163], a[64:67], v[244:247]
v_exp_f32 v207, v207
v_mfma_f32_16x16x32_bf16 v[200:203], a[164:167], a[68:71], v[200:203]
ds_read_b128 a[144:147], v236 offset:10240
v_cvt_pk_bf16_f32 v18, v204, v205
v_mfma_f32_16x16x32_bf16 v[200:203], a[168:171], a[72:75], v[200:203]
ds_read_b128 a[148:151], v237 offset:10240
v_cvt_pk_bf16_f32 v19, v206, v207
v_mfma_f32_16x16x32_bf16 v[200:203], a[172:175], a[76:79], v[200:203]
v_mul_f32 v224, s41, v224
v_mul_f32 v225, s41, v225
v_mfma_f32_16x16x32_bf16 v[200:203], v[192:195], a[80:83], v[200:203]
v_exp_f32 v224, v224
v_mfma_f32_16x16x32_bf16 v[200:203], v[196:199], a[84:87], v[200:203]
v_mul_f32 v226, s41, v226
v_mul_f32 v227, s41, v227
v_mfma_f32_16x16x32_bf16 v[200:203], a[152:155], a[88:91], v[200:203]
v_exp_f32 v225, v225
v_mfma_f32_16x16x32_bf16 v[200:203], a[156:159], a[92:95], v[200:203]
v_exp_f32 v226, v226
v_mfma_f32_16x16x32_bf16 v[208:211], a[252:255], v[16:19], v[208:211]
buffer_load_dwordx4 v239, s[16:19], s59 offen lds
v_mfma_f32_16x16x32_bf16 v[204:207], a[156:159], a[124:127], v[220:223]
s_add_u32 m0, s69, s60
v_exp_f32 v227, v227
v_mfma_f32_16x16x32_bf16 v[204:207], a[152:155], a[120:123], v[204:207]
ds_read_b128 a[156:159], v237 offset:11264
v_cvt_pk_bf16_f32 v66, v224, v225
v_mfma_f32_16x16x32_bf16 v[204:207], v[196:199], a[116:119], v[204:207]
ds_read_b128 a[152:155], v236 offset:11264
v_cvt_pk_bf16_f32 v67, v226, v227
v_mfma_f32_16x16x32_bf16 v[204:207], v[192:195], a[112:115], v[204:207]
buffer_store_dwordx4 a[180:183], v239, s[24:27], s51 offen offset:256 sc1
v_mul_f32 v200, s41, v200
v_mul_f32 v201, s41, v201
v_mfma_f32_16x16x32_bf16 v[204:207], a[172:175], a[108:111], v[204:207]
v_exp_f32 v200, v200
v_mfma_f32_16x16x32_bf16 v[204:207], a[168:171], a[104:107], v[204:207]
v_mul_f32 v202, s41, v202
v_mul_f32 v203, s41, v203
v_mfma_f32_16x16x32_bf16 v[204:207], a[164:167], a[100:103], v[204:207]
v_exp_f32 v201, v201
v_mfma_f32_16x16x32_bf16 v[204:207], a[160:163], a[96:99], v[204:207]
s_waitcnt lgkmcnt(2)
v_exp_f32 v202, v202
v_mfma_f32_16x16x32_bf16 v[224:227], a[128:131], a[0:3], v[228:231]
v_exp_f32 v203, v203
v_mfma_f32_16x16x32_bf16 v[224:227], a[132:135], a[4:7], v[224:227]
ds_read_b128 a[160:163], v236 offset:16384
v_cvt_pk_bf16_f32 v114, v200, v201
v_mfma_f32_16x16x32_bf16 v[224:227], a[136:139], a[8:11], v[224:227]
ds_read_b128 a[164:167], v237 offset:16384
v_cvt_pk_bf16_f32 v115, v202, v203
v_mfma_f32_16x16x32_bf16 v[224:227], a[140:143], a[12:15], v[224:227]
v_mul_f32 v204, s41, v204
v_mul_f32 v205, s41, v205
v_mfma_f32_16x16x32_bf16 v[224:227], a[144:147], a[16:19], v[224:227]
v_exp_f32 v204, v204
v_mfma_f32_16x16x32_bf16 v[224:227], a[148:151], a[20:23], v[224:227]
s_waitcnt lgkmcnt(2)
v_mul_f32 v206, s41, v206
v_mul_f32 v207, s41, v207
v_mfma_f32_16x16x32_bf16 v[224:227], a[152:155], a[24:27], v[224:227]
v_exp_f32 v205, v205
v_mfma_f32_16x16x32_bf16 v[224:227], a[156:159], a[28:31], v[224:227]
v_exp_f32 v206, v206
v_mfma_f32_16x16x32_bf16 v[210:213], a[252:255], v[64:67], v[210:213]
buffer_load_dwordx4 v239, s[16:19], s60 offen lds
v_mfma_f32_16x16x32_bf16 v[200:203], a[156:159], a[60:63], v[252:255]
s_add_u32 m0, s69, s61
v_exp_f32 v207, v207
v_mfma_f32_16x16x32_bf16 v[200:203], a[152:155], a[56:59], v[200:203]
ds_read_b128 a[168:171], v236 offset:17408
v_cvt_pk_bf16_f32 v162, v204, v205
v_mfma_f32_16x16x32_bf16 v[200:203], a[148:151], a[52:55], v[200:203]
ds_read_b128 a[172:175], v237 offset:17408
v_cvt_pk_bf16_f32 v163, v206, v207
v_mfma_f32_16x16x32_bf16 v[200:203], a[144:147], a[48:51], v[200:203]
v_mul_f32 v224, s41, v224
v_mul_f32 v225, s41, v225
v_mfma_f32_16x16x32_bf16 v[200:203], a[140:143], a[44:47], v[200:203]
v_exp_f32 v224, v224
v_mfma_f32_16x16x32_bf16 v[200:203], a[136:139], a[40:43], v[200:203]
v_mul_f32 v226, s41, v226
v_mul_f32 v227, s41, v227
v_mfma_f32_16x16x32_bf16 v[200:203], a[132:135], a[36:39], v[200:203]
v_exp_f32 v225, v225
v_mfma_f32_16x16x32_bf16 v[200:203], a[128:131], a[32:35], v[200:203]
v_exp_f32 v226, v226
v_mfma_f32_16x16x32_bf16 v[204:207], a[128:131], a[64:67], v[244:247]
v_exp_f32 v227, v227
v_mfma_f32_16x16x32_bf16 v[204:207], a[132:135], a[68:71], v[204:207]
ds_read_b128 v[192:195], v236 offset:18432
v_cvt_pk_bf16_f32 v20, v224, v225
v_mfma_f32_16x16x32_bf16 v[204:207], a[136:139], a[72:75], v[204:207]
ds_read_b128 v[196:199], v237 offset:18432
v_cvt_pk_bf16_f32 v21, v226, v227
v_mfma_f32_16x16x32_bf16 v[204:207], a[140:143], a[76:79], v[204:207]
v_mul_f32 v200, s41, v200
v_mul_f32 v201, s41, v201
v_mfma_f32_16x16x32_bf16 v[204:207], a[144:147], a[80:83], v[204:207]
v_exp_f32 v200, v200
v_mfma_f32_16x16x32_bf16 v[204:207], a[148:151], a[84:87], v[204:207]
buffer_store_dwordx4 a[184:187], v239, s[24:27], s52 offen offset:256 sc1
v_mul_f32 v202, s41, v202
v_mul_f32 v203, s41, v203
v_mfma_f32_16x16x32_bf16 v[204:207], a[152:155], a[88:91], v[204:207]
v_exp_f32 v201, v201
v_mfma_f32_16x16x32_bf16 v[204:207], a[156:159], a[92:95], v[204:207]
v_exp_f32 v202, v202
v_mfma_f32_16x16x32_bf16 v[212:215], a[252:255], v[112:115], v[212:215]
buffer_load_dwordx4 v239, s[16:19], s61 offen lds
v_mfma_f32_16x16x32_bf16 v[224:227], a[156:159], a[124:127], v[220:223]
s_add_u32 m0, s75, s56
v_exp_f32 v203, v203
v_mfma_f32_16x16x32_bf16 v[224:227], a[152:155], a[120:123], v[224:227]
ds_read_b128 a[156:159], v237 offset:19456
v_cvt_pk_bf16_f32 v68, v200, v201
v_mfma_f32_16x16x32_bf16 v[224:227], a[148:151], a[116:119], v[224:227]
ds_read_b128 a[152:155], v236 offset:19456
v_cvt_pk_bf16_f32 v69, v202, v203
v_mfma_f32_16x16x32_bf16 v[224:227], a[144:147], a[112:115], v[224:227]
s_mov_b32 s18, 85632
v_mul_f32 v204, s41, v204
v_mul_f32 v205, s41, v205
v_mfma_f32_16x16x32_bf16 v[224:227], a[140:143], a[108:111], v[224:227]
s_add_u32 s16, s72, s37
s_addc_u32 s17, s73, 0
v_exp_f32 v204, v204
v_mfma_f32_16x16x32_bf16 v[224:227], a[136:139], a[104:107], v[224:227]
v_mul_f32 v206, s41, v206
v_mul_f32 v207, s41, v207
v_mfma_f32_16x16x32_bf16 v[224:227], a[132:135], a[100:103], v[224:227]
v_exp_f32 v205, v205
v_mfma_f32_16x16x32_bf16 v[224:227], a[128:131], a[96:99], v[224:227]
s_waitcnt vmcnt(10) lgkmcnt(0)
v_exp_f32 v206, v206
v_mfma_f32_16x16x32_bf16 v[200:203], a[160:163], a[0:3], v[228:231]
s_barrier
v_exp_f32 v207, v207
v_mfma_f32_16x16x32_bf16 v[200:203], a[164:167], a[4:7], v[200:203]
ds_read_b128 a[128:131], v236 offset:24576
v_cvt_pk_bf16_f32 v116, v204, v205
v_mfma_f32_16x16x32_bf16 v[200:203], a[168:171], a[8:11], v[200:203]
ds_read_b128 a[132:135], v237 offset:24576
v_cvt_pk_bf16_f32 v117, v206, v207
v_mfma_f32_16x16x32_bf16 v[200:203], a[172:175], a[12:15], v[200:203]
v_mul_f32 v224, s41, v224
v_mul_f32 v225, s41, v225
v_mfma_f32_16x16x32_bf16 v[200:203], v[192:195], a[16:19], v[200:203]
v_exp_f32 v224, v224
v_mfma_f32_16x16x32_bf16 v[200:203], v[196:199], a[20:23], v[200:203]
v_mul_f32 v226, s41, v226
v_mul_f32 v227, s41, v227
v_mfma_f32_16x16x32_bf16 v[200:203], a[152:155], a[24:27], v[200:203]
v_exp_f32 v225, v225
v_mfma_f32_16x16x32_bf16 v[200:203], a[156:159], a[28:31], v[200:203]
v_exp_f32 v226, v226
v_mfma_f32_16x16x32_bf16 v[214:217], a[252:255], v[160:163], v[214:217]
buffer_load_dwordx4 v239, s[92:95], s56 offen lds
v_mfma_f32_16x16x32_bf16 v[204:207], a[156:159], a[60:63], v[252:255]
s_add_u32 m0, s75, s57
v_exp_f32 v227, v227
v_mfma_f32_16x16x32_bf16 v[204:207], a[152:155], a[56:59], v[204:207]
ds_read_b128 a[136:139], v236 offset:25600
v_cvt_pk_bf16_f32 v164, v224, v225
v_mfma_f32_16x16x32_bf16 v[204:207], v[196:199], a[52:55], v[204:207]
ds_read_b128 a[140:143], v237 offset:25600
v_cvt_pk_bf16_f32 v165, v226, v227
v_mfma_f32_16x16x32_bf16 v[204:207], v[192:195], a[48:51], v[204:207]
s_lshl_b32 s43, s56, 3
v_mul_f32 v200, s41, v200
v_mul_f32 v201, s41, v201
v_mfma_f32_16x16x32_bf16 v[204:207], a[172:175], a[44:47], v[204:207]
s_lshl_b32 s44, s32, 14
v_exp_f32 v200, v200
v_mfma_f32_16x16x32_bf16 v[204:207], a[168:171], a[40:43], v[204:207]
s_add_u32 s43, s43, s44
v_mul_f32 v202, s41, v202
v_mul_f32 v203, s41, v203
v_mfma_f32_16x16x32_bf16 v[204:207], a[164:167], a[36:39], v[204:207]
s_add_u32 s43, s43, s37
v_exp_f32 v201, v201
v_mfma_f32_16x16x32_bf16 v[204:207], a[160:163], a[32:35], v[204:207]
s_add_u32 s84, s8, s43
s_addc_u32 s85, s9, 0
v_exp_f32 v202, v202
v_mfma_f32_16x16x32_bf16 v[224:227], a[160:163], a[64:67], v[244:247]
v_exp_f32 v203, v203
v_bfe_u32 v232, v248, 4, 4
v_mfma_f32_16x16x32_bf16 v[224:227], a[164:167], a[68:71], v[224:227]
ds_read_b128 a[144:147], v236 offset:26624
v_cvt_pk_bf16_f32 v22, v200, v201
v_lshlrev_b32 v232, 10, v232
v_mfma_f32_16x16x32_bf16 v[224:227], a[168:171], a[72:75], v[224:227]
ds_read_b128 a[148:151], v237 offset:26624
v_cvt_pk_bf16_f32 v23, v202, v203
v_mfma_f32_16x16x32_bf16 v[224:227], a[172:175], a[76:79], v[224:227]
global_load_dword v233, v232, s[84:85] offset:256
v_mul_f32 v204, s41, v204
v_mul_f32 v205, s41, v205
v_mfma_f32_16x16x32_bf16 v[224:227], v[192:195], a[80:83], v[224:227]
buffer_store_dwordx4 a[188:191], v239, s[24:27], s53 offen offset:256 sc1
v_exp_f32 v204, v204
v_mfma_f32_16x16x32_bf16 v[224:227], v[196:199], a[84:87], v[224:227]
v_mul_f32 v206, s41, v206
v_mul_f32 v207, s41, v207
v_mfma_f32_16x16x32_bf16 v[224:227], a[152:155], a[88:91], v[224:227]
v_exp_f32 v205, v205
v_mfma_f32_16x16x32_bf16 v[224:227], a[156:159], a[92:95], v[224:227]
v_exp_f32 v206, v206
v_mfma_f32_16x16x32_bf16 v[208:211], a[252:255], v[20:23], v[208:211]
buffer_load_dwordx4 v239, s[92:95], s57 offen lds
v_mfma_f32_16x16x32_bf16 v[200:203], a[156:159], a[124:127], v[220:223]
s_add_u32 m0, s75, s58
v_exp_f32 v207, v207
v_mfma_f32_16x16x32_bf16 v[200:203], a[152:155], a[120:123], v[200:203]
ds_read_b128 a[156:159], v237 offset:27648
v_cvt_pk_bf16_f32 v70, v204, v205
v_mfma_f32_16x16x32_bf16 v[200:203], v[196:199], a[116:119], v[200:203]
ds_read_b128 a[152:155], v236 offset:27648
v_cvt_pk_bf16_f32 v71, v206, v207
v_mfma_f32_16x16x32_bf16 v[200:203], v[192:195], a[112:115], v[200:203]
s_add_u32 s74, s101, L_text_end-16384-L_pc4
v_mul_f32 v224, s41, v224
v_mul_f32 v225, s41, v225
v_mfma_f32_16x16x32_bf16 v[200:203], a[172:175], a[108:111], v[200:203]
s_getpc_b64 s[28:29]
L_pc4:
s_add_u32 s28, s28, s74
s_addc_u32 s29, s29, 0
v_exp_f32 v224, v224
v_mfma_f32_16x16x32_bf16 v[200:203], a[168:171], a[104:107], v[200:203]
global_load_dword v251, v239, s[28:29]
v_mul_f32 v226, s41, v226
v_mul_f32 v227, s41, v227
v_mfma_f32_16x16x32_bf16 v[200:203], a[164:167], a[100:103], v[200:203]
v_exp_f32 v225, v225
v_mfma_f32_16x16x32_bf16 v[200:203], a[160:163], a[96:99], v[200:203]
s_waitcnt lgkmcnt(2)
v_exp_f32 v226, v226
v_mfma_f32_16x16x32_bf16 v[204:207], a[128:131], a[0:3], v[228:231]
v_exp_f32 v227, v227
v_mfma_f32_16x16x32_bf16 v[204:207], a[132:135], a[4:7], v[204:207]
ds_read_b128 a[160:163], v236 offset:32768
v_cvt_pk_bf16_f32 v118, v224, v225
v_mfma_f32_16x16x32_bf16 v[204:207], a[136:139], a[8:11], v[204:207]
ds_read_b128 a[164:167], v237 offset:32768
v_cvt_pk_bf16_f32 v119, v226, v227
v_mfma_f32_16x16x32_bf16 v[204:207], a[140:143], a[12:15], v[204:207]
v_mul_f32 v200, s41, v200
v_mul_f32 v201, s41, v201
v_mfma_f32_16x16x32_bf16 v[204:207], a[144:147], a[16:19], v[204:207]
v_exp_f32 v200, v200
v_mfma_f32_16x16x32_bf16 v[204:207], a[148:151], a[20:23], v[204:207]
s_waitcnt lgkmcnt(2)
v_mul_f32 v202, s41, v202
v_mul_f32 v203, s41, v203
v_mfma_f32_16x16x32_bf16 v[204:207], a[152:155], a[24:27], v[204:207]
v_exp_f32 v201, v201
v_mfma_f32_16x16x32_bf16 v[204:207], a[156:159], a[28:31], v[204:207]
v_exp_f32 v202, v202
v_mfma_f32_16x16x32_bf16 v[210:213], a[252:255], v[68:71], v[210:213]
buffer_load_dwordx4 v239, s[92:95], s58 offen lds
v_mfma_f32_16x16x32_bf16 v[224:227], a[156:159], a[60:63], v[252:255]
s_add_u32 m0, s75, s59
v_exp_f32 v203, v203
v_mfma_f32_16x16x32_bf16 v[224:227], a[152:155], a[56:59], v[224:227]
ds_read_b128 a[168:171], v236 offset:33792
v_cvt_pk_bf16_f32 v166, v200, v201
v_mfma_f32_16x16x32_bf16 v[224:227], a[148:151], a[52:55], v[224:227]
ds_read_b128 a[172:175], v237 offset:33792
v_cvt_pk_bf16_f32 v167, v202, v203
v_mfma_f32_16x16x32_bf16 v[224:227], a[144:147], a[48:51], v[224:227]
v_mul_f32 v204, s41, v204
v_mul_f32 v205, s41, v205
v_mfma_f32_16x16x32_bf16 v[224:227], a[140:143], a[44:47], v[224:227]
v_exp_f32 v204, v204
v_mfma_f32_16x16x32_bf16 v[224:227], a[136:139], a[40:43], v[224:227]
v_mul_f32 v206, s41, v206
v_mul_f32 v207, s41, v207
v_mfma_f32_16x16x32_bf16 v[224:227], a[132:135], a[36:39], v[224:227]
v_exp_f32 v205, v205
v_mfma_f32_16x16x32_bf16 v[224:227], a[128:131], a[32:35], v[224:227]
v_exp_f32 v206, v206
v_mfma_f32_16x16x32_bf16 v[200:203], a[128:131], a[64:67], v[244:247]
v_exp_f32 v207, v207
v_mfma_f32_16x16x32_bf16 v[200:203], a[132:135], a[68:71], v[200:203]
ds_read_b128 v[192:195], v236 offset:34816
v_cvt_pk_bf16_f32 v24, v204, v205
v_mfma_f32_16x16x32_bf16 v[200:203], a[136:139], a[72:75], v[200:203]
ds_read_b128 v[196:199], v237 offset:34816
v_cvt_pk_bf16_f32 v25, v206, v207
v_mfma_f32_16x16x32_bf16 v[200:203], a[140:143], a[76:79], v[200:203]
buffer_store_dwordx4 a[192:195], v239, s[24:27], s54 offen offset:256 sc1
v_mul_f32 v224, s41, v224
v_mul_f32 v225, s41, v225
v_mfma_f32_16x16x32_bf16 v[200:203], a[144:147], a[80:83], v[200:203]
v_exp_f32 v224, v224
v_mfma_f32_16x16x32_bf16 v[200:203], a[148:151], a[84:87], v[200:203]
v_mul_f32 v226, s41, v226
v_mul_f32 v227, s41, v227
v_mfma_f32_16x16x32_bf16 v[200:203], a[152:155], a[88:91], v[200:203]
v_exp_f32 v225, v225
v_mfma_f32_16x16x32_bf16 v[200:203], a[156:159], a[92:95], v[200:203]
v_exp_f32 v226, v226
v_mfma_f32_16x16x32_bf16 v[212:215], a[252:255], v[116:119], v[212:215]
buffer_load_dwordx4 v239, s[92:95], s59 offen lds
v_mfma_f32_16x16x32_bf16 v[204:207], a[156:159], a[124:127], v[220:223]
s_add_u32 m0, s75, s60
v_exp_f32 v227, v227
v_mfma_f32_16x16x32_bf16 v[204:207], a[152:155], a[120:123], v[204:207]
ds_read_b128 a[156:159], v237 offset:35840
v_cvt_pk_bf16_f32 v72, v224, v225
v_mfma_f32_16x16x32_bf16 v[204:207], a[148:151], a[116:119], v[204:207]
ds_read_b128 a[152:155], v236 offset:35840
v_cvt_pk_bf16_f32 v73, v226, v227
v_mfma_f32_16x16x32_bf16 v[204:207], a[144:147], a[112:115], v[204:207]
v_mul_f32 v200, s41, v200
v_mul_f32 v201, s41, v201
v_mfma_f32_16x16x32_bf16 v[204:207], a[140:143], a[108:111], v[204:207]
v_exp_f32 v200, v200
v_mfma_f32_16x16x32_bf16 v[204:207], a[136:139], a[104:107], v[204:207]
v_mul_f32 v202, s41, v202
v_mul_f32 v203, s41, v203
v_mfma_f32_16x16x32_bf16 v[204:207], a[132:135], a[100:103], v[204:207]
v_exp_f32 v201, v201
v_mfma_f32_16x16x32_bf16 v[204:207], a[128:131], a[96:99], v[204:207]
s_waitcnt lgkmcnt(2)
v_exp_f32 v202, v202
v_mfma_f32_16x16x32_bf16 v[224:227], a[160:163], a[0:3], v[228:231]
v_exp_f32 v203, v203
v_mfma_f32_16x16x32_bf16 v[224:227], a[164:167], a[4:7], v[224:227]
ds_read_b128 a[128:131], v236 offset:40960
v_cvt_pk_bf16_f32 v120, v200, v201
v_mfma_f32_16x16x32_bf16 v[224:227], a[168:171], a[8:11], v[224:227]
ds_read_b128 a[132:135], v237 offset:40960
v_cvt_pk_bf16_f32 v121, v202, v203
v_mfma_f32_16x16x32_bf16 v[224:227], a[172:175], a[12:15], v[224:227]
v_mul_f32 v204, s41, v204
v_mul_f32 v205, s41, v205
v_mfma_f32_16x16x32_bf16 v[224:227], v[192:195], a[16:19], v[224:227]
v_exp_f32 v204, v204
v_mfma_f32_16x16x32_bf16 v[224:227], v[196:199], a[20:23], v[224:227]
s_waitcnt lgkmcnt(2)
v_mul_f32 v206, s41, v206
v_mul_f32 v207, s41, v207
v_mfma_f32_16x16x32_bf16 v[224:227], a[152:155], a[24:27], v[224:227]
v_exp_f32 v205, v205
v_mfma_f32_16x16x32_bf16 v[224:227], a[156:159], a[28:31], v[224:227]
v_exp_f32 v206, v206
v_mfma_f32_16x16x32_bf16 v[214:217], a[252:255], v[164:167], v[214:217]
buffer_load_dwordx4 v239, s[92:95], s60 offen lds
v_mfma_f32_16x16x32_bf16 v[200:203], a[156:159], a[60:63], v[252:255]
s_add_u32 m0, s75, s61
v_exp_f32 v207, v207
v_mfma_f32_16x16x32_bf16 v[200:203], a[152:155], a[56:59], v[200:203]
ds_read_b128 a[136:139], v236 offset:41984
v_cvt_pk_bf16_f32 v168, v204, v205
v_mfma_f32_16x16x32_bf16 v[200:203], v[196:199], a[52:55], v[200:203]
ds_read_b128 a[140:143], v237 offset:41984
v_cvt_pk_bf16_f32 v169, v206, v207
v_mfma_f32_16x16x32_bf16 v[200:203], v[192:195], a[48:51], v[200:203]
v_mul_f32 v224, s41, v224
v_mul_f32 v225, s41, v225
v_mfma_f32_16x16x32_bf16 v[200:203], a[172:175], a[44:47], v[200:203]
v_exp_f32 v224, v224
v_mfma_f32_16x16x32_bf16 v[200:203], a[168:171], a[40:43], v[200:203]
v_mul_f32 v226, s41, v226
v_mul_f32 v227, s41, v227
v_mfma_f32_16x16x32_bf16 v[200:203], a[164:167], a[36:39], v[200:203]
v_exp_f32 v225, v225
v_mfma_f32_16x16x32_bf16 v[200:203], a[160:163], a[32:35], v[200:203]
v_exp_f32 v226, v226
v_mfma_f32_16x16x32_bf16 v[204:207], a[160:163], a[64:67], v[244:247]
v_exp_f32 v227, v227
v_mfma_f32_16x16x32_bf16 v[204:207], a[164:167], a[68:71], v[204:207]
ds_read_b128 a[144:147], v236 offset:43008
v_cvt_pk_bf16_f32 v26, v224, v225
v_mfma_f32_16x16x32_bf16 v[204:207], a[168:171], a[72:75], v[204:207]
ds_read_b128 a[148:151], v237 offset:43008
v_cvt_pk_bf16_f32 v27, v226, v227
v_mfma_f32_16x16x32_bf16 v[204:207], a[172:175], a[76:79], v[204:207]
buffer_store_dwordx4 a[196:199], v239, s[24:27], s55 offen offset:256 sc1
v_mul_f32 v200, s41, v200
v_mul_f32 v201, s41, v201
v_mfma_f32_16x16x32_bf16 v[204:207], v[192:195], a[80:83], v[204:207]
v_exp_f32 v200, v200
v_mfma_f32_16x16x32_bf16 v[204:207], v[196:199], a[84:87], v[204:207]
v_mul_f32 v202, s41, v202
v_mul_f32 v203, s41, v203
v_mfma_f32_16x16x32_bf16 v[204:207], a[152:155], a[88:91], v[204:207]
v_exp_f32 v201, v201
v_mfma_f32_16x16x32_bf16 v[204:207], a[156:159], a[92:95], v[204:207]
v_exp_f32 v202, v202
v_mfma_f32_16x16x32_bf16 v[208:211], a[252:255], v[24:27], v[208:211]
buffer_load_dwordx4 v239, s[92:95], s61 offen lds
v_mfma_f32_16x16x32_bf16 v[224:227], a[156:159], a[124:127], v[220:223]
s_add_u32 m0, s38, s56
v_exp_f32 v203, v203
v_mfma_f32_16x16x32_bf16 v[224:227], a[152:155], a[120:123], v[224:227]
ds_read_b128 a[156:159], v237 offset:44032
v_cvt_pk_bf16_f32 v74, v200, v201
v_mfma_f32_16x16x32_bf16 v[224:227], v[196:199], a[116:119], v[224:227]
ds_read_b128 a[152:155], v236 offset:44032
v_cvt_pk_bf16_f32 v75, v202, v203
v_mfma_f32_16x16x32_bf16 v[224:227], v[192:195], a[112:115], v[224:227]
s_mov_b32 s94, 85632
v_mul_f32 v204, s41, v204
v_mul_f32 v205, s41, v205
v_mfma_f32_16x16x32_bf16 v[224:227], a[172:175], a[108:111], v[224:227]
s_add_u32 s68, s37, 98304
v_exp_f32 v204, v204
v_mfma_f32_16x16x32_bf16 v[224:227], a[168:171], a[104:107], v[224:227]
ds_read_b128 a[200:203], v248 offset:0
v_mul_f32 v206, s41, v206
v_mul_f32 v207, s41, v207
v_mfma_f32_16x16x32_bf16 v[224:227], a[164:167], a[100:103], v[224:227]
ds_read_b128 a[204:207], v248 offset:4096
v_exp_f32 v205, v205
v_mfma_f32_16x16x32_bf16 v[224:227], a[160:163], a[96:99], v[224:227]
s_waitcnt lgkmcnt(4)
v_exp_f32 v206, v206
v_mfma_f32_16x16x32_bf16 v[200:203], a[128:131], a[0:3], v[228:231]
s_add_u32 s92, s72, s68
s_addc_u32 s93, s73, 0
v_exp_f32 v207, v207
v_mfma_f32_16x16x32_bf16 v[200:203], a[132:135], a[4:7], v[200:203]
ds_read_b128 a[160:163], v236 offset:49152
v_cvt_pk_bf16_f32 v122, v204, v205
v_mfma_f32_16x16x32_bf16 v[200:203], a[136:139], a[8:11], v[200:203]
ds_read_b128 a[164:167], v237 offset:49152
v_cvt_pk_bf16_f32 v123, v206, v207
v_mfma_f32_16x16x32_bf16 v[200:203], a[140:143], a[12:15], v[200:203]
v_mul_f32 v224, s41, v224
v_mul_f32 v225, s41, v225
v_mfma_f32_16x16x32_bf16 v[200:203], a[144:147], a[16:19], v[200:203]
s_waitcnt lgkmcnt(2)
v_exp_f32 v224, v224
v_mfma_f32_16x16x32_bf16 v[200:203], a[148:151], a[20:23], v[200:203]
s_waitcnt lgkmcnt(4)
v_mul_f32 v226, s41, v226
v_mul_f32 v227, s41, v227
v_mfma_f32_16x16x32_bf16 v[200:203], a[152:155], a[24:27], v[200:203]
v_exp_f32 v225, v225
v_mfma_f32_16x16x32_bf16 v[200:203], a[156:159], a[28:31], v[200:203]
v_exp_f32 v226, v226
v_mfma_f32_16x16x32_bf16 v[210:213], a[252:255], v[72:75], v[210:213]
buffer_load_dwordx4 v239, s[16:19], s62 offen lds
v_mfma_f32_16x16x32_bf16 v[204:207], a[156:159], a[60:63], v[252:255]
global_load_dword v233, v232, s[84:85] offset:768
v_exp_f32 v227, v227
v_mfma_f32_16x16x32_bf16 v[204:207], a[152:155], a[56:59], v[204:207]
ds_read_b128 a[168:171], v236 offset:50176
v_cvt_pk_bf16_f32 v170, v224, v225
v_mfma_f32_16x16x32_bf16 v[204:207], a[148:151], a[52:55], v[204:207]
ds_read_b128 a[172:175], v237 offset:50176
v_cvt_pk_bf16_f32 v171, v226, v227
v_mfma_f32_16x16x32_bf16 v[204:207], a[144:147], a[48:51], v[204:207]
s_add_u32 m0, s38, s57
v_mul_f32 v200, s41, v200
v_mul_f32 v201, s41, v201
v_mfma_f32_16x16x32_bf16 v[204:207], a[140:143], a[44:47], v[204:207]
v_exp_f32 v200, v200
v_mfma_f32_16x16x32_bf16 v[204:207], a[136:139], a[40:43], v[204:207]
v_mul_f32 v202, s41, v202
v_mul_f32 v203, s41, v203
v_mfma_f32_16x16x32_bf16 v[204:207], a[132:135], a[36:39], v[204:207]
v_exp_f32 v201, v201
v_mfma_f32_16x16x32_bf16 v[204:207], a[128:131], a[32:35], v[204:207]
v_exp_f32 v202, v202
v_mfma_f32_16x16x32_bf16 v[224:227], a[128:131], a[64:67], v[244:247]
v_exp_f32 v203, v203
v_mfma_f32_16x16x32_bf16 v[224:227], a[132:135], a[68:71], v[224:227]
ds_read_b128 v[192:195], v236 offset:51200
v_cvt_pk_bf16_f32 v28, v200, v201
v_mfma_f32_16x16x32_bf16 v[224:227], a[136:139], a[72:75], v[224:227]
ds_read_b128 v[196:199], v237 offset:51200
v_cvt_pk_bf16_f32 v29, v202, v203
v_mfma_f32_16x16x32_bf16 v[224:227], a[140:143], a[76:79], v[224:227]
buffer_store_dwordx4 a[200:203], v239, s[24:27], s48 offen offset:384 sc1
v_mul_f32 v204, s41, v204
v_mul_f32 v205, s41, v205
v_mfma_f32_16x16x32_bf16 v[224:227], a[144:147], a[80:83], v[224:227]
v_exp_f32 v204, v204
v_mfma_f32_16x16x32_bf16 v[224:227], a[148:151], a[84:87], v[224:227]
v_mul_f32 v206, s41, v206
v_mul_f32 v207, s41, v207
v_mfma_f32_16x16x32_bf16 v[224:227], a[152:155], a[88:91], v[224:227]
v_exp_f32 v205, v205
v_mfma_f32_16x16x32_bf16 v[224:227], a[156:159], a[92:95], v[224:227]
v_exp_f32 v206, v206
v_mfma_f32_16x16x32_bf16 v[212:215], a[252:255], v[120:123], v[212:215]
buffer_load_dwordx4 v239, s[16:19], s63 offen lds
v_mfma_f32_16x16x32_bf16 v[200:203], a[156:159], a[124:127], v[220:223]
s_add_u32 m0, s38, s58
v_exp_f32 v207, v207
v_mfma_f32_16x16x32_bf16 v[200:203], a[152:155], a[120:123], v[200:203]
ds_read_b128 a[156:159], v237 offset:52224
v_cvt_pk_bf16_f32 v76, v204, v205
v_mfma_f32_16x16x32_bf16 v[200:203], a[148:151], a[116:119], v[200:203]
ds_read_b128 a[152:155], v236 offset:52224
v_cvt_pk_bf16_f32 v77, v206, v207
v_mfma_f32_16x16x32_bf16 v[200:203], a[144:147], a[112:115], v[200:203]
v_mul_f32 v224, s41, v224
v_mul_f32 v225, s41, v225
v_mfma_f32_16x16x32_bf16 v[200:203], a[140:143], a[108:111], v[200:203]
v_exp_f32 v224, v224
v_mfma_f32_16x16x32_bf16 v[200:203], a[136:139], a[104:107], v[200:203]
v_mul_f32 v226, s41, v226
v_mul_f32 v227, s41, v227
v_mfma_f32_16x16x32_bf16 v[200:203], a[132:135], a[100:103], v[200:203]
v_exp_f32 v225, v225
v_mfma_f32_16x16x32_bf16 v[200:203], a[128:131], a[96:99], v[200:203]
s_waitcnt lgkmcnt(2)
v_exp_f32 v226, v226
v_mfma_f32_16x16x32_bf16 v[204:207], a[160:163], a[0:3], v[228:231]
v_exp_f32 v227, v227
v_mfma_f32_16x16x32_bf16 v[204:207], a[164:167], a[4:7], v[204:207]
ds_read_b128 a[128:131], v236 offset:57344
v_cvt_pk_bf16_f32 v124, v224, v225
v_mfma_f32_16x16x32_bf16 v[204:207], a[168:171], a[8:11], v[204:207]
ds_read_b128 a[132:135], v237 offset:57344
v_cvt_pk_bf16_f32 v125, v226, v227
v_mfma_f32_16x16x32_bf16 v[204:207], a[172:175], a[12:15], v[204:207]
v_mul_f32 v200, s41, v200
v_mul_f32 v201, s41, v201
v_mfma_f32_16x16x32_bf16 v[204:207], v[192:195], a[16:19], v[204:207]
v_exp_f32 v200, v200
v_mfma_f32_16x16x32_bf16 v[204:207], v[196:199], a[20:23], v[204:207]
s_waitcnt lgkmcnt(2)
v_mul_f32 v202, s41, v202
v_mul_f32 v203, s41, v203
v_mfma_f32_16x16x32_bf16 v[204:207], a[152:155], a[24:27], v[204:207]
v_exp_f32 v201, v201
v_mfma_f32_16x16x32_bf16 v[204:207], a[156:159], a[28:31], v[204:207]
v_exp_f32 v202, v202
v_mfma_f32_16x16x32_bf16 v[214:217], a[252:255], v[168:171], v[214:217]
buffer_load_dwordx4 v239, s[16:19], s64 offen lds
v_mfma_f32_16x16x32_bf16 v[224:227], a[156:159], a[60:63], v[252:255]
s_add_u32 m0, s38, s59
v_exp_f32 v203, v203
v_mfma_f32_16x16x32_bf16 v[224:227], a[152:155], a[56:59], v[224:227]
ds_read_b128 a[136:139], v236 offset:58368
v_cvt_pk_bf16_f32 v172, v200, v201
v_mfma_f32_16x16x32_bf16 v[224:227], v[196:199], a[52:55], v[224:227]
ds_read_b128 a[140:143], v237 offset:58368
v_cvt_pk_bf16_f32 v173, v202, v203
v_mfma_f32_16x16x32_bf16 v[224:227], v[192:195], a[48:51], v[224:227]
v_mul_f32 v204, s41, v204
v_mul_f32 v205, s41, v205
v_mfma_f32_16x16x32_bf16 v[224:227], a[172:175], a[44:47], v[224:227]
v_exp_f32 v204, v204
v_mfma_f32_16x16x32_bf16 v[224:227], a[168:171], a[40:43], v[224:227]
v_mul_f32 v206, s41, v206
v_mul_f32 v207, s41, v207
v_mfma_f32_16x16x32_bf16 v[224:227], a[164:167], a[36:39], v[224:227]
v_exp_f32 v205, v205
v_mfma_f32_16x16x32_bf16 v[224:227], a[160:163], a[32:35], v[224:227]
v_exp_f32 v206, v206
v_mfma_f32_16x16x32_bf16 v[200:203], a[160:163], a[64:67], v[244:247]
v_exp_f32 v207, v207
v_mfma_f32_16x16x32_bf16 v[200:203], a[164:167], a[68:71], v[200:203]
ds_read_b128 a[144:147], v236 offset:59392
v_cvt_pk_bf16_f32 v30, v204, v205
v_mfma_f32_16x16x32_bf16 v[200:203], a[168:171], a[72:75], v[200:203]
ds_read_b128 a[148:151], v237 offset:59392
v_cvt_pk_bf16_f32 v31, v206, v207
v_mfma_f32_16x16x32_bf16 v[200:203], a[172:175], a[76:79], v[200:203]
buffer_store_dwordx4 a[204:207], v239, s[24:27], s49 offen offset:384 sc1
v_mul_f32 v224, s41, v224
v_mul_f32 v225, s41, v225
v_mfma_f32_16x16x32_bf16 v[200:203], v[192:195], a[80:83], v[200:203]
v_exp_f32 v224, v224
v_mfma_f32_16x16x32_bf16 v[200:203], v[196:199], a[84:87], v[200:203]
v_mul_f32 v226, s41, v226
v_mul_f32 v227, s41, v227
v_mfma_f32_16x16x32_bf16 v[200:203], a[152:155], a[88:91], v[200:203]
v_exp_f32 v225, v225
v_mfma_f32_16x16x32_bf16 v[200:203], a[156:159], a[92:95], v[200:203]
v_exp_f32 v226, v226
v_mfma_f32_16x16x32_bf16 v[208:211], a[252:255], v[28:31], v[208:211]
buffer_load_dwordx4 v239, s[16:19], s65 offen lds
v_mfma_f32_16x16x32_bf16 v[204:207], a[156:159], a[124:127], v[220:223]
s_add_u32 m0, s38, s60
v_exp_f32 v227, v227
v_mfma_f32_16x16x32_bf16 v[204:207], a[152:155], a[120:123], v[204:207]
ds_read_b128 a[156:159], v237 offset:60416
v_cvt_pk_bf16_f32 v78, v224, v225
v_mfma_f32_16x16x32_bf16 v[204:207], v[196:199], a[116:119], v[204:207]
ds_read_b128 a[152:155], v236 offset:60416
v_cvt_pk_bf16_f32 v79, v226, v227
v_mfma_f32_16x16x32_bf16 v[204:207], v[192:195], a[112:115], v[204:207]
ds_read_b128 a[208:211], v248 offset:8192
v_mul_f32 v200, s41, v200
v_mul_f32 v201, s41, v201
v_mfma_f32_16x16x32_bf16 v[204:207], a[172:175], a[108:111], v[204:207]
ds_read_b128 a[212:215], v248 offset:12288
v_exp_f32 v200, v200
v_mfma_f32_16x16x32_bf16 v[204:207], a[168:171], a[104:107], v[204:207]
v_mul_f32 v202, s41, v202
v_mul_f32 v203, s41, v203
v_mfma_f32_16x16x32_bf16 v[204:207], a[164:167], a[100:103], v[204:207]
v_exp_f32 v201, v201
v_mfma_f32_16x16x32_bf16 v[204:207], a[160:163], a[96:99], v[204:207]
s_waitcnt lgkmcnt(4)
v_exp_f32 v202, v202
v_mfma_f32_16x16x32_bf16 v[224:227], a[128:131], a[0:3], v[228:231]
v_exp_f32 v203, v203
v_mfma_f32_16x16x32_bf16 v[224:227], a[132:135], a[4:7], v[224:227]
ds_read_b128 a[160:163], v249 offset:8192
v_cvt_pk_bf16_f32 v126, v200, v201
v_mfma_f32_16x16x32_bf16 v[224:227], a[136:139], a[8:11], v[224:227]
ds_read_b128 a[164:167], v250 offset:8192
v_cvt_pk_bf16_f32 v127, v202, v203
v_mfma_f32_16x16x32_bf16 v[224:227], a[140:143], a[12:15], v[224:227]
s_waitcnt lgkmcnt(2)
v_mul_f32 v204, s41, v204
v_mul_f32 v205, s41, v205
v_mfma_f32_16x16x32_bf16 v[224:227], a[144:147], a[16:19], v[224:227]
v_exp_f32 v204, v204
v_mfma_f32_16x16x32_bf16 v[224:227], a[148:151], a[20:23], v[224:227]
s_waitcnt lgkmcnt(4)
v_mul_f32 v206, s41, v206
v_mul_f32 v207, s41, v207
v_mfma_f32_16x16x32_bf16 v[224:227], a[152:155], a[24:27], v[224:227]
v_exp_f32 v205, v205
v_mfma_f32_16x16x32_bf16 v[224:227], a[156:159], a[28:31], v[224:227]
v_exp_f32 v206, v206
v_mfma_f32_16x16x32_bf16 v[210:213], a[252:255], v[76:79], v[210:213]
buffer_load_dwordx4 v239, s[16:19], s66 offen lds
v_mfma_f32_16x16x32_bf16 v[200:203], a[156:159], a[60:63], v[252:255]
s_add_u32 m0, s38, s61
v_exp_f32 v207, v207
v_mfma_f32_16x16x32_bf16 v[200:203], a[152:155], a[56:59], v[200:203]
ds_read_b128 a[168:171], v249 offset:9216
v_cvt_pk_bf16_f32 v174, v204, v205
v_mfma_f32_16x16x32_bf16 v[200:203], a[148:151], a[52:55], v[200:203]
ds_read_b128 a[172:175], v250 offset:9216
v_cvt_pk_bf16_f32 v175, v206, v207
v_mfma_f32_16x16x32_bf16 v[200:203], a[144:147], a[48:51], v[200:203]
v_mul_f32 v224, s41, v224
v_mul_f32 v225, s41, v225
v_mfma_f32_16x16x32_bf16 v[200:203], a[140:143], a[44:47], v[200:203]
v_exp_f32 v224, v224
v_mfma_f32_16x16x32_bf16 v[200:203], a[136:139], a[40:43], v[200:203]
v_mul_f32 v226, s41, v226
v_mul_f32 v227, s41, v227
v_mfma_f32_16x16x32_bf16 v[200:203], a[132:135], a[36:39], v[200:203]
v_exp_f32 v225, v225
v_mfma_f32_16x16x32_bf16 v[200:203], a[128:131], a[32:35], v[200:203]
v_exp_f32 v226, v226
v_mfma_f32_16x16x32_bf16 v[204:207], a[128:131], a[64:67], v[244:247]
buffer_store_dwordx4 a[208:211], v239, s[24:27], s50 offen offset:384 sc1
v_exp_f32 v227, v227
v_mfma_f32_16x16x32_bf16 v[204:207], a[132:135], a[68:71], v[204:207]
ds_read_b128 v[192:195], v249 offset:10240
v_cvt_pk_bf16_f32 v32, v224, v225
v_mfma_f32_16x16x32_bf16 v[204:207], a[136:139], a[72:75], v[204:207]
ds_read_b128 v[196:199], v250 offset:10240
v_cvt_pk_bf16_f32 v33, v226, v227
v_mfma_f32_16x16x32_bf16 v[204:207], a[140:143], a[76:79], v[204:207]
v_mul_f32 v200, s41, v200
v_mul_f32 v201, s41, v201
v_mfma_f32_16x16x32_bf16 v[204:207], a[144:147], a[80:83], v[204:207]
v_exp_f32 v200, v200
v_mfma_f32_16x16x32_bf16 v[204:207], a[148:151], a[84:87], v[204:207]
v_mul_f32 v202, s41, v202
v_mul_f32 v203, s41, v203
v_mfma_f32_16x16x32_bf16 v[204:207], a[152:155], a[88:91], v[204:207]
v_exp_f32 v201, v201
v_mfma_f32_16x16x32_bf16 v[204:207], a[156:159], a[92:95], v[204:207]
v_exp_f32 v202, v202
v_mfma_f32_16x16x32_bf16 v[212:215], a[252:255], v[124:127], v[212:215]
buffer_load_dwordx4 v239, s[16:19], s67 offen lds
v_mfma_f32_16x16x32_bf16 v[224:227], a[156:159], a[124:127], v[220:223]
s_add_u32 m0, s39, s56
v_exp_f32 v203, v203
v_mfma_f32_16x16x32_bf16 v[224:227], a[152:155], a[120:123], v[224:227]
ds_read_b128 a[156:159], v250 offset:11264
v_cvt_pk_bf16_f32 v80, v200, v201
v_mfma_f32_16x16x32_bf16 v[224:227], a[148:151], a[116:119], v[224:227]
ds_read_b128 a[152:155], v249 offset:11264
v_cvt_pk_bf16_f32 v81, v202, v203
v_mfma_f32_16x16x32_bf16 v[224:227], a[144:147], a[112:115], v[224:227]
s_add_u32 s16, s16, 128
s_addc_u32 s17, s17, 0
v_mul_f32 v204, s41, v204
v_mul_f32 v205, s41, v205
v_mfma_f32_16x16x32_bf16 v[224:227], a[140:143], a[108:111], v[224:227]
v_exp_f32 v204, v204
v_mfma_f32_16x16x32_bf16 v[224:227], a[136:139], a[104:107], v[224:227]
v_mul_f32 v206, s41, v206
v_mul_f32 v207, s41, v207
v_mfma_f32_16x16x32_bf16 v[224:227], a[132:135], a[100:103], v[224:227]
v_exp_f32 v205, v205
v_mfma_f32_16x16x32_bf16 v[224:227], a[128:131], a[96:99], v[224:227]
s_waitcnt vmcnt(10) lgkmcnt(0)
v_exp_f32 v206, v206
v_mfma_f32_16x16x32_bf16 v[200:203], a[160:163], a[0:3], v[228:231]
s_barrier
v_exp_f32 v207, v207
v_mfma_f32_16x16x32_bf16 v[200:203], a[164:167], a[4:7], v[200:203]
ds_read_b128 a[128:131], v249 offset:16384
v_cvt_pk_bf16_f32 v128, v204, v205
v_mfma_f32_16x16x32_bf16 v[200:203], a[168:171], a[8:11], v[200:203]
ds_read_b128 a[132:135], v250 offset:16384
v_cvt_pk_bf16_f32 v129, v206, v207
v_mfma_f32_16x16x32_bf16 v[200:203], a[172:175], a[12:15], v[200:203]
v_mul_f32 v224, s41, v224
v_mul_f32 v225, s41, v225
v_mfma_f32_16x16x32_bf16 v[200:203], v[192:195], a[16:19], v[200:203]
v_exp_f32 v224, v224
v_mfma_f32_16x16x32_bf16 v[200:203], v[196:199], a[20:23], v[200:203]
v_mul_f32 v226, s41, v226
v_mul_f32 v227, s41, v227
v_mfma_f32_16x16x32_bf16 v[200:203], a[152:155], a[24:27], v[200:203]
v_exp_f32 v225, v225
v_mfma_f32_16x16x32_bf16 v[200:203], a[156:159], a[28:31], v[200:203]
v_exp_f32 v226, v226
v_mfma_f32_16x16x32_bf16 v[214:217], a[252:255], v[172:175], v[214:217]
buffer_load_dwordx4 v239, s[92:95], s62 offen lds
v_mfma_f32_16x16x32_bf16 v[204:207], a[156:159], a[60:63], v[252:255]
s_add_u32 m0, s39, s57
v_exp_f32 v227, v227
v_mfma_f32_16x16x32_bf16 v[204:207], a[152:155], a[56:59], v[204:207]
ds_read_b128 a[136:139], v249 offset:17408
v_cvt_pk_bf16_f32 v176, v224, v225
v_mfma_f32_16x16x32_bf16 v[204:207], v[196:199], a[52:55], v[204:207]
ds_read_b128 a[140:143], v250 offset:17408
v_cvt_pk_bf16_f32 v177, v226, v227
v_mfma_f32_16x16x32_bf16 v[204:207], v[192:195], a[48:51], v[204:207]
global_load_dword v233, v232, s[84:85] offset:384
v_mul_f32 v200, s41, v200
v_mul_f32 v201, s41, v201
v_mfma_f32_16x16x32_bf16 v[204:207], a[172:175], a[44:47], v[204:207]
v_exp_f32 v200, v200
v_mfma_f32_16x16x32_bf16 v[204:207], a[168:171], a[40:43], v[204:207]
v_mul_f32 v202, s41, v202
v_mul_f32 v203, s41, v203
v_mfma_f32_16x16x32_bf16 v[204:207], a[164:167], a[36:39], v[204:207]
v_exp_f32 v201, v201
v_mfma_f32_16x16x32_bf16 v[204:207], a[160:163], a[32:35], v[204:207]
v_exp_f32 v202, v202
v_mfma_f32_16x16x32_bf16 v[224:227], a[160:163], a[64:67], v[244:247]
v_exp_f32 v203, v203
v_mfma_f32_16x16x32_bf16 v[224:227], a[164:167], a[68:71], v[224:227]
ds_read_b128 a[144:147], v249 offset:18432
v_cvt_pk_bf16_f32 v34, v200, v201
v_mfma_f32_16x16x32_bf16 v[224:227], a[168:171], a[72:75], v[224:227]
ds_read_b128 a[148:151], v250 offset:18432
v_cvt_pk_bf16_f32 v35, v202, v203
v_mfma_f32_16x16x32_bf16 v[224:227], a[172:175], a[76:79], v[224:227]
v_mul_f32 v204, s41, v204
v_mul_f32 v205, s41, v205
v_mfma_f32_16x16x32_bf16 v[224:227], v[192:195], a[80:83], v[224:227]
buffer_store_dwordx4 a[212:215], v239, s[24:27], s51 offen offset:384 sc1
v_exp_f32 v204, v204
v_mfma_f32_16x16x32_bf16 v[224:227], v[196:199], a[84:87], v[224:227]
v_mul_f32 v206, s41, v206
v_mul_f32 v207, s41, v207
v_mfma_f32_16x16x32_bf16 v[224:227], a[152:155], a[88:91], v[224:227]
v_exp_f32 v205, v205
v_mfma_f32_16x16x32_bf16 v[224:227], a[156:159], a[92:95], v[224:227]
v_exp_f32 v206, v206
v_mfma_f32_16x16x32_bf16 v[208:211], a[252:255], v[32:35], v[208:211]
buffer_load_dwordx4 v239, s[92:95], s63 offen lds
v_mfma_f32_16x16x32_bf16 v[200:203], a[156:159], a[124:127], v[220:223]
s_add_u32 m0, s39, s58
v_exp_f32 v207, v207
v_mfma_f32_16x16x32_bf16 v[200:203], a[152:155], a[120:123], v[200:203]
ds_read_b128 a[156:159], v250 offset:19456
v_cvt_pk_bf16_f32 v82, v204, v205
v_mfma_f32_16x16x32_bf16 v[200:203], v[196:199], a[116:119], v[200:203]
ds_read_b128 a[152:155], v249 offset:19456
v_cvt_pk_bf16_f32 v83, v206, v207
v_mfma_f32_16x16x32_bf16 v[200:203], v[192:195], a[112:115], v[200:203]
v_mul_f32 v224, s41, v224
v_mul_f32 v225, s41, v225
v_mfma_f32_16x16x32_bf16 v[200:203], a[172:175], a[108:111], v[200:203]
v_exp_f32 v224, v224
v_mfma_f32_16x16x32_bf16 v[200:203], a[168:171], a[104:107], v[200:203]
v_mul_f32 v226, s41, v226
v_mul_f32 v227, s41, v227
v_mfma_f32_16x16x32_bf16 v[200:203], a[164:167], a[100:103], v[200:203]
v_exp_f32 v225, v225
v_mfma_f32_16x16x32_bf16 v[200:203], a[160:163], a[96:99], v[200:203]
s_waitcnt lgkmcnt(2)
v_exp_f32 v226, v226
v_mfma_f32_16x16x32_bf16 v[204:207], a[128:131], a[0:3], v[228:231]
v_exp_f32 v227, v227
v_mfma_f32_16x16x32_bf16 v[204:207], a[132:135], a[4:7], v[204:207]
ds_read_b128 a[160:163], v249 offset:24576
v_cvt_pk_bf16_f32 v130, v224, v225
v_mfma_f32_16x16x32_bf16 v[204:207], a[136:139], a[8:11], v[204:207]
ds_read_b128 a[164:167], v250 offset:24576
v_cvt_pk_bf16_f32 v131, v226, v227
v_mfma_f32_16x16x32_bf16 v[204:207], a[140:143], a[12:15], v[204:207]
v_mul_f32 v200, s41, v200
v_mul_f32 v201, s41, v201
v_mfma_f32_16x16x32_bf16 v[204:207], a[144:147], a[16:19], v[204:207]
v_exp_f32 v200, v200
v_mfma_f32_16x16x32_bf16 v[204:207], a[148:151], a[20:23], v[204:207]
s_waitcnt lgkmcnt(2)
v_mul_f32 v202, s41, v202
v_mul_f32 v203, s41, v203
v_mfma_f32_16x16x32_bf16 v[204:207], a[152:155], a[24:27], v[204:207]
ds_read_b128 a[216:219], v248 offset:16384
v_exp_f32 v201, v201
v_mfma_f32_16x16x32_bf16 v[204:207], a[156:159], a[28:31], v[204:207]
ds_read_b128 a[220:223], v248 offset:20480
v_exp_f32 v202, v202
v_mfma_f32_16x16x32_bf16 v[210:213], a[252:255], v[80:83], v[210:213]
buffer_load_dwordx4 v239, s[92:95], s64 offen lds
v_mfma_f32_16x16x32_bf16 v[224:227], a[156:159], a[60:63], v[252:255]
s_add_u32 m0, s39, s59
v_exp_f32 v203, v203
v_mfma_f32_16x16x32_bf16 v[224:227], a[152:155], a[56:59], v[224:227]
ds_read_b128 a[168:171], v249 offset:25600
v_cvt_pk_bf16_f32 v178, v200, v201
v_mfma_f32_16x16x32_bf16 v[224:227], a[148:151], a[52:55], v[224:227]
ds_read_b128 a[172:175], v250 offset:25600
v_cvt_pk_bf16_f32 v179, v202, v203
v_mfma_f32_16x16x32_bf16 v[224:227], a[144:147], a[48:51], v[224:227]
v_mul_f32 v204, s41, v204
v_mul_f32 v205, s41, v205
v_mfma_f32_16x16x32_bf16 v[224:227], a[140:143], a[44:47], v[224:227]
s_waitcnt lgkmcnt(2)
v_exp_f32 v204, v204
v_mfma_f32_16x16x32_bf16 v[224:227], a[136:139], a[40:43], v[224:227]
v_mul_f32 v206, s41, v206
v_mul_f32 v207, s41, v207
v_mfma_f32_16x16x32_bf16 v[224:227], a[132:135], a[36:39], v[224:227]
v_exp_f32 v205, v205
v_mfma_f32_16x16x32_bf16 v[224:227], a[128:131], a[32:35], v[224:227]
v_exp_f32 v206, v206
v_mfma_f32_16x16x32_bf16 v[200:203], a[128:131], a[64:67], v[244:247]
v_exp_f32 v207, v207
v_mfma_f32_16x16x32_bf16 v[200:203], a[132:135], a[68:71], v[200:203]
ds_read_b128 v[192:195], v249 offset:26624
v_cvt_pk_bf16_f32 v36, v204, v205
v_mfma_f32_16x16x32_bf16 v[200:203], a[136:139], a[72:75], v[200:203]
ds_read_b128 v[196:199], v250 offset:26624
v_cvt_pk_bf16_f32 v37, v206, v207
v_mfma_f32_16x16x32_bf16 v[200:203], a[140:143], a[76:79], v[200:203]
v_mul_f32 v224, s41, v224
v_mul_f32 v225, s41, v225
v_mfma_f32_16x16x32_bf16 v[200:203], a[144:147], a[80:83], v[200:203]
v_exp_f32 v224, v224
v_mfma_f32_16x16x32_bf16 v[200:203], a[148:151], a[84:87], v[200:203]
v_mul_f32 v226, s41, v226
v_mul_f32 v227, s41, v227
v_mfma_f32_16x16x32_bf16 v[200:203], a[152:155], a[88:91], v[200:203]
v_exp_f32 v225, v225
v_mfma_f32_16x16x32_bf16 v[200:203], a[156:159], a[92:95], v[200:203]
v_exp_f32 v226, v226
v_mfma_f32_16x16x32_bf16 v[212:215], a[252:255], v[128:131], v[212:215]
buffer_load_dwordx4 v239, s[92:95], s65 offen lds
v_mfma_f32_16x16x32_bf16 v[204:207], a[156:159], a[124:127], v[220:223]
s_add_u32 m0, s39, s60
v_exp_f32 v227, v227
v_mfma_f32_16x16x32_bf16 v[204:207], a[152:155], a[120:123], v[204:207]
ds_read_b128 a[156:159], v250 offset:27648
v_cvt_pk_bf16_f32 v84, v224, v225
v_mfma_f32_16x16x32_bf16 v[204:207], a[148:151], a[116:119], v[204:207]
ds_read_b128 a[152:155], v249 offset:27648
v_cvt_pk_bf16_f32 v85, v226, v227
v_mfma_f32_16x16x32_bf16 v[204:207], a[144:147], a[112:115], v[204:207]
buffer_store_dwordx4 a[216:219], v239, s[24:27], s52 offen offset:384 sc1
v_mul_f32 v200, s41, v200
v_mul_f32 v201, s41, v201
v_mfma_f32_16x16x32_bf16 v[204:207], a[140:143], a[108:111], v[204:207]
v_exp_f32 v200, v200
v_mfma_f32_16x16x32_bf16 v[204:207], a[136:139], a[104:107], v[204:207]
v_mul_f32 v202, s41, v202
v_mul_f32 v203, s41, v203
v_mfma_f32_16x16x32_bf16 v[204:207], a[132:135], a[100:103], v[204:207]
v_exp_f32 v201, v201
v_mfma_f32_16x16x32_bf16 v[204:207], a[128:131], a[96:99], v[204:207]
s_waitcnt lgkmcnt(2)
v_exp_f32 v202, v202
v_mfma_f32_16x16x32_bf16 v[224:227], a[160:163], a[0:3], v[228:231]
v_exp_f32 v203, v203
v_mfma_f32_16x16x32_bf16 v[224:227], a[164:167], a[4:7], v[224:227]
ds_read_b128 a[128:131], v249 offset:32768
v_cvt_pk_bf16_f32 v132, v200, v201
v_mfma_f32_16x16x32_bf16 v[224:227], a[168:171], a[8:11], v[224:227]
ds_read_b128 a[132:135], v250 offset:32768
v_cvt_pk_bf16_f32 v133, v202, v203
v_mfma_f32_16x16x32_bf16 v[224:227], a[172:175], a[12:15], v[224:227]
v_mul_f32 v204, s41, v204
v_mul_f32 v205, s41, v205
v_mfma_f32_16x16x32_bf16 v[224:227], v[192:195], a[16:19], v[224:227]
v_exp_f32 v204, v204
v_mfma_f32_16x16x32_bf16 v[224:227], v[196:199], a[20:23], v[224:227]
s_waitcnt lgkmcnt(2)
v_mul_f32 v206, s41, v206
v_mul_f32 v207, s41, v207
v_mfma_f32_16x16x32_bf16 v[224:227], a[152:155], a[24:27], v[224:227]
v_exp_f32 v205, v205
v_mfma_f32_16x16x32_bf16 v[224:227], a[156:159], a[28:31], v[224:227]
v_exp_f32 v206, v206
v_mfma_f32_16x16x32_bf16 v[214:217], a[252:255], v[176:179], v[214:217]
buffer_load_dwordx4 v239, s[92:95], s66 offen lds
v_mfma_f32_16x16x32_bf16 v[200:203], a[156:159], a[60:63], v[252:255]
s_add_u32 m0, s39, s61
v_exp_f32 v207, v207
v_mfma_f32_16x16x32_bf16 v[200:203], a[152:155], a[56:59], v[200:203]
ds_read_b128 a[136:139], v249 offset:33792
v_cvt_pk_bf16_f32 v180, v204, v205
v_mfma_f32_16x16x32_bf16 v[200:203], v[196:199], a[52:55], v[200:203]
ds_read_b128 a[140:143], v250 offset:33792
v_cvt_pk_bf16_f32 v181, v206, v207
v_mfma_f32_16x16x32_bf16 v[200:203], v[192:195], a[48:51], v[200:203]
v_mul_f32 v224, s41, v224
v_mul_f32 v225, s41, v225
v_mfma_f32_16x16x32_bf16 v[200:203], a[172:175], a[44:47], v[200:203]
v_exp_f32 v224, v224
v_mfma_f32_16x16x32_bf16 v[200:203], a[168:171], a[40:43], v[200:203]
v_mul_f32 v226, s41, v226
v_mul_f32 v227, s41, v227
v_mfma_f32_16x16x32_bf16 v[200:203], a[164:167], a[36:39], v[200:203]
v_exp_f32 v225, v225
v_mfma_f32_16x16x32_bf16 v[200:203], a[160:163], a[32:35], v[200:203]
v_exp_f32 v226, v226
v_mfma_f32_16x16x32_bf16 v[204:207], a[160:163], a[64:67], v[244:247]
v_exp_f32 v227, v227
v_mfma_f32_16x16x32_bf16 v[204:207], a[164:167], a[68:71], v[204:207]
ds_read_b128 a[144:147], v249 offset:34816
v_cvt_pk_bf16_f32 v38, v224, v225
v_mfma_f32_16x16x32_bf16 v[204:207], a[168:171], a[72:75], v[204:207]
ds_read_b128 a[148:151], v250 offset:34816
v_cvt_pk_bf16_f32 v39, v226, v227
v_mfma_f32_16x16x32_bf16 v[204:207], a[172:175], a[76:79], v[204:207]
v_mul_f32 v200, s41, v200
v_mul_f32 v201, s41, v201
v_mfma_f32_16x16x32_bf16 v[204:207], v[192:195], a[80:83], v[204:207]
v_exp_f32 v200, v200
v_mfma_f32_16x16x32_bf16 v[204:207], v[196:199], a[84:87], v[204:207]
v_mul_f32 v202, s41, v202
v_mul_f32 v203, s41, v203
v_mfma_f32_16x16x32_bf16 v[204:207], a[152:155], a[88:91], v[204:207]
v_exp_f32 v201, v201
v_mfma_f32_16x16x32_bf16 v[204:207], a[156:159], a[92:95], v[204:207]
v_exp_f32 v202, v202
v_mfma_f32_16x16x32_bf16 v[208:211], a[252:255], v[36:39], v[208:211]
buffer_load_dwordx4 v239, s[92:95], s67 offen lds
v_mfma_f32_16x16x32_bf16 v[224:227], a[156:159], a[124:127], v[220:223]
s_add_u32 m0, s40, s56
v_exp_f32 v203, v203
v_mfma_f32_16x16x32_bf16 v[224:227], a[152:155], a[120:123], v[224:227]
ds_read_b128 a[156:159], v250 offset:35840
v_cvt_pk_bf16_f32 v86, v200, v201
v_mfma_f32_16x16x32_bf16 v[224:227], v[196:199], a[116:119], v[224:227]
ds_read_b128 a[152:155], v249 offset:35840
v_cvt_pk_bf16_f32 v87, v202, v203
v_mfma_f32_16x16x32_bf16 v[224:227], v[192:195], a[112:115], v[224:227]
s_add_u32 s92, s92, 128
s_addc_u32 s93, s93, 0
v_mul_f32 v204, s41, v204
v_mul_f32 v205, s41, v205
v_mfma_f32_16x16x32_bf16 v[224:227], a[172:175], a[108:111], v[224:227]
v_exp_f32 v204, v204
v_mfma_f32_16x16x32_bf16 v[224:227], a[168:171], a[104:107], v[224:227]
v_mul_f32 v206, s41, v206
v_mul_f32 v207, s41, v207
v_mfma_f32_16x16x32_bf16 v[224:227], a[164:167], a[100:103], v[224:227]
v_exp_f32 v205, v205
v_mfma_f32_16x16x32_bf16 v[224:227], a[160:163], a[96:99], v[224:227]
s_waitcnt lgkmcnt(2)
v_exp_f32 v206, v206
v_mfma_f32_16x16x32_bf16 v[200:203], a[128:131], a[0:3], v[228:231]
buffer_store_dwordx4 a[220:223], v239, s[24:27], s53 offen offset:384 sc1
v_exp_f32 v207, v207
v_mfma_f32_16x16x32_bf16 v[200:203], a[132:135], a[4:7], v[200:203]
ds_read_b128 a[160:163], v249 offset:40960
v_cvt_pk_bf16_f32 v134, v204, v205
v_mfma_f32_16x16x32_bf16 v[200:203], a[136:139], a[8:11], v[200:203]
ds_read_b128 a[164:167], v250 offset:40960
v_cvt_pk_bf16_f32 v135, v206, v207
v_mfma_f32_16x16x32_bf16 v[200:203], a[140:143], a[12:15], v[200:203]
v_mul_f32 v224, s41, v224
v_mul_f32 v225, s41, v225
v_mfma_f32_16x16x32_bf16 v[200:203], a[144:147], a[16:19], v[200:203]
v_exp_f32 v224, v224
v_mfma_f32_16x16x32_bf16 v[200:203], a[148:151], a[20:23], v[200:203]
s_waitcnt lgkmcnt(2)
v_mul_f32 v226, s41, v226
v_mul_f32 v227, s41, v227
v_mfma_f32_16x16x32_bf16 v[200:203], a[152:155], a[24:27], v[200:203]
v_exp_f32 v225, v225
v_mfma_f32_16x16x32_bf16 v[200:203], a[156:159], a[28:31], v[200:203]
v_exp_f32 v226, v226
v_mfma_f32_16x16x32_bf16 v[210:213], a[252:255], v[84:87], v[210:213]
buffer_load_dwordx4 v239, s[16:19], s62 offen lds
v_mfma_f32_16x16x32_bf16 v[204:207], a[156:159], a[60:63], v[252:255]
global_load_dword v233, v232, s[84:85] offset:896
v_exp_f32 v227, v227
v_mfma_f32_16x16x32_bf16 v[204:207], a[152:155], a[56:59], v[204:207]
ds_read_b128 a[168:171], v249 offset:41984
v_cvt_pk_bf16_f32 v182, v224, v225
v_mfma_f32_16x16x32_bf16 v[204:207], a[148:151], a[52:55], v[204:207]
ds_read_b128 a[172:175], v250 offset:41984
v_cvt_pk_bf16_f32 v183, v226, v227
v_mfma_f32_16x16x32_bf16 v[204:207], a[144:147], a[48:51], v[204:207]
s_add_u32 m0, s40, s57
v_mul_f32 v200, s41, v200
v_mul_f32 v201, s41, v201
v_mfma_f32_16x16x32_bf16 v[204:207], a[140:143], a[44:47], v[204:207]
v_exp_f32 v200, v200
v_mfma_f32_16x16x32_bf16 v[204:207], a[136:139], a[40:43], v[204:207]
v_mul_f32 v202, s41, v202
v_mul_f32 v203, s41, v203
v_mfma_f32_16x16x32_bf16 v[204:207], a[132:135], a[36:39], v[204:207]
v_exp_f32 v201, v201
v_mfma_f32_16x16x32_bf16 v[204:207], a[128:131], a[32:35], v[204:207]
v_exp_f32 v202, v202
v_mfma_f32_16x16x32_bf16 v[224:227], a[128:131], a[64:67], v[244:247]
ds_read_b128 a[224:227], v248 offset:24576
v_exp_f32 v203, v203
v_mfma_f32_16x16x32_bf16 v[224:227], a[132:135], a[68:71], v[224:227]
ds_read_b128 v[192:195], v249 offset:43008
v_cvt_pk_bf16_f32 v40, v200, v201
v_mfma_f32_16x16x32_bf16 v[224:227], a[136:139], a[72:75], v[224:227]
ds_read_b128 v[196:199], v250 offset:43008
v_cvt_pk_bf16_f32 v41, v202, v203
v_mfma_f32_16x16x32_bf16 v[224:227], a[140:143], a[76:79], v[224:227]
ds_read_b128 a[228:231], v248 offset:28672
v_mul_f32 v204, s41, v204
v_mul_f32 v205, s41, v205
v_mfma_f32_16x16x32_bf16 v[224:227], a[144:147], a[80:83], v[224:227]
v_exp_f32 v204, v204
v_mfma_f32_16x16x32_bf16 v[224:227], a[148:151], a[84:87], v[224:227]
v_mul_f32 v206, s41, v206
v_mul_f32 v207, s41, v207
v_mfma_f32_16x16x32_bf16 v[224:227], a[152:155], a[88:91], v[224:227]
v_exp_f32 v205, v205
v_mfma_f32_16x16x32_bf16 v[224:227], a[156:159], a[92:95], v[224:227]
v_exp_f32 v206, v206
v_mfma_f32_16x16x32_bf16 v[212:215], a[252:255], v[132:135], v[212:215]
buffer_load_dwordx4 v239, s[16:19], s63 offen lds
v_mfma_f32_16x16x32_bf16 v[200:203], a[156:159], a[124:127], v[220:223]
s_add_u32 m0, s40, s58
v_exp_f32 v207, v207
v_mfma_f32_16x16x32_bf16 v[200:203], a[152:155], a[120:123], v[200:203]
ds_read_b128 a[156:159], v250 offset:44032
v_cvt_pk_bf16_f32 v88, v204, v205
v_mfma_f32_16x16x32_bf16 v[200:203], a[148:151], a[116:119], v[200:203]
ds_read_b128 a[152:155], v249 offset:44032
v_cvt_pk_bf16_f32 v89, v206, v207
v_mfma_f32_16x16x32_bf16 v[200:203], a[144:147], a[112:115], v[200:203]
s_waitcnt lgkmcnt(2)
v_mul_f32 v224, s41, v224
v_mul_f32 v225, s41, v225
v_mfma_f32_16x16x32_bf16 v[200:203], a[140:143], a[108:111], v[200:203]
v_exp_f32 v224, v224
v_mfma_f32_16x16x32_bf16 v[200:203], a[136:139], a[104:107], v[200:203]
v_mul_f32 v226, s41, v226
v_mul_f32 v227, s41, v227
v_mfma_f32_16x16x32_bf16 v[200:203], a[132:135], a[100:103], v[200:203]
v_exp_f32 v225, v225
v_mfma_f32_16x16x32_bf16 v[200:203], a[128:131], a[96:99], v[200:203]
s_waitcnt lgkmcnt(3)
v_exp_f32 v226, v226
v_mfma_f32_16x16x32_bf16 v[204:207], a[160:163], a[0:3], v[228:231]
v_exp_f32 v227, v227
v_mfma_f32_16x16x32_bf16 v[204:207], a[164:167], a[4:7], v[204:207]
ds_read_b128 a[128:131], v249 offset:49152
v_cvt_pk_bf16_f32 v136, v224, v225
v_mfma_f32_16x16x32_bf16 v[204:207], a[168:171], a[8:11], v[204:207]
ds_read_b128 a[132:135], v250 offset:49152
v_cvt_pk_bf16_f32 v137, v226, v227
v_mfma_f32_16x16x32_bf16 v[204:207], a[172:175], a[12:15], v[204:207]
v_mul_f32 v200, s41, v200
v_mul_f32 v201, s41, v201
v_mfma_f32_16x16x32_bf16 v[204:207], v[192:195], a[16:19], v[204:207]
v_exp_f32 v200, v200
v_mfma_f32_16x16x32_bf16 v[204:207], v[196:199], a[20:23], v[204:207]
s_waitcnt lgkmcnt(2)
v_mul_f32 v202, s41, v202
v_mul_f32 v203, s41, v203
v_mfma_f32_16x16x32_bf16 v[204:207], a[152:155], a[24:27], v[204:207]
buffer_store_dwordx4 a[224:227], v239, s[24:27], s54 offen offset:384 sc1
v_exp_f32 v201, v201
v_mfma_f32_16x16x32_bf16 v[204:207], a[156:159], a[28:31], v[204:207]
v_exp_f32 v202, v202
v_mfma_f32_16x16x32_bf16 v[214:217], a[252:255], v[180:183], v[214:217]
buffer_load_dwordx4 v239, s[16:19], s64 offen lds
v_mfma_f32_16x16x32_bf16 v[224:227], a[156:159], a[60:63], v[252:255]
s_add_u32 m0, s40, s59
v_exp_f32 v203, v203
v_mfma_f32_16x16x32_bf16 v[224:227], a[152:155], a[56:59], v[224:227]
ds_read_b128 a[136:139], v249 offset:50176
v_cvt_pk_bf16_f32 v184, v200, v201
v_mfma_f32_16x16x32_bf16 v[224:227], v[196:199], a[52:55], v[224:227]
ds_read_b128 a[140:143], v250 offset:50176
v_cvt_pk_bf16_f32 v185, v202, v203
v_mfma_f32_16x16x32_bf16 v[224:227], v[192:195], a[48:51], v[224:227]
v_mul_f32 v204, s41, v204
v_mul_f32 v205, s41, v205
v_mfma_f32_16x16x32_bf16 v[224:227], a[172:175], a[44:47], v[224:227]
v_exp_f32 v204, v204
v_mfma_f32_16x16x32_bf16 v[224:227], a[168:171], a[40:43], v[224:227]
v_mul_f32 v206, s41, v206
v_mul_f32 v207, s41, v207
v_mfma_f32_16x16x32_bf16 v[224:227], a[164:167], a[36:39], v[224:227]
v_exp_f32 v205, v205
v_mfma_f32_16x16x32_bf16 v[224:227], a[160:163], a[32:35], v[224:227]
v_exp_f32 v206, v206
v_mfma_f32_16x16x32_bf16 v[200:203], a[160:163], a[64:67], v[244:247]
v_exp_f32 v207, v207
v_mfma_f32_16x16x32_bf16 v[200:203], a[164:167], a[68:71], v[200:203]
ds_read_b128 a[144:147], v249 offset:51200
v_cvt_pk_bf16_f32 v42, v204, v205
v_mfma_f32_16x16x32_bf16 v[200:203], a[168:171], a[72:75], v[200:203]
ds_read_b128 a[148:151], v250 offset:51200
v_cvt_pk_bf16_f32 v43, v206, v207
v_mfma_f32_16x16x32_bf16 v[200:203], a[172:175], a[76:79], v[200:203]
v_mul_f32 v224, s41, v224
v_mul_f32 v225, s41, v225
v_mfma_f32_16x16x32_bf16 v[200:203], v[192:195], a[80:83], v[200:203]
v_exp_f32 v224, v224
v_mfma_f32_16x16x32_bf16 v[200:203], v[196:199], a[84:87], v[200:203]
v_mul_f32 v226, s41, v226
v_mul_f32 v227, s41, v227
v_mfma_f32_16x16x32_bf16 v[200:203], a[152:155], a[88:91], v[200:203]
v_exp_f32 v225, v225
v_mfma_f32_16x16x32_bf16 v[200:203], a[156:159], a[92:95], v[200:203]
v_exp_f32 v226, v226
v_mfma_f32_16x16x32_bf16 v[208:211], a[252:255], v[40:43], v[208:211]
buffer_load_dwordx4 v239, s[16:19], s65 offen lds
v_mfma_f32_16x16x32_bf16 v[204:207], a[156:159], a[124:127], v[220:223]
s_add_u32 m0, s40, s60
v_exp_f32 v227, v227
v_mfma_f32_16x16x32_bf16 v[204:207], a[152:155], a[120:123], v[204:207]
ds_read_b128 a[156:159], v250 offset:52224
v_cvt_pk_bf16_f32 v90, v224, v225
v_mfma_f32_16x16x32_bf16 v[204:207], v[196:199], a[116:119], v[204:207]
ds_read_b128 a[152:155], v249 offset:52224
v_cvt_pk_bf16_f32 v91, v226, v227
v_mfma_f32_16x16x32_bf16 v[204:207], v[192:195], a[112:115], v[204:207]
v_mul_f32 v200, s41, v200
v_mul_f32 v201, s41, v201
v_mfma_f32_16x16x32_bf16 v[204:207], a[172:175], a[108:111], v[204:207]
v_exp_f32 v200, v200
v_mfma_f32_16x16x32_bf16 v[204:207], a[168:171], a[104:107], v[204:207]
v_mul_f32 v202, s41, v202
v_mul_f32 v203, s41, v203
v_mfma_f32_16x16x32_bf16 v[204:207], a[164:167], a[100:103], v[204:207]
v_exp_f32 v201, v201
v_mfma_f32_16x16x32_bf16 v[204:207], a[160:163], a[96:99], v[204:207]
s_waitcnt lgkmcnt(2)
v_exp_f32 v202, v202
v_mfma_f32_16x16x32_bf16 v[224:227], a[128:131], a[0:3], v[228:231]
v_exp_f32 v203, v203
v_mfma_f32_16x16x32_bf16 v[224:227], a[132:135], a[4:7], v[224:227]
ds_read_b128 a[160:163], v249 offset:57344
v_cvt_pk_bf16_f32 v138, v200, v201
v_mfma_f32_16x16x32_bf16 v[224:227], a[136:139], a[8:11], v[224:227]
ds_read_b128 a[164:167], v250 offset:57344
v_cvt_pk_bf16_f32 v139, v202, v203
v_mfma_f32_16x16x32_bf16 v[224:227], a[140:143], a[12:15], v[224:227]
v_mul_f32 v204, s41, v204
v_mul_f32 v205, s41, v205
v_mfma_f32_16x16x32_bf16 v[224:227], a[144:147], a[16:19], v[224:227]
v_exp_f32 v204, v204
v_mfma_f32_16x16x32_bf16 v[224:227], a[148:151], a[20:23], v[224:227]
s_waitcnt lgkmcnt(2)
v_mul_f32 v206, s41, v206
v_mul_f32 v207, s41, v207
v_mfma_f32_16x16x32_bf16 v[224:227], a[152:155], a[24:27], v[224:227]
v_exp_f32 v205, v205
v_mfma_f32_16x16x32_bf16 v[224:227], a[156:159], a[28:31], v[224:227]
v_exp_f32 v206, v206
v_mfma_f32_16x16x32_bf16 v[210:213], a[252:255], v[88:91], v[210:213]
buffer_load_dwordx4 v239, s[16:19], s66 offen lds
v_mfma_f32_16x16x32_bf16 v[200:203], a[156:159], a[60:63], v[252:255]
s_add_u32 m0, s40, s61
v_exp_f32 v207, v207
v_mfma_f32_16x16x32_bf16 v[200:203], a[152:155], a[56:59], v[200:203]
ds_read_b128 a[168:171], v249 offset:58368
v_cvt_pk_bf16_f32 v186, v204, v205
v_mfma_f32_16x16x32_bf16 v[200:203], a[148:151], a[52:55], v[200:203]
ds_read_b128 a[172:175], v250 offset:58368
v_cvt_pk_bf16_f32 v187, v206, v207
v_mfma_f32_16x16x32_bf16 v[200:203], a[144:147], a[48:51], v[200:203]
buffer_store_dwordx4 a[228:231], v239, s[24:27], s55 offen offset:384 sc1
v_mul_f32 v224, s41, v224
v_mul_f32 v225, s41, v225
v_mfma_f32_16x16x32_bf16 v[200:203], a[140:143], a[44:47], v[200:203]
s_add_u32 s24, s10, s96
s_addc_u32 s25, s11, 0
v_exp_f32 v224, v224
v_mfma_f32_16x16x32_bf16 v[200:203], a[136:139], a[40:43], v[200:203]
v_mul_f32 v226, s41, v226
v_mul_f32 v227, s41, v227
v_mfma_f32_16x16x32_bf16 v[200:203], a[132:135], a[36:39], v[200:203]
v_exp_f32 v225, v225
v_mfma_f32_16x16x32_bf16 v[200:203], a[128:131], a[32:35], v[200:203]
v_exp_f32 v226, v226
v_mfma_f32_16x16x32_bf16 v[204:207], a[128:131], a[64:67], v[244:247]
v_exp_f32 v227, v227
v_mfma_f32_16x16x32_bf16 v[204:207], a[132:135], a[68:71], v[204:207]
ds_read_b128 v[192:195], v249 offset:59392
v_cvt_pk_bf16_f32 v44, v224, v225
v_mfma_f32_16x16x32_bf16 v[204:207], a[136:139], a[72:75], v[204:207]
ds_read_b128 v[196:199], v250 offset:59392
v_cvt_pk_bf16_f32 v45, v226, v227
v_mfma_f32_16x16x32_bf16 v[204:207], a[140:143], a[76:79], v[204:207]
v_mul_f32 v200, s41, v200
v_mul_f32 v201, s41, v201
v_mfma_f32_16x16x32_bf16 v[204:207], a[144:147], a[80:83], v[204:207]
v_exp_f32 v200, v200
v_mfma_f32_16x16x32_bf16 v[204:207], a[148:151], a[84:87], v[204:207]
v_mul_f32 v202, s41, v202
v_mul_f32 v203, s41, v203
v_mfma_f32_16x16x32_bf16 v[204:207], a[152:155], a[88:91], v[204:207]
v_exp_f32 v201, v201
v_mfma_f32_16x16x32_bf16 v[204:207], a[156:159], a[92:95], v[204:207]
v_exp_f32 v202, v202
v_mfma_f32_16x16x32_bf16 v[212:215], a[252:255], v[136:139], v[212:215]
buffer_load_dwordx4 v239, s[16:19], s67 offen lds
v_mfma_f32_16x16x32_bf16 v[224:227], a[156:159], a[124:127], v[220:223]
s_add_u32 m0, s69, s56
v_exp_f32 v203, v203
v_mfma_f32_16x16x32_bf16 v[224:227], a[152:155], a[120:123], v[224:227]
ds_read_b128 a[156:159], v250 offset:60416
v_cvt_pk_bf16_f32 v92, v200, v201
v_mfma_f32_16x16x32_bf16 v[224:227], a[148:151], a[116:119], v[224:227]
ds_read_b128 a[152:155], v249 offset:60416
v_cvt_pk_bf16_f32 v93, v202, v203
v_mfma_f32_16x16x32_bf16 v[224:227], a[144:147], a[112:115], v[224:227]
s_add_u32 s16, s16, 128
s_addc_u32 s17, s17, 0
v_mul_f32 v204, s41, v204
v_mul_f32 v205, s41, v205
v_mfma_f32_16x16x32_bf16 v[224:227], a[140:143], a[108:111], v[224:227]
v_exp_f32 v204, v204
v_mfma_f32_16x16x32_bf16 v[224:227], a[136:139], a[104:107], v[224:227]
v_mul_f32 v206, s41, v206
v_mul_f32 v207, s41, v207
v_mfma_f32_16x16x32_bf16 v[224:227], a[132:135], a[100:103], v[224:227]
v_exp_f32 v205, v205
v_mfma_f32_16x16x32_bf16 v[224:227], a[128:131], a[96:99], v[224:227]
s_waitcnt vmcnt(10) lgkmcnt(0)
v_exp_f32 v206, v206
v_mfma_f32_16x16x32_bf16 v[200:203], a[160:163], a[0:3], v[228:231]
s_barrier
v_exp_f32 v207, v207
v_mfma_f32_16x16x32_bf16 v[200:203], a[164:167], a[4:7], v[200:203]
ds_read_b64_tr_b16 a[128:129], v234 offset:0
v_cvt_pk_bf16_f32 v140, v204, v205
v_mfma_f32_16x16x32_bf16 v[200:203], a[168:171], a[8:11], v[200:203]
ds_read_b64_tr_b16 a[130:131], v234 offset:2048
v_cvt_pk_bf16_f32 v141, v206, v207
v_mfma_f32_16x16x32_bf16 v[200:203], a[172:175], a[12:15], v[200:203]
v_mul_f32 v224, s41, v224
v_mul_f32 v225, s41, v225
v_mfma_f32_16x16x32_bf16 v[200:203], v[192:195], a[16:19], v[200:203]
v_exp_f32 v224, v224
v_mfma_f32_16x16x32_bf16 v[200:203], v[196:199], a[20:23], v[200:203]
v_mul_f32 v226, s41, v226
v_mul_f32 v227, s41, v227
v_mfma_f32_16x16x32_bf16 v[200:203], a[152:155], a[24:27], v[200:203]
v_exp_f32 v225, v225
v_mfma_f32_16x16x32_bf16 v[200:203], a[156:159], a[28:31], v[200:203]
v_exp_f32 v226, v226
v_mfma_f32_16x16x32_bf16 v[214:217], a[252:255], v[184:187], v[214:217]
ds_read_b64_tr_b16 a[132:133], v234 offset:4096
v_mfma_f32_16x16x32_bf16 v[204:207], a[156:159], a[60:63], v[252:255]
v_exp_f32 v227, v227
v_mfma_f32_16x16x32_bf16 v[204:207], a[152:155], a[56:59], v[204:207]
ds_read_b64_tr_b16 a[134:135], v234 offset:6144
v_cvt_pk_bf16_f32 v188, v224, v225
v_mfma_f32_16x16x32_bf16 v[204:207], v[196:199], a[52:55], v[204:207]
ds_read_b64_tr_b16 a[136:137], v234 offset:8192
v_cvt_pk_bf16_f32 v189, v226, v227
v_mfma_f32_16x16x32_bf16 v[204:207], v[192:195], a[48:51], v[204:207]
v_mul_f32 v200, s41, v200
v_mul_f32 v201, s41, v201
v_mfma_f32_16x16x32_bf16 v[204:207], a[172:175], a[44:47], v[204:207]
v_exp_f32 v200, v200
v_mfma_f32_16x16x32_bf16 v[204:207], a[168:171], a[40:43], v[204:207]
ds_read_b64_tr_b16 a[138:139], v234 offset:10240
v_mul_f32 v202, s41, v202
v_mul_f32 v203, s41, v203
v_mfma_f32_16x16x32_bf16 v[204:207], a[164:167], a[36:39], v[204:207]
v_exp_f32 v201, v201
v_mfma_f32_16x16x32_bf16 v[204:207], a[160:163], a[32:35], v[204:207]
v_exp_f32 v202, v202
v_mfma_f32_16x16x32_bf16 v[224:227], a[160:163], a[64:67], v[244:247]
v_exp_f32 v203, v203
v_mfma_f32_16x16x32_bf16 v[224:227], a[164:167], a[68:71], v[224:227]
ds_read_b64_tr_b16 a[140:141], v234 offset:12288
v_cvt_pk_bf16_f32 v46, v200, v201
v_mfma_f32_16x16x32_bf16 v[224:227], a[168:171], a[72:75], v[224:227]
ds_read_b64_tr_b16 a[142:143], v234 offset:14336
v_cvt_pk_bf16_f32 v47, v202, v203
v_mfma_f32_16x16x32_bf16 v[224:227], a[172:175], a[76:79], v[224:227]
v_mul_f32 v204, s41, v204
v_mul_f32 v205, s41, v205
v_mfma_f32_16x16x32_bf16 v[224:227], v[192:195], a[80:83], v[224:227]
v_exp_f32 v204, v204
v_mfma_f32_16x16x32_bf16 v[224:227], v[196:199], a[84:87], v[224:227]
ds_read_b64_tr_b16 a[144:145], v234 offset:16384
v_mul_f32 v206, s41, v206
v_mul_f32 v207, s41, v207
v_mfma_f32_16x16x32_bf16 v[224:227], a[152:155], a[88:91], v[224:227]
v_exp_f32 v205, v205
v_mfma_f32_16x16x32_bf16 v[224:227], a[156:159], a[92:95], v[224:227]
v_exp_f32 v206, v206
v_mfma_f32_16x16x32_bf16 v[208:211], a[252:255], v[44:47], v[208:211]
ds_read_b64_tr_b16 a[146:147], v234 offset:18432
v_mfma_f32_16x16x32_bf16 v[200:203], a[156:159], a[124:127], v[220:223]
v_exp_f32 v207, v207
v_mfma_f32_16x16x32_bf16 v[200:203], a[152:155], a[120:123], v[200:203]
ds_read_b64_tr_b16 a[148:149], v234 offset:20480
v_cvt_pk_bf16_f32 v94, v204, v205
v_mfma_f32_16x16x32_bf16 v[200:203], v[196:199], a[116:119], v[200:203]
ds_read_b64_tr_b16 a[150:151], v234 offset:22528
v_cvt_pk_bf16_f32 v95, v206, v207
v_mfma_f32_16x16x32_bf16 v[200:203], v[192:195], a[112:115], v[200:203]
v_mul_f32 v224, s41, v224
v_mul_f32 v225, s41, v225
v_mfma_f32_16x16x32_bf16 v[200:203], a[172:175], a[108:111], v[200:203]
v_exp_f32 v224, v224
v_mfma_f32_16x16x32_bf16 v[200:203], a[168:171], a[104:107], v[200:203]
v_mul_f32 v226, s41, v226
v_mul_f32 v227, s41, v227
v_mfma_f32_16x16x32_bf16 v[200:203], a[164:167], a[100:103], v[200:203]
v_exp_f32 v225, v225
v_mfma_f32_16x16x32_bf16 v[200:203], a[160:163], a[96:99], v[200:203]
v_exp_f32 v226, v226
v_mfma_f32_16x16x32_bf16 v[210:213], a[252:255], v[92:95], v[210:213]
s_waitcnt lgkmcnt(0)
v_exp_f32 v227, v227
L_p2_2:
v_mfma_f32_16x16x32_bf16 v[192:195], a[148:151], v[20:23], 0
ds_read_b64_tr_b16 a[152:153], v234 offset:24576
v_cvt_pk_bf16_f32 v142, v224, v225
v_mfma_f32_16x16x32_bf16 v[192:195], a[144:147], v[16:19], v[192:195]
ds_read_b64_tr_b16 a[154:155], v234 offset:26624
v_cvt_pk_bf16_f32 v143, v226, v227
v_mfma_f32_16x16x32_bf16 v[192:195], a[140:143], v[12:15], v[192:195]
v_mul_f32 v200, s41, v200
v_mul_f32 v201, s41, v201
v_mfma_f32_16x16x32_bf16 v[192:195], a[136:139], v[8:11], v[192:195]
v_exp_f32 v200, v200
v_mfma_f32_16x16x32_bf16 v[192:195], a[132:135], v[4:7], v[192:195]
v_mul_f32 v202, s41, v202
v_mul_f32 v203, s41, v203
v_mfma_f32_16x16x32_bf16 v[192:195], a[128:131], v[0:3], v[192:195]
v_exp_f32 v201, v201
v_mfma_f32_16x16x32_bf16 v[212:215], a[252:255], v[140:143], v[212:215]
v_exp_f32 v202, v202
v_mfma_f32_16x16x32_bf16 v[196:199], a[128:131], v[48:51], 0
v_exp_f32 v203, v203
v_mfma_f32_16x16x32_bf16 v[196:199], a[132:135], v[52:55], v[196:199]
ds_read_b64_tr_b16 a[156:157], v234 offset:28672
v_cvt_pk_bf16_f32 v190, v200, v201
v_mfma_f32_16x16x32_bf16 v[196:199], a[136:139], v[56:59], v[196:199]
ds_read_b64_tr_b16 a[158:159], v234 offset:30720
v_cvt_pk_bf16_f32 v191, v202, v203
v_mfma_f32_16x16x32_bf16 v[196:199], a[140:143], v[60:63], v[196:199]
ds_read_b64_tr_b16 a[160:161], v234 offset:32768
v_add_f32 v224, v208, v210
v_mfma_f32_16x16x32_bf16 v[196:199], a[144:147], v[64:67], v[196:199]
ds_read_b64_tr_b16 a[162:163], v234 offset:34816
v_add_f32 v224, v224, v212
v_mfma_f32_16x16x32_bf16 v[196:199], a[148:151], v[68:71], v[196:199]
buffer_load_dwordx4 v239, s[92:95], s62 offen lds
v_mfma_f32_16x16x32_bf16 v[214:217], a[252:255], v[188:191], v[214:217]
s_add_u32 m0, s69, s57
v_min3_f32 v225, v208, v210, v212
v_mfma_f32_16x16x32_bf16 v[200:203], a[148:151], v[116:119], 0
ds_read_b64_tr_b16 a[164:165], v234 offset:36864
v_mfma_f32_16x16x32_bf16 v[200:203], a[144:147], v[112:115], v[200:203]
ds_read_b64_tr_b16 a[166:167], v234 offset:38912
v_mfma_f32_16x16x32_bf16 v[200:203], a[140:143], v[108:111], v[200:203]
ds_read_b64_tr_b16 a[168:169], v234 offset:40960
v_add_f32 v224, v224, v214
v_mfma_f32_16x16x32_bf16 v[200:203], a[136:139], v[104:107], v[200:203]
ds_read_b64_tr_b16 a[170:171], v234 offset:43008
v_cmp_ngt_f32 vcc, s42, v224
v_mfma_f32_16x16x32_bf16 v[200:203], a[132:135], v[100:103], v[200:203]
ds_read_b64_tr_b16 a[172:173], v234 offset:45056
v_min_f32 v225, v225, v214
v_mfma_f32_16x16x32_bf16 v[200:203], a[128:131], v[96:99], v[200:203]
ds_read_b64_tr_b16 a[174:175], v234 offset:47104
v_cmp_gt_f32_e64 s[98:99], s100, v225
v_mfma_f32_16x16x32_bf16 v[204:207], a[128:131], v[144:147], 0
buffer_load_dwordx4 v239, s[92:95], s63 offen lds
v_mfma_f32_16x16x32_bf16 v[204:207], a[132:135], v[148:151], v[204:207]
s_or_b64 vcc, vcc, s[98:99]
s_add_u32 m0, s69, s58
v_xor_b32 v234, 32, v234
v_mfma_f32_16x16x32_bf16 v[204:207], a[136:139], v[152:155], v[204:207]
v_mfma_f32_16x16x32_bf16 v[204:207], a[140:143], v[156:159], v[204:207]
v_mfma_f32_16x16x32_bf16 v[204:207], a[144:147], v[160:163], v[204:207]
v_mfma_f32_16x16x32_bf16 v[204:207], a[148:151], v[164:167], v[204:207]
s_waitcnt lgkmcnt(0)
s_cbranch_vccnz L_fb2
L_back2:
v_mfma_f32_16x16x32_bf16 v[204:207], a[172:175], v[188:191], v[204:207]
v_rcp_f32 v247, v214
v_mfma_f32_16x16x32_bf16 v[204:207], a[168:171], v[184:187], v[204:207]
ds_read_b64_tr_b16 a[128:129], v234 offset:0
v_mfma_f32_16x16x32_bf16 v[204:207], a[164:167], v[180:183], v[204:207]
ds_read_b64_tr_b16 a[130:131], v234 offset:2048
v_mfma_f32_16x16x32_bf16 v[204:207], a[160:163], v[176:179], v[204:207]
ds_read_b64_tr_b16 a[132:133], v234 offset:4096
v_mfma_f32_16x16x32_bf16 v[204:207], a[156:159], v[172:175], v[204:207]
v_rcp_f32 v246, v212
v_mfma_f32_16x16x32_bf16 v[204:207], a[152:155], v[168:171], v[204:207]
ds_read_b64_tr_b16 a[134:135], v234 offset:6144
v_mfma_f32_16x16x32_bf16 v[200:203], a[152:155], v[120:123], v[200:203]
ds_read_b64_tr_b16 a[136:137], v234 offset:8192
v_mfma_f32_16x16x32_bf16 v[200:203], a[156:159], v[124:127], v[200:203]
ds_read_b64_tr_b16 a[138:139], v234 offset:10240
v_mfma_f32_16x16x32_bf16 v[200:203], a[160:163], v[128:131], v[200:203]
buffer_load_dwordx4 v239, s[92:95], s64 offen lds
v_mfma_f32_16x16x32_bf16 v[200:203], a[164:167], v[132:135], v[200:203]
ds_read_b64_tr_b16 a[140:141], v234 offset:12288
v_max3_f32 v228, |v204|, |v205|, |v206|
v_mfma_f32_16x16x32_bf16 v[200:203], a[168:171], v[136:139], v[200:203]
ds_read_b64_tr_b16 a[142:143], v234 offset:14336
v_mul_f32 v204, v247, v204
v_mfma_f32_16x16x32_bf16 v[200:203], a[172:175], v[140:143], v[200:203]
ds_read_b64_tr_b16 a[144:145], v234 offset:16384
v_mul_f32 v205, v247, v205
v_mfma_f32_16x16x32_bf16 v[196:199], a[172:175], v[92:95], v[196:199]
s_add_u32 m0, s69, s59
v_rcp_f32 v244, v208
v_mfma_f32_16x16x32_bf16 v[196:199], a[168:171], v[88:91], v[196:199]
ds_read_b64_tr_b16 a[146:147], v234 offset:18432
v_rcp_f32 v245, v210
v_mfma_f32_16x16x32_bf16 v[196:199], a[164:167], v[84:87], v[196:199]
ds_read_b64_tr_b16 a[148:149], v234 offset:20480
v_cvt_pk_bf16_f32 v216, v204, v205
v_mfma_f32_16x16x32_bf16 v[196:199], a[160:163], v[80:83], v[196:199]
ds_read_b64_tr_b16 a[150:151], v234 offset:22528
v_mul_f32 v206, v247, v206
v_mfma_f32_16x16x32_bf16 v[196:199], a[156:159], v[76:79], v[196:199]
v_max_f32_e64 v228, v228, |v207|
v_mul_f32 v207, v247, v207
v_mfma_f32_16x16x32_bf16 v[196:199], a[152:155], v[72:75], v[196:199]
buffer_load_dwordx4 v239, s[92:95], s65 offen lds
v_mfma_f32_16x16x32_bf16 v[192:195], a[152:155], v[24:27], v[192:195]
s_add_u32 m0, s69, s60
v_cvt_pk_bf16_f32 v217, v206, v207
v_max3_f32 v229, |v200|, |v201|, |v202|
v_mfma_f32_16x16x32_bf16 v[192:195], a[156:159], v[28:31], v[192:195]
ds_write_b64 v240, v[216:217] offset:24576
v_mfma_f32_16x16x32_bf16 v[192:195], a[160:163], v[32:35], v[192:195]
v_mul_f32 v200, v246, v200
v_mul_f32 v201, v246, v201
v_mfma_f32_16x16x32_bf16 v[192:195], a[164:167], v[36:39], v[192:195]
v_cvt_pk_bf16_f32 v208, v200, v201
v_mul_f32 v202, v246, v202
v_mfma_f32_16x16x32_bf16 v[192:195], a[168:171], v[40:43], v[192:195]
v_max_f32_e64 v229, v229, |v203|
v_mul_f32 v203, v246, v203
v_mfma_f32_16x16x32_bf16 v[192:195], a[172:175], v[44:47], v[192:195]
s_waitcnt lgkmcnt(1)
v_cvt_pk_bf16_f32 v209, v202, v203
v_min_f32 v228, v228, v229
v_mfma_f32_16x16x32_bf16 v[204:207], a[148:151], v[164:167], 0
v_max3_f32 v229, |v196|, |v197|, |v198|
v_mul_f32 v196, v245, v196
v_mfma_f32_16x16x32_bf16 v[204:207], a[144:147], v[160:163], v[204:207]
ds_read_b64_tr_b16 a[152:153], v234 offset:24576
v_mul_f32 v197, v245, v197
v_mfma_f32_16x16x32_bf16 v[204:207], a[140:143], v[156:159], v[204:207]
ds_read_b64_tr_b16 a[154:155], v234 offset:26624
v_cvt_pk_bf16_f32 v226, v196, v197
v_mfma_f32_16x16x32_bf16 v[204:207], a[136:139], v[152:155], v[204:207]
ds_read_b64_tr_b16 a[156:157], v234 offset:28672
v_mul_f32 v198, v245, v198
v_mfma_f32_16x16x32_bf16 v[204:207], a[132:135], v[148:151], v[204:207]
buffer_load_dwordx4 v239, s[92:95], s66 offen lds
v_mfma_f32_16x16x32_bf16 v[204:207], a[128:131], v[144:147], v[204:207]
ds_read_b64_tr_b16 a[158:159], v234 offset:30720
v_max_f32_e64 v229, v229, |v199|
v_mfma_f32_16x16x32_bf16 v[200:203], a[128:131], v[96:99], 0
ds_read_b64_tr_b16 a[160:161], v234 offset:32768
v_mul_f32 v199, v245, v199
v_mfma_f32_16x16x32_bf16 v[200:203], a[132:135], v[100:103], v[200:203]
ds_read_b64_tr_b16 a[162:163], v234 offset:34816
v_cvt_pk_bf16_f32 v227, v198, v199
v_mfma_f32_16x16x32_bf16 v[200:203], a[136:139], v[104:107], v[200:203]
s_add_u32 m0, s69, s61
v_min_f32 v228, v228, v229
v_max3_f32 v229, |v192|, |v193|, |v194|
v_mfma_f32_16x16x32_bf16 v[200:203], a[140:143], v[108:111], v[200:203]
ds_read_b64_tr_b16 a[164:165], v234 offset:36864
v_mul_f32 v192, v244, v192
v_mfma_f32_16x16x32_bf16 v[200:203], a[144:147], v[112:115], v[200:203]
ds_read_b64_tr_b16 a[166:167], v234 offset:38912
v_mul_f32 v193, v244, v193
v_mfma_f32_16x16x32_bf16 v[200:203], a[148:151], v[116:119], v[200:203]
ds_read_b64_tr_b16 a[168:169], v234 offset:40960
v_cvt_pk_bf16_f32 v224, v192, v193
v_mfma_f32_16x16x32_bf16 v[196:199], a[148:151], v[68:71], 0
v_mul_f32 v194, v244, v194
v_max_f32_e64 v229, v229, |v195|
v_mfma_f32_16x16x32_bf16 v[196:199], a[144:147], v[64:67], v[196:199]
ds_read_b64_tr_b16 a[170:171], v234 offset:43008
v_mul_f32 v195, v244, v195
v_mfma_f32_16x16x32_bf16 v[196:199], a[140:143], v[60:63], v[196:199]
ds_read_b64_tr_b16 a[172:173], v234 offset:45056
v_cvt_pk_bf16_f32 v225, v194, v195
v_mfma_f32_16x16x32_bf16 v[196:199], a[136:139], v[56:59], v[196:199]
ds_read_b64_tr_b16 a[174:175], v234 offset:47104
v_min_f32 v228, v228, v229
v_mfma_f32_16x16x32_bf16 v[196:199], a[132:135], v[52:55], v[196:199]
buffer_load_dwordx4 v239, s[92:95], s67 offen lds
v_mfma_f32_16x16x32_bf16 v[196:199], a[128:131], v[48:51], v[196:199]
ds_write_b64 v240, v[224:225] offset:0
v_mfma_f32_16x16x32_bf16 v[192:195], a[128:131], v[0:3], 0
ds_write_b64 v240, v[226:227] offset:8192
v_mfma_f32_16x16x32_bf16 v[192:195], a[132:135], v[4:7], v[192:195]
ds_write_b64 v240, v[208:209] offset:16384
v_mfma_f32_16x16x32_bf16 v[192:195], a[136:139], v[8:11], v[192:195]
s_add_u32 m0, s75, s56
v_xor_b32 v234, 0x60, v234
v_cmp_gt_f32 vcc, s79, v228
v_mfma_f32_16x16x32_bf16 v[192:195], a[140:143], v[12:15], v[192:195]
s_add_u32 s92, s92, 128
s_addc_u32 s93, s93, 0
v_mul_f32 v228, 0x40800000, v228
v_mfma_f32_16x16x32_bf16 v[192:195], a[144:147], v[16:19], v[192:195]
v_cndmask_b32 v228, 0, v228, vcc
v_mov_b32 v229, v228
v_mfma_f32_16x16x32_bf16 v[192:195], a[148:151], v[20:23], v[192:195]
s_waitcnt lgkmcnt(3)
v_mov_b32 v230, v228
v_mov_b32 v231, v228
v_mfma_f32_16x16x32_bf16 v[192:195], a[172:175], v[44:47], v[192:195]
v_mul_f32_e64 v252, -v228, v244
v_mul_f32_e64 v253, -v228, v245
v_mfma_f32_16x16x32_bf16 v[192:195], a[168:171], v[40:43], v[192:195]
ds_read_b64_tr_b16 a[128:129], v234 offset:0
v_mul_f32_e64 v254, -v228, v246
v_mfma_f32_16x16x32_bf16 v[192:195], a[164:167], v[36:39], v[192:195]
ds_read_b64_tr_b16 a[130:131], v234 offset:2048
v_mul_f32_e64 v255, -v228, v247
v_mfma_f32_16x16x32_bf16 v[192:195], a[160:163], v[32:35], v[192:195]
ds_read_b64_tr_b16 a[132:133], v234 offset:4096
v_mfma_f32_16x16x32_bf16 v[192:195], a[156:159], v[28:31], v[192:195]
buffer_load_dwordx4 v239, s[16:19], s62 offen lds
v_mfma_f32_16x16x32_bf16 v[192:195], a[152:155], v[24:27], v[192:195]
ds_read_b64_tr_b16 a[134:135], v234 offset:6144
s_add_u32 m0, s75, s57
v_mfma_f32_16x16x32_bf16 v[196:199], a[152:155], v[72:75], v[196:199]
ds_read_b64_tr_b16 a[136:137], v234 offset:8192
v_mfma_f32_16x16x32_bf16 v[196:199], a[156:159], v[76:79], v[196:199]
ds_read_b64_tr_b16 a[138:139], v234 offset:10240
v_mfma_f32_16x16x32_bf16 v[196:199], a[160:163], v[80:83], v[196:199]
v_mfma_f32_16x16x32_bf16 v[196:199], a[164:167], v[84:87], v[196:199]
ds_read_b64_tr_b16 a[140:141], v234 offset:12288
v_mul_f32 v192, v244, v192
v_mfma_f32_16x16x32_bf16 v[196:199], a[168:171], v[88:91], v[196:199]
ds_read_b64_tr_b16 a[142:143], v234 offset:14336
v_mul_f32 v193, v244, v193
v_mfma_f32_16x16x32_bf16 v[196:199], a[172:175], v[92:95], v[196:199]
ds_read_b64_tr_b16 a[144:145], v234 offset:16384
v_cvt_pk_bf16_f32 v192, v192, v193
v_mfma_f32_16x16x32_bf16 v[200:203], a[172:175], v[140:143], v[200:203]
v_mul_f32 v194, v244, v194
v_mul_f32 v195, v244, v195
v_mfma_f32_16x16x32_bf16 v[200:203], a[168:171], v[136:139], v[200:203]
ds_read_b64_tr_b16 a[146:147], v234 offset:18432
v_cvt_pk_bf16_f32 v193, v194, v195
v_mfma_f32_16x16x32_bf16 v[200:203], a[164:167], v[132:135], v[200:203]
ds_read_b64_tr_b16 a[148:149], v234 offset:20480
v_mfma_f32_16x16x32_bf16 v[200:203], a[160:163], v[128:131], v[200:203]
ds_read_b64_tr_b16 a[150:151], v234 offset:22528
v_mul_f32 v196, v245, v196
v_mfma_f32_16x16x32_bf16 v[200:203], a[156:159], v[124:127], v[200:203]
ds_write_b64 v241, v[192:193] offset:0
v_mfma_f32_16x16x32_bf16 v[200:203], a[152:155], v[120:123], v[200:203]
buffer_load_dwordx4 v239, s[16:19], s63 offen lds
v_mfma_f32_16x16x32_bf16 v[204:207], a[152:155], v[168:171], v[204:207]
s_add_u32 m0, s75, s58
v_mul_f32 v197, v245, v197
v_cvt_pk_bf16_f32 v196, v196, v197
v_mfma_f32_16x16x32_bf16 v[204:207], a[156:159], v[172:175], v[204:207]
v_mul_f32 v198, v245, v198
v_mul_f32 v199, v245, v199
v_mfma_f32_16x16x32_bf16 v[204:207], a[160:163], v[176:179], v[204:207]
v_cvt_pk_bf16_f32 v197, v198, v199
v_mfma_f32_16x16x32_bf16 v[204:207], a[164:167], v[180:183], v[204:207]
ds_write_b64 v241, v[196:197] offset:8192
v_mfma_f32_16x16x32_bf16 v[204:207], a[168:171], v[184:187], v[204:207]
v_mul_f32 v200, v246, v200
v_mul_f32 v201, v246, v201
v_mfma_f32_16x16x32_bf16 v[204:207], a[172:175], v[188:191], v[204:207]
s_waitcnt lgkmcnt(2)
v_cvt_pk_bf16_f32 v210, v200, v201
v_mul_f32 v202, v246, v202
v_mfma_f32_16x16x32_bf16 v[192:195], a[148:151], v[20:23], v[228:231]
v_mul_f32 v203, v246, v203
v_cvt_pk_bf16_f32 v211, v202, v203
v_mfma_f32_16x16x32_bf16 v[192:195], a[144:147], v[16:19], v[192:195]
ds_read_b64_tr_b16 a[152:153], v234 offset:24576
v_mfma_f32_16x16x32_bf16 v[192:195], a[140:143], v[12:15], v[192:195]
ds_read_b64_tr_b16 a[154:155], v234 offset:26624
v_mfma_f32_16x16x32_bf16 v[192:195], a[136:139], v[8:11], v[192:195]
ds_read_b64_tr_b16 a[156:157], v234 offset:28672
v_mul_f32 v204, v247, v204
v_mfma_f32_16x16x32_bf16 v[192:195], a[132:135], v[4:7], v[192:195]
buffer_load_dwordx4 v239, s[16:19], s64 offen lds
v_mfma_f32_16x16x32_bf16 v[192:195], a[128:131], v[0:3], v[192:195]
ds_read_b64_tr_b16 a[158:159], v234 offset:30720
v_mul_f32 v205, v247, v205
v_mfma_f32_16x16x32_bf16 v[196:199], a[128:131], v[48:51], v[228:231]
ds_read_b64_tr_b16 a[160:161], v234 offset:32768
v_cvt_pk_bf16_f32 v218, v204, v205
v_mfma_f32_16x16x32_bf16 v[196:199], a[132:135], v[52:55], v[196:199]
ds_read_b64_tr_b16 a[162:163], v234 offset:34816
v_mul_f32 v206, v247, v206
v_mfma_f32_16x16x32_bf16 v[196:199], a[136:139], v[56:59], v[196:199]
s_add_u32 m0, s75, s59
v_mul_f32 v207, v247, v207
v_cvt_pk_bf16_f32 v219, v206, v207
v_mfma_f32_16x16x32_bf16 v[196:199], a[140:143], v[60:63], v[196:199]
ds_read_b64_tr_b16 a[164:165], v234 offset:36864
v_mfma_f32_16x16x32_bf16 v[196:199], a[144:147], v[64:67], v[196:199]
ds_read_b64_tr_b16 a[166:167], v234 offset:38912
v_mfma_f32_16x16x32_bf16 v[196:199], a[148:151], v[68:71], v[196:199]
ds_read_b64_tr_b16 a[168:169], v234 offset:40960
v_mfma_f32_16x16x32_bf16 v[200:203], a[148:151], v[116:119], v[228:231]
v_mfma_f32_16x16x32_bf16 v[200:203], a[144:147], v[112:115], v[200:203]
ds_read_b64_tr_b16 a[170:171], v234 offset:43008
v_mfma_f32_16x16x32_bf16 v[200:203], a[140:143], v[108:111], v[200:203]
ds_read_b64_tr_b16 a[172:173], v234 offset:45056
v_mfma_f32_16x16x32_bf16 v[200:203], a[136:139], v[104:107], v[200:203]
ds_read_b64_tr_b16 a[174:175], v234 offset:47104
v_xor_b32 v234, 32, v234
v_mfma_f32_16x16x32_bf16 v[200:203], a[132:135], v[100:103], v[200:203]
buffer_load_dwordx4 v239, s[16:19], s65 offen lds
v_mfma_f32_16x16x32_bf16 v[200:203], a[128:131], v[96:99], v[200:203]
ds_write_b64 v241, v[210:211] offset:16384
v_mfma_f32_16x16x32_bf16 v[204:207], a[128:131], v[144:147], v[228:231]
ds_write_b64 v241, v[218:219] offset:24576
v_mfma_f32_16x16x32_bf16 v[204:207], a[132:135], v[148:151], v[204:207]
s_add_u32 m0, s75, s60
v_mfma_f32_16x16x32_bf16 v[204:207], a[136:139], v[152:155], v[204:207]
v_mfma_f32_16x16x32_bf16 v[204:207], a[140:143], v[156:159], v[204:207]
v_mfma_f32_16x16x32_bf16 v[204:207], a[144:147], v[160:163], v[204:207]
v_mfma_f32_16x16x32_bf16 v[204:207], a[148:151], v[164:167], v[204:207]
s_waitcnt lgkmcnt(2)
v_mfma_f32_16x16x32_bf16 v[204:207], a[172:175], v[188:191], v[204:207]
v_mfma_f32_16x16x32_bf16 v[204:207], a[168:171], v[184:187], v[204:207]
ds_read_b64_tr_b16 a[128:129], v234 offset:0
v_mfma_f32_16x16x32_bf16 v[204:207], a[164:167], v[180:183], v[204:207]
ds_read_b64_tr_b16 a[130:131], v234 offset:2048
v_mfma_f32_16x16x32_bf16 v[204:207], a[160:163], v[176:179], v[204:207]
ds_read_b64_tr_b16 a[132:133], v234 offset:4096
v_mfma_f32_16x16x32_bf16 v[204:207], a[156:159], v[172:175], v[204:207]
buffer_load_dwordx4 v239, s[16:19], s66 offen lds
v_mfma_f32_16x16x32_bf16 v[204:207], a[152:155], v[168:171], v[204:207]
ds_read_b64_tr_b16 a[134:135], v234 offset:6144
s_add_u32 m0, s75, s61
v_mfma_f32_16x16x32_bf16 v[200:203], a[152:155], v[120:123], v[200:203]
ds_read_b64_tr_b16 a[136:137], v234 offset:8192
v_mfma_f32_16x16x32_bf16 v[200:203], a[156:159], v[124:127], v[200:203]
ds_read_b64_tr_b16 a[138:139], v234 offset:10240
v_mfma_f32_16x16x32_bf16 v[200:203], a[160:163], v[128:131], v[200:203]
v_mfma_f32_16x16x32_bf16 v[200:203], a[164:167], v[132:135], v[200:203]
ds_read_b64_tr_b16 a[140:141], v234 offset:12288
v_fma_f32 v204, v204, v247, v255
v_mfma_f32_16x16x32_bf16 v[200:203], a[168:171], v[136:139], v[200:203]
ds_read_b64_tr_b16 a[142:143], v234 offset:14336
v_fma_f32 v205, v205, v247, v255
v_mfma_f32_16x16x32_bf16 v[200:203], a[172:175], v[140:143], v[200:203]
ds_read_b64_tr_b16 a[144:145], v234 offset:16384
v_cvt_pk_bf16_f32 v220, v204, v205
v_mfma_f32_16x16x32_bf16 v[196:199], a[172:175], v[92:95], v[196:199]
v_fma_f32 v206, v206, v247, v255
v_fma_f32 v207, v207, v247, v255
v_mfma_f32_16x16x32_bf16 v[196:199], a[168:171], v[88:91], v[196:199]
ds_read_b64_tr_b16 a[146:147], v234 offset:18432
v_cvt_pk_bf16_f32 v221, v206, v207
v_mfma_f32_16x16x32_bf16 v[196:199], a[164:167], v[84:87], v[196:199]
ds_read_b64_tr_b16 a[148:149], v234 offset:20480
v_mfma_f32_16x16x32_bf16 v[196:199], a[160:163], v[80:83], v[196:199]
ds_read_b64_tr_b16 a[150:151], v234 offset:22528
v_fma_f32 v200, v200, v246, v254
v_mfma_f32_16x16x32_bf16 v[196:199], a[156:159], v[76:79], v[196:199]
buffer_load_dwordx4 v239, s[16:19], s67 offen lds
v_mfma_f32_16x16x32_bf16 v[196:199], a[152:155], v[72:75], v[196:199]
ds_write_b64 v242, v[220:221] offset:24576
v_mfma_f32_16x16x32_bf16 v[192:195], a[152:155], v[24:27], v[192:195]
s_add_u32 m0, s38, s56
v_fma_f32 v201, v201, v246, v254
v_cvt_pk_bf16_f32 v212, v200, v201
v_mfma_f32_16x16x32_bf16 v[192:195], a[156:159], v[28:31], v[192:195]
v_fma_f32 v202, v202, v246, v254
v_fma_f32 v203, v203, v246, v254
v_mfma_f32_16x16x32_bf16 v[192:195], a[160:163], v[32:35], v[192:195]
s_add_u32 s16, s16, 128
s_addc_u32 s17, s17, 0
v_cvt_pk_bf16_f32 v213, v202, v203
v_mfma_f32_16x16x32_bf16 v[192:195], a[164:167], v[36:39], v[192:195]
ds_write_b64 v242, v[212:213] offset:16384
v_mfma_f32_16x16x32_bf16 v[192:195], a[168:171], v[40:43], v[192:195]
v_fma_f32 v196, v196, v245, v253
v_fma_f32 v197, v197, v245, v253
v_mfma_f32_16x16x32_bf16 v[192:195], a[172:175], v[44:47], v[192:195]
s_waitcnt lgkmcnt(2)
v_cvt_pk_bf16_f32 v196, v196, v197
v_fma_f32 v198, v198, v245, v253
v_mfma_f32_16x16x32_bf16 v[204:207], a[148:151], v[164:167], v[228:231]
v_fma_f32 v199, v199, v245, v253
v_cvt_pk_bf16_f32 v197, v198, v199
v_mfma_f32_16x16x32_bf16 v[204:207], a[144:147], v[160:163], v[204:207]
ds_read_b64_tr_b16 a[152:153], v234 offset:24576
v_mfma_f32_16x16x32_bf16 v[204:207], a[140:143], v[156:159], v[204:207]
ds_read_b64_tr_b16 a[154:155], v234 offset:26624
v_mfma_f32_16x16x32_bf16 v[204:207], a[136:139], v[152:155], v[204:207]
ds_read_b64_tr_b16 a[156:157], v234 offset:28672
v_fma_f32 v192, v192, v244, v252
v_mfma_f32_16x16x32_bf16 v[204:207], a[132:135], v[148:151], v[204:207]
ds_write_b64 v242, v[196:197] offset:8192
v_mfma_f32_16x16x32_bf16 v[204:207], a[128:131], v[144:147], v[204:207]
ds_read_b64_tr_b16 a[158:159], v234 offset:30720
v_fma_f32 v193, v193, v244, v252
v_mfma_f32_16x16x32_bf16 v[200:203], a[128:131], v[96:99], v[228:231]
ds_read_b64_tr_b16 a[160:161], v234 offset:32768
v_cvt_pk_bf16_f32 v192, v192, v193
v_mfma_f32_16x16x32_bf16 v[200:203], a[132:135], v[100:103], v[200:203]
ds_read_b64_tr_b16 a[162:163], v234 offset:34816
v_fma_f32 v194, v194, v244, v252
v_mfma_f32_16x16x32_bf16 v[200:203], a[136:139], v[104:107], v[200:203]
v_fma_f32 v195, v195, v244, v252
v_cvt_pk_bf16_f32 v193, v194, v195
v_mfma_f32_16x16x32_bf16 v[200:203], a[140:143], v[108:111], v[200:203]
ds_read_b64_tr_b16 a[164:165], v234 offset:36864
v_mfma_f32_16x16x32_bf16 v[200:203], a[144:147], v[112:115], v[200:203]
ds_read_b64_tr_b16 a[166:167], v234 offset:38912
v_mfma_f32_16x16x32_bf16 v[200:203], a[148:151], v[116:119], v[200:203]
ds_read_b64_tr_b16 a[168:169], v234 offset:40960
v_mfma_f32_16x16x32_bf16 v[196:199], a[148:151], v[68:71], v[228:231]
v_mfma_f32_16x16x32_bf16 v[196:199], a[144:147], v[64:67], v[196:199]
ds_read_b64_tr_b16 a[170:171], v234 offset:43008
v_mfma_f32_16x16x32_bf16 v[196:199], a[140:143], v[60:63], v[196:199]
ds_read_b64_tr_b16 a[172:173], v234 offset:45056
v_mfma_f32_16x16x32_bf16 v[196:199], a[136:139], v[56:59], v[196:199]
ds_read_b64_tr_b16 a[174:175], v234 offset:47104
v_xor_b32 v234, 0x60, v234
v_mfma_f32_16x16x32_bf16 v[196:199], a[132:135], v[52:55], v[196:199]
ds_write_b64 v242, v[192:193] offset:0
v_mfma_f32_16x16x32_bf16 v[196:199], a[128:131], v[48:51], v[196:199]
v_mfma_f32_16x16x32_bf16 v[192:195], a[128:131], v[0:3], v[228:231]
v_mfma_f32_16x16x32_bf16 v[192:195], a[132:135], v[4:7], v[192:195]
v_mfma_f32_16x16x32_bf16 v[192:195], a[136:139], v[8:11], v[192:195]
v_mfma_f32_16x16x32_bf16 v[192:195], a[140:143], v[12:15], v[192:195]
v_mfma_f32_16x16x32_bf16 v[192:195], a[144:147], v[16:19], v[192:195]
v_mfma_f32_16x16x32_bf16 v[192:195], a[148:151], v[20:23], v[192:195]
s_waitcnt vmcnt(6) lgkmcnt(1)
v_mfma_f32_16x16x32_bf16 v[192:195], a[172:175], v[44:47], v[192:195]
s_barrier
v_mfma_f32_16x16x32_bf16 v[192:195], a[168:171], v[40:43], v[192:195]
ds_read_b64_tr_b16 a[128:129], v234 offset:49152
v_mfma_f32_16x16x32_bf16 v[192:195], a[164:167], v[36:39], v[192:195]
ds_read_b64_tr_b16 a[130:131], v234 offset:51200
v_mfma_f32_16x16x32_bf16 v[192:195], a[160:163], v[32:35], v[192:195]
ds_read_b64_tr_b16 a[132:133], v234 offset:53248
v_mfma_f32_16x16x32_bf16 v[192:195], a[156:159], v[28:31], v[192:195]
buffer_load_dwordx4 v239, s[92:95], s62 offen lds
v_mfma_f32_16x16x32_bf16 v[192:195], a[152:155], v[24:27], v[192:195]
ds_read_b64_tr_b16 a[134:135], v234 offset:55296
s_add_u32 m0, s38, s57
v_mfma_f32_16x16x32_bf16 v[196:199], a[152:155], v[72:75], v[196:199]
ds_read_b64_tr_b16 a[136:137], v234 offset:57344
v_mfma_f32_16x16x32_bf16 v[196:199], a[156:159], v[76:79], v[196:199]
ds_read_b64_tr_b16 a[138:139], v234 offset:59392
v_mfma_f32_16x16x32_bf16 v[196:199], a[160:163], v[80:83], v[196:199]
v_mfma_f32_16x16x32_bf16 v[196:199], a[164:167], v[84:87], v[196:199]
ds_read_b64_tr_b16 a[140:141], v234 offset:61440
v_fma_f32 v192, v192, v244, v252
v_mfma_f32_16x16x32_bf16 v[196:199], a[168:171], v[88:91], v[196:199]
ds_read_b64_tr_b16 a[142:143], v234 offset:63488
v_fma_f32 v193, v193, v244, v252
v_mfma_f32_16x16x32_bf16 v[196:199], a[172:175], v[92:95], v[196:199]
ds_read_b64_tr_b16 a[144:145], v235 offset:8192
v_cvt_pk_bf16_f32 v192, v192, v193
v_mfma_f32_16x16x32_bf16 v[200:203], a[172:175], v[140:143], v[200:203]
v_fma_f32 v194, v194, v244, v252
v_fma_f32 v195, v195, v244, v252
v_mfma_f32_16x16x32_bf16 v[200:203], a[168:171], v[136:139], v[200:203]
ds_read_b64_tr_b16 a[146:147], v235 offset:10240
v_cvt_pk_bf16_f32 v193, v194, v195
v_mfma_f32_16x16x32_bf16 v[200:203], a[164:167], v[132:135], v[200:203]
ds_read_b64_tr_b16 a[148:149], v235 offset:12288
v_mfma_f32_16x16x32_bf16 v[200:203], a[160:163], v[128:131], v[200:203]
ds_read_b64_tr_b16 a[150:151], v235 offset:14336
v_fma_f32 v196, v196, v245, v253
v_mfma_f32_16x16x32_bf16 v[200:203], a[156:159], v[124:127], v[200:203]
ds_write_b64 v243, v[192:193] offset:0
v_mfma_f32_16x16x32_bf16 v[200:203], a[152:155], v[120:123], v[200:203]
buffer_load_dwordx4 v239, s[92:95], s63 offen lds
v_mfma_f32_16x16x32_bf16 v[204:207], a[152:155], v[168:171], v[204:207]
s_add_u32 m0, s38, s58
v_fma_f32 v197, v197, v245, v253
v_cvt_pk_bf16_f32 v196, v196, v197
v_mfma_f32_16x16x32_bf16 v[204:207], a[156:159], v[172:175], v[204:207]
ds_read_b128 a[232:235], v248 offset:0
v_fma_f32 v198, v198, v245, v253
v_mfma_f32_16x16x32_bf16 v[204:207], a[160:163], v[176:179], v[204:207]
ds_read_b128 a[236:239], v248 offset:4096
v_fma_f32 v199, v199, v245, v253
v_mfma_f32_16x16x32_bf16 v[204:207], a[164:167], v[180:183], v[204:207]
v_cvt_pk_bf16_f32 v197, v198, v199
v_fma_f32 v200, v200, v246, v254
v_mfma_f32_16x16x32_bf16 v[204:207], a[168:171], v[184:187], v[204:207]
ds_write_b64 v243, v[196:197] offset:8192
v_mfma_f32_16x16x32_bf16 v[204:207], a[172:175], v[188:191], v[204:207]
s_waitcnt lgkmcnt(4)
v_fma_f32 v201, v201, v246, v254
v_cvt_pk_bf16_f32 v214, v200, v201
v_mfma_f32_16x16x32_bf16 v[192:195], a[148:151], v[20:23], v[228:231]
v_fma_f32 v202, v202, v246, v254
v_fma_f32 v203, v203, v246, v254
v_mfma_f32_16x16x32_bf16 v[192:195], a[144:147], v[16:19], v[192:195]
ds_read_b64_tr_b16 a[152:153], v235 offset:16384
v_cvt_pk_bf16_f32 v215, v202, v203
v_mfma_f32_16x16x32_bf16 v[192:195], a[140:143], v[12:15], v[192:195]
ds_read_b64_tr_b16 a[154:155], v235 offset:18432
s_waitcnt lgkmcnt(3)
v_mfma_f32_16x16x32_bf16 v[192:195], a[136:139], v[8:11], v[192:195]
ds_read_b64_tr_b16 a[156:157], v235 offset:20480
v_fma_f32 v204, v204, v247, v255
v_mfma_f32_16x16x32_bf16 v[192:195], a[132:135], v[4:7], v[192:195]
ds_read_b128 a[240:243], v248 offset:8192
v_fma_f32 v205, v205, v247, v255
v_mfma_f32_16x16x32_bf16 v[192:195], a[128:131], v[0:3], v[192:195]
ds_read_b64_tr_b16 a[158:159], v235 offset:22528
v_cvt_pk_bf16_f32 v222, v204, v205
v_mfma_f32_16x16x32_bf16 v[196:199], a[128:131], v[48:51], v[228:231]
ds_read_b64_tr_b16 a[160:161], v235 offset:24576
v_fma_f32 v206, v206, v247, v255
v_mfma_f32_16x16x32_bf16 v[196:199], a[132:135], v[52:55], v[196:199]
ds_read_b64_tr_b16 a[162:163], v235 offset:26624
v_fma_f32 v207, v207, v247, v255
v_mfma_f32_16x16x32_bf16 v[196:199], a[136:139], v[56:59], v[196:199]
buffer_load_dwordx4 v239, s[92:95], s64 offen lds
v_mfma_f32_16x16x32_bf16 v[196:199], a[140:143], v[60:63], v[196:199]
ds_read_b64_tr_b16 a[164:165], v235 offset:28672
v_cvt_pk_bf16_f32 v223, v206, v207
v_mfma_f32_16x16x32_bf16 v[196:199], a[144:147], v[64:67], v[196:199]
ds_read_b64_tr_b16 a[166:167], v235 offset:30720
s_add_u32 m0, s38, s59
v_mfma_f32_16x16x32_bf16 v[196:199], a[148:151], v[68:71], v[196:199]
ds_read_b64_tr_b16 a[168:169], v235 offset:32768
v_mfma_f32_16x16x32_bf16 v[200:203], a[148:151], v[116:119], v[228:231]
buffer_store_dwordx4 a[232:235], v239, s[24:27], s48 offen offset:0 sc1
v_mfma_f32_16x16x32_bf16 v[200:203], a[144:147], v[112:115], v[200:203]
ds_read_b64_tr_b16 a[170:171], v235 offset:34816
v_mfma_f32_16x16x32_bf16 v[200:203], a[140:143], v[108:111], v[200:203]
ds_read_b64_tr_b16 a[172:173], v235 offset:36864
v_mfma_f32_16x16x32_bf16 v[200:203], a[136:139], v[104:107], v[200:203]
ds_read_b64_tr_b16 a[174:175], v235 offset:38912
v_xor_b32 v234, 32, v234
v_mfma_f32_16x16x32_bf16 v[200:203], a[132:135], v[100:103], v[200:203]
ds_read_b128 a[244:247], v248 offset:12288
v_xor_b32 v235, 32, v235
v_mfma_f32_16x16x32_bf16 v[200:203], a[128:131], v[96:99], v[200:203]
ds_write_b64 v243, v[214:215] offset:16384
v_mfma_f32_16x16x32_bf16 v[204:207], a[128:131], v[144:147], v[228:231]
ds_write_b64 v243, v[222:223] offset:24576
v_mfma_f32_16x16x32_bf16 v[204:207], a[132:135], v[148:151], v[204:207]
v_mfma_f32_16x16x32_bf16 v[204:207], a[136:139], v[152:155], v[204:207]
buffer_store_dwordx4 a[236:239], v239, s[24:27], s49 offen offset:0 sc1
v_mfma_f32_16x16x32_bf16 v[204:207], a[140:143], v[156:159], v[204:207]
buffer_load_dwordx4 v239, s[92:95], s65 offen lds
v_mfma_f32_16x16x32_bf16 v[204:207], a[144:147], v[160:163], v[204:207]
ds_read_b128 a[248:251], v248 offset:16384
s_add_u32 m0, s38, s60
v_mfma_f32_16x16x32_bf16 v[204:207], a[148:151], v[164:167], v[204:207]
s_waitcnt lgkmcnt(4)
s_waitcnt lgkmcnt(3)
v_mfma_f32_16x16x32_bf16 v[204:207], a[172:175], v[188:191], v[204:207]
ds_read_b128 a[176:179], v248 offset:20480
v_mfma_f32_16x16x32_bf16 v[204:207], a[168:171], v[184:187], v[204:207]
ds_read_b64_tr_b16 a[128:129], v234 offset:49152
v_mfma_f32_16x16x32_bf16 v[204:207], a[164:167], v[180:183], v[204:207]
ds_read_b64_tr_b16 a[130:131], v234 offset:51200
v_mfma_f32_16x16x32_bf16 v[204:207], a[160:163], v[176:179], v[204:207]
ds_read_b64_tr_b16 a[132:133], v234 offset:53248
v_mfma_f32_16x16x32_bf16 v[204:207], a[156:159], v[172:175], v[204:207]
ds_read_b128 a[180:183], v248 offset:24576
v_mfma_f32_16x16x32_bf16 v[204:207], a[152:155], v[168:171], v[204:207]
ds_read_b64_tr_b16 a[134:135], v234 offset:55296
v_mfma_f32_16x16x32_bf16 v[200:203], a[152:155], v[120:123], v[200:203]
ds_read_b64_tr_b16 a[136:137], v234 offset:57344
s_waitcnt lgkmcnt(6)
v_mfma_f32_16x16x32_bf16 v[200:203], a[156:159], v[124:127], v[200:203]
ds_read_b64_tr_b16 a[138:139], v234 offset:59392
v_mfma_f32_16x16x32_bf16 v[200:203], a[160:163], v[128:131], v[200:203]
ds_read_b128 a[184:187], v248 offset:28672
v_mfma_f32_16x16x32_bf16 v[200:203], a[164:167], v[132:135], v[200:203]
ds_read_b64_tr_b16 a[140:141], v234 offset:61440
v_fma_f32 v204, v204, v247, v255
v_mfma_f32_16x16x32_bf16 v[200:203], a[168:171], v[136:139], v[200:203]
ds_read_b64_tr_b16 a[142:143], v234 offset:63488
v_fma_f32 v205, v205, v247, v255
v_mfma_f32_16x16x32_bf16 v[200:203], a[172:175], v[140:143], v[200:203]
ds_read_b64_tr_b16 a[144:145], v235 offset:8192
v_cvt_pk_bf16_f32 v216, v204, v205
v_mfma_f32_16x16x32_bf16 v[196:199], a[172:175], v[92:95], v[196:199]
buffer_load_dwordx4 v239, s[92:95], s66 offen lds
v_mfma_f32_16x16x32_bf16 v[196:199], a[168:171], v[88:91], v[196:199]
ds_read_b64_tr_b16 a[146:147], v235 offset:10240
v_fma_f32 v206, v206, v247, v255
v_mfma_f32_16x16x32_bf16 v[196:199], a[164:167], v[84:87], v[196:199]
ds_read_b64_tr_b16 a[148:149], v235 offset:12288
v_fma_f32 v207, v207, v247, v255
v_mfma_f32_16x16x32_bf16 v[196:199], a[160:163], v[80:83], v[196:199]
ds_read_b64_tr_b16 a[150:151], v235 offset:14336
v_cvt_pk_bf16_f32 v217, v206, v207
v_mfma_f32_16x16x32_bf16 v[196:199], a[156:159], v[76:79], v[196:199]
ds_write_b64 v240, v[216:217] offset:24576
v_mfma_f32_16x16x32_bf16 v[196:199], a[152:155], v[72:75], v[196:199]
s_add_u32 m0, s38, s61
v_fma_f32 v200, v200, v246, v254
v_fma_f32 v201, v201, v246, v254
v_mfma_f32_16x16x32_bf16 v[192:195], a[152:155], v[24:27], v[192:195]
s_waitcnt lgkmcnt(7)
v_cvt_pk_bf16_f32 v208, v200, v201
v_fma_f32 v202, v202, v246, v254
v_mfma_f32_16x16x32_bf16 v[192:195], a[156:159], v[28:31], v[192:195]
v_fma_f32 v203, v203, v246, v254
v_cvt_pk_bf16_f32 v209, v202, v203
v_mfma_f32_16x16x32_bf16 v[192:195], a[160:163], v[32:35], v[192:195]
buffer_store_dwordx4 a[240:243], v239, s[24:27], s50 offen offset:0 sc1
v_mfma_f32_16x16x32_bf16 v[192:195], a[164:167], v[36:39], v[192:195]
ds_write_b64 v240, v[208:209] offset:16384
v_mfma_f32_16x16x32_bf16 v[192:195], a[168:171], v[40:43], v[192:195]
v_fma_f32 v196, v196, v245, v253
v_fma_f32 v197, v197, v245, v253
v_mfma_f32_16x16x32_bf16 v[192:195], a[172:175], v[44:47], v[192:195]
s_waitcnt lgkmcnt(2)
v_cvt_pk_bf16_f32 v226, v196, v197
v_fma_f32 v198, v198, v245, v253
v_mfma_f32_16x16x32_bf16 v[204:207], a[148:151], v[164:167], v[228:231]
v_fma_f32 v199, v199, v245, v253
v_cvt_pk_bf16_f32 v227, v198, v199
v_mfma_f32_16x16x32_bf16 v[204:207], a[144:147], v[160:163], v[204:207]
ds_read_b64_tr_b16 a[152:153], v235 offset:16384
v_mfma_f32_16x16x32_bf16 v[204:207], a[140:143], v[156:159], v[204:207]
ds_read_b64_tr_b16 a[154:155], v235 offset:18432
v_mfma_f32_16x16x32_bf16 v[204:207], a[136:139], v[152:155], v[204:207]
ds_read_b64_tr_b16 a[156:157], v235 offset:20480
v_fma_f32 v192, v192, v244, v252
v_mfma_f32_16x16x32_bf16 v[204:207], a[132:135], v[148:151], v[204:207]
buffer_load_dwordx4 v239, s[92:95], s67 offen lds
v_mfma_f32_16x16x32_bf16 v[204:207], a[128:131], v[144:147], v[204:207]
ds_read_b64_tr_b16 a[158:159], v235 offset:22528
v_fma_f32 v193, v193, v244, v252
v_mfma_f32_16x16x32_bf16 v[200:203], a[128:131], v[96:99], v[228:231]
ds_read_b64_tr_b16 a[160:161], v235 offset:24576
v_cvt_pk_bf16_f32 v224, v192, v193
v_mfma_f32_16x16x32_bf16 v[200:203], a[132:135], v[100:103], v[200:203]
ds_read_b64_tr_b16 a[162:163], v235 offset:26624
v_fma_f32 v194, v194, v244, v252
v_mfma_f32_16x16x32_bf16 v[200:203], a[136:139], v[104:107], v[200:203]
s_add_u32 m0, s39, s56
v_fma_f32 v195, v195, v244, v252
v_cvt_pk_bf16_f32 v225, v194, v195
v_mfma_f32_16x16x32_bf16 v[200:203], a[140:143], v[108:111], v[200:203]
ds_read_b64_tr_b16 a[164:165], v235 offset:28672
v_mfma_f32_16x16x32_bf16 v[200:203], a[144:147], v[112:115], v[200:203]
ds_read_b64_tr_b16 a[166:167], v235 offset:30720
v_mfma_f32_16x16x32_bf16 v[200:203], a[148:151], v[116:119], v[200:203]
ds_read_b64_tr_b16 a[168:169], v235 offset:32768
v_mfma_f32_16x16x32_bf16 v[196:199], a[148:151], v[68:71], v[228:231]
s_add_u32 s92, s92, 128
s_addc_u32 s93, s93, 0
v_mfma_f32_16x16x32_bf16 v[196:199], a[144:147], v[64:67], v[196:199]
ds_read_b64_tr_b16 a[170:171], v235 offset:34816
v_mfma_f32_16x16x32_bf16 v[196:199], a[140:143], v[60:63], v[196:199]
ds_read_b64_tr_b16 a[172:173], v235 offset:36864
v_mfma_f32_16x16x32_bf16 v[196:199], a[136:139], v[56:59], v[196:199]
ds_read_b64_tr_b16 a[174:175], v235 offset:38912
v_xor_b32 v234, 0x60, v234
v_mfma_f32_16x16x32_bf16 v[196:199], a[132:135], v[52:55], v[196:199]
buffer_load_dwordx4 v239, s[16:19], s62 offen lds
v_mfma_f32_16x16x32_bf16 v[196:199], a[128:131], v[48:51], v[196:199]
ds_write_b64 v240, v[224:225] offset:0
v_mfma_f32_16x16x32_bf16 v[192:195], a[128:131], v[0:3], v[228:231]
ds_write_b64 v240, v[226:227] offset:8192
v_mfma_f32_16x16x32_bf16 v[192:195], a[132:135], v[4:7], v[192:195]
buffer_store_dwordx4 a[244:247], v239, s[24:27], s51 offen offset:0 sc1
v_mfma_f32_16x16x32_bf16 v[192:195], a[136:139], v[8:11], v[192:195]
s_add_u32 m0, s39, s57
v_xor_b32 v235, 0x60, v235
v_mfma_f32_16x16x32_bf16 v[192:195], a[140:143], v[12:15], v[192:195]
v_mfma_f32_16x16x32_bf16 v[192:195], a[144:147], v[16:19], v[192:195]
v_mfma_f32_16x16x32_bf16 v[192:195], a[148:151], v[20:23], v[192:195]
s_waitcnt lgkmcnt(2)
v_mfma_f32_16x16x32_bf16 v[192:195], a[172:175], v[44:47], v[192:195]
v_mfma_f32_16x16x32_bf16 v[192:195], a[168:171], v[40:43], v[192:195]
ds_read_b64_tr_b16 a[128:129], v234 offset:49152
v_mfma_f32_16x16x32_bf16 v[192:195], a[164:167], v[36:39], v[192:195]
ds_read_b64_tr_b16 a[130:131], v234 offset:51200
v_mfma_f32_16x16x32_bf16 v[192:195], a[160:163], v[32:35], v[192:195]
ds_read_b64_tr_b16 a[132:133], v234 offset:53248
v_mfma_f32_16x16x32_bf16 v[192:195], a[156:159], v[28:31], v[192:195]
v_mfma_f32_16x16x32_bf16 v[192:195], a[152:155], v[24:27], v[192:195]
ds_read_b64_tr_b16 a[134:135], v234 offset:55296
v_mfma_f32_16x16x32_bf16 v[196:199], a[152:155], v[72:75], v[196:199]
ds_read_b64_tr_b16 a[136:137], v234 offset:57344
v_mfma_f32_16x16x32_bf16 v[196:199], a[156:159], v[76:79], v[196:199]
ds_read_b64_tr_b16 a[138:139], v234 offset:59392
v_mfma_f32_16x16x32_bf16 v[196:199], a[160:163], v[80:83], v[196:199]
buffer_load_dwordx4 v239, s[16:19], s63 offen lds
v_mfma_f32_16x16x32_bf16 v[196:199], a[164:167], v[84:87], v[196:199]
ds_read_b64_tr_b16 a[140:141], v234 offset:61440
v_fma_f32 v192, v192, v244, v252
v_mfma_f32_16x16x32_bf16 v[196:199], a[168:171], v[88:91], v[196:199]
ds_read_b64_tr_b16 a[142:143], v234 offset:63488
v_fma_f32 v193, v193, v244, v252
v_mfma_f32_16x16x32_bf16 v[196:199], a[172:175], v[92:95], v[196:199]
ds_read_b64_tr_b16 a[144:145], v235 offset:8192
v_cvt_pk_bf16_f32 v192, v192, v193
v_mfma_f32_16x16x32_bf16 v[200:203], a[172:175], v[140:143], v[200:203]
s_add_u32 m0, s39, s58
v_fma_f32 v194, v194, v244, v252
v_fma_f32 v195, v195, v244, v252
v_mfma_f32_16x16x32_bf16 v[200:203], a[168:171], v[136:139], v[200:203]
ds_read_b64_tr_b16 a[146:147], v235 offset:10240
v_cvt_pk_bf16_f32 v193, v194, v195
v_mfma_f32_16x16x32_bf16 v[200:203], a[164:167], v[132:135], v[200:203]
ds_read_b64_tr_b16 a[148:149], v235 offset:12288
v_mfma_f32_16x16x32_bf16 v[200:203], a[160:163], v[128:131], v[200:203]
ds_read_b64_tr_b16 a[150:151], v235 offset:14336
v_fma_f32 v196, v196, v245, v253
v_mfma_f32_16x16x32_bf16 v[200:203], a[156:159], v[124:127], v[200:203]
ds_write_b64 v241, v[192:193] offset:0
v_mfma_f32_16x16x32_bf16 v[200:203], a[152:155], v[120:123], v[200:203]
v_fma_f32 v197, v197, v245, v253
v_cvt_pk_bf16_f32 v196, v196, v197
v_mfma_f32_16x16x32_bf16 v[204:207], a[152:155], v[168:171], v[204:207]
v_fma_f32 v198, v198, v245, v253
v_fma_f32 v199, v199, v245, v253
v_mfma_f32_16x16x32_bf16 v[204:207], a[156:159], v[172:175], v[204:207]
buffer_store_dwordx4 a[248:251], v239, s[24:27], s52 offen offset:0 sc1
v_mfma_f32_16x16x32_bf16 v[204:207], a[160:163], v[176:179], v[204:207]
buffer_load_dwordx4 v239, s[16:19], s64 offen lds
v_mfma_f32_16x16x32_bf16 v[204:207], a[164:167], v[180:183], v[204:207]
s_add_u32 m0, s39, s59
v_cvt_pk_bf16_f32 v197, v198, v199
v_fma_f32 v200, v200, v246, v254
v_mfma_f32_16x16x32_bf16 v[204:207], a[168:171], v[184:187], v[204:207]
ds_write_b64 v241, v[196:197] offset:8192
v_mfma_f32_16x16x32_bf16 v[204:207], a[172:175], v[188:191], v[204:207]
s_waitcnt lgkmcnt(2)
v_fma_f32 v201, v201, v246, v254
v_cvt_pk_bf16_f32 v210, v200, v201
v_mfma_f32_16x16x32_bf16 v[192:195], a[148:151], v[20:23], v[228:231]
v_fma_f32 v202, v202, v246, v254
v_fma_f32 v203, v203, v246, v254
v_mfma_f32_16x16x32_bf16 v[192:195], a[144:147], v[16:19], v[192:195]
ds_read_b64_tr_b16 a[152:153], v235 offset:16384
v_cvt_pk_bf16_f32 v211, v202, v203
v_mfma_f32_16x16x32_bf16 v[192:195], a[140:143], v[12:15], v[192:195]
ds_read_b64_tr_b16 a[154:155], v235 offset:18432
v_mfma_f32_16x16x32_bf16 v[192:195], a[136:139], v[8:11], v[192:195]
ds_read_b64_tr_b16 a[156:157], v235 offset:20480
v_fma_f32 v204, v204, v247, v255
v_mfma_f32_16x16x32_bf16 v[192:195], a[132:135], v[4:7], v[192:195]
v_fma_f32 v205, v205, v247, v255
v_cvt_pk_bf16_f32 v218, v204, v205
v_mfma_f32_16x16x32_bf16 v[192:195], a[128:131], v[0:3], v[192:195]
ds_read_b64_tr_b16 a[158:159], v235 offset:22528
v_fma_f32 v206, v206, v247, v255
v_mfma_f32_16x16x32_bf16 v[196:199], a[128:131], v[48:51], v[228:231]
ds_read_b64_tr_b16 a[160:161], v235 offset:24576
v_fma_f32 v207, v207, v247, v255
v_mfma_f32_16x16x32_bf16 v[196:199], a[132:135], v[52:55], v[196:199]
ds_read_b64_tr_b16 a[162:163], v235 offset:26624
v_cvt_pk_bf16_f32 v219, v206, v207
v_mfma_f32_16x16x32_bf16 v[196:199], a[136:139], v[56:59], v[196:199]
v_mfma_f32_16x16x32_bf16 v[196:199], a[140:143], v[60:63], v[196:199]
ds_read_b64_tr_b16 a[164:165], v235 offset:28672
v_mfma_f32_16x16x32_bf16 v[196:199], a[144:147], v[64:67], v[196:199]
ds_read_b64_tr_b16 a[166:167], v235 offset:30720
v_mfma_f32_16x16x32_bf16 v[196:199], a[148:151], v[68:71], v[196:199]
ds_read_b64_tr_b16 a[168:169], v235 offset:32768
v_mfma_f32_16x16x32_bf16 v[200:203], a[148:151], v[116:119], v[228:231]
buffer_load_dwordx4 v239, s[16:19], s65 offen lds
v_mfma_f32_16x16x32_bf16 v[200:203], a[144:147], v[112:115], v[200:203]
ds_read_b64_tr_b16 a[170:171], v235 offset:34816
s_add_u32 m0, s39, s60
v_mfma_f32_16x16x32_bf16 v[200:203], a[140:143], v[108:111], v[200:203]
ds_read_b64_tr_b16 a[172:173], v235 offset:36864
v_mfma_f32_16x16x32_bf16 v[200:203], a[136:139], v[104:107], v[200:203]
ds_read_b64_tr_b16 a[174:175], v235 offset:38912
v_xor_b32 v234, 32, v234
v_mfma_f32_16x16x32_bf16 v[200:203], a[132:135], v[100:103], v[200:203]
ds_write_b64 v241, v[210:211] offset:16384
v_mfma_f32_16x16x32_bf16 v[200:203], a[128:131], v[96:99], v[200:203]
ds_write_b64 v241, v[218:219] offset:24576
v_mfma_f32_16x16x32_bf16 v[204:207], a[128:131], v[144:147], v[228:231]
buffer_store_dwordx4 a[176:179], v239, s[24:27], s53 offen offset:0 sc1
v_mfma_f32_16x16x32_bf16 v[204:207], a[132:135], v[148:151], v[204:207]
v_xor_b32 v235, 32, v235
v_mfma_f32_16x16x32_bf16 v[204:207], a[136:139], v[152:155], v[204:207]
v_mfma_f32_16x16x32_bf16 v[204:207], a[140:143], v[156:159], v[204:207]
v_mfma_f32_16x16x32_bf16 v[204:207], a[144:147], v[160:163], v[204:207]
v_mfma_f32_16x16x32_bf16 v[204:207], a[148:151], v[164:167], v[204:207]
s_waitcnt lgkmcnt(2)
v_mfma_f32_16x16x32_bf16 v[204:207], a[172:175], v[188:191], v[204:207]
buffer_load_dwordx4 v239, s[16:19], s66 offen lds
v_mfma_f32_16x16x32_bf16 v[204:207], a[168:171], v[184:187], v[204:207]
ds_read_b64_tr_b16 a[128:129], v234 offset:49152
s_add_u32 m0, s39, s61
v_mfma_f32_16x16x32_bf16 v[204:207], a[164:167], v[180:183], v[204:207]
ds_read_b64_tr_b16 a[130:131], v234 offset:51200
v_mfma_f32_16x16x32_bf16 v[204:207], a[160:163], v[176:179], v[204:207]
ds_read_b64_tr_b16 a[132:133], v234 offset:53248
v_mfma_f32_16x16x32_bf16 v[204:207], a[156:159], v[172:175], v[204:207]
v_mfma_f32_16x16x32_bf16 v[204:207], a[152:155], v[168:171], v[204:207]
ds_read_b64_tr_b16 a[134:135], v234 offset:55296
v_mfma_f32_16x16x32_bf16 v[200:203], a[152:155], v[120:123], v[200:203]
ds_read_b64_tr_b16 a[136:137], v234 offset:57344
v_mfma_f32_16x16x32_bf16 v[200:203], a[156:159], v[124:127], v[200:203]
ds_read_b64_tr_b16 a[138:139], v234 offset:59392
v_mfma_f32_16x16x32_bf16 v[200:203], a[160:163], v[128:131], v[200:203]
v_mfma_f32_16x16x32_bf16 v[200:203], a[164:167], v[132:135], v[200:203]
ds_read_b64_tr_b16 a[140:141], v234 offset:61440
v_fma_f32 v204, v204, v247, v255
v_mfma_f32_16x16x32_bf16 v[200:203], a[168:171], v[136:139], v[200:203]
ds_read_b64_tr_b16 a[142:143], v234 offset:63488
v_fma_f32 v205, v205, v247, v255
v_mfma_f32_16x16x32_bf16 v[200:203], a[172:175], v[140:143], v[200:203]
ds_read_b64_tr_b16 a[144:145], v235 offset:8192
v_cvt_pk_bf16_f32 v220, v204, v205
v_mfma_f32_16x16x32_bf16 v[196:199], a[172:175], v[92:95], v[196:199]
v_fma_f32 v206, v206, v247, v255
v_fma_f32 v207, v207, v247, v255
v_mfma_f32_16x16x32_bf16 v[196:199], a[168:171], v[88:91], v[196:199]
ds_read_b64_tr_b16 a[146:147], v235 offset:10240
v_cvt_pk_bf16_f32 v221, v206, v207
v_mfma_f32_16x16x32_bf16 v[196:199], a[164:167], v[84:87], v[196:199]
ds_read_b64_tr_b16 a[148:149], v235 offset:12288
v_mfma_f32_16x16x32_bf16 v[196:199], a[160:163], v[80:83], v[196:199]
ds_read_b64_tr_b16 a[150:151], v235 offset:14336
v_fma_f32 v200, v200, v246, v254
v_mfma_f32_16x16x32_bf16 v[196:199], a[156:159], v[76:79], v[196:199]
buffer_load_dwordx4 v239, s[16:19], s67 offen lds
v_mfma_f32_16x16x32_bf16 v[196:199], a[152:155], v[72:75], v[196:199]
ds_write_b64 v242, v[220:221] offset:24576
v_mfma_f32_16x16x32_bf16 v[192:195], a[152:155], v[24:27], v[192:195]
buffer_store_dwordx4 a[180:183], v239, s[24:27], s54 offen offset:0 sc1
v_mfma_f32_16x16x32_bf16 v[192:195], a[156:159], v[28:31], v[192:195]
s_add_u32 m0, s40, s56
v_fma_f32 v201, v201, v246, v254
v_cvt_pk_bf16_f32 v212, v200, v201
v_mfma_f32_16x16x32_bf16 v[192:195], a[160:163], v[32:35], v[192:195]
v_fma_f32 v202, v202, v246, v254
v_fma_f32 v203, v203, v246, v254
v_mfma_f32_16x16x32_bf16 v[192:195], a[164:167], v[36:39], v[192:195]
v_cvt_pk_bf16_f32 v213, v202, v203
v_fma_f32 v196, v196, v245, v253
v_mfma_f32_16x16x32_bf16 v[192:195], a[168:171], v[40:43], v[192:195]
ds_write_b64 v242, v[212:213] offset:16384
v_mfma_f32_16x16x32_bf16 v[192:195], a[172:175], v[44:47], v[192:195]
s_waitcnt lgkmcnt(2)
v_fma_f32 v197, v197, v245, v253
v_cvt_pk_bf16_f32 v196, v196, v197
v_mfma_f32_16x16x32_bf16 v[204:207], a[148:151], v[164:167], v[228:231]
v_fma_f32 v198, v198, v245, v253
v_fma_f32 v199, v199, v245, v253
v_mfma_f32_16x16x32_bf16 v[204:207], a[144:147], v[160:163], v[204:207]
ds_read_b64_tr_b16 a[152:153], v235 offset:16384
v_cvt_pk_bf16_f32 v197, v198, v199
v_mfma_f32_16x16x32_bf16 v[204:207], a[140:143], v[156:159], v[204:207]
ds_read_b64_tr_b16 a[154:155], v235 offset:18432
v_mfma_f32_16x16x32_bf16 v[204:207], a[136:139], v[152:155], v[204:207]
ds_read_b64_tr_b16 a[156:157], v235 offset:20480
v_fma_f32 v192, v192, v244, v252
v_mfma_f32_16x16x32_bf16 v[204:207], a[132:135], v[148:151], v[204:207]
ds_write_b64 v242, v[196:197] offset:8192
v_mfma_f32_16x16x32_bf16 v[204:207], a[128:131], v[144:147], v[204:207]
ds_read_b64_tr_b16 a[158:159], v235 offset:22528
v_fma_f32 v193, v193, v244, v252
v_mfma_f32_16x16x32_bf16 v[200:203], a[128:131], v[96:99], v[228:231]
ds_read_b64_tr_b16 a[160:161], v235 offset:24576
v_cvt_pk_bf16_f32 v192, v192, v193
v_mfma_f32_16x16x32_bf16 v[200:203], a[132:135], v[100:103], v[200:203]
ds_read_b64_tr_b16 a[162:163], v235 offset:26624
v_fma_f32 v194, v194, v244, v252
v_mfma_f32_16x16x32_bf16 v[200:203], a[136:139], v[104:107], v[200:203]
v_fma_f32 v195, v195, v244, v252
v_cvt_pk_bf16_f32 v193, v194, v195
v_mfma_f32_16x16x32_bf16 v[200:203], a[140:143], v[108:111], v[200:203]
ds_read_b64_tr_b16 a[164:165], v235 offset:28672
v_mfma_f32_16x16x32_bf16 v[200:203], a[144:147], v[112:115], v[200:203]
ds_read_b64_tr_b16 a[166:167], v235 offset:30720
v_mfma_f32_16x16x32_bf16 v[200:203], a[148:151], v[116:119], v[200:203]
ds_read_b64_tr_b16 a[168:169], v235 offset:32768
v_mfma_f32_16x16x32_bf16 v[196:199], a[148:151], v[68:71], v[228:231]
v_mfma_f32_16x16x32_bf16 v[196:199], a[144:147], v[64:67], v[196:199]
ds_read_b64_tr_b16 a[170:171], v235 offset:34816
v_mfma_f32_16x16x32_bf16 v[196:199], a[140:143], v[60:63], v[196:199]
ds_read_b64_tr_b16 a[172:173], v235 offset:36864
v_mfma_f32_16x16x32_bf16 v[196:199], a[136:139], v[56:59], v[196:199]
ds_read_b64_tr_b16 a[174:175], v235 offset:38912
v_xor_b32 v234, 0x60, v234
v_mfma_f32_16x16x32_bf16 v[196:199], a[132:135], v[52:55], v[196:199]
ds_write_b64 v242, v[192:193] offset:0
v_mfma_f32_16x16x32_bf16 v[196:199], a[128:131], v[48:51], v[196:199]
buffer_store_dwordx4 a[184:187], v239, s[24:27], s55 offen offset:0 sc1
v_mfma_f32_16x16x32_bf16 v[192:195], a[128:131], v[0:3], v[228:231]
v_xor_b32 v235, 0x60, v235
v_mfma_f32_16x16x32_bf16 v[192:195], a[132:135], v[4:7], v[192:195]
v_mfma_f32_16x16x32_bf16 v[192:195], a[136:139], v[8:11], v[192:195]
v_mfma_f32_16x16x32_bf16 v[192:195], a[140:143], v[12:15], v[192:195]
v_mfma_f32_16x16x32_bf16 v[192:195], a[144:147], v[16:19], v[192:195]
v_mfma_f32_16x16x32_bf16 v[192:195], a[148:151], v[20:23], v[192:195]
s_waitcnt vmcnt(11) lgkmcnt(1)
v_mfma_f32_16x16x32_bf16 v[192:195], a[172:175], v[44:47], v[192:195]
s_barrier
v_mfma_f32_16x16x32_bf16 v[192:195], a[168:171], v[40:43], v[192:195]
ds_read_b64_tr_b16 a[128:129], v235 offset:40960
v_mfma_f32_16x16x32_bf16 v[192:195], a[164:167], v[36:39], v[192:195]
ds_read_b64_tr_b16 a[130:131], v235 offset:43008
v_mfma_f32_16x16x32_bf16 v[192:195], a[160:163], v[32:35], v[192:195]
ds_read_b64_tr_b16 a[132:133], v235 offset:45056
v_mfma_f32_16x16x32_bf16 v[192:195], a[156:159], v[28:31], v[192:195]
buffer_load_dwordx4 v239, s[92:95], s62 offen lds
v_mfma_f32_16x16x32_bf16 v[192:195], a[152:155], v[24:27], v[192:195]
ds_read_b64_tr_b16 a[134:135], v235 offset:47104
s_add_u32 m0, s40, s57
v_mfma_f32_16x16x32_bf16 v[196:199], a[152:155], v[72:75], v[196:199]
ds_read_b64_tr_b16 a[136:137], v235 offset:49152
v_mfma_f32_16x16x32_bf16 v[196:199], a[156:159], v[76:79], v[196:199]
ds_read_b64_tr_b16 a[138:139], v235 offset:51200
v_mfma_f32_16x16x32_bf16 v[196:199], a[160:163], v[80:83], v[196:199]
v_mfma_f32_16x16x32_bf16 v[196:199], a[164:167], v[84:87], v[196:199]
ds_read_b64_tr_b16 a[140:141], v235 offset:53248
v_fma_f32 v192, v192, v244, v252
v_mfma_f32_16x16x32_bf16 v[196:199], a[168:171], v[88:91], v[196:199]
ds_read_b64_tr_b16 a[142:143], v235 offset:55296
v_fma_f32 v193, v193, v244, v252
v_mfma_f32_16x16x32_bf16 v[196:199], a[172:175], v[92:95], v[196:199]
ds_read_b64_tr_b16 a[144:145], v235 offset:57344
v_cvt_pk_bf16_f32 v192, v192, v193
v_mfma_f32_16x16x32_bf16 v[200:203], a[172:175], v[140:143], v[200:203]
v_fma_f32 v194, v194, v244, v252
v_fma_f32 v195, v195, v244, v252
v_mfma_f32_16x16x32_bf16 v[200:203], a[168:171], v[136:139], v[200:203]
ds_read_b64_tr_b16 a[146:147], v235 offset:59392
v_cvt_pk_bf16_f32 v193, v194, v195
v_mfma_f32_16x16x32_bf16 v[200:203], a[164:167], v[132:135], v[200:203]
ds_read_b64_tr_b16 a[148:149], v235 offset:61440
v_mfma_f32_16x16x32_bf16 v[200:203], a[160:163], v[128:131], v[200:203]
ds_read_b64_tr_b16 a[150:151], v235 offset:63488
v_fma_f32 v196, v196, v245, v253
v_mfma_f32_16x16x32_bf16 v[200:203], a[156:159], v[124:127], v[200:203]
ds_write_b64 v243, v[192:193] offset:0
v_mfma_f32_16x16x32_bf16 v[200:203], a[152:155], v[120:123], v[200:203]
v_fma_f32 v197, v197, v245, v253
v_cvt_pk_bf16_f32 v196, v196, v197
v_mfma_f32_16x16x32_bf16 v[204:207], a[152:155], v[168:171], v[204:207]
buffer_load_dwordx4 v239, s[92:95], s63 offen lds
v_mfma_f32_16x16x32_bf16 v[204:207], a[156:159], v[172:175], v[204:207]
ds_read_b128 a[188:191], v248 offset:0
v_fma_f32 v198, v198, v245, v253
v_mfma_f32_16x16x32_bf16 v[204:207], a[160:163], v[176:179], v[204:207]
ds_read_b128 a[192:195], v248 offset:4096
v_fma_f32 v199, v199, v245, v253
v_mfma_f32_16x16x32_bf16 v[204:207], a[164:167], v[180:183], v[204:207]
s_add_u32 m0, s40, s58
v_cvt_pk_bf16_f32 v197, v198, v199
v_fma_f32 v200, v200, v246, v254
v_mfma_f32_16x16x32_bf16 v[204:207], a[168:171], v[184:187], v[204:207]
ds_write_b64 v243, v[196:197] offset:8192
v_mfma_f32_16x16x32_bf16 v[204:207], a[172:175], v[188:191], v[204:207]
s_waitcnt lgkmcnt(4)
v_fma_f32 v201, v201, v246, v254
v_cvt_pk_bf16_f32 v214, v200, v201
v_mfma_f32_16x16x32_bf16 v[192:195], a[148:151], v[20:23], v[228:231]
v_fma_f32 v202, v202, v246, v254
v_fma_f32 v203, v203, v246, v254
v_mfma_f32_16x16x32_bf16 v[192:195], a[144:147], v[16:19], v[192:195]
ds_read_b64_tr_b16 a[152:153], v234 offset:0
v_cvt_pk_bf16_f32 v215, v202, v203
v_mfma_f32_16x16x32_bf16 v[192:195], a[140:143], v[12:15], v[192:195]
ds_read_b64_tr_b16 a[154:155], v234 offset:2048
s_waitcnt lgkmcnt(3)
v_mfma_f32_16x16x32_bf16 v[192:195], a[136:139], v[8:11], v[192:195]
ds_read_b64_tr_b16 a[156:157], v234 offset:4096
v_fma_f32 v204, v204, v247, v255
v_mfma_f32_16x16x32_bf16 v[192:195], a[132:135], v[4:7], v[192:195]
ds_read_b128 a[196:199], v248 offset:8192
v_fma_f32 v205, v205, v247, v255
v_mfma_f32_16x16x32_bf16 v[192:195], a[128:131], v[0:3], v[192:195]
ds_read_b64_tr_b16 a[158:159], v234 offset:6144
v_cvt_pk_bf16_f32 v222, v204, v205
v_mfma_f32_16x16x32_bf16 v[196:199], a[128:131], v[48:51], v[228:231]
ds_read_b64_tr_b16 a[160:161], v234 offset:8192
v_fma_f32 v206, v206, v247, v255
v_mfma_f32_16x16x32_bf16 v[196:199], a[132:135], v[52:55], v[196:199]
ds_read_b64_tr_b16 a[162:163], v234 offset:10240
v_fma_f32 v207, v207, v247, v255
v_mfma_f32_16x16x32_bf16 v[196:199], a[136:139], v[56:59], v[196:199]
ds_read_b128 a[200:203], v248 offset:12288
v_cvt_pk_bf16_f32 v223, v206, v207
v_mfma_f32_16x16x32_bf16 v[196:199], a[140:143], v[60:63], v[196:199]
ds_read_b64_tr_b16 a[164:165], v234 offset:12288
v_mfma_f32_16x16x32_bf16 v[196:199], a[144:147], v[64:67], v[196:199]
ds_read_b64_tr_b16 a[166:167], v234 offset:14336
v_mfma_f32_16x16x32_bf16 v[196:199], a[148:151], v[68:71], v[196:199]
ds_read_b64_tr_b16 a[168:169], v234 offset:16384
v_mfma_f32_16x16x32_bf16 v[200:203], a[148:151], v[116:119], v[228:231]
buffer_load_dwordx4 v239, s[92:95], s64 offen lds
v_mfma_f32_16x16x32_bf16 v[200:203], a[144:147], v[112:115], v[200:203]
ds_read_b64_tr_b16 a[170:171], v234 offset:18432
s_add_u32 m0, s40, s59
v_mfma_f32_16x16x32_bf16 v[200:203], a[140:143], v[108:111], v[200:203]
ds_read_b64_tr_b16 a[172:173], v234 offset:20480
s_waitcnt lgkmcnt(5)
v_mfma_f32_16x16x32_bf16 v[200:203], a[136:139], v[104:107], v[200:203]
ds_read_b64_tr_b16 a[174:175], v234 offset:22528
v_xor_b32 v234, 32, v234
v_mfma_f32_16x16x32_bf16 v[200:203], a[132:135], v[100:103], v[200:203]
buffer_store_dwordx4 a[188:191], v239, s[24:27], s48 offen offset:128 sc1
v_mfma_f32_16x16x32_bf16 v[200:203], a[128:131], v[96:99], v[200:203]
ds_write_b64 v243, v[214:215] offset:16384
v_mfma_f32_16x16x32_bf16 v[204:207], a[128:131], v[144:147], v[228:231]
ds_write_b64 v243, v[222:223] offset:24576
v_mfma_f32_16x16x32_bf16 v[204:207], a[132:135], v[148:151], v[204:207]
v_xor_b32 v235, 32, v235
v_mfma_f32_16x16x32_bf16 v[204:207], a[136:139], v[152:155], v[204:207]
buffer_store_dwordx4 a[192:195], v239, s[24:27], s49 offen offset:128 sc1
v_mfma_f32_16x16x32_bf16 v[204:207], a[140:143], v[156:159], v[204:207]
ds_read_b128 a[204:207], v248 offset:16384
v_mfma_f32_16x16x32_bf16 v[204:207], a[144:147], v[160:163], v[204:207]
ds_read_b128 a[208:211], v248 offset:20480
v_mfma_f32_16x16x32_bf16 v[204:207], a[148:151], v[164:167], v[204:207]
s_waitcnt lgkmcnt(4)
v_mfma_f32_16x16x32_bf16 v[204:207], a[172:175], v[188:191], v[204:207]
ds_read_b128 a[212:215], v248 offset:24576
v_mfma_f32_16x16x32_bf16 v[204:207], a[168:171], v[184:187], v[204:207]
ds_read_b64_tr_b16 a[128:129], v235 offset:40960
v_mfma_f32_16x16x32_bf16 v[204:207], a[164:167], v[180:183], v[204:207]
ds_read_b64_tr_b16 a[130:131], v235 offset:43008
v_mfma_f32_16x16x32_bf16 v[204:207], a[160:163], v[176:179], v[204:207]
ds_read_b64_tr_b16 a[132:133], v235 offset:45056
v_mfma_f32_16x16x32_bf16 v[204:207], a[156:159], v[172:175], v[204:207]
buffer_load_dwordx4 v239, s[92:95], s65 offen lds
v_mfma_f32_16x16x32_bf16 v[204:207], a[152:155], v[168:171], v[204:207]
ds_read_b64_tr_b16 a[134:135], v235 offset:47104
s_add_u32 m0, s40, s60
v_mfma_f32_16x16x32_bf16 v[200:203], a[152:155], v[120:123], v[200:203]
ds_read_b64_tr_b16 a[136:137], v235 offset:49152
s_waitcnt lgkmcnt(6)
v_mfma_f32_16x16x32_bf16 v[200:203], a[156:159], v[124:127], v[200:203]
ds_read_b64_tr_b16 a[138:139], v235 offset:51200
v_mfma_f32_16x16x32_bf16 v[200:203], a[160:163], v[128:131], v[200:203]
ds_read_b128 a[216:219], v248 offset:28672
v_mfma_f32_16x16x32_bf16 v[200:203], a[164:167], v[132:135], v[200:203]
ds_read_b64_tr_b16 a[140:141], v235 offset:53248
v_fma_f32 v204, v204, v247, v255
v_mfma_f32_16x16x32_bf16 v[200:203], a[168:171], v[136:139], v[200:203]
ds_read_b64_tr_b16 a[142:143], v235 offset:55296
v_fma_f32 v205, v205, v247, v255
v_mfma_f32_16x16x32_bf16 v[200:203], a[172:175], v[140:143], v[200:203]
ds_read_b64_tr_b16 a[144:145], v235 offset:57344
v_cvt_pk_bf16_f32 v216, v204, v205
v_mfma_f32_16x16x32_bf16 v[196:199], a[172:175], v[92:95], v[196:199]
v_fma_f32 v206, v206, v247, v255
v_fma_f32 v207, v207, v247, v255
v_mfma_f32_16x16x32_bf16 v[196:199], a[168:171], v[88:91], v[196:199]
ds_read_b64_tr_b16 a[146:147], v235 offset:59392
v_cvt_pk_bf16_f32 v217, v206, v207
v_mfma_f32_16x16x32_bf16 v[196:199], a[164:167], v[84:87], v[196:199]
ds_read_b64_tr_b16 a[148:149], v235 offset:61440
s_waitcnt lgkmcnt(5)
v_mfma_f32_16x16x32_bf16 v[196:199], a[160:163], v[80:83], v[196:199]
ds_read_b64_tr_b16 a[150:151], v235 offset:63488
v_fma_f32 v200, v200, v246, v254
v_mfma_f32_16x16x32_bf16 v[196:199], a[156:159], v[76:79], v[196:199]
ds_write_b64 v240, v[216:217] offset:24576
v_mfma_f32_16x16x32_bf16 v[196:199], a[152:155], v[72:75], v[196:199]
buffer_load_dwordx4 v239, s[92:95], s66 offen lds
v_mfma_f32_16x16x32_bf16 v[192:195], a[152:155], v[24:27], v[192:195]
s_add_u32 m0, s40, s61
v_fma_f32 v201, v201, v246, v254
v_cvt_pk_bf16_f32 v208, v200, v201
v_mfma_f32_16x16x32_bf16 v[192:195], a[156:159], v[28:31], v[192:195]
v_fma_f32 v202, v202, v246, v254
v_fma_f32 v203, v203, v246, v254
v_mfma_f32_16x16x32_bf16 v[192:195], a[160:163], v[32:35], v[192:195]
buffer_store_dwordx4 a[196:199], v239, s[24:27], s50 offen offset:128 sc1
v_mfma_f32_16x16x32_bf16 v[192:195], a[164:167], v[36:39], v[192:195]
v_cvt_pk_bf16_f32 v209, v202, v203
v_fma_f32 v196, v196, v245, v253
v_mfma_f32_16x16x32_bf16 v[192:195], a[168:171], v[40:43], v[192:195]
ds_write_b64 v240, v[208:209] offset:16384
v_mfma_f32_16x16x32_bf16 v[192:195], a[172:175], v[44:47], v[192:195]
s_waitcnt lgkmcnt(2)
v_fma_f32 v197, v197, v245, v253
v_cvt_pk_bf16_f32 v226, v196, v197
v_mfma_f32_16x16x32_bf16 v[204:207], a[148:151], v[164:167], v[228:231]
v_fma_f32 v198, v198, v245, v253
v_fma_f32 v199, v199, v245, v253
v_mfma_f32_16x16x32_bf16 v[204:207], a[144:147], v[160:163], v[204:207]
ds_read_b64_tr_b16 a[152:153], v234 offset:0
v_cvt_pk_bf16_f32 v227, v198, v199
v_mfma_f32_16x16x32_bf16 v[204:207], a[140:143], v[156:159], v[204:207]
ds_read_b64_tr_b16 a[154:155], v234 offset:2048
v_mfma_f32_16x16x32_bf16 v[204:207], a[136:139], v[152:155], v[204:207]
ds_read_b64_tr_b16 a[156:157], v234 offset:4096
v_fma_f32 v192, v192, v244, v252
v_mfma_f32_16x16x32_bf16 v[204:207], a[132:135], v[148:151], v[204:207]
v_fma_f32 v193, v193, v244, v252
v_cvt_pk_bf16_f32 v224, v192, v193
v_mfma_f32_16x16x32_bf16 v[204:207], a[128:131], v[144:147], v[204:207]
ds_read_b64_tr_b16 a[158:159], v234 offset:6144
v_fma_f32 v194, v194, v244, v252
v_mfma_f32_16x16x32_bf16 v[200:203], a[128:131], v[96:99], v[228:231]
ds_read_b64_tr_b16 a[160:161], v234 offset:8192
v_fma_f32 v195, v195, v244, v252
v_mfma_f32_16x16x32_bf16 v[200:203], a[132:135], v[100:103], v[200:203]
ds_read_b64_tr_b16 a[162:163], v234 offset:10240
v_cvt_pk_bf16_f32 v225, v194, v195
v_mfma_f32_16x16x32_bf16 v[200:203], a[136:139], v[104:107], v[200:203]
v_mfma_f32_16x16x32_bf16 v[200:203], a[140:143], v[108:111], v[200:203]
ds_read_b64_tr_b16 a[164:165], v234 offset:12288
v_mfma_f32_16x16x32_bf16 v[200:203], a[144:147], v[112:115], v[200:203]
ds_read_b64_tr_b16 a[166:167], v234 offset:14336
v_mfma_f32_16x16x32_bf16 v[200:203], a[148:151], v[116:119], v[200:203]
ds_read_b64_tr_b16 a[168:169], v234 offset:16384
v_mfma_f32_16x16x32_bf16 v[196:199], a[148:151], v[68:71], v[228:231]
buffer_load_dwordx4 v239, s[92:95], s67 offen lds
v_mfma_f32_16x16x32_bf16 v[196:199], a[144:147], v[64:67], v[196:199]
ds_read_b64_tr_b16 a[170:171], v234 offset:18432
v_mfma_f32_16x16x32_bf16 v[196:199], a[140:143], v[60:63], v[196:199]
ds_read_b64_tr_b16 a[172:173], v234 offset:20480
v_mfma_f32_16x16x32_bf16 v[196:199], a[136:139], v[56:59], v[196:199]
ds_read_b64_tr_b16 a[174:175], v234 offset:22528
v_xor_b32 v234, 0x60, v234
v_mfma_f32_16x16x32_bf16 v[196:199], a[132:135], v[52:55], v[196:199]
ds_write_b64 v240, v[224:225] offset:0
v_mfma_f32_16x16x32_bf16 v[196:199], a[128:131], v[48:51], v[196:199]
ds_write_b64 v240, v[226:227] offset:8192
v_mfma_f32_16x16x32_bf16 v[192:195], a[128:131], v[0:3], v[228:231]
v_xor_b32 v235, 0x60, v235
v_mfma_f32_16x16x32_bf16 v[192:195], a[132:135], v[4:7], v[192:195]
buffer_store_dwordx4 a[200:203], v239, s[24:27], s51 offen offset:128 sc1
v_mfma_f32_16x16x32_bf16 v[192:195], a[136:139], v[8:11], v[192:195]
v_mfma_f32_16x16x32_bf16 v[192:195], a[140:143], v[12:15], v[192:195]
v_mfma_f32_16x16x32_bf16 v[192:195], a[144:147], v[16:19], v[192:195]
v_mfma_f32_16x16x32_bf16 v[192:195], a[148:151], v[20:23], v[192:195]
s_waitcnt lgkmcnt(2)
v_mfma_f32_16x16x32_bf16 v[192:195], a[172:175], v[44:47], v[192:195]
v_mfma_f32_16x16x32_bf16 v[192:195], a[168:171], v[40:43], v[192:195]
ds_read_b64_tr_b16 a[128:129], v235 offset:40960
v_mfma_f32_16x16x32_bf16 v[192:195], a[164:167], v[36:39], v[192:195]
ds_read_b64_tr_b16 a[130:131], v235 offset:43008
v_mfma_f32_16x16x32_bf16 v[192:195], a[160:163], v[32:35], v[192:195]
ds_read_b64_tr_b16 a[132:133], v235 offset:45056
v_mfma_f32_16x16x32_bf16 v[192:195], a[156:159], v[28:31], v[192:195]
v_mfma_f32_16x16x32_bf16 v[192:195], a[152:155], v[24:27], v[192:195]
ds_read_b64_tr_b16 a[134:135], v235 offset:47104
v_mfma_f32_16x16x32_bf16 v[196:199], a[152:155], v[72:75], v[196:199]
ds_read_b64_tr_b16 a[136:137], v235 offset:49152
v_mfma_f32_16x16x32_bf16 v[196:199], a[156:159], v[76:79], v[196:199]
ds_read_b64_tr_b16 a[138:139], v235 offset:51200
v_mfma_f32_16x16x32_bf16 v[196:199], a[160:163], v[80:83], v[196:199]
v_mfma_f32_16x16x32_bf16 v[196:199], a[164:167], v[84:87], v[196:199]
ds_read_b64_tr_b16 a[140:141], v235 offset:53248
v_fma_f32 v192, v192, v244, v252
v_mfma_f32_16x16x32_bf16 v[196:199], a[168:171], v[88:91], v[196:199]
ds_read_b64_tr_b16 a[142:143], v235 offset:55296
v_fma_f32 v193, v193, v244, v252
v_mfma_f32_16x16x32_bf16 v[196:199], a[172:175], v[92:95], v[196:199]
ds_read_b64_tr_b16 a[144:145], v235 offset:57344
v_cvt_pk_bf16_f32 v192, v192, v193
v_mfma_f32_16x16x32_bf16 v[200:203], a[172:175], v[140:143], v[200:203]
v_fma_f32 v194, v194, v244, v252
v_fma_f32 v195, v195, v244, v252
v_mfma_f32_16x16x32_bf16 v[200:203], a[168:171], v[136:139], v[200:203]
ds_read_b64_tr_b16 a[146:147], v235 offset:59392
v_cvt_pk_bf16_f32 v193, v194, v195
v_mfma_f32_16x16x32_bf16 v[200:203], a[164:167], v[132:135], v[200:203]
ds_read_b64_tr_b16 a[148:149], v235 offset:61440
v_mfma_f32_16x16x32_bf16 v[200:203], a[160:163], v[128:131], v[200:203]
ds_read_b64_tr_b16 a[150:151], v235 offset:63488
v_fma_f32 v196, v196, v245, v253
v_mfma_f32_16x16x32_bf16 v[200:203], a[156:159], v[124:127], v[200:203]
ds_write_b64 v241, v[192:193] offset:0
v_mfma_f32_16x16x32_bf16 v[200:203], a[152:155], v[120:123], v[200:203]
v_fma_f32 v197, v197, v245, v253
v_cvt_pk_bf16_f32 v196, v196, v197
v_mfma_f32_16x16x32_bf16 v[204:207], a[152:155], v[168:171], v[204:207]
v_fma_f32 v198, v198, v245, v253
v_fma_f32 v199, v199, v245, v253
v_mfma_f32_16x16x32_bf16 v[204:207], a[156:159], v[172:175], v[204:207]
buffer_store_dwordx4 a[204:207], v239, s[24:27], s52 offen offset:128 sc1
v_mfma_f32_16x16x32_bf16 v[204:207], a[160:163], v[176:179], v[204:207]
v_cvt_pk_bf16_f32 v197, v198, v199
v_mfma_f32_16x16x32_bf16 v[204:207], a[164:167], v[180:183], v[204:207]
ds_write_b64 v241, v[196:197] offset:8192
v_mfma_f32_16x16x32_bf16 v[204:207], a[168:171], v[184:187], v[204:207]
v_fma_f32 v200, v200, v246, v254
v_fma_f32 v201, v201, v246, v254
v_mfma_f32_16x16x32_bf16 v[204:207], a[172:175], v[188:191], v[204:207]
s_waitcnt lgkmcnt(2)
v_cvt_pk_bf16_f32 v210, v200, v201
v_fma_f32 v202, v202, v246, v254
v_mfma_f32_16x16x32_bf16 v[192:195], a[148:151], v[20:23], v[228:231]
v_fma_f32 v203, v203, v246, v254
v_cvt_pk_bf16_f32 v211, v202, v203
v_mfma_f32_16x16x32_bf16 v[192:195], a[144:147], v[16:19], v[192:195]
ds_read_b64_tr_b16 a[152:153], v234 offset:0
v_mfma_f32_16x16x32_bf16 v[192:195], a[140:143], v[12:15], v[192:195]
ds_read_b64_tr_b16 a[154:155], v234 offset:2048
v_mfma_f32_16x16x32_bf16 v[192:195], a[136:139], v[8:11], v[192:195]
ds_read_b64_tr_b16 a[156:157], v234 offset:4096
v_fma_f32 v204, v204, v247, v255
v_mfma_f32_16x16x32_bf16 v[192:195], a[132:135], v[4:7], v[192:195]
v_fma_f32 v205, v205, v247, v255
v_cvt_pk_bf16_f32 v218, v204, v205
v_mfma_f32_16x16x32_bf16 v[192:195], a[128:131], v[0:3], v[192:195]
ds_read_b64_tr_b16 a[158:159], v234 offset:6144
v_fma_f32 v206, v206, v247, v255
v_mfma_f32_16x16x32_bf16 v[196:199], a[128:131], v[48:51], v[228:231]
ds_read_b64_tr_b16 a[160:161], v234 offset:8192
v_fma_f32 v207, v207, v247, v255
v_mfma_f32_16x16x32_bf16 v[196:199], a[132:135], v[52:55], v[196:199]
ds_read_b64_tr_b16 a[162:163], v234 offset:10240
v_cvt_pk_bf16_f32 v219, v206, v207
v_mfma_f32_16x16x32_bf16 v[196:199], a[136:139], v[56:59], v[196:199]
v_mfma_f32_16x16x32_bf16 v[196:199], a[140:143], v[60:63], v[196:199]
ds_read_b64_tr_b16 a[164:165], v234 offset:12288
v_mfma_f32_16x16x32_bf16 v[196:199], a[144:147], v[64:67], v[196:199]
ds_read_b64_tr_b16 a[166:167], v234 offset:14336
v_mfma_f32_16x16x32_bf16 v[196:199], a[148:151], v[68:71], v[196:199]
ds_read_b64_tr_b16 a[168:169], v234 offset:16384
v_mfma_f32_16x16x32_bf16 v[200:203], a[148:151], v[116:119], v[228:231]
v_mfma_f32_16x16x32_bf16 v[200:203], a[144:147], v[112:115], v[200:203]
ds_read_b64_tr_b16 a[170:171], v234 offset:18432
v_mfma_f32_16x16x32_bf16 v[200:203], a[140:143], v[108:111], v[200:203]
ds_read_b64_tr_b16 a[172:173], v234 offset:20480
v_mfma_f32_16x16x32_bf16 v[200:203], a[136:139], v[104:107], v[200:203]
ds_read_b64_tr_b16 a[174:175], v234 offset:22528
v_xor_b32 v234, 32, v234
v_mfma_f32_16x16x32_bf16 v[200:203], a[132:135], v[100:103], v[200:203]
ds_write_b64 v241, v[210:211] offset:16384
v_mfma_f32_16x16x32_bf16 v[200:203], a[128:131], v[96:99], v[200:203]
ds_write_b64 v241, v[218:219] offset:24576
v_mfma_f32_16x16x32_bf16 v[204:207], a[128:131], v[144:147], v[228:231]
buffer_store_dwordx4 a[208:211], v239, s[24:27], s53 offen offset:128 sc1
v_mfma_f32_16x16x32_bf16 v[204:207], a[132:135], v[148:151], v[204:207]
v_xor_b32 v235, 32, v235
v_mfma_f32_16x16x32_bf16 v[204:207], a[136:139], v[152:155], v[204:207]
v_mfma_f32_16x16x32_bf16 v[204:207], a[140:143], v[156:159], v[204:207]
v_mfma_f32_16x16x32_bf16 v[204:207], a[144:147], v[160:163], v[204:207]
v_mfma_f32_16x16x32_bf16 v[204:207], a[148:151], v[164:167], v[204:207]
s_waitcnt lgkmcnt(2)
v_mfma_f32_16x16x32_bf16 v[204:207], a[172:175], v[188:191], v[204:207]
v_mfma_f32_16x16x32_bf16 v[204:207], a[168:171], v[184:187], v[204:207]
ds_read_b64_tr_b16 a[128:129], v235 offset:40960
v_mfma_f32_16x16x32_bf16 v[204:207], a[164:167], v[180:183], v[204:207]
ds_read_b64_tr_b16 a[130:131], v235 offset:43008
v_mfma_f32_16x16x32_bf16 v[204:207], a[160:163], v[176:179], v[204:207]
ds_read_b64_tr_b16 a[132:133], v235 offset:45056
v_mfma_f32_16x16x32_bf16 v[204:207], a[156:159], v[172:175], v[204:207]
v_mfma_f32_16x16x32_bf16 v[204:207], a[152:155], v[168:171], v[204:207]
ds_read_b64_tr_b16 a[134:135], v235 offset:47104
v_mfma_f32_16x16x32_bf16 v[200:203], a[152:155], v[120:123], v[200:203]
ds_read_b64_tr_b16 a[136:137], v235 offset:49152
v_mfma_f32_16x16x32_bf16 v[200:203], a[156:159], v[124:127], v[200:203]
ds_read_b64_tr_b16 a[138:139], v235 offset:51200
v_mfma_f32_16x16x32_bf16 v[200:203], a[160:163], v[128:131], v[200:203]
v_mfma_f32_16x16x32_bf16 v[200:203], a[164:167], v[132:135], v[200:203]
ds_read_b64_tr_b16 a[140:141], v235 offset:53248
v_fma_f32 v204, v204, v247, v255
v_mfma_f32_16x16x32_bf16 v[200:203], a[168:171], v[136:139], v[200:203]
ds_read_b64_tr_b16 a[142:143], v235 offset:55296
v_fma_f32 v205, v205, v247, v255
v_mfma_f32_16x16x32_bf16 v[200:203], a[172:175], v[140:143], v[200:203]
ds_read_b64_tr_b16 a[144:145], v235 offset:57344
v_cvt_pk_bf16_f32 v220, v204, v205
v_mfma_f32_16x16x32_bf16 v[196:199], a[172:175], v[92:95], v[196:199]
v_fma_f32 v206, v206, v247, v255
v_fma_f32 v207, v207, v247, v255
v_mfma_f32_16x16x32_bf16 v[196:199], a[168:171], v[88:91], v[196:199]
ds_read_b64_tr_b16 a[146:147], v235 offset:59392
v_cvt_pk_bf16_f32 v221, v206, v207
v_mfma_f32_16x16x32_bf16 v[196:199], a[164:167], v[84:87], v[196:199]
ds_read_b64_tr_b16 a[148:149], v235 offset:61440
v_mfma_f32_16x16x32_bf16 v[196:199], a[160:163], v[80:83], v[196:199]
ds_read_b64_tr_b16 a[150:151], v235 offset:63488
v_fma_f32 v200, v200, v246, v254
v_mfma_f32_16x16x32_bf16 v[196:199], a[156:159], v[76:79], v[196:199]
ds_write_b64 v242, v[220:221] offset:24576
v_mfma_f32_16x16x32_bf16 v[196:199], a[152:155], v[72:75], v[196:199]
v_fma_f32 v201, v201, v246, v254
v_cvt_pk_bf16_f32 v212, v200, v201
v_mfma_f32_16x16x32_bf16 v[192:195], a[152:155], v[24:27], v[192:195]
buffer_store_dwordx4 a[212:215], v239, s[24:27], s54 offen offset:128 sc1
v_mfma_f32_16x16x32_bf16 v[192:195], a[156:159], v[28:31], v[192:195]
v_fma_f32 v202, v202, v246, v254
v_fma_f32 v203, v203, v246, v254
v_mfma_f32_16x16x32_bf16 v[192:195], a[160:163], v[32:35], v[192:195]
v_cvt_pk_bf16_f32 v213, v202, v203
v_mfma_f32_16x16x32_bf16 v[192:195], a[164:167], v[36:39], v[192:195]
ds_write_b64 v242, v[212:213] offset:16384
v_mfma_f32_16x16x32_bf16 v[192:195], a[168:171], v[40:43], v[192:195]
v_fma_f32 v196, v196, v245, v253
v_fma_f32 v197, v197, v245, v253
v_mfma_f32_16x16x32_bf16 v[192:195], a[172:175], v[44:47], v[192:195]
s_waitcnt lgkmcnt(2)
v_cvt_pk_bf16_f32 v196, v196, v197
v_fma_f32 v198, v198, v245, v253
v_mfma_f32_16x16x32_bf16 v[204:207], a[148:151], v[164:167], v[228:231]
v_fma_f32 v199, v199, v245, v253
v_cvt_pk_bf16_f32 v197, v198, v199
v_mfma_f32_16x16x32_bf16 v[204:207], a[144:147], v[160:163], v[204:207]
ds_read_b64_tr_b16 a[152:153], v234 offset:0
v_mfma_f32_16x16x32_bf16 v[204:207], a[140:143], v[156:159], v[204:207]
ds_read_b64_tr_b16 a[154:155], v234 offset:2048
v_mfma_f32_16x16x32_bf16 v[204:207], a[136:139], v[152:155], v[204:207]
ds_read_b64_tr_b16 a[156:157], v234 offset:4096
v_fma_f32 v192, v192, v244, v252
v_mfma_f32_16x16x32_bf16 v[204:207], a[132:135], v[148:151], v[204:207]
ds_write_b64 v242, v[196:197] offset:8192
v_mfma_f32_16x16x32_bf16 v[204:207], a[128:131], v[144:147], v[204:207]
ds_read_b64_tr_b16 a[158:159], v234 offset:6144
v_fma_f32 v193, v193, v244, v252
v_mfma_f32_16x16x32_bf16 v[200:203], a[128:131], v[96:99], v[228:231]
ds_read_b64_tr_b16 a[160:161], v234 offset:8192
v_cvt_pk_bf16_f32 v192, v192, v193
v_mfma_f32_16x16x32_bf16 v[200:203], a[132:135], v[100:103], v[200:203]
ds_read_b64_tr_b16 a[162:163], v234 offset:10240
v_fma_f32 v194, v194, v244, v252
v_mfma_f32_16x16x32_bf16 v[200:203], a[136:139], v[104:107], v[200:203]
v_fma_f32 v195, v195, v244, v252
v_cvt_pk_bf16_f32 v193, v194, v195
v_mfma_f32_16x16x32_bf16 v[200:203], a[140:143], v[108:111], v[200:203]
ds_read_b64_tr_b16 a[164:165], v234 offset:12288
v_mfma_f32_16x16x32_bf16 v[200:203], a[144:147], v[112:115], v[200:203]
ds_read_b64_tr_b16 a[166:167], v234 offset:14336
v_mfma_f32_16x16x32_bf16 v[200:203], a[148:151], v[116:119], v[200:203]
ds_read_b64_tr_b16 a[168:169], v234 offset:16384
v_mfma_f32_16x16x32_bf16 v[196:199], a[148:151], v[68:71], v[228:231]
v_mfma_f32_16x16x32_bf16 v[196:199], a[144:147], v[64:67], v[196:199]
ds_read_b64_tr_b16 a[170:171], v234 offset:18432
v_mfma_f32_16x16x32_bf16 v[196:199], a[140:143], v[60:63], v[196:199]
ds_read_b64_tr_b16 a[172:173], v234 offset:20480
v_mfma_f32_16x16x32_bf16 v[196:199], a[136:139], v[56:59], v[196:199]
ds_read_b64_tr_b16 a[174:175], v234 offset:22528
v_xor_b32 v234, 0x60, v234
v_mfma_f32_16x16x32_bf16 v[196:199], a[132:135], v[52:55], v[196:199]
ds_write_b64 v242, v[192:193] offset:0
v_mfma_f32_16x16x32_bf16 v[196:199], a[128:131], v[48:51], v[196:199]
buffer_store_dwordx4 a[216:219], v239, s[24:27], s55 offen offset:128 sc1
v_mfma_f32_16x16x32_bf16 v[192:195], a[128:131], v[0:3], v[228:231]
v_xor_b32 v235, 0x60, v235
v_mfma_f32_16x16x32_bf16 v[192:195], a[132:135], v[4:7], v[192:195]
v_mfma_f32_16x16x32_bf16 v[192:195], a[136:139], v[8:11], v[192:195]
v_mfma_f32_16x16x32_bf16 v[192:195], a[140:143], v[12:15], v[192:195]
v_mfma_f32_16x16x32_bf16 v[192:195], a[144:147], v[16:19], v[192:195]
v_mfma_f32_16x16x32_bf16 v[192:195], a[148:151], v[20:23], v[192:195]
s_waitcnt vmcnt(5) lgkmcnt(1)
v_mfma_f32_16x16x32_bf16 v[192:195], a[172:175], v[44:47], v[192:195]
s_barrier
v_mfma_f32_16x16x32_bf16 v[192:195], a[168:171], v[40:43], v[192:195]
ds_read_b64_tr_b16 a[128:129], v234 offset:24576
v_mfma_f32_16x16x32_bf16 v[192:195], a[164:167], v[36:39], v[192:195]
ds_read_b64_tr_b16 a[130:131], v234 offset:26624
v_mfma_f32_16x16x32_bf16 v[192:195], a[160:163], v[32:35], v[192:195]
ds_read_b64_tr_b16 a[132:133], v234 offset:28672
v_mfma_f32_16x16x32_bf16 v[192:195], a[156:159], v[28:31], v[192:195]
v_mfma_f32_16x16x32_bf16 v[192:195], a[152:155], v[24:27], v[192:195]
ds_read_b64_tr_b16 a[134:135], v234 offset:30720
v_mfma_f32_16x16x32_bf16 v[196:199], a[152:155], v[72:75], v[196:199]
ds_read_b64_tr_b16 a[136:137], v234 offset:32768
v_mfma_f32_16x16x32_bf16 v[196:199], a[156:159], v[76:79], v[196:199]
ds_read_b64_tr_b16 a[138:139], v234 offset:34816
v_mfma_f32_16x16x32_bf16 v[196:199], a[160:163], v[80:83], v[196:199]
v_mfma_f32_16x16x32_bf16 v[196:199], a[164:167], v[84:87], v[196:199]
ds_read_b64_tr_b16 a[140:141], v234 offset:36864
v_fma_f32 v192, v192, v244, v252
v_mfma_f32_16x16x32_bf16 v[196:199], a[168:171], v[88:91], v[196:199]
ds_read_b64_tr_b16 a[142:143], v234 offset:38912
v_fma_f32 v193, v193, v244, v252
v_mfma_f32_16x16x32_bf16 v[196:199], a[172:175], v[92:95], v[196:199]
ds_read_b64_tr_b16 a[144:145], v234 offset:40960
v_cvt_pk_bf16_f32 v192, v192, v193
v_mfma_f32_16x16x32_bf16 v[200:203], a[172:175], v[140:143], v[200:203]
v_fma_f32 v194, v194, v244, v252
v_fma_f32 v195, v195, v244, v252
v_mfma_f32_16x16x32_bf16 v[200:203], a[168:171], v[136:139], v[200:203]
ds_read_b64_tr_b16 a[146:147], v234 offset:43008
v_cvt_pk_bf16_f32 v193, v194, v195
v_mfma_f32_16x16x32_bf16 v[200:203], a[164:167], v[132:135], v[200:203]
ds_read_b64_tr_b16 a[148:149], v234 offset:45056
v_mfma_f32_16x16x32_bf16 v[200:203], a[160:163], v[128:131], v[200:203]
ds_read_b64_tr_b16 a[150:151], v234 offset:47104
v_fma_f32 v196, v196, v245, v253
v_mfma_f32_16x16x32_bf16 v[200:203], a[156:159], v[124:127], v[200:203]
ds_write_b64 v243, v[192:193] offset:0
v_mfma_f32_16x16x32_bf16 v[200:203], a[152:155], v[120:123], v[200:203]
ds_read_b64_tr_b16 a[0:1], v234 offset:49152
v_fma_f32 v197, v197, v245, v253
v_mfma_f32_16x16x32_bf16 v[204:207], a[152:155], v[168:171], v[204:207]
ds_read_b64_tr_b16 a[2:3], v234 offset:51200
v_cvt_pk_bf16_f32 v196, v196, v197
v_mfma_f32_16x16x32_bf16 v[204:207], a[156:159], v[172:175], v[204:207]
ds_read_b64_tr_b16 a[4:5], v234 offset:53248
v_fma_f32 v198, v198, v245, v253
v_mfma_f32_16x16x32_bf16 v[204:207], a[160:163], v[176:179], v[204:207]
ds_read_b64_tr_b16 a[6:7], v234 offset:55296
v_fma_f32 v199, v199, v245, v253
v_mfma_f32_16x16x32_bf16 v[204:207], a[164:167], v[180:183], v[204:207]
ds_read_b64_tr_b16 a[8:9], v234 offset:57344
v_cvt_pk_bf16_f32 v197, v198, v199
v_mfma_f32_16x16x32_bf16 v[204:207], a[168:171], v[184:187], v[204:207]
ds_write_b64 v243, v[196:197] offset:8192
v_mfma_f32_16x16x32_bf16 v[204:207], a[172:175], v[188:191], v[204:207]
s_waitcnt lgkmcnt(7)
v_fma_f32 v200, v200, v246, v254
v_fma_f32 v201, v201, v246, v254
v_mfma_f32_16x16x32_bf16 v[192:195], a[148:151], v[20:23], v[228:231]
ds_read_b64_tr_b16 a[10:11], v234 offset:59392
v_cvt_pk_bf16_f32 v214, v200, v201
v_mfma_f32_16x16x32_bf16 v[192:195], a[144:147], v[16:19], v[192:195]
ds_read_b64_tr_b16 a[12:13], v234 offset:61440
v_fma_f32 v202, v202, v246, v254
v_mfma_f32_16x16x32_bf16 v[192:195], a[140:143], v[12:15], v[192:195]
ds_read_b64_tr_b16 a[14:15], v234 offset:63488
v_fma_f32 v203, v203, v246, v254
v_mfma_f32_16x16x32_bf16 v[192:195], a[136:139], v[8:11], v[192:195]
ds_read_b64_tr_b16 a[16:17], v235 offset:8192
v_cvt_pk_bf16_f32 v215, v202, v203
v_mfma_f32_16x16x32_bf16 v[192:195], a[132:135], v[4:7], v[192:195]
ds_read_b64_tr_b16 a[18:19], v235 offset:10240
v_fma_f32 v204, v204, v247, v255
v_mfma_f32_16x16x32_bf16 v[192:195], a[128:131], v[0:3], v[192:195]
ds_read_b64_tr_b16 a[20:21], v235 offset:12288
v_fma_f32 v205, v205, v247, v255
v_mfma_f32_16x16x32_bf16 v[196:199], a[128:131], v[48:51], v[228:231]
ds_read_b128 a[220:223], v248 offset:0
v_cvt_pk_bf16_f32 v222, v204, v205
v_mfma_f32_16x16x32_bf16 v[196:199], a[132:135], v[52:55], v[196:199]
ds_read_b64_tr_b16 a[22:23], v235 offset:14336
v_fma_f32 v206, v206, v247, v255
v_mfma_f32_16x16x32_bf16 v[196:199], a[136:139], v[56:59], v[196:199]
ds_read_b128 a[224:227], v248 offset:4096
v_fma_f32 v207, v207, v247, v255
v_mfma_f32_16x16x32_bf16 v[196:199], a[140:143], v[60:63], v[196:199]
ds_read_b128 a[228:231], v248 offset:8192
v_cvt_pk_bf16_f32 v223, v206, v207
v_mfma_f32_16x16x32_bf16 v[196:199], a[144:147], v[64:67], v[196:199]
ds_read_b128 a[232:235], v248 offset:12288
v_xor_b32 v234, 32, v234
v_mfma_f32_16x16x32_bf16 v[196:199], a[148:151], v[68:71], v[196:199]
ds_write_b64 v243, v[214:215] offset:16384
v_mfma_f32_16x16x32_bf16 v[200:203], a[148:151], v[116:119], v[228:231]
ds_write_b64 v243, v[222:223] offset:24576
v_mfma_f32_16x16x32_bf16 v[200:203], a[144:147], v[112:115], v[200:203]
v_xor_b32 v235, 32, v235
v_mfma_f32_16x16x32_bf16 v[200:203], a[140:143], v[108:111], v[200:203]
ds_read_b64_tr_b16 a[24:25], v234 offset:24576
s_waitcnt lgkmcnt(5)
v_mfma_f32_16x16x32_bf16 v[200:203], a[136:139], v[104:107], v[200:203]
buffer_store_dwordx4 a[220:223], v239, s[24:27], s48 offen offset:256 sc1
v_mfma_f32_16x16x32_bf16 v[200:203], a[132:135], v[100:103], v[200:203]
buffer_store_dwordx4 a[224:227], v239, s[24:27], s49 offen offset:256 sc1
v_mfma_f32_16x16x32_bf16 v[200:203], a[128:131], v[96:99], v[200:203]
ds_read_b64_tr_b16 a[26:27], v234 offset:26624
s_waitcnt lgkmcnt(4)
v_mfma_f32_16x16x32_bf16 v[204:207], a[128:131], v[144:147], v[228:231]
ds_read_b64_tr_b16 a[28:29], v234 offset:28672
v_mfma_f32_16x16x32_bf16 v[204:207], a[132:135], v[148:151], v[204:207]
ds_read_b64_tr_b16 a[30:31], v234 offset:30720
v_mfma_f32_16x16x32_bf16 v[204:207], a[136:139], v[152:155], v[204:207]
ds_read_b64_tr_b16 a[32:33], v234 offset:32768
v_mfma_f32_16x16x32_bf16 v[204:207], a[140:143], v[156:159], v[204:207]
ds_read_b64_tr_b16 a[34:35], v234 offset:34816
v_mfma_f32_16x16x32_bf16 v[204:207], a[144:147], v[160:163], v[204:207]
ds_read_b64_tr_b16 a[36:37], v234 offset:36864
v_mfma_f32_16x16x32_bf16 v[204:207], a[148:151], v[164:167], v[204:207]
ds_read_b64_tr_b16 a[38:39], v234 offset:38912
s_waitcnt lgkmcnt(13)
v_mfma_f32_16x16x32_bf16 v[204:207], a[20:23], v[188:191], v[204:207]
ds_read_b64_tr_b16 a[40:41], v234 offset:40960
v_mfma_f32_16x16x32_bf16 v[204:207], a[16:19], v[184:187], v[204:207]
ds_read_b64_tr_b16 a[42:43], v234 offset:43008
v_mfma_f32_16x16x32_bf16 v[204:207], a[12:15], v[180:183], v[204:207]
ds_read_b64_tr_b16 a[44:45], v234 offset:45056
v_mfma_f32_16x16x32_bf16 v[204:207], a[8:11], v[176:179], v[204:207]
ds_read_b64_tr_b16 a[46:47], v234 offset:47104
v_mfma_f32_16x16x32_bf16 v[204:207], a[4:7], v[172:175], v[204:207]
ds_read_b64_tr_b16 a[48:49], v234 offset:49152
v_mfma_f32_16x16x32_bf16 v[204:207], a[0:3], v[168:171], v[204:207]
ds_read_b64_tr_b16 a[50:51], v234 offset:51200
v_mfma_f32_16x16x32_bf16 v[200:203], a[0:3], v[120:123], v[200:203]
ds_read_b64_tr_b16 a[52:53], v234 offset:53248
v_mfma_f32_16x16x32_bf16 v[200:203], a[4:7], v[124:127], v[200:203]
ds_read_b64_tr_b16 a[54:55], v234 offset:55296
v_mfma_f32_16x16x32_bf16 v[200:203], a[8:11], v[128:131], v[200:203]
ds_read_b64_tr_b16 a[56:57], v234 offset:57344
v_mfma_f32_16x16x32_bf16 v[200:203], a[12:15], v[132:135], v[200:203]
buffer_store_dwordx4 a[228:231], v239, s[24:27], s50 offen offset:256 sc1
v_mfma_f32_16x16x32_bf16 v[200:203], a[16:19], v[136:139], v[200:203]
ds_read_b64_tr_b16 a[58:59], v234 offset:59392
v_fma_f32 v204, v204, v247, v255
v_mfma_f32_16x16x32_bf16 v[200:203], a[20:23], v[140:143], v[200:203]
ds_read_b64_tr_b16 a[60:61], v234 offset:61440
v_fma_f32 v205, v205, v247, v255
v_mfma_f32_16x16x32_bf16 v[196:199], a[20:23], v[92:95], v[196:199]
ds_read_b64_tr_b16 a[62:63], v234 offset:63488
v_cvt_pk_bf16_f32 v216, v204, v205
v_mfma_f32_16x16x32_bf16 v[196:199], a[16:19], v[88:91], v[196:199]
ds_read_b64_tr_b16 a[64:65], v235 offset:8192
v_fma_f32 v206, v206, v247, v255
v_mfma_f32_16x16x32_bf16 v[196:199], a[12:15], v[84:87], v[196:199]
ds_read_b64_tr_b16 a[66:67], v235 offset:10240
v_fma_f32 v207, v207, v247, v255
v_mfma_f32_16x16x32_bf16 v[196:199], a[8:11], v[80:83], v[196:199]
ds_read_b64_tr_b16 a[68:69], v235 offset:12288
v_cvt_pk_bf16_f32 v217, v206, v207
v_mfma_f32_16x16x32_bf16 v[196:199], a[4:7], v[76:79], v[196:199]
ds_read_b64_tr_b16 a[70:71], v235 offset:14336
v_fma_f32 v200, v200, v246, v254
v_mfma_f32_16x16x32_bf16 v[196:199], a[0:3], v[72:75], v[196:199]
ds_read_b128 a[236:239], v248 offset:16384
v_fma_f32 v201, v201, v246, v254
v_mfma_f32_16x16x32_bf16 v[192:195], a[0:3], v[24:27], v[192:195]
ds_read_b128 a[240:243], v248 offset:20480
v_cvt_pk_bf16_f32 v208, v200, v201
v_mfma_f32_16x16x32_bf16 v[192:195], a[4:7], v[28:31], v[192:195]
ds_read_b128 a[244:247], v248 offset:24576
v_fma_f32 v202, v202, v246, v254
v_mfma_f32_16x16x32_bf16 v[192:195], a[8:11], v[32:35], v[192:195]
buffer_store_dwordx4 a[232:235], v239, s[24:27], s51 offen offset:256 sc1
v_mfma_f32_16x16x32_bf16 v[192:195], a[12:15], v[36:39], v[192:195]
ds_read_b128 a[248:251], v248 offset:28672
v_fma_f32 v203, v203, v246, v254
v_mfma_f32_16x16x32_bf16 v[192:195], a[16:19], v[40:43], v[192:195]
ds_write_b64 v240, v[216:217] offset:24576
v_mfma_f32_16x16x32_bf16 v[192:195], a[20:23], v[44:47], v[192:195]
s_waitcnt lgkmcnt(15)
v_cvt_pk_bf16_f32 v209, v202, v203
v_fma_f32 v196, v196, v245, v253
v_mfma_f32_16x16x32_bf16 v[204:207], a[44:47], v[164:167], v[228:231]
ds_write_b64 v240, v[208:209] offset:16384
v_mfma_f32_16x16x32_bf16 v[204:207], a[40:43], v[160:163], v[204:207]
s_waitcnt lgkmcnt(4)
v_fma_f32 v197, v197, v245, v253
v_cvt_pk_bf16_f32 v226, v196, v197
v_mfma_f32_16x16x32_bf16 v[204:207], a[36:39], v[156:159], v[204:207]
v_fma_f32 v198, v198, v245, v253
v_fma_f32 v199, v199, v245, v253
v_mfma_f32_16x16x32_bf16 v[204:207], a[32:35], v[152:155], v[204:207]
s_waitcnt lgkmcnt(2)
v_xor_b32 v234, 0x60, v234
v_xor_b32 v235, 0x60, v235
v_mfma_f32_16x16x32_bf16 v[204:207], a[28:31], v[148:151], v[204:207]
ds_read_b64_tr_b16 a[72:73], v234 offset:24576
v_cvt_pk_bf16_f32 v227, v198, v199
v_mfma_f32_16x16x32_bf16 v[204:207], a[24:27], v[144:147], v[204:207]
ds_read_b64_tr_b16 a[74:75], v234 offset:26624
v_fma_f32 v192, v192, v244, v252
v_mfma_f32_16x16x32_bf16 v[200:203], a[24:27], v[96:99], v[228:231]
ds_read_b64_tr_b16 a[76:77], v234 offset:28672
v_fma_f32 v193, v193, v244, v252
v_mfma_f32_16x16x32_bf16 v[200:203], a[28:31], v[100:103], v[200:203]
ds_read_b64_tr_b16 a[78:79], v234 offset:30720
v_cvt_pk_bf16_f32 v224, v192, v193
v_mfma_f32_16x16x32_bf16 v[200:203], a[32:35], v[104:107], v[200:203]
ds_read_b64_tr_b16 a[80:81], v234 offset:32768
v_fma_f32 v194, v194, v244, v252
v_mfma_f32_16x16x32_bf16 v[200:203], a[36:39], v[108:111], v[200:203]
ds_read_b64_tr_b16 a[82:83], v234 offset:34816
v_fma_f32 v195, v195, v244, v252
v_mfma_f32_16x16x32_bf16 v[200:203], a[40:43], v[112:115], v[200:203]
ds_read_b64_tr_b16 a[84:85], v234 offset:36864
v_cvt_pk_bf16_f32 v225, v194, v195
v_mfma_f32_16x16x32_bf16 v[200:203], a[44:47], v[116:119], v[200:203]
ds_read_b64_tr_b16 a[86:87], v234 offset:38912
v_mfma_f32_16x16x32_bf16 v[196:199], a[44:47], v[68:71], v[228:231]
ds_read_b64_tr_b16 a[88:89], v234 offset:40960
v_mfma_f32_16x16x32_bf16 v[196:199], a[40:43], v[64:67], v[196:199]
ds_read_b64_tr_b16 a[90:91], v234 offset:43008
v_mfma_f32_16x16x32_bf16 v[196:199], a[36:39], v[60:63], v[196:199]
ds_read_b64_tr_b16 a[92:93], v234 offset:45056
v_mfma_f32_16x16x32_bf16 v[196:199], a[32:35], v[56:59], v[196:199]
ds_read_b64_tr_b16 a[94:95], v234 offset:47104
v_mfma_f32_16x16x32_bf16 v[196:199], a[28:31], v[52:55], v[196:199]
ds_read_b64_tr_b16 a[96:97], v234 offset:49152
v_mfma_f32_16x16x32_bf16 v[196:199], a[24:27], v[48:51], v[196:199]
ds_read_b64_tr_b16 a[98:99], v234 offset:51200
v_mfma_f32_16x16x32_bf16 v[192:195], a[24:27], v[0:3], v[228:231]
ds_read_b64_tr_b16 a[100:101], v234 offset:53248
v_mfma_f32_16x16x32_bf16 v[192:195], a[28:31], v[4:7], v[192:195]
buffer_store_dwordx4 a[236:239], v239, s[24:27], s52 offen offset:256 sc1
v_mfma_f32_16x16x32_bf16 v[192:195], a[32:35], v[8:11], v[192:195]
ds_read_b64_tr_b16 a[102:103], v234 offset:55296
v_mfma_f32_16x16x32_bf16 v[192:195], a[36:39], v[12:15], v[192:195]
ds_read_b64_tr_b16 a[104:105], v234 offset:57344
v_mfma_f32_16x16x32_bf16 v[192:195], a[40:43], v[16:19], v[192:195]
ds_read_b64_tr_b16 a[106:107], v234 offset:59392
v_mfma_f32_16x16x32_bf16 v[192:195], a[44:47], v[20:23], v[192:195]
ds_read_b64_tr_b16 a[108:109], v234 offset:61440
s_waitcnt lgkmcnt(15)
v_mfma_f32_16x16x32_bf16 v[192:195], a[68:71], v[44:47], v[192:195]
ds_read_b64_tr_b16 a[110:111], v234 offset:63488
v_mfma_f32_16x16x32_bf16 v[192:195], a[64:67], v[40:43], v[192:195]
ds_read_b64_tr_b16 a[112:113], v235 offset:8192
v_mfma_f32_16x16x32_bf16 v[192:195], a[60:63], v[36:39], v[192:195]
ds_read_b64_tr_b16 a[114:115], v235 offset:10240
v_mfma_f32_16x16x32_bf16 v[192:195], a[56:59], v[32:35], v[192:195]
ds_read_b64_tr_b16 a[116:117], v235 offset:12288
v_mfma_f32_16x16x32_bf16 v[192:195], a[52:55], v[28:31], v[192:195]
ds_read_b64_tr_b16 a[118:119], v235 offset:14336
v_xor_b32 v234, 32, v234
v_mfma_f32_16x16x32_bf16 v[192:195], a[48:51], v[24:27], v[192:195]
buffer_store_dwordx4 a[240:243], v239, s[24:27], s53 offen offset:256 sc1
v_mfma_f32_16x16x32_bf16 v[196:199], a[48:51], v[72:75], v[196:199]
ds_write_b64 v240, v[224:225] offset:0
v_mfma_f32_16x16x32_bf16 v[196:199], a[52:55], v[76:79], v[196:199]
ds_write_b64 v240, v[226:227] offset:8192
v_mfma_f32_16x16x32_bf16 v[196:199], a[56:59], v[80:83], v[196:199]
v_xor_b32 v235, 32, v235
v_mfma_f32_16x16x32_bf16 v[196:199], a[60:63], v[84:87], v[196:199]
ds_read_b64_tr_b16 a[152:153], v234 offset:24576
v_mfma_f32_16x16x32_bf16 v[196:199], a[64:67], v[88:91], v[196:199]
ds_read_b64_tr_b16 a[154:155], v234 offset:26624
v_fma_f32 v192, v192, v244, v252
v_mfma_f32_16x16x32_bf16 v[196:199], a[68:71], v[92:95], v[196:199]
ds_read_b64_tr_b16 a[156:157], v234 offset:28672
v_fma_f32 v193, v193, v244, v252
v_mfma_f32_16x16x32_bf16 v[200:203], a[68:71], v[140:143], v[200:203]
ds_read_b64_tr_b16 a[158:159], v234 offset:30720
v_cvt_pk_bf16_f32 v192, v192, v193
v_mfma_f32_16x16x32_bf16 v[200:203], a[64:67], v[136:139], v[200:203]
ds_read_b64_tr_b16 a[160:161], v234 offset:32768
v_fma_f32 v194, v194, v244, v252
v_mfma_f32_16x16x32_bf16 v[200:203], a[60:63], v[132:135], v[200:203]
ds_read_b64_tr_b16 a[162:163], v234 offset:34816
v_fma_f32 v195, v195, v244, v252
v_mfma_f32_16x16x32_bf16 v[200:203], a[56:59], v[128:131], v[200:203]
ds_read_b64_tr_b16 a[164:165], v234 offset:36864
v_cvt_pk_bf16_f32 v193, v194, v195
v_mfma_f32_16x16x32_bf16 v[200:203], a[52:55], v[124:127], v[200:203]
ds_read_b64_tr_b16 a[166:167], v234 offset:38912
v_fma_f32 v196, v196, v245, v253
v_mfma_f32_16x16x32_bf16 v[200:203], a[48:51], v[120:123], v[200:203]
ds_read_b64_tr_b16 a[168:169], v234 offset:40960
v_fma_f32 v197, v197, v245, v253
v_mfma_f32_16x16x32_bf16 v[204:207], a[48:51], v[168:171], v[204:207]
ds_read_b64_tr_b16 a[170:171], v234 offset:43008
v_cvt_pk_bf16_f32 v196, v196, v197
v_mfma_f32_16x16x32_bf16 v[204:207], a[52:55], v[172:175], v[204:207]
ds_read_b64_tr_b16 a[172:173], v234 offset:45056
v_fma_f32 v198, v198, v245, v253
v_mfma_f32_16x16x32_bf16 v[204:207], a[56:59], v[176:179], v[204:207]
ds_read_b64_tr_b16 a[174:175], v234 offset:47104
v_fma_f32 v199, v199, v245, v253
v_mfma_f32_16x16x32_bf16 v[204:207], a[60:63], v[180:183], v[204:207]
ds_write_b64 v241, v[192:193] offset:0
v_mfma_f32_16x16x32_bf16 v[204:207], a[64:67], v[184:187], v[204:207]
ds_read_b64_tr_b16 a[128:129], v234 offset:49152
v_cvt_pk_bf16_f32 v197, v198, v199
v_mfma_f32_16x16x32_bf16 v[204:207], a[68:71], v[188:191], v[204:207]
ds_read_b64_tr_b16 a[130:131], v234 offset:51200
s_waitcnt lgkmcnt(15)
v_mfma_f32_16x16x32_bf16 v[192:195], a[72:75], v[0:3], v[228:231]
ds_read_b64_tr_b16 a[132:133], v234 offset:53248
v_fma_f32 v200, v200, v246, v254
v_mfma_f32_16x16x32_bf16 v[192:195], a[76:79], v[4:7], v[192:195]
ds_read_b64_tr_b16 a[134:135], v234 offset:55296
v_fma_f32 v201, v201, v246, v254
v_mfma_f32_16x16x32_bf16 v[192:195], a[80:83], v[8:11], v[192:195]
ds_read_b64_tr_b16 a[136:137], v234 offset:57344
v_cvt_pk_bf16_f32 v210, v200, v201
v_mfma_f32_16x16x32_bf16 v[192:195], a[84:87], v[12:15], v[192:195]
ds_read_b64_tr_b16 a[138:139], v234 offset:59392
v_fma_f32 v202, v202, v246, v254
v_mfma_f32_16x16x32_bf16 v[192:195], a[88:91], v[16:19], v[192:195]
ds_write_b64 v241, v[196:197] offset:8192
v_mfma_f32_16x16x32_bf16 v[192:195], a[92:95], v[20:23], v[192:195]
ds_read_b64_tr_b16 a[140:141], v234 offset:61440
s_waitcnt lgkmcnt(15)
v_mfma_f32_16x16x32_bf16 v[192:195], a[96:99], v[24:27], v[192:195]
ds_read_b64_tr_b16 a[142:143], v234 offset:63488
v_fma_f32 v203, v203, v246, v254
v_mfma_f32_16x16x32_bf16 v[192:195], a[100:103], v[28:31], v[192:195]
ds_read_b64_tr_b16 a[144:145], v235 offset:8192
v_cvt_pk_bf16_f32 v211, v202, v203
v_mfma_f32_16x16x32_bf16 v[192:195], a[104:107], v[32:35], v[192:195]
ds_read_b64_tr_b16 a[146:147], v235 offset:10240
v_fma_f32 v204, v204, v247, v255
v_mfma_f32_16x16x32_bf16 v[192:195], a[108:111], v[36:39], v[192:195]
ds_read_b64_tr_b16 a[148:149], v235 offset:12288
v_fma_f32 v205, v205, v247, v255
v_mfma_f32_16x16x32_bf16 v[192:195], a[112:115], v[40:43], v[192:195]
buffer_store_dwordx4 a[244:247], v239, s[24:27], s54 offen offset:256 sc1
v_mfma_f32_16x16x32_bf16 v[192:195], a[116:119], v[44:47], v[192:195]
ds_read_b64_tr_b16 a[150:151], v235 offset:14336
s_waitcnt lgkmcnt(14)
v_mfma_f32_16x16x32_bf16 v[196:199], a[152:155], v[0:3], v[228:231]
buffer_store_dwordx4 a[248:251], v239, s[24:27], s55 offen offset:256 sc1
v_mfma_f32_16x16x32_bf16 v[196:199], a[156:159], v[4:7], v[196:199]
ds_write_b64 v241, v[210:211] offset:16384
v_mfma_f32_16x16x32_bf16 v[196:199], a[160:163], v[8:11], v[196:199]
v_cvt_pk_bf16_f32 v218, v204, v205
v_fma_f32 v206, v206, v247, v255
v_mfma_f32_16x16x32_bf16 v[196:199], a[164:167], v[12:15], v[196:199]
v_fma_f32 v207, v207, v247, v255
v_cvt_pk_bf16_f32 v219, v206, v207
v_mfma_f32_16x16x32_bf16 v[196:199], a[168:171], v[16:19], v[196:199]
ds_write_b64 v241, v[218:219] offset:24576
v_mfma_f32_16x16x32_bf16 v[196:199], a[172:175], v[20:23], v[196:199]
s_waitcnt lgkmcnt(2)
v_fma_f32 v192, v192, v244, v252
v_fma_f32 v193, v193, v244, v252
v_mfma_f32_16x16x32_bf16 v[196:199], a[128:131], v[24:27], v[196:199]
v_cvt_pk_bf16_f32 v192, v192, v193
v_fma_f32 v194, v194, v244, v252
v_mfma_f32_16x16x32_bf16 v[196:199], a[132:135], v[28:31], v[196:199]
v_fma_f32 v195, v195, v244, v252
v_cvt_pk_bf16_f32 v193, v194, v195
v_mfma_f32_16x16x32_bf16 v[196:199], a[136:139], v[32:35], v[196:199]
ds_write_b64 v242, v[192:193] offset:0
v_mfma_f32_16x16x32_bf16 v[196:199], a[140:143], v[36:39], v[196:199]
v_mfma_f32_16x16x32_bf16 v[196:199], a[144:147], v[40:43], v[196:199]
v_mfma_f32_16x16x32_bf16 v[196:199], a[148:151], v[44:47], v[196:199]
v_mfma_f32_16x16x32_bf16 v[200:203], a[72:75], v[48:51], v[228:231]
v_mfma_f32_16x16x32_bf16 v[200:203], a[76:79], v[52:55], v[200:203]
v_mfma_f32_16x16x32_bf16 v[200:203], a[80:83], v[56:59], v[200:203]
v_mfma_f32_16x16x32_bf16 v[200:203], a[84:87], v[60:63], v[200:203]
v_mfma_f32_16x16x32_bf16 v[200:203], a[88:91], v[64:67], v[200:203]
s_nop 2
v_fma_f32 v196, v196, v244, v252
v_fma_f32 v197, v197, v244, v252
v_mfma_f32_16x16x32_bf16 v[200:203], a[92:95], v[68:71], v[200:203]
v_cvt_pk_bf16_f32 v196, v196, v197
v_fma_f32 v198, v198, v244, v252
v_mfma_f32_16x16x32_bf16 v[200:203], a[96:99], v[72:75], v[200:203]
v_fma_f32 v199, v199, v244, v252
v_cvt_pk_bf16_f32 v197, v198, v199
v_mfma_f32_16x16x32_bf16 v[200:203], a[100:103], v[76:79], v[200:203]
ds_write_b64 v243, v[196:197] offset:0
v_mfma_f32_16x16x32_bf16 v[200:203], a[104:107], v[80:83], v[200:203]
ds_read_b128 a[176:179], v248 offset:0
v_mfma_f32_16x16x32_bf16 v[200:203], a[108:111], v[84:87], v[200:203]
ds_read_b128 a[180:183], v248 offset:4096
v_mfma_f32_16x16x32_bf16 v[200:203], a[112:115], v[88:91], v[200:203]
v_mfma_f32_16x16x32_bf16 v[200:203], a[116:119], v[92:95], v[200:203]
v_mfma_f32_16x16x32_bf16 v[204:207], a[152:155], v[48:51], v[228:231]
v_mfma_f32_16x16x32_bf16 v[204:207], a[156:159], v[52:55], v[204:207]
v_mfma_f32_16x16x32_bf16 v[204:207], a[160:163], v[56:59], v[204:207]
v_mfma_f32_16x16x32_bf16 v[204:207], a[164:167], v[60:63], v[204:207]
s_waitcnt lgkmcnt(0)
v_mfma_f32_16x16x32_bf16 v[204:207], a[168:171], v[64:67], v[204:207]
buffer_store_dwordx4 a[176:179], v239, s[24:27], s48 offen offset:384 nt
v_mfma_f32_16x16x32_bf16 v[204:207], a[172:175], v[68:71], v[204:207]
buffer_store_dwordx4 a[180:183], v239, s[24:27], s49 offen offset:384 nt
v_mfma_f32_16x16x32_bf16 v[204:207], a[128:131], v[72:75], v[204:207]
v_fma_f32 v200, v200, v245, v253
v_fma_f32 v201, v201, v245, v253
v_mfma_f32_16x16x32_bf16 v[204:207], a[132:135], v[76:79], v[204:207]
v_cvt_pk_bf16_f32 v200, v200, v201
v_fma_f32 v202, v202, v245, v253
v_mfma_f32_16x16x32_bf16 v[204:207], a[136:139], v[80:83], v[204:207]
v_fma_f32 v203, v203, v245, v253
v_cvt_pk_bf16_f32 v201, v202, v203
v_mfma_f32_16x16x32_bf16 v[204:207], a[140:143], v[84:87], v[204:207]
ds_write_b64 v242, v[200:201] offset:8192
v_mfma_f32_16x16x32_bf16 v[204:207], a[144:147], v[88:91], v[204:207]
v_mfma_f32_16x16x32_bf16 v[204:207], a[148:151], v[92:95], v[204:207]
v_mfma_f32_16x16x32_bf16 v[192:195], a[72:75], v[96:99], v[228:231]
v_mfma_f32_16x16x32_bf16 v[192:195], a[76:79], v[100:103], v[192:195]
v_mfma_f32_16x16x32_bf16 v[192:195], a[80:83], v[104:107], v[192:195]
v_mfma_f32_16x16x32_bf16 v[192:195], a[84:87], v[108:111], v[192:195]
v_mfma_f32_16x16x32_bf16 v[192:195], a[88:91], v[112:115], v[192:195]
s_nop 2
v_fma_f32 v204, v204, v245, v253
v_fma_f32 v205, v205, v245, v253
v_mfma_f32_16x16x32_bf16 v[192:195], a[92:95], v[116:119], v[192:195]
v_cvt_pk_bf16_f32 v204, v204, v205
v_fma_f32 v206, v206, v245, v253
v_mfma_f32_16x16x32_bf16 v[192:195], a[96:99], v[120:123], v[192:195]
v_fma_f32 v207, v207, v245, v253
v_cvt_pk_bf16_f32 v205, v206, v207
v_mfma_f32_16x16x32_bf16 v[192:195], a[100:103], v[124:127], v[192:195]
ds_write_b64 v243, v[204:205] offset:8192
v_mfma_f32_16x16x32_bf16 v[192:195], a[104:107], v[128:131], v[192:195]
ds_read_b128 a[184:187], v248 offset:8192
v_mfma_f32_16x16x32_bf16 v[192:195], a[108:111], v[132:135], v[192:195]
ds_read_b128 a[188:191], v248 offset:12288
v_mfma_f32_16x16x32_bf16 v[192:195], a[112:115], v[136:139], v[192:195]
v_mfma_f32_16x16x32_bf16 v[192:195], a[116:119], v[140:143], v[192:195]
v_mfma_f32_16x16x32_bf16 v[196:199], a[152:155], v[96:99], v[228:231]
v_mfma_f32_16x16x32_bf16 v[196:199], a[156:159], v[100:103], v[196:199]
v_mfma_f32_16x16x32_bf16 v[196:199], a[160:163], v[104:107], v[196:199]
v_mfma_f32_16x16x32_bf16 v[196:199], a[164:167], v[108:111], v[196:199]
s_waitcnt lgkmcnt(0)
v_mfma_f32_16x16x32_bf16 v[196:199], a[168:171], v[112:115], v[196:199]
buffer_store_dwordx4 a[184:187], v239, s[24:27], s50 offen offset:384 nt
v_mfma_f32_16x16x32_bf16 v[196:199], a[172:175], v[116:119], v[196:199]
buffer_store_dwordx4 a[188:191], v239, s[24:27], s51 offen offset:384 nt
v_mfma_f32_16x16x32_bf16 v[196:199], a[128:131], v[120:123], v[196:199]
v_fma_f32 v192, v192, v246, v254
v_fma_f32 v193, v193, v246, v254
v_mfma_f32_16x16x32_bf16 v[196:199], a[132:135], v[124:127], v[196:199]
v_cvt_pk_bf16_f32 v192, v192, v193
v_fma_f32 v194, v194, v246, v254
v_mfma_f32_16x16x32_bf16 v[196:199], a[136:139], v[128:131], v[196:199]
v_fma_f32 v195, v195, v246, v254
v_cvt_pk_bf16_f32 v193, v194, v195
v_mfma_f32_16x16x32_bf16 v[196:199], a[140:143], v[132:135], v[196:199]
ds_write_b64 v242, v[192:193] offset:16384
v_mfma_f32_16x16x32_bf16 v[196:199], a[144:147], v[136:139], v[196:199]
v_mfma_f32_16x16x32_bf16 v[196:199], a[148:151], v[140:143], v[196:199]
v_mfma_f32_16x16x32_bf16 v[200:203], a[72:75], v[144:147], v[228:231]
v_mfma_f32_16x16x32_bf16 v[200:203], a[76:79], v[148:151], v[200:203]
v_mfma_f32_16x16x32_bf16 v[200:203], a[80:83], v[152:155], v[200:203]
v_mfma_f32_16x16x32_bf16 v[200:203], a[84:87], v[156:159], v[200:203]
v_mfma_f32_16x16x32_bf16 v[200:203], a[88:91], v[160:163], v[200:203]
s_nop 2
v_fma_f32 v196, v196, v246, v254
v_fma_f32 v197, v197, v246, v254
v_mfma_f32_16x16x32_bf16 v[200:203], a[92:95], v[164:167], v[200:203]
v_cvt_pk_bf16_f32 v196, v196, v197
v_fma_f32 v198, v198, v246, v254
v_mfma_f32_16x16x32_bf16 v[200:203], a[96:99], v[168:171], v[200:203]
v_fma_f32 v199, v199, v246, v254
v_cvt_pk_bf16_f32 v197, v198, v199
v_mfma_f32_16x16x32_bf16 v[200:203], a[100:103], v[172:175], v[200:203]
ds_write_b64 v243, v[196:197] offset:16384
v_mfma_f32_16x16x32_bf16 v[200:203], a[104:107], v[176:179], v[200:203]
ds_read_b128 a[192:195], v248 offset:16384
v_mfma_f32_16x16x32_bf16 v[200:203], a[108:111], v[180:183], v[200:203]
ds_read_b128 a[196:199], v248 offset:20480
v_mfma_f32_16x16x32_bf16 v[200:203], a[112:115], v[184:187], v[200:203]
v_mfma_f32_16x16x32_bf16 v[200:203], a[116:119], v[188:191], v[200:203]
v_mfma_f32_16x16x32_bf16 v[204:207], a[152:155], v[144:147], v[228:231]
v_mfma_f32_16x16x32_bf16 v[204:207], a[156:159], v[148:151], v[204:207]
v_mfma_f32_16x16x32_bf16 v[204:207], a[160:163], v[152:155], v[204:207]
v_mfma_f32_16x16x32_bf16 v[204:207], a[164:167], v[156:159], v[204:207]
s_waitcnt lgkmcnt(0)
v_mfma_f32_16x16x32_bf16 v[204:207], a[168:171], v[160:163], v[204:207]
buffer_store_dwordx4 a[192:195], v239, s[24:27], s52 offen offset:384 nt
v_mfma_f32_16x16x32_bf16 v[204:207], a[172:175], v[164:167], v[204:207]
buffer_store_dwordx4 a[196:199], v239, s[24:27], s53 offen offset:384 nt
v_mfma_f32_16x16x32_bf16 v[204:207], a[128:131], v[168:171], v[204:207]
v_fma_f32 v200, v200, v247, v255
v_fma_f32 v201, v201, v247, v255
v_mfma_f32_16x16x32_bf16 v[204:207], a[132:135], v[172:175], v[204:207]
v_cvt_pk_bf16_f32 v200, v200, v201
v_fma_f32 v202, v202, v247, v255
v_mfma_f32_16x16x32_bf16 v[204:207], a[136:139], v[176:179], v[204:207]
v_fma_f32 v203, v203, v247, v255
v_cvt_pk_bf16_f32 v201, v202, v203
v_mfma_f32_16x16x32_bf16 v[204:207], a[140:143], v[180:183], v[204:207]
ds_write_b64 v242, v[200:201] offset:24576
v_mfma_f32_16x16x32_bf16 v[204:207], a[144:147], v[184:187], v[204:207]
v_mfma_f32_16x16x32_bf16 v[204:207], a[148:151], v[188:191], v[204:207]
s_nop 7
v_fma_f32 v204, v204, v247, v255
v_fma_f32 v205, v205, v247, v255
v_cvt_pk_bf16_f32 v204, v204, v205
v_fma_f32 v206, v206, v247, v255
v_fma_f32 v207, v207, v247, v255
v_cvt_pk_bf16_f32 v205, v206, v207
ds_write_b64 v243, v[204:205] offset:24576
ds_read_b128 a[200:203], v248 offset:24576
ds_read_b128 a[204:207], v248 offset:28672
s_waitcnt lgkmcnt(0)
buffer_store_dwordx4 a[200:203], v239, s[24:27], s54 offen offset:384 nt
buffer_store_dwordx4 a[204:207], v239, s[24:27], s55 offen offset:384 nt
L_end:
s_endpgm
L_fb0:
s_mov_b32 s33, 0
s_add_u32 s28, s6, s35
s_addc_u32 s29, s7, 0
s_branch L_fb
L_fb1:
s_mov_b32 s33, 1
s_add_u32 s28, s6, s36
s_addc_u32 s29, s7, 0
s_branch L_fb
L_fb2:
s_mov_b32 s33, 2
s_add_u32 s28, s6, s37
s_addc_u32 s29, s7, 0
L_fb:
s_waitcnt vmcnt(0) lgkmcnt(0)
s_nop 15
v_mbcnt_lo_u32_b32 v228, -1, 0
v_mbcnt_hi_u32_b32 v228, -1, v228
v_and_b32 v229, 15, v228
v_lshrrev_b32 v228, 4, v228
v_lshlrev_b32 v228, 4, v228
v_lshl_add_u32 v230, v229, 9, v228
v_mov_b32 v244, 0xff800000
v_mov_b32 v245, 0xff800000
v_mov_b32 v246, 0xff800000
v_mov_b32 v247, 0xff800000
s_mov_b32 s74, 0
L_fba:
buffer_load_dwordx4 v[208:211], v230, s[28:31], s74 offen offset:0
buffer_load_dwordx4 v[212:215], v230, s[28:31], s74 offen offset:64
buffer_load_dwordx4 v[216:219], v230, s[28:31], s74 offen offset:128
buffer_load_dwordx4 v[220:223], v230, s[28:31], s74 offen offset:192
s_waitcnt vmcnt(0)
v_mfma_f32_16x16x32_bf16 v[192:195], v[208:211], a[0:3], 0
v_mfma_f32_16x16x32_bf16 v[192:195], v[212:215], a[4:7], v[192:195]
v_mfma_f32_16x16x32_bf16 v[192:195], v[216:219], a[8:11], v[192:195]
v_mfma_f32_16x16x32_bf16 v[192:195], v[220:223], a[12:15], v[192:195]
v_mfma_f32_16x16x32_bf16 v[196:199], v[208:211], a[32:35], 0
v_mfma_f32_16x16x32_bf16 v[196:199], v[212:215], a[36:39], v[196:199]
v_mfma_f32_16x16x32_bf16 v[196:199], v[216:219], a[40:43], v[196:199]
v_mfma_f32_16x16x32_bf16 v[196:199], v[220:223], a[44:47], v[196:199]
v_mfma_f32_16x16x32_bf16 v[200:203], v[208:211], a[64:67], 0
v_mfma_f32_16x16x32_bf16 v[200:203], v[212:215], a[68:71], v[200:203]
v_mfma_f32_16x16x32_bf16 v[200:203], v[216:219], a[72:75], v[200:203]
v_mfma_f32_16x16x32_bf16 v[200:203], v[220:223], a[76:79], v[200:203]
v_mfma_f32_16x16x32_bf16 v[204:207], v[208:211], a[96:99], 0
v_mfma_f32_16x16x32_bf16 v[204:207], v[212:215], a[100:103], v[204:207]
v_mfma_f32_16x16x32_bf16 v[204:207], v[216:219], a[104:107], v[204:207]
v_mfma_f32_16x16x32_bf16 v[204:207], v[220:223], a[108:111], v[204:207]
s_nop 15
buffer_load_dwordx4 v[208:211], v230, s[28:31], s74 offen offset:256
buffer_load_dwordx4 v[212:215], v230, s[28:31], s74 offen offset:320
buffer_load_dwordx4 v[216:219], v230, s[28:31], s74 offen offset:384
buffer_load_dwordx4 v[220:223], v230, s[28:31], s74 offen offset:448
s_waitcnt vmcnt(0)
v_mfma_f32_16x16x32_bf16 v[192:195], v[208:211], a[16:19], v[192:195]
v_mfma_f32_16x16x32_bf16 v[192:195], v[212:215], a[20:23], v[192:195]
v_mfma_f32_16x16x32_bf16 v[192:195], v[216:219], a[24:27], v[192:195]
v_mfma_f32_16x16x32_bf16 v[192:195], v[220:223], a[28:31], v[192:195]
v_mfma_f32_16x16x32_bf16 v[196:199], v[208:211], a[48:51], v[196:199]
v_mfma_f32_16x16x32_bf16 v[196:199], v[212:215], a[52:55], v[196:199]
v_mfma_f32_16x16x32_bf16 v[196:199], v[216:219], a[56:59], v[196:199]
v_mfma_f32_16x16x32_bf16 v[196:199], v[220:223], a[60:63], v[196:199]
v_mfma_f32_16x16x32_bf16 v[200:203], v[208:211], a[80:83], v[200:203]
v_mfma_f32_16x16x32_bf16 v[200:203], v[212:215], a[84:87], v[200:203]
v_mfma_f32_16x16x32_bf16 v[200:203], v[216:219], a[88:91], v[200:203]
v_mfma_f32_16x16x32_bf16 v[200:203], v[220:223], a[92:95], v[200:203]
v_mfma_f32_16x16x32_bf16 v[204:207], v[208:211], a[112:115], v[204:207]
v_mfma_f32_16x16x32_bf16 v[204:207], v[212:215], a[116:119], v[204:207]
v_mfma_f32_16x16x32_bf16 v[204:207], v[216:219], a[120:123], v[204:207]
v_mfma_f32_16x16x32_bf16 v[204:207], v[220:223], a[124:127], v[204:207]
s_nop 15
v_max3_f32 v244, v244, v192, v193
v_max3_f32 v244, v244, v194, v195
v_max3_f32 v245, v245, v196, v197
v_max3_f32 v245, v245, v198, v199
v_max3_f32 v246, v246, v200, v201
v_max3_f32 v246, v246, v202, v203
v_max3_f32 v247, v247, v204, v205
v_max3_f32 v247, v247, v206, v207
s_add_u32 s74, s74, 8192
s_cmp_lt_u32 s74, 196608
s_cbranch_scc1 L_fba
v_mov_b32 v228, v244
s_nop 1
v_permlane32_swap_b32 v244, v228
v_max_f32 v244, v244, v228
v_mov_b32 v228, v244
s_nop 1
v_permlane16_swap_b32 v244, v228
v_max_f32 v244, v244, v228
v_mov_b32 v228, v245
s_nop 1
v_permlane32_swap_b32 v245, v228
v_max_f32 v245, v245, v228
v_mov_b32 v228, v245
s_nop 1
v_permlane16_swap_b32 v245, v228
v_max_f32 v245, v245, v228
v_mov_b32 v228, v246
s_nop 1
v_permlane32_swap_b32 v246, v228
v_max_f32 v246, v246, v228
v_mov_b32 v228, v246
s_nop 1
v_permlane16_swap_b32 v246, v228
v_max_f32 v246, v246, v228
v_mov_b32 v228, v247
s_nop 1
v_permlane32_swap_b32 v247, v228
v_max_f32 v247, v247, v228
v_mov_b32 v228, v247
s_nop 1
v_permlane16_swap_b32 v247, v228
v_max_f32 v247, v247, v228
s_mov_b32 s74, 0
L_fbb:
buffer_load_dwordx4 v[208:211], v230, s[28:31], s74 offen offset:0
buffer_load_dwordx4 v[212:215], v230, s[28:31], s74 offen offset:64
buffer_load_dwordx4 v[216:219], v230, s[28:31], s74 offen offset:128
buffer_load_dwordx4 v[220:223], v230, s[28:31], s74 offen offset:192
s_waitcnt vmcnt(0)
v_mfma_f32_16x16x32_bf16 v[192:195], v[208:211], a[0:3], 0
v_mfma_f32_16x16x32_bf16 v[192:195], v[212:215], a[4:7], v[192:195]
v_mfma_f32_16x16x32_bf16 v[192:195], v[216:219], a[8:11], v[192:195]
v_mfma_f32_16x16x32_bf16 v[192:195], v[220:223], a[12:15], v[192:195]
v_mfma_f32_16x16x32_bf16 v[196:199], v[208:211], a[32:35], 0
v_mfma_f32_16x16x32_bf16 v[196:199], v[212:215], a[36:39], v[196:199]
v_mfma_f32_16x16x32_bf16 v[196:199], v[216:219], a[40:43], v[196:199]
v_mfma_f32_16x16x32_bf16 v[196:199], v[220:223], a[44:47], v[196:199]
v_mfma_f32_16x16x32_bf16 v[200:203], v[208:211], a[64:67], 0
v_mfma_f32_16x16x32_bf16 v[200:203], v[212:215], a[68:71], v[200:203]
v_mfma_f32_16x16x32_bf16 v[200:203], v[216:219], a[72:75], v[200:203]
v_mfma_f32_16x16x32_bf16 v[200:203], v[220:223], a[76:79], v[200:203]
v_mfma_f32_16x16x32_bf16 v[204:207], v[208:211], a[96:99], 0
v_mfma_f32_16x16x32_bf16 v[204:207], v[212:215], a[100:103], v[204:207]
v_mfma_f32_16x16x32_bf16 v[204:207], v[216:219], a[104:107], v[204:207]
v_mfma_f32_16x16x32_bf16 v[204:207], v[220:223], a[108:111], v[204:207]
s_nop 15
buffer_load_dwordx4 v[208:211], v230, s[28:31], s74 offen offset:256
buffer_load_dwordx4 v[212:215], v230, s[28:31], s74 offen offset:320
buffer_load_dwordx4 v[216:219], v230, s[28:31], s74 offen offset:384
buffer_load_dwordx4 v[220:223], v230, s[28:31], s74 offen offset:448
s_waitcnt vmcnt(0)
v_mfma_f32_16x16x32_bf16 v[192:195], v[208:211], a[16:19], v[192:195]
v_mfma_f32_16x16x32_bf16 v[192:195], v[212:215], a[20:23], v[192:195]
v_mfma_f32_16x16x32_bf16 v[192:195], v[216:219], a[24:27], v[192:195]
v_mfma_f32_16x16x32_bf16 v[192:195], v[220:223], a[28:31], v[192:195]
v_mfma_f32_16x16x32_bf16 v[196:199], v[208:211], a[48:51], v[196:199]
v_mfma_f32_16x16x32_bf16 v[196:199], v[212:215], a[52:55], v[196:199]
v_mfma_f32_16x16x32_bf16 v[196:199], v[216:219], a[56:59], v[196:199]
v_mfma_f32_16x16x32_bf16 v[196:199], v[220:223], a[60:63], v[196:199]
v_mfma_f32_16x16x32_bf16 v[200:203], v[208:211], a[80:83], v[200:203]
v_mfma_f32_16x16x32_bf16 v[200:203], v[212:215], a[84:87], v[200:203]
v_mfma_f32_16x16x32_bf16 v[200:203], v[216:219], a[88:91], v[200:203]
v_mfma_f32_16x16x32_bf16 v[200:203], v[220:223], a[92:95], v[200:203]
v_mfma_f32_16x16x32_bf16 v[204:207], v[208:211], a[112:115], v[204:207]
v_mfma_f32_16x16x32_bf16 v[204:207], v[212:215], a[116:119], v[204:207]
v_mfma_f32_16x16x32_bf16 v[204:207], v[216:219], a[120:123], v[204:207]
v_mfma_f32_16x16x32_bf16 v[204:207], v[220:223], a[124:127], v[204:207]
s_nop 15
v_sub_f32 v192, v192, v244
v_sub_f32 v193, v193, v244
v_sub_f32 v194, v194, v244
v_sub_f32 v195, v195, v244
v_mul_f32 v192, s41, v192
v_mul_f32 v193, s41, v193
v_mul_f32 v194, s41, v194
v_mul_f32 v195, s41, v195
v_exp_f32 v192, v192
v_exp_f32 v193, v193
v_exp_f32 v194, v194
v_exp_f32 v195, v195
v_mov_b32 v0, v2
v_mov_b32 v1, v3
v_mov_b32 v2, v4
v_mov_b32 v3, v5
v_mov_b32 v4, v6
v_mov_b32 v5, v7
v_mov_b32 v6, v8
v_mov_b32 v7, v9
v_mov_b32 v8, v10
v_mov_b32 v9, v11
v_mov_b32 v10, v12
v_mov_b32 v11, v13
v_mov_b32 v12, v14
v_mov_b32 v13, v15
v_mov_b32 v14, v16
v_mov_b32 v15, v17
v_mov_b32 v16, v18
v_mov_b32 v17, v19
v_mov_b32 v18, v20
v_mov_b32 v19, v21
v_mov_b32 v20, v22
v_mov_b32 v21, v23
v_mov_b32 v22, v24
v_mov_b32 v23, v25
v_mov_b32 v24, v26
v_mov_b32 v25, v27
v_mov_b32 v26, v28
v_mov_b32 v27, v29
v_mov_b32 v28, v30
v_mov_b32 v29, v31
v_mov_b32 v30, v32
v_mov_b32 v31, v33
v_mov_b32 v32, v34
v_mov_b32 v33, v35
v_mov_b32 v34, v36
v_mov_b32 v35, v37
v_mov_b32 v36, v38
v_mov_b32 v37, v39
v_mov_b32 v38, v40
v_mov_b32 v39, v41
v_mov_b32 v40, v42
v_mov_b32 v41, v43
v_mov_b32 v42, v44
v_mov_b32 v43, v45
v_mov_b32 v44, v46
v_mov_b32 v45, v47
v_cvt_pk_bf16_f32 v46, v192, v193
v_cvt_pk_bf16_f32 v47, v194, v195
v_sub_f32 v196, v196, v245
v_sub_f32 v197, v197, v245
v_sub_f32 v198, v198, v245
v_sub_f32 v199, v199, v245
v_mul_f32 v196, s41, v196
v_mul_f32 v197, s41, v197
v_mul_f32 v198, s41, v198
v_mul_f32 v199, s41, v199
v_exp_f32 v196, v196
v_exp_f32 v197, v197
v_exp_f32 v198, v198
v_exp_f32 v199, v199
v_mov_b32 v48, v50
v_mov_b32 v49, v51
v_mov_b32 v50, v52
v_mov_b32 v51, v53
v_mov_b32 v52, v54
v_mov_b32 v53, v55
v_mov_b32 v54, v56
v_mov_b32 v55, v57
v_mov_b32 v56, v58
v_mov_b32 v57, v59
v_mov_b32 v58, v60
v_mov_b32 v59, v61
v_mov_b32 v60, v62
v_mov_b32 v61, v63
v_mov_b32 v62, v64
v_mov_b32 v63, v65
v_mov_b32 v64, v66
v_mov_b32 v65, v67
v_mov_b32 v66, v68
v_mov_b32 v67, v69
v_mov_b32 v68, v70
v_mov_b32 v69, v71
v_mov_b32 v70, v72
v_mov_b32 v71, v73
v_mov_b32 v72, v74
v_mov_b32 v73, v75
v_mov_b32 v74, v76
v_mov_b32 v75, v77
v_mov_b32 v76, v78
v_mov_b32 v77, v79
v_mov_b32 v78, v80
v_mov_b32 v79, v81
v_mov_b32 v80, v82
v_mov_b32 v81, v83
v_mov_b32 v82, v84
v_mov_b32 v83, v85
v_mov_b32 v84, v86
v_mov_b32 v85, v87
v_mov_b32 v86, v88
v_mov_b32 v87, v89
v_mov_b32 v88, v90
v_mov_b32 v89, v91
v_mov_b32 v90, v92
v_mov_b32 v91, v93
v_mov_b32 v92, v94
v_mov_b32 v93, v95
v_cvt_pk_bf16_f32 v94, v196, v197
v_cvt_pk_bf16_f32 v95, v198, v199
v_sub_f32 v200, v200, v246
v_sub_f32 v201, v201, v246
v_sub_f32 v202, v202, v246
v_sub_f32 v203, v203, v246
v_mul_f32 v200, s41, v200
v_mul_f32 v201, s41, v201
v_mul_f32 v202, s41, v202
v_mul_f32 v203, s41, v203
v_exp_f32 v200, v200
v_exp_f32 v201, v201
v_exp_f32 v202, v202
v_exp_f32 v203, v203
v_mov_b32 v96, v98
v_mov_b32 v97, v99
v_mov_b32 v98, v100
v_mov_b32 v99, v101
v_mov_b32 v100, v102
v_mov_b32 v101, v103
v_mov_b32 v102, v104
v_mov_b32 v103, v105
v_mov_b32 v104, v106
v_mov_b32 v105, v107
v_mov_b32 v106, v108
v_mov_b32 v107, v109
v_mov_b32 v108, v110
v_mov_b32 v109, v111
v_mov_b32 v110, v112
v_mov_b32 v111, v113
v_mov_b32 v112, v114
v_mov_b32 v113, v115
v_mov_b32 v114, v116
v_mov_b32 v115, v117
v_mov_b32 v116, v118
v_mov_b32 v117, v119
v_mov_b32 v118, v120
v_mov_b32 v119, v121
v_mov_b32 v120, v122
v_mov_b32 v121, v123
v_mov_b32 v122, v124
v_mov_b32 v123, v125
v_mov_b32 v124, v126
v_mov_b32 v125, v127
v_mov_b32 v126, v128
v_mov_b32 v127, v129
v_mov_b32 v128, v130
v_mov_b32 v129, v131
v_mov_b32 v130, v132
v_mov_b32 v131, v133
v_mov_b32 v132, v134
v_mov_b32 v133, v135
v_mov_b32 v134, v136
v_mov_b32 v135, v137
v_mov_b32 v136, v138
v_mov_b32 v137, v139
v_mov_b32 v138, v140
v_mov_b32 v139, v141
v_mov_b32 v140, v142
v_mov_b32 v141, v143
v_cvt_pk_bf16_f32 v142, v200, v201
v_cvt_pk_bf16_f32 v143, v202, v203
v_sub_f32 v204, v204, v247
v_sub_f32 v205, v205, v247
v_sub_f32 v206, v206, v247
v_sub_f32 v207, v207, v247
v_mul_f32 v204, s41, v204
v_mul_f32 v205, s41, v205
v_mul_f32 v206, s41, v206
v_mul_f32 v207, s41, v207
v_exp_f32 v204, v204
v_exp_f32 v205, v205
v_exp_f32 v206, v206
v_exp_f32 v207, v207
v_mov_b32 v144, v146
v_mov_b32 v145, v147
v_mov_b32 v146, v148
v_mov_b32 v147, v149
v_mov_b32 v148, v150
v_mov_b32 v149, v151
v_mov_b32 v150, v152
v_mov_b32 v151, v153
v_mov_b32 v152, v154
v_mov_b32 v153, v155
v_mov_b32 v154, v156
v_mov_b32 v155, v157
v_mov_b32 v156, v158
v_mov_b32 v157, v159
v_mov_b32 v158, v160
v_mov_b32 v159, v161
v_mov_b32 v160, v162
v_mov_b32 v161, v163
v_mov_b32 v162, v164
v_mov_b32 v163, v165
v_mov_b32 v164, v166
v_mov_b32 v165, v167
v_mov_b32 v166, v168
v_mov_b32 v167, v169
v_mov_b32 v168, v170
v_mov_b32 v169, v171
v_mov_b32 v170, v172
v_mov_b32 v171, v173
v_mov_b32 v172, v174
v_mov_b32 v173, v175
v_mov_b32 v174, v176
v_mov_b32 v175, v177
v_mov_b32 v176, v178
v_mov_b32 v177, v179
v_mov_b32 v178, v180
v_mov_b32 v179, v181
v_mov_b32 v180, v182
v_mov_b32 v181, v183
v_mov_b32 v182, v184
v_mov_b32 v183, v185
v_mov_b32 v184, v186
v_mov_b32 v185, v187
v_mov_b32 v186, v188
v_mov_b32 v187, v189
v_mov_b32 v188, v190
v_mov_b32 v189, v191
v_cvt_pk_bf16_f32 v190, v204, v205
v_cvt_pk_bf16_f32 v191, v206, v207
s_add_u32 s74, s74, 8192
s_cmp_lt_u32 s74, 196608
s_cbranch_scc1 L_fbb
s_nop 3
v_mfma_f32_16x16x32_bf16 v[208:211], a[252:255], v[0:3], 0
v_mfma_f32_16x16x32_bf16 v[208:211], a[252:255], v[4:7], v[208:211]
v_mfma_f32_16x16x32_bf16 v[208:211], a[252:255], v[8:11], v[208:211]
v_mfma_f32_16x16x32_bf16 v[208:211], a[252:255], v[12:15], v[208:211]
v_mfma_f32_16x16x32_bf16 v[208:211], a[252:255], v[16:19], v[208:211]
v_mfma_f32_16x16x32_bf16 v[208:211], a[252:255], v[20:23], v[208:211]
v_mfma_f32_16x16x32_bf16 v[208:211], a[252:255], v[24:27], v[208:211]
v_mfma_f32_16x16x32_bf16 v[208:211], a[252:255], v[28:31], v[208:211]
v_mfma_f32_16x16x32_bf16 v[208:211], a[252:255], v[32:35], v[208:211]
v_mfma_f32_16x16x32_bf16 v[208:211], a[252:255], v[36:39], v[208:211]
v_mfma_f32_16x16x32_bf16 v[208:211], a[252:255], v[40:43], v[208:211]
v_mfma_f32_16x16x32_bf16 v[208:211], a[252:255], v[44:47], v[208:211]
s_nop 7
v_mfma_f32_16x16x32_bf16 v[210:213], a[252:255], v[48:51], 0
v_mfma_f32_16x16x32_bf16 v[210:213], a[252:255], v[52:55], v[210:213]
v_mfma_f32_16x16x32_bf16 v[210:213], a[252:255], v[56:59], v[210:213]
v_mfma_f32_16x16x32_bf16 v[210:213], a[252:255], v[60:63], v[210:213]
v_mfma_f32_16x16x32_bf16 v[210:213], a[252:255], v[64:67], v[210:213]
v_mfma_f32_16x16x32_bf16 v[210:213], a[252:255], v[68:71], v[210:213]
v_mfma_f32_16x16x32_bf16 v[210:213], a[252:255], v[72:75], v[210:213]
v_mfma_f32_16x16x32_bf16 v[210:213], a[252:255], v[76:79], v[210:213]
v_mfma_f32_16x16x32_bf16 v[210:213], a[252:255], v[80:83], v[210:213]
v_mfma_f32_16x16x32_bf16 v[210:213], a[252:255], v[84:87], v[210:213]
v_mfma_f32_16x16x32_bf16 v[210:213], a[252:255], v[88:91], v[210:213]
v_mfma_f32_16x16x32_bf16 v[210:213], a[252:255], v[92:95], v[210:213]
s_nop 7
v_mfma_f32_16x16x32_bf16 v[212:215], a[252:255], v[96:99], 0
v_mfma_f32_16x16x32_bf16 v[212:215], a[252:255], v[100:103], v[212:215]
v_mfma_f32_16x16x32_bf16 v[212:215], a[252:255], v[104:107], v[212:215]
v_mfma_f32_16x16x32_bf16 v[212:215], a[252:255], v[108:111], v[212:215]
v_mfma_f32_16x16x32_bf16 v[212:215], a[252:255], v[112:115], v[212:215]
v_mfma_f32_16x16x32_bf16 v[212:215], a[252:255], v[116:119], v[212:215]
v_mfma_f32_16x16x32_bf16 v[212:215], a[252:255], v[120:123], v[212:215]
v_mfma_f32_16x16x32_bf16 v[212:215], a[252:255], v[124:127], v[212:215]
v_mfma_f32_16x16x32_bf16 v[212:215], a[252:255], v[128:131], v[212:215]
v_mfma_f32_16x16x32_bf16 v[212:215], a[252:255], v[132:135], v[212:215]
v_mfma_f32_16x16x32_bf16 v[212:215], a[252:255], v[136:139], v[212:215]
v_mfma_f32_16x16x32_bf16 v[212:215], a[252:255], v[140:143], v[212:215]
s_nop 7
v_mfma_f32_16x16x32_bf16 v[214:217], a[252:255], v[144:147], 0
v_mfma_f32_16x16x32_bf16 v[214:217], a[252:255], v[148:151], v[214:217]
v_mfma_f32_16x16x32_bf16 v[214:217], a[252:255], v[152:155], v[214:217]
v_mfma_f32_16x16x32_bf16 v[214:217], a[252:255], v[156:159], v[214:217]
v_mfma_f32_16x16x32_bf16 v[214:217], a[252:255], v[160:163], v[214:217]
v_mfma_f32_16x16x32_bf16 v[214:217], a[252:255], v[164:167], v[214:217]
v_mfma_f32_16x16x32_bf16 v[214:217], a[252:255], v[168:171], v[214:217]
v_mfma_f32_16x16x32_bf16 v[214:217], a[252:255], v[172:175], v[214:217]
v_mfma_f32_16x16x32_bf16 v[214:217], a[252:255], v[176:179], v[214:217]
v_mfma_f32_16x16x32_bf16 v[214:217], a[252:255], v[180:183], v[214:217]
v_mfma_f32_16x16x32_bf16 v[214:217], a[252:255], v[184:187], v[214:217]
v_mfma_f32_16x16x32_bf16 v[214:217], a[252:255], v[188:191], v[214:217]
s_nop 7
v_mfma_f32_16x16x32_bf16 v[192:195], a[148:151], v[20:23], 0
v_mfma_f32_16x16x32_bf16 v[192:195], a[144:147], v[16:19], v[192:195]
v_mfma_f32_16x16x32_bf16 v[192:195], a[140:143], v[12:15], v[192:195]
v_mfma_f32_16x16x32_bf16 v[192:195], a[136:139], v[8:11], v[192:195]
v_mfma_f32_16x16x32_bf16 v[192:195], a[132:135], v[4:7], v[192:195]
v_mfma_f32_16x16x32_bf16 v[192:195], a[128:131], v[0:3], v[192:195]
v_mfma_f32_16x16x32_bf16 v[196:199], a[128:131], v[48:51], 0
v_mfma_f32_16x16x32_bf16 v[196:199], a[132:135], v[52:55], v[196:199]
v_mfma_f32_16x16x32_bf16 v[196:199], a[136:139], v[56:59], v[196:199]
v_mfma_f32_16x16x32_bf16 v[196:199], a[140:143], v[60:63], v[196:199]
v_mfma_f32_16x16x32_bf16 v[196:199], a[144:147], v[64:67], v[196:199]
v_mfma_f32_16x16x32_bf16 v[196:199], a[148:151], v[68:71], v[196:199]
v_mfma_f32_16x16x32_bf16 v[200:203], a[148:151], v[116:119], 0
v_mfma_f32_16x16x32_bf16 v[200:203], a[144:147], v[112:115], v[200:203]
v_mfma_f32_16x16x32_bf16 v[200:203], a[140:143], v[108:111], v[200:203]
v_mfma_f32_16x16x32_bf16 v[200:203], a[136:139], v[104:107], v[200:203]
v_mfma_f32_16x16x32_bf16 v[200:203], a[132:135], v[100:103], v[200:203]
v_mfma_f32_16x16x32_bf16 v[200:203], a[128:131], v[96:99], v[200:203]
v_mfma_f32_16x16x32_bf16 v[204:207], a[128:131], v[144:147], 0
v_mfma_f32_16x16x32_bf16 v[204:207], a[132:135], v[148:151], v[204:207]
v_mfma_f32_16x16x32_bf16 v[204:207], a[136:139], v[152:155], v[204:207]
v_mfma_f32_16x16x32_bf16 v[204:207], a[140:143], v[156:159], v[204:207]
v_mfma_f32_16x16x32_bf16 v[204:207], a[144:147], v[160:163], v[204:207]
v_mfma_f32_16x16x32_bf16 v[204:207], a[148:151], v[164:167], v[204:207]
s_nop 15
s_cmp_eq_u32 s33, 0
s_cbranch_scc1 L_back0
s_cmp_eq_u32 s33, 1
s_cbranch_scc1 L_back1
s_branch L_back2
L_text_end:
.section .rodata,"a"
.p2align 6
.amdhsa_kernel standalone__gqa_softmax__near_ridge_kernel
  .amdhsa_next_free_vgpr 512
  .amdhsa_next_free_sgpr 102
  .amdhsa_accum_offset 256
  .amdhsa_group_segment_fixed_size 0
  .amdhsa_kernarg_size 48
  .amdhsa_user_sgpr_count 2
  .amdhsa_user_sgpr_kernarg_segment_ptr 1
  .amdhsa_system_sgpr_workgroup_id_x 1
.end_amdhsa_kernel
```
